```python
import torch

def _softmax(x, axis=-1):
    return torch.softmax(x, dim=axis)
def _gelu(x):
    return torch.nn.functional.gelu(x, approximate="tanh")
def _silu(x):
    return torch.nn.functional.silu(x)
def _sigmoid(x):
    return torch.sigmoid(x)
def _layernorm(x, axis=-1, eps=1e-5):
    m = x.mean(dim=axis, keepdim=True)
    v = x.var(dim=axis, keepdim=True, unbiased=False)
    return (x - m) / torch.sqrt(v + eps)
def _scatter_add(tgt, idx, src, axis=0):
    return tgt.clone().index_add_(axis, idx, src)
def _segment_sum(src, seg, n):
    out = torch.zeros((n,) + src.shape[1:], dtype=src.dtype)
    return out.index_add_(0, seg, src)
def _pad(x, pw):
    flat = tuple(v for pair in reversed(pw) for v in pair)
    return torch.nn.functional.pad(x, flat)

kernel_name = 'gated_mix__compressed_kv_cla__geglu_ffn__prompt'

def setup_inputs():

    _w = (lambda a: (lambda t: t.to(torch.bfloat16) if t.is_floating_point() else t)(torch.as_tensor(a)))
    def _A_setup():
        B, H, Sq, Sk, D, M = 1, 32, 2048, 2048, 128, 1024
        Dc = 4 * D
        return {
            "x": _w((lambda *s: torch.randn(*s, dtype=torch.bfloat16) * 0.05)(B, Sq, M)),
            "c_kv": _w((lambda *s: torch.randn(*s, dtype=torch.bfloat16) * 0.4)(B, Sk, Dc)),
            "w_q": _w((lambda *s: torch.randn(*s, dtype=torch.bfloat16) * 6.4)(M, H, D) * (M ** -0.5)),
            "w_uk": _w((lambda *s: torch.randn(*s, dtype=torch.bfloat16) * 6.4)(Dc, H, D) * (Dc ** -0.5)),
            "w_uv": _w((lambda *s: torch.randn(*s, dtype=torch.bfloat16) * 0.4)(Dc, H, D) * (Dc ** -0.5)),
            "w_o": _w((lambda *s: torch.randn(*s, dtype=torch.bfloat16) * 0.4)(H, D, M) * ((H * D) ** -0.5)),
        }
    _A_in = _A_setup()

    def _B_setup():
        B, S, D, F = 1, 2048, 1024, 3584
        return {
            "x": _w((lambda *s: torch.randn(*s, dtype=torch.bfloat16) * 0.05)(B, S, D)),
            "w_gate": _w((lambda *s: torch.randn(*s, dtype=torch.bfloat16) * 0.05)(D, F)),
            "w_up": _w((lambda *s: torch.randn(*s, dtype=torch.bfloat16) * 0.05)(D, F)),
            "w_down": _w((lambda *s: torch.randn(*s, dtype=torch.bfloat16) * 0.05)(F, D)),
        }
    _B_in = _B_setup()

    return {
        "A_x": _A_in["x"],
        "A_c_kv": _A_in["c_kv"],
        "A_w_q": _A_in["w_q"],
        "A_w_uk": _A_in["w_uk"],
        "A_w_uv": _A_in["w_uv"],
        "A_w_o": _A_in["w_o"],
        "B_x": _B_in["x"],
        "B_w_gate": _B_in["w_gate"],
        "B_w_up": _B_in["w_up"],
        "B_w_down": _B_in["w_down"],
        "gate_w": _w((lambda *s: torch.randn(*s, dtype=torch.bfloat16) * 0.05)(1024) * 16.0),
    }

def reference(A_x, A_c_kv, A_w_q, A_w_uk, A_w_uv, A_w_o, B_x, B_w_gate, B_w_up, B_w_down, gate_w):
    def _A_ref(x, c_kv, w_q, w_uk, w_uv, w_o):
        B, Sq, M = x.shape[0], x.shape[1], x.shape[2]
        Sk = c_kv.shape[1]
        H, D = w_q.shape[1], w_q.shape[2]
        q = torch.einsum("bqm,mhd->bhqd", x, w_q)
        k = torch.einsum("bkc,chd->bhkd", c_kv, w_uk)
        v = torch.einsum("bkc,chd->bhkd", c_kv, w_uv)
        scores = torch.einsum("bhqd,bhkd->bhqk", q, k) * (D ** -0.5)
        off = Sk - Sq
        qi = torch.arange(Sq)[:, None]
        kj = torch.arange(Sk)[None, :]
        cmask = kj <= (qi + off)
        scores = torch.where(cmask[None, None], scores, -1e9)
        p = _softmax(scores, axis=-1)
        ctx = torch.einsum("bhqk,bhkd->bhqd", p, v)
        return torch.einsum("bhqd,hdm->bqm", ctx, w_o)

    def _B_ref(x, w_gate, w_up, w_down):
        return (_gelu(x @ w_gate) * (x @ w_up)) @ w_down

    x = A_x
    g = _sigmoid((x * gate_w).sum(-1, keepdims=True))
    a = _A_ref(x, A_c_kv, A_w_q, A_w_uk, A_w_uv, A_w_o)
    b = _B_ref(x, B_w_gate, B_w_up, B_w_down)
    return g * a + (1 - g) * b
```

```asm
; @launch grid=(256,1,1) block=(256,1,1) lds=139264
.amdgcn_target "amdgcn-amd-amdhsa--gfx950"
.text
.globl gated_mix__compressed_kv_cla__geglu_ffn__prompt_kernel
.p2align 8
.type gated_mix__compressed_kv_cla__geglu_ffn__prompt_kernel,@function
gated_mix__compressed_kv_cla__geglu_ffn__prompt_kernel:
    s_cmp_ge_u32 s2, 256
    s_cbranch_scc1 gated_mix__compressed_kv_cla__geglu_ffn__prompt_kernel_end
    s_load_dwordx16 s[8:23], s[0:1], 0
    s_load_dwordx8 s[24:31], s[0:1], 64
    s_load_dwordx4 s[32:35], s[0:1], 96
    v_and_b32 v250, 63, v0
    v_lshrrev_b32 v4, 6, v0
    s_nop 0
    v_readfirstlane_b32 s101, v4
    s_nop 3
    s_lshr_b32 s65, s101, 1
    s_and_b32 s66, s101, 1
    s_and_b32 s3, s2, 7
    s_lshr_b32 s4, s2, 3
    s_lshr_b32 s5, s4, 3
    s_and_b32 s6, s4, 7
    s_lshl_b32 s7, s3, 1
    s_and_b32 s67, s5, 1
    s_add_u32 s7, s7, s67
    s_lshl_b32 s7, s7, 3
    s_add_u32 s7, s7, s6
    s_add_u32 s7, s7, 0x400
    s_mul_i32 s69, s3, 28
    s_add_u32 s69, s69, s4
    s_add_u32 s69, s69, 0x700
    s_cmp_lt_u32 s4, 28
    s_cselect_b32 s69, s69, 0
    s_add_u32 s3, s7, 0x100
    s_add_u32 s4, s7, 0x200
    s_cmp_lt_u32 s5, 2
    s_cselect_b32 s67, s7, s3
    s_cselect_b32 s68, s69, s4
    s_cselect_b32 s69, 0, s69
    s_brev_b32 s70, 1
    s_waitcnt lgkmcnt(0)
    s_bfe_u32 s5, s67, 0x20008
    s_bfe_u32 s6, s67, 0x50003
    s_sub_u32 s7, s5, 1
    s_cmp_lt_u32 s7, 2
    s_cselect_b32 s36, s10, s8
    s_cselect_b32 s37, s11, s9
    s_mov_b32 s7, 2097152
    s_cselect_b32 s38, s7, 4194304
    s_mov_b32 s39, 0x20000
    s_mov_b32 s7, 1024
    s_cselect_b32 s26, s7, 2048
    s_cmp_eq_u32 s5, 3
    s_cbranch_scc1 g1_db2_gu
    s_mov_b32 s40, s12
    s_mov_b32 s41, s13
    s_mov_b32 s42, 8388608
    s_cmp_eq_u32 s5, 1
    s_cselect_b32 s40, s14, s40
    s_cselect_b32 s41, s15, s41
    s_cselect_b32 s42, 4194304, s42
    s_cmp_eq_u32 s5, 2
    s_cselect_b32 s40, s16, s40
    s_cselect_b32 s41, s17, s41
    s_cselect_b32 s42, 4194304, s42
    s_mov_b32 s30, 8192
    s_lshl_b32 s27, s6, 9
    s_lshl_b32 s3, s101, 7
    s_add_u32 s27, s27, s3
    s_branch g1_db2_src
g1_db2_gu:
    s_cmp_eq_u32 s66, 0
    s_cselect_b32 s40, s22, s24
    s_cselect_b32 s41, s23, s25
    s_mov_b32 s42, 7340032
    s_mov_b32 s30, 7168
    s_lshl_b32 s27, s6, 8
    s_lshl_b32 s3, s65, 7
    s_add_u32 s27, s27, s3
g1_db2_src:
    s_mov_b32 s43, 0x20000
    s_and_b32 s3, s67, 7
    s_lshl_b32 s3, s3, 8
    s_mul_i32 s21, s3, s26
    v_lshrrev_b32 v4, 3, v250
    s_mul_i32 s3, s101, 64
    v_add_u32 v4, s3, v4
    v_mul_lo_u32 v4, v4, s26
    v_add_u32 v4, s21, v4
    v_and_b32 v5, 7, v250
    v_lshrrev_b32 v6, 4, v250
    v_xor_b32 v5, v5, v6
    v_lshl_add_u32 v246, v5, 4, v4
    v_xor_b32 v5, 4, v5
    v_lshl_add_u32 v247, v5, 4, v4
    s_mul_i32 s44, s26, 0
    s_mul_i32 s45, s26, 8
    s_sub_u32 s45, s45, 1024
    s_mul_i32 s46, s26, 16
    s_sub_u32 s46, s46, 2048
    s_mul_i32 s47, s26, 24
    s_sub_u32 s47, s47, 3072
    s_mul_i32 s48, s26, 32
    s_mul_i32 s49, s26, 40
    s_sub_u32 s49, s49, 1024
    s_mul_i32 s50, s26, 48
    s_sub_u32 s50, s50, 2048
    s_mul_i32 s51, s26, 56
    s_sub_u32 s51, s51, 3072
    s_mov_b32 s62, 128
    v_lshrrev_b32 v4, 3, v250
    v_mul_lo_u32 v4, v4, s30
    v_add_u32 v4, s27, v4
    v_and_b32 v5, 7, v250
    v_bfe_u32 v6, v250, 4, 1
    v_lshlrev_b32 v6, 1, v6
    v_xor_b32 v5, v5, v6
    v_lshl_add_u32 v248, v5, 4, v4
    v_xor_b32 v5, 4, v5
    v_lshl_add_u32 v249, v5, 4, v4
    s_mul_i32 s52, s30, 0
    s_mul_i32 s53, s30, 8
    s_sub_u32 s53, s53, 1024
    s_mul_i32 s54, s30, 16
    s_sub_u32 s54, s54, 2048
    s_mul_i32 s55, s30, 24
    s_sub_u32 s55, s55, 3072
    s_mul_i32 s56, s30, 32
    s_mul_i32 s57, s30, 40
    s_sub_u32 s57, s57, 1024
    s_mul_i32 s58, s30, 48
    s_sub_u32 s58, s58, 2048
    s_mul_i32 s59, s30, 56
    s_sub_u32 s59, s59, 3072
    s_lshl_b32 s63, s30, 6
g1_sp1_done:
    v_and_b32 v4, 15, v250
    v_lshrrev_b32 v5, 4, v250
    v_lshrrev_b32 v6, 1, v4
    v_and_b32 v6, 7, v6
    v_lshlrev_b32 v4, 7, v4
    s_mul_i32 s3, s65, 16384
    v_add_u32 v4, s3, v4
    v_add_u32 v7, 0, v5
    v_xor_b32 v7, v7, v6
    v_lshl_add_u32 v240, v7, 4, v4
    v_add_u32 v7, 4, v5
    v_xor_b32 v7, v7, v6
    v_lshl_add_u32 v241, v7, 4, v4
    v_lshrrev_b32 v4, 4, v250
    v_lshlrev_b32 v4, 3, v4
    v_bfe_u32 v5, v250, 2, 2
    v_add_u32 v4, v4, v5
    v_bfe_u32 v5, v4, 1, 1
    v_lshlrev_b32 v5, 5, v5
    v_bfe_u32 v6, v4, 3, 1
    v_lshl_add_u32 v5, v6, 6, v5
    v_lshlrev_b32 v4, 7, v4
    v_and_b32 v6, 3, v250
    v_lshl_add_u32 v4, v6, 3, v4
    s_mul_i32 s3, s66, 256
    s_lshr_b32 s4, s3, 7
    s_lshl_b32 s4, s4, 13
    s_add_u32 s4, s4, 65536
    s_and_b32 s3, s3, 127
    v_add_u32 v4, s4, v4
    v_xor_b32 v5, s3, v5
    v_xor_b32 v6, 0, v5
    v_add_u32 v242, v4, v6
    v_xor_b32 v6, 32, v5
    v_add_u32 v243, v4, v6
    v_xor_b32 v6, 64, v5
    v_add_u32 v244, v4, v6
    v_xor_b32 v6, 96, v5
    v_add_u32 v245, v4, v6
    s_mul_i32 s60, s101, 8192
    s_add_u32 s60, s60, 0
    s_mul_i32 s61, s101, 8192
    s_add_u32 s61, s61, 65536
    s_add_u32 m0, s60, 0
    s_nop 0
    buffer_load_dwordx4 v246, s[36:39], s44 offen offset:0 lds
    buffer_load_dwordx4 v247, s[36:39], s45 offen offset:1024 lds
    buffer_load_dwordx4 v246, s[36:39], s46 offen offset:2048 lds
    buffer_load_dwordx4 v247, s[36:39], s47 offen offset:3072 lds
    s_add_u32 m0, s60, 4096
    s_nop 0
    buffer_load_dwordx4 v246, s[36:39], s48 offen offset:0 lds
    buffer_load_dwordx4 v247, s[36:39], s49 offen offset:1024 lds
    buffer_load_dwordx4 v246, s[36:39], s50 offen offset:2048 lds
    buffer_load_dwordx4 v247, s[36:39], s51 offen offset:3072 lds
    v_add_u32 v246, s62, v246
    v_add_u32 v247, s62, v247
    s_add_u32 m0, s61, 0
    s_nop 0
    buffer_load_dwordx4 v248, s[40:43], s52 offen offset:0 lds
    buffer_load_dwordx4 v249, s[40:43], s53 offen offset:1024 lds
    buffer_load_dwordx4 v248, s[40:43], s54 offen offset:2048 lds
    buffer_load_dwordx4 v249, s[40:43], s55 offen offset:3072 lds
    s_add_u32 m0, s61, 4096
    s_nop 0
    buffer_load_dwordx4 v248, s[40:43], s56 offen offset:0 lds
    buffer_load_dwordx4 v249, s[40:43], s57 offen offset:1024 lds
    buffer_load_dwordx4 v248, s[40:43], s58 offen offset:2048 lds
    buffer_load_dwordx4 v249, s[40:43], s59 offen offset:3072 lds
    v_add_u32 v248, s63, v248
    v_add_u32 v249, s63, v249
    s_add_u32 m0, s60, 32768
    s_nop 0
    buffer_load_dwordx4 v246, s[36:39], s44 offen offset:0 lds
    buffer_load_dwordx4 v247, s[36:39], s45 offen offset:1024 lds
    buffer_load_dwordx4 v246, s[36:39], s46 offen offset:2048 lds
    buffer_load_dwordx4 v247, s[36:39], s47 offen offset:3072 lds
    s_add_u32 m0, s60, 36864
    s_nop 0
    buffer_load_dwordx4 v246, s[36:39], s48 offen offset:0 lds
    buffer_load_dwordx4 v247, s[36:39], s49 offen offset:1024 lds
    buffer_load_dwordx4 v246, s[36:39], s50 offen offset:2048 lds
    buffer_load_dwordx4 v247, s[36:39], s51 offen offset:3072 lds
    v_add_u32 v246, s62, v246
    v_add_u32 v247, s62, v247
    s_add_u32 m0, s61, 32768
    s_nop 0
    buffer_load_dwordx4 v248, s[40:43], s52 offen offset:0 lds
    buffer_load_dwordx4 v249, s[40:43], s53 offen offset:1024 lds
    buffer_load_dwordx4 v248, s[40:43], s54 offen offset:2048 lds
    buffer_load_dwordx4 v249, s[40:43], s55 offen offset:3072 lds
    s_add_u32 m0, s61, 36864
    s_nop 0
    buffer_load_dwordx4 v248, s[40:43], s56 offen offset:0 lds
    buffer_load_dwordx4 v249, s[40:43], s57 offen offset:1024 lds
    buffer_load_dwordx4 v248, s[40:43], s58 offen offset:2048 lds
    buffer_load_dwordx4 v249, s[40:43], s59 offen offset:3072 lds
    v_add_u32 v248, s63, v248
    v_add_u32 v249, s63, v249
    v_mov_b32 v252, 0xc0135761
    v_mov_b32 v253, 0xc0135761
    s_add_u32 s80, s34, 84934656
    s_addc_u32 s81, s35, 0
    s_mov_b32 s82, 16384
    s_mov_b32 s83, 0x20000
    s_bfe_u32 s5, s67, 0x20008
    s_bfe_u32 s6, s67, 0x50003
    s_cmp_eq_u32 s5, 3
    s_cbranch_scc1 g1_db3_gu
    s_mov_b32 s76, s12
    s_mov_b32 s77, s13
    s_mov_b32 s78, 8388608
    s_cmp_eq_u32 s5, 1
    s_cselect_b32 s76, s14, s76
    s_cselect_b32 s77, s15, s77
    s_cselect_b32 s78, 4194304, s78
    s_cmp_eq_u32 s5, 2
    s_cselect_b32 s76, s16, s76
    s_cselect_b32 s77, s17, s77
    s_cselect_b32 s78, 4194304, s78
    s_mov_b32 s30, 8192
    s_lshl_b32 s27, s6, 9
    s_lshl_b32 s3, s101, 7
    s_add_u32 s27, s27, s3
    s_branch g1_db3_src
g1_db3_gu:
    s_cmp_eq_u32 s66, 0
    s_cselect_b32 s76, s22, s24
    s_cselect_b32 s77, s23, s25
    s_mov_b32 s78, 7340032
    s_mov_b32 s30, 7168
    s_lshl_b32 s27, s6, 8
    s_lshl_b32 s3, s65, 7
    s_add_u32 s27, s27, s3
g1_db3_src:
    s_mov_b32 s79, 0x20000
    s_cmp_eq_u32 s67, 0
    s_cselect_b32 s78, 0, s78
    v_lshrrev_b32 v254, 3, v250
    v_lshlrev_b32 v254, 6, v254
    v_and_b32 v7, 7, v250
    s_and_b32 s3, s67, 7
    s_lshl_b32 s3, s3, 3
    v_add3_u32 v254, v254, v7, s3
    v_mul_lo_u32 v254, v254, s30
    v_add_u32 v254, s27, v254
    v_bfrev_b32 v7, 1
    v_cmp_gt_u32 vcc, 16, v250
    s_lshl_b32 s20, s30, 7
    s_nop 0
    v_cndmask_b32 v254, v7, v254, vcc
    v_add_u32 v254, s20, v254
    buffer_load_dword v255, v254, s[76:79], 0 offen
    v_add_u32 v254, s20, v254
    s_mov_b32 s84, s32
    s_mov_b32 s85, s33
    s_mov_b32 s86, 32
    s_mov_b32 s87, 0x20000
    s_mov_b32 s88, 0
    s_brev_b32 s90, 1
    s_brev_b32 s89, 1
    s_lshl_b32 s3, s101, 8
    s_add_u32 s3, s3, s2
    s_cmp_lt_u32 s3, 32
    s_cselect_b32 s89, s2, s89
    s_lshl_b32 s3, s2, 2
    s_add_u32 s3, s3, s101
    s_lshl_b32 s3, s3, 7
    v_lshlrev_b32 v251, 2, v250
    v_mov_b32 v5, 0
    s_mov_b32 exec_hi, 0
    buffer_store_dword v5, v251, s[80:83], s3 offen sc1
    s_mov_b64 exec, -1
    s_and_b32 s3, s2, 7
    s_lshl_b32 s3, s3, 2
    s_lshr_b32 s4, s2, 6
    s_add_u32 s3, s3, s4
    s_lshl_b32 s3, s3, 2
    s_add_u32 s3, s3, s101
    s_lshl_b32 s3, s3, 1
    s_bfe_u32 s4, s2, 0x30003
    s_lshl_b32 s4, s4, 8
    s_add_u32 s3, s3, s4
    v_lshlrev_b32 v4, 7, v250
    s_lshl_b32 s4, s3, 11
    s_add_u32 s72, s8, s4
    s_addc_u32 s73, s9, 0
    s_mov_b32 s74, 4096
    s_mov_b32 s75, 0x20000
    buffer_load_dword v255, v4, s[72:75], 0 offen
    s_lshl_b32 s4, s3, 10
    s_add_u32 s72, s10, s4
    s_addc_u32 s73, s11, 0
    s_mov_b32 s74, 2048
    buffer_load_dword v255, v4, s[72:75], 0 offen
    buffer_load_dword v255, v254, s[76:79], 0 offen
    v_add_u32 v254, s20, v254
    s_bfe_u32 s31, s2, 0x20003
    s_lshl_b32 s31, s31, 2
    s_add_u32 s31, s31, s101
    s_getpc_b64 s[4:5]
cpf_mg:
    s_add_u32 s4, s4, gated_mix__compressed_kv_cla__geglu_ffn__prompt_kernel-cpf_mg
    s_addc_u32 s5, s5, -1
    s_mov_b32 s6, mega_code_end-gated_mix__compressed_kv_cla__geglu_ffn__prompt_kernel
    s_mov_b32 s7, 0x20000
    s_lshl_b32 s3, s31, 13
    v_lshlrev_b32 v4, 7, v250
    buffer_load_dword v255, v4, s[4:7], s3 offen
    s_waitcnt vmcnt(14)
    s_barrier
    ds_read_b128 a[0:3], v240 offset:0
    ds_read_b128 a[4:7], v241 offset:0
    ds_read_b128 a[8:11], v240 offset:2048
    ds_read_b128 a[12:15], v241 offset:2048
    ds_read_b128 a[16:19], v240 offset:4096
    ds_read_b128 a[20:23], v241 offset:4096
    ds_read_b128 a[24:27], v240 offset:6144
    ds_read_b128 a[28:31], v241 offset:6144
    ds_read_b128 a[32:35], v240 offset:8192
    ds_read_b128 a[36:39], v241 offset:8192
    ds_read_b128 a[40:43], v240 offset:10240
    ds_read_b128 a[44:47], v241 offset:10240
    ds_read_b128 a[48:51], v240 offset:12288
    ds_read_b128 a[52:55], v241 offset:12288
    ds_read_b128 a[56:59], v240 offset:14336
    ds_read_b128 a[60:63], v241 offset:14336
    ds_read_b64_tr_b16 a[128:129], v242 offset:0
    ds_read_b64_tr_b16 a[130:131], v242 offset:512
    ds_read_b64_tr_b16 a[132:133], v242 offset:4096
    ds_read_b64_tr_b16 a[134:135], v242 offset:4608
    ds_read_b64_tr_b16 a[136:137], v243 offset:0
    ds_read_b64_tr_b16 a[138:139], v243 offset:512
    ds_read_b64_tr_b16 a[140:141], v243 offset:4096
    ds_read_b64_tr_b16 a[142:143], v243 offset:4608
    s_waitcnt lgkmcnt(0)
    s_barrier
g1_tile:
    v_lshlrev_b32 v251, 2, v250
    s_bfe_u32 s5, s67, 0x20008
    s_sub_u32 s7, s5, 1
    s_cmp_lt_u32 s7, 2
    s_cselect_b32 s64, 3, 7
    s_cmp_eq_u32 s5, 2
    s_cbranch_scc1 g1_S_first
g1_N_first:
    s_waitcnt lgkmcnt(4)
    v_mfma_f32_16x16x32_bf16 v[16:19], a[128:131], a[0:3], 0
    s_add_u32 m0, s60, 0
    ds_read_b64_tr_b16 a[144:145], v244 offset:0
    v_mfma_f32_16x16x32_bf16 v[16:19], a[132:135], a[4:7], v[16:19]
    buffer_load_dwordx4 v246, s[36:39], s44 offen offset:0 lds
    v_mfma_f32_16x16x32_bf16 v[20:23], a[128:131], a[8:11], 0
    ds_read_b64_tr_b16 a[146:147], v244 offset:512
    v_mfma_f32_16x16x32_bf16 v[20:23], a[132:135], a[12:15], v[20:23]
    v_mfma_f32_16x16x32_bf16 v[24:27], a[128:131], a[16:19], 0
    ds_read_b64_tr_b16 a[148:149], v244 offset:4096
    v_mfma_f32_16x16x32_bf16 v[24:27], a[132:135], a[20:23], v[24:27]
    v_mfma_f32_16x16x32_bf16 v[28:31], a[128:131], a[24:27], 0
    ds_read_b64_tr_b16 a[150:151], v244 offset:4608
    buffer_load_dwordx4 v247, s[36:39], s45 offen offset:1024 lds
    v_mfma_f32_16x16x32_bf16 v[28:31], a[132:135], a[28:31], v[28:31]
    v_mfma_f32_16x16x32_bf16 v[32:35], a[128:131], a[32:35], 0
    ds_read_b128 a[64:67], v240 offset:32768
    v_mfma_f32_16x16x32_bf16 v[32:35], a[132:135], a[36:39], v[32:35]
    v_mfma_f32_16x16x32_bf16 v[36:39], a[128:131], a[40:43], 0
    ds_read_b128 a[68:71], v241 offset:32768
    v_mfma_f32_16x16x32_bf16 v[36:39], a[132:135], a[44:47], v[36:39]
    buffer_load_dwordx4 v246, s[36:39], s46 offen offset:2048 lds
    v_mfma_f32_16x16x32_bf16 v[40:43], a[128:131], a[48:51], 0
    v_mfma_f32_16x16x32_bf16 v[40:43], a[132:135], a[52:55], v[40:43]
    v_mfma_f32_16x16x32_bf16 v[44:47], a[128:131], a[56:59], 0
    v_mfma_f32_16x16x32_bf16 v[44:47], a[132:135], a[60:63], v[44:47]
    s_waitcnt lgkmcnt(6)
    v_mfma_f32_16x16x32_bf16 v[48:51], a[136:139], a[0:3], 0
    ds_read_b64_tr_b16 a[152:153], v245 offset:0
    buffer_load_dwordx4 v247, s[36:39], s47 offen offset:3072 lds
    v_mfma_f32_16x16x32_bf16 v[48:51], a[140:143], a[4:7], v[48:51]
    s_add_u32 m0, s60, 4096
    v_mfma_f32_16x16x32_bf16 v[52:55], a[136:139], a[8:11], 0
    ds_read_b64_tr_b16 a[154:155], v245 offset:512
    v_mfma_f32_16x16x32_bf16 v[52:55], a[140:143], a[12:15], v[52:55]
    v_mfma_f32_16x16x32_bf16 v[56:59], a[136:139], a[16:19], 0
    ds_read_b64_tr_b16 a[156:157], v245 offset:4096
    v_mfma_f32_16x16x32_bf16 v[56:59], a[140:143], a[20:23], v[56:59]
    buffer_load_dwordx4 v246, s[36:39], s48 offen offset:0 lds
    v_mfma_f32_16x16x32_bf16 v[60:63], a[136:139], a[24:27], 0
    ds_read_b64_tr_b16 a[158:159], v245 offset:4608
    v_mfma_f32_16x16x32_bf16 v[60:63], a[140:143], a[28:31], v[60:63]
    v_mfma_f32_16x16x32_bf16 v[64:67], a[136:139], a[32:35], 0
    ds_read_b128 a[72:75], v240 offset:34816
    v_mfma_f32_16x16x32_bf16 v[64:67], a[140:143], a[36:39], v[64:67]
    v_mfma_f32_16x16x32_bf16 v[68:71], a[136:139], a[40:43], 0
    ds_read_b128 a[76:79], v241 offset:34816
    buffer_load_dwordx4 v247, s[36:39], s49 offen offset:1024 lds
    v_mfma_f32_16x16x32_bf16 v[68:71], a[140:143], a[44:47], v[68:71]
    v_mfma_f32_16x16x32_bf16 v[72:75], a[136:139], a[48:51], 0
    ds_read_b128 a[80:83], v240 offset:36864
    v_mfma_f32_16x16x32_bf16 v[72:75], a[140:143], a[52:55], v[72:75]
    v_mfma_f32_16x16x32_bf16 v[76:79], a[136:139], a[56:59], 0
    v_mfma_f32_16x16x32_bf16 v[76:79], a[140:143], a[60:63], v[76:79]
    s_waitcnt lgkmcnt(9)
    buffer_load_dwordx4 v246, s[36:39], s50 offen offset:2048 lds
    v_mfma_f32_16x16x32_bf16 v[80:83], a[144:147], a[0:3], 0
    ds_read_b64_tr_b16 a[128:129], v242 offset:8192
    v_mfma_f32_16x16x32_bf16 v[80:83], a[148:151], a[4:7], v[80:83]
    v_mfma_f32_16x16x32_bf16 v[84:87], a[144:147], a[8:11], 0
    ds_read_b64_tr_b16 a[130:131], v242 offset:8704
    v_mfma_f32_16x16x32_bf16 v[84:87], a[148:151], a[12:15], v[84:87]
    v_mfma_f32_16x16x32_bf16 v[88:91], a[144:147], a[16:19], 0
    ds_read_b64_tr_b16 a[132:133], v242 offset:12288
    buffer_load_dwordx4 v247, s[36:39], s51 offen offset:3072 lds
    v_mfma_f32_16x16x32_bf16 v[88:91], a[148:151], a[20:23], v[88:91]
    v_add_u32 v246, s62, v246
    v_add_u32 v247, s62, v247
    v_mfma_f32_16x16x32_bf16 v[92:95], a[144:147], a[24:27], 0
    ds_read_b64_tr_b16 a[134:135], v242 offset:12800
    v_mfma_f32_16x16x32_bf16 v[92:95], a[148:151], a[28:31], v[92:95]
    v_mfma_f32_16x16x32_bf16 v[96:99], a[144:147], a[32:35], 0
    ds_read_b128 a[84:87], v241 offset:36864
    v_mfma_f32_16x16x32_bf16 v[96:99], a[148:151], a[36:39], v[96:99]
    buffer_load_dword v255, v254, s[76:79], 0 offen
    v_add_u32 v254, s20, v254
    v_mfma_f32_16x16x32_bf16 v[100:103], a[144:147], a[40:43], 0
    ds_read_b128 a[88:91], v240 offset:38912
    v_mfma_f32_16x16x32_bf16 v[100:103], a[148:151], a[44:47], v[100:103]
    v_mfma_f32_16x16x32_bf16 v[104:107], a[144:147], a[48:51], 0
    ds_read_b128 a[92:95], v241 offset:38912
    v_mfma_f32_16x16x32_bf16 v[104:107], a[148:151], a[52:55], v[104:107]
    v_mfma_f32_16x16x32_bf16 v[108:111], a[144:147], a[56:59], 0
    buffer_load_dword a240, v251, s[84:87], s90 offen sc1
    v_mfma_f32_16x16x32_bf16 v[108:111], a[148:151], a[60:63], v[108:111]
    s_waitcnt lgkmcnt(10)
    v_mfma_f32_16x16x32_bf16 v[112:115], a[152:155], a[0:3], 0
    ds_read_b64_tr_b16 a[136:137], v243 offset:8192
    v_mfma_f32_16x16x32_bf16 v[112:115], a[156:159], a[4:7], v[112:115]
    v_mfma_f32_16x16x32_bf16 v[116:119], a[152:155], a[8:11], 0
    ds_read_b64_tr_b16 a[138:139], v243 offset:8704
    v_mfma_f32_16x16x32_bf16 v[116:119], a[156:159], a[12:15], v[116:119]
    v_mfma_f32_16x16x32_bf16 v[120:123], a[152:155], a[16:19], 0
    ds_read_b64_tr_b16 a[140:141], v243 offset:12288
    v_mfma_f32_16x16x32_bf16 v[120:123], a[156:159], a[20:23], v[120:123]
    v_mfma_f32_16x16x32_bf16 v[124:127], a[152:155], a[24:27], 0
    ds_read_b64_tr_b16 a[142:143], v243 offset:12800
    v_mfma_f32_16x16x32_bf16 v[124:127], a[156:159], a[28:31], v[124:127]
    v_mfma_f32_16x16x32_bf16 v[128:131], a[152:155], a[32:35], 0
    ds_read_b128 a[96:99], v240 offset:40960
    v_mfma_f32_16x16x32_bf16 v[128:131], a[156:159], a[36:39], v[128:131]
    v_mfma_f32_16x16x32_bf16 v[132:135], a[152:155], a[40:43], 0
    ds_read_b128 a[100:103], v241 offset:40960
    v_mfma_f32_16x16x32_bf16 v[132:135], a[156:159], a[44:47], v[132:135]
    v_mfma_f32_16x16x32_bf16 v[136:139], a[152:155], a[48:51], 0
    v_mfma_f32_16x16x32_bf16 v[136:139], a[156:159], a[52:55], v[136:139]
    v_mfma_f32_16x16x32_bf16 v[140:143], a[152:155], a[56:59], 0
    v_mfma_f32_16x16x32_bf16 v[140:143], a[156:159], a[60:63], v[140:143]
    s_waitcnt lgkmcnt(9)
    v_mfma_f32_16x16x32_bf16 v[144:147], a[128:131], a[0:3], 0
    ds_read_b64_tr_b16 a[144:145], v244 offset:8192
    v_mfma_f32_16x16x32_bf16 v[144:147], a[132:135], a[4:7], v[144:147]
    v_mfma_f32_16x16x32_bf16 v[148:151], a[128:131], a[8:11], 0
    ds_read_b64_tr_b16 a[146:147], v244 offset:8704
    v_mfma_f32_16x16x32_bf16 v[148:151], a[132:135], a[12:15], v[148:151]
    v_mfma_f32_16x16x32_bf16 v[152:155], a[128:131], a[16:19], 0
    ds_read_b64_tr_b16 a[148:149], v244 offset:12288
    v_mfma_f32_16x16x32_bf16 v[152:155], a[132:135], a[20:23], v[152:155]
    v_mfma_f32_16x16x32_bf16 v[156:159], a[128:131], a[24:27], 0
    ds_read_b64_tr_b16 a[150:151], v244 offset:12800
    v_mfma_f32_16x16x32_bf16 v[156:159], a[132:135], a[28:31], v[156:159]
    v_mfma_f32_16x16x32_bf16 v[160:163], a[128:131], a[32:35], 0
    ds_read_b128 a[104:107], v240 offset:43008
    v_mfma_f32_16x16x32_bf16 v[160:163], a[132:135], a[36:39], v[160:163]
    v_mfma_f32_16x16x32_bf16 v[164:167], a[128:131], a[40:43], 0
    ds_read_b128 a[108:111], v241 offset:43008
    v_mfma_f32_16x16x32_bf16 v[164:167], a[132:135], a[44:47], v[164:167]
    v_mfma_f32_16x16x32_bf16 v[168:171], a[128:131], a[48:51], 0
    ds_read_b128 a[112:115], v240 offset:45056
    v_mfma_f32_16x16x32_bf16 v[168:171], a[132:135], a[52:55], v[168:171]
    v_mfma_f32_16x16x32_bf16 v[172:175], a[128:131], a[56:59], 0
    v_mfma_f32_16x16x32_bf16 v[172:175], a[132:135], a[60:63], v[172:175]
    s_waitcnt lgkmcnt(9)
    v_mfma_f32_16x16x32_bf16 v[176:179], a[136:139], a[0:3], 0
    ds_read_b64_tr_b16 a[152:153], v245 offset:8192
    v_mfma_f32_16x16x32_bf16 v[176:179], a[140:143], a[4:7], v[176:179]
    v_mfma_f32_16x16x32_bf16 v[180:183], a[136:139], a[8:11], 0
    ds_read_b64_tr_b16 a[154:155], v245 offset:8704
    v_mfma_f32_16x16x32_bf16 v[180:183], a[140:143], a[12:15], v[180:183]
    v_mfma_f32_16x16x32_bf16 v[184:187], a[136:139], a[16:19], 0
    ds_read_b64_tr_b16 a[156:157], v245 offset:12288
    v_mfma_f32_16x16x32_bf16 v[184:187], a[140:143], a[20:23], v[184:187]
    v_mfma_f32_16x16x32_bf16 v[188:191], a[136:139], a[24:27], 0
    ds_read_b64_tr_b16 a[158:159], v245 offset:12800
    v_mfma_f32_16x16x32_bf16 v[188:191], a[140:143], a[28:31], v[188:191]
    v_mfma_f32_16x16x32_bf16 v[192:195], a[136:139], a[32:35], 0
    ds_read_b128 a[116:119], v241 offset:45056
    v_mfma_f32_16x16x32_bf16 v[192:195], a[140:143], a[36:39], v[192:195]
    v_mfma_f32_16x16x32_bf16 v[196:199], a[136:139], a[40:43], 0
    ds_read_b128 a[120:123], v240 offset:47104
    v_mfma_f32_16x16x32_bf16 v[196:199], a[140:143], a[44:47], v[196:199]
    v_mfma_f32_16x16x32_bf16 v[200:203], a[136:139], a[48:51], 0
    ds_read_b128 a[124:127], v241 offset:47104
    v_mfma_f32_16x16x32_bf16 v[200:203], a[140:143], a[52:55], v[200:203]
    v_mfma_f32_16x16x32_bf16 v[204:207], a[136:139], a[56:59], 0
    v_mfma_f32_16x16x32_bf16 v[204:207], a[140:143], a[60:63], v[204:207]
    s_waitcnt vmcnt(2) lgkmcnt(0)
    s_barrier
    s_mov_b64 exec, 1
    buffer_store_dword v252, v250, s[80:83], s70 offen sc1
    buffer_store_byte v252, v250, s[84:87], s89 offen sc1
    s_mov_b64 exec, -1
    s_brev_b32 s89, 1
    v_mfma_f32_16x16x32_bf16 v[208:211], a[144:147], a[0:3], 0
    s_add_u32 m0, s61, 0
    ds_read_b64_tr_b16 a[128:129], v242 offset:32768
    v_mfma_f32_16x16x32_bf16 v[208:211], a[148:151], a[4:7], v[208:211]
    buffer_load_dwordx4 v248, s[40:43], s52 offen offset:0 lds
    v_mfma_f32_16x16x32_bf16 v[212:215], a[144:147], a[8:11], 0
    v_mfma_f32_16x16x32_bf16 v[212:215], a[148:151], a[12:15], v[212:215]
    ds_read_b64_tr_b16 a[130:131], v242 offset:33280
    v_mfma_f32_16x16x32_bf16 v[216:219], a[144:147], a[16:19], 0
    v_mfma_f32_16x16x32_bf16 v[216:219], a[148:151], a[20:23], v[216:219]
    buffer_load_dwordx4 v249, s[40:43], s53 offen offset:1024 lds
    v_mfma_f32_16x16x32_bf16 v[220:223], a[144:147], a[24:27], 0
    ds_read_b64_tr_b16 a[132:133], v242 offset:36864
    v_mfma_f32_16x16x32_bf16 v[220:223], a[148:151], a[28:31], v[220:223]
    v_mfma_f32_16x16x32_bf16 v[224:227], a[144:147], a[32:35], 0
    v_mfma_f32_16x16x32_bf16 v[224:227], a[148:151], a[36:39], v[224:227]
    ds_read_b64_tr_b16 a[134:135], v242 offset:37376
    buffer_load_dwordx4 v248, s[40:43], s54 offen offset:2048 lds
    v_mfma_f32_16x16x32_bf16 v[228:231], a[144:147], a[40:43], 0
    v_mfma_f32_16x16x32_bf16 v[228:231], a[148:151], a[44:47], v[228:231]
    v_mfma_f32_16x16x32_bf16 v[232:235], a[144:147], a[48:51], 0
    v_mfma_f32_16x16x32_bf16 v[232:235], a[148:151], a[52:55], v[232:235]
    buffer_load_dwordx4 v249, s[40:43], s55 offen offset:3072 lds
    v_mfma_f32_16x16x32_bf16 v[236:239], a[144:147], a[56:59], 0
    s_add_u32 m0, s61, 4096
    v_mfma_f32_16x16x32_bf16 v[236:239], a[148:151], a[60:63], v[236:239]
    v_mfma_f32_16x16x32_bf16 a[208:211], a[152:155], a[0:3], 0
    ds_read_b64_tr_b16 a[136:137], v243 offset:32768
    v_mfma_f32_16x16x32_bf16 a[208:211], a[156:159], a[4:7], a[208:211]
    buffer_load_dwordx4 v248, s[40:43], s56 offen offset:0 lds
    v_mfma_f32_16x16x32_bf16 a[212:215], a[152:155], a[8:11], 0
    v_mfma_f32_16x16x32_bf16 a[212:215], a[156:159], a[12:15], a[212:215]
    ds_read_b64_tr_b16 a[138:139], v243 offset:33280
    v_mfma_f32_16x16x32_bf16 a[216:219], a[152:155], a[16:19], 0
    v_mfma_f32_16x16x32_bf16 a[216:219], a[156:159], a[20:23], a[216:219]
    buffer_load_dwordx4 v249, s[40:43], s57 offen offset:1024 lds
    v_mfma_f32_16x16x32_bf16 a[220:223], a[152:155], a[24:27], 0
    ds_read_b64_tr_b16 a[140:141], v243 offset:36864
    v_mfma_f32_16x16x32_bf16 a[220:223], a[156:159], a[28:31], a[220:223]
    v_mfma_f32_16x16x32_bf16 a[224:227], a[152:155], a[32:35], 0
    v_mfma_f32_16x16x32_bf16 a[224:227], a[156:159], a[36:39], a[224:227]
    ds_read_b64_tr_b16 a[142:143], v243 offset:37376
    buffer_load_dwordx4 v248, s[40:43], s58 offen offset:2048 lds
    v_mfma_f32_16x16x32_bf16 a[228:231], a[152:155], a[40:43], 0
    v_mfma_f32_16x16x32_bf16 a[228:231], a[156:159], a[44:47], a[228:231]
    v_mfma_f32_16x16x32_bf16 a[232:235], a[152:155], a[48:51], 0
    v_mfma_f32_16x16x32_bf16 a[232:235], a[156:159], a[52:55], a[232:235]
    buffer_load_dwordx4 v249, s[40:43], s59 offen offset:3072 lds
    v_add_u32 v248, s63, v248
    v_mfma_f32_16x16x32_bf16 a[236:239], a[152:155], a[56:59], 0
    v_add_u32 v249, s63, v249
    v_mfma_f32_16x16x32_bf16 a[236:239], a[156:159], a[60:63], a[236:239]
    s_waitcnt lgkmcnt(4)
    v_mfma_f32_16x16x32_bf16 v[16:19], a[128:131], a[64:67], v[16:19]
    s_add_u32 m0, s60, 32768
    ds_read_b64_tr_b16 a[144:145], v244 offset:32768
    v_mfma_f32_16x16x32_bf16 v[16:19], a[132:135], a[68:71], v[16:19]
    buffer_load_dwordx4 v246, s[36:39], s44 offen offset:0 lds
    v_mfma_f32_16x16x32_bf16 v[20:23], a[128:131], a[72:75], v[20:23]
    ds_read_b64_tr_b16 a[146:147], v244 offset:33280
    v_mfma_f32_16x16x32_bf16 v[20:23], a[132:135], a[76:79], v[20:23]
    v_mfma_f32_16x16x32_bf16 v[24:27], a[128:131], a[80:83], v[24:27]
    ds_read_b64_tr_b16 a[148:149], v244 offset:36864
    v_mfma_f32_16x16x32_bf16 v[24:27], a[132:135], a[84:87], v[24:27]
    v_mfma_f32_16x16x32_bf16 v[28:31], a[128:131], a[88:91], v[28:31]
    ds_read_b64_tr_b16 a[150:151], v244 offset:37376
    buffer_load_dwordx4 v247, s[36:39], s45 offen offset:1024 lds
    v_mfma_f32_16x16x32_bf16 v[28:31], a[132:135], a[92:95], v[28:31]
    v_mfma_f32_16x16x32_bf16 v[32:35], a[128:131], a[96:99], v[32:35]
    ds_read_b128 a[0:3], v240 offset:0
    v_mfma_f32_16x16x32_bf16 v[32:35], a[132:135], a[100:103], v[32:35]
    v_mfma_f32_16x16x32_bf16 v[36:39], a[128:131], a[104:107], v[36:39]
    ds_read_b128 a[4:7], v241 offset:0
    v_mfma_f32_16x16x32_bf16 v[36:39], a[132:135], a[108:111], v[36:39]
    buffer_load_dwordx4 v246, s[36:39], s46 offen offset:2048 lds
    v_mfma_f32_16x16x32_bf16 v[40:43], a[128:131], a[112:115], v[40:43]
    v_mfma_f32_16x16x32_bf16 v[40:43], a[132:135], a[116:119], v[40:43]
    v_mfma_f32_16x16x32_bf16 v[44:47], a[128:131], a[120:123], v[44:47]
    v_mfma_f32_16x16x32_bf16 v[44:47], a[132:135], a[124:127], v[44:47]
    s_waitcnt lgkmcnt(6)
    v_mfma_f32_16x16x32_bf16 v[48:51], a[136:139], a[64:67], v[48:51]
    ds_read_b64_tr_b16 a[152:153], v245 offset:32768
    buffer_load_dwordx4 v247, s[36:39], s47 offen offset:3072 lds
    v_mfma_f32_16x16x32_bf16 v[48:51], a[140:143], a[68:71], v[48:51]
    s_add_u32 m0, s60, 36864
    v_mfma_f32_16x16x32_bf16 v[52:55], a[136:139], a[72:75], v[52:55]
    ds_read_b64_tr_b16 a[154:155], v245 offset:33280
    v_mfma_f32_16x16x32_bf16 v[52:55], a[140:143], a[76:79], v[52:55]
    v_mfma_f32_16x16x32_bf16 v[56:59], a[136:139], a[80:83], v[56:59]
    ds_read_b64_tr_b16 a[156:157], v245 offset:36864
    v_mfma_f32_16x16x32_bf16 v[56:59], a[140:143], a[84:87], v[56:59]
    buffer_load_dwordx4 v246, s[36:39], s48 offen offset:0 lds
    v_mfma_f32_16x16x32_bf16 v[60:63], a[136:139], a[88:91], v[60:63]
    ds_read_b64_tr_b16 a[158:159], v245 offset:37376
    v_mfma_f32_16x16x32_bf16 v[60:63], a[140:143], a[92:95], v[60:63]
    v_mfma_f32_16x16x32_bf16 v[64:67], a[136:139], a[96:99], v[64:67]
    ds_read_b128 a[8:11], v240 offset:2048
    v_mfma_f32_16x16x32_bf16 v[64:67], a[140:143], a[100:103], v[64:67]
    v_mfma_f32_16x16x32_bf16 v[68:71], a[136:139], a[104:107], v[68:71]
    ds_read_b128 a[12:15], v241 offset:2048
    buffer_load_dwordx4 v247, s[36:39], s49 offen offset:1024 lds
    v_mfma_f32_16x16x32_bf16 v[68:71], a[140:143], a[108:111], v[68:71]
    v_mfma_f32_16x16x32_bf16 v[72:75], a[136:139], a[112:115], v[72:75]
    ds_read_b128 a[16:19], v240 offset:4096
    v_mfma_f32_16x16x32_bf16 v[72:75], a[140:143], a[116:119], v[72:75]
    v_mfma_f32_16x16x32_bf16 v[76:79], a[136:139], a[120:123], v[76:79]
    v_mfma_f32_16x16x32_bf16 v[76:79], a[140:143], a[124:127], v[76:79]
    s_waitcnt lgkmcnt(9)
    buffer_load_dwordx4 v246, s[36:39], s50 offen offset:2048 lds
    v_mfma_f32_16x16x32_bf16 v[80:83], a[144:147], a[64:67], v[80:83]
    ds_read_b64_tr_b16 a[128:129], v242 offset:40960
    v_mfma_f32_16x16x32_bf16 v[80:83], a[148:151], a[68:71], v[80:83]
    v_mfma_f32_16x16x32_bf16 v[84:87], a[144:147], a[72:75], v[84:87]
    ds_read_b64_tr_b16 a[130:131], v242 offset:41472
    v_mfma_f32_16x16x32_bf16 v[84:87], a[148:151], a[76:79], v[84:87]
    v_mfma_f32_16x16x32_bf16 v[88:91], a[144:147], a[80:83], v[88:91]
    ds_read_b64_tr_b16 a[132:133], v242 offset:45056
    buffer_load_dwordx4 v247, s[36:39], s51 offen offset:3072 lds
    v_mfma_f32_16x16x32_bf16 v[88:91], a[148:151], a[84:87], v[88:91]
    v_add_u32 v246, s62, v246
    v_add_u32 v247, s62, v247
    v_mfma_f32_16x16x32_bf16 v[92:95], a[144:147], a[88:91], v[92:95]
    ds_read_b64_tr_b16 a[134:135], v242 offset:45568
    v_mfma_f32_16x16x32_bf16 v[92:95], a[148:151], a[92:95], v[92:95]
    v_mfma_f32_16x16x32_bf16 v[96:99], a[144:147], a[96:99], v[96:99]
    ds_read_b128 a[20:23], v241 offset:4096
    v_mfma_f32_16x16x32_bf16 v[96:99], a[148:151], a[100:103], v[96:99]
    v_mfma_f32_16x16x32_bf16 v[100:103], a[144:147], a[104:107], v[100:103]
    ds_read_b128 a[24:27], v240 offset:6144
    v_mfma_f32_16x16x32_bf16 v[100:103], a[148:151], a[108:111], v[100:103]
    v_mfma_f32_16x16x32_bf16 v[104:107], a[144:147], a[112:115], v[104:107]
    ds_read_b128 a[28:31], v241 offset:6144
    v_mfma_f32_16x16x32_bf16 v[104:107], a[148:151], a[116:119], v[104:107]
    v_mfma_f32_16x16x32_bf16 v[108:111], a[144:147], a[120:123], v[108:111]
    v_mfma_f32_16x16x32_bf16 v[108:111], a[148:151], a[124:127], v[108:111]
    s_waitcnt lgkmcnt(10)
    v_mfma_f32_16x16x32_bf16 v[112:115], a[152:155], a[64:67], v[112:115]
    ds_read_b64_tr_b16 a[136:137], v243 offset:40960
    v_mfma_f32_16x16x32_bf16 v[112:115], a[156:159], a[68:71], v[112:115]
    v_mfma_f32_16x16x32_bf16 v[116:119], a[152:155], a[72:75], v[116:119]
    ds_read_b64_tr_b16 a[138:139], v243 offset:41472
    v_mfma_f32_16x16x32_bf16 v[116:119], a[156:159], a[76:79], v[116:119]
    v_mfma_f32_16x16x32_bf16 v[120:123], a[152:155], a[80:83], v[120:123]
    ds_read_b64_tr_b16 a[140:141], v243 offset:45056
    v_mfma_f32_16x16x32_bf16 v[120:123], a[156:159], a[84:87], v[120:123]
    v_mfma_f32_16x16x32_bf16 v[124:127], a[152:155], a[88:91], v[124:127]
    ds_read_b64_tr_b16 a[142:143], v243 offset:45568
    v_mfma_f32_16x16x32_bf16 v[124:127], a[156:159], a[92:95], v[124:127]
    v_mfma_f32_16x16x32_bf16 v[128:131], a[152:155], a[96:99], v[128:131]
    ds_read_b128 a[32:35], v240 offset:8192
    v_mfma_f32_16x16x32_bf16 v[128:131], a[156:159], a[100:103], v[128:131]
    v_mfma_f32_16x16x32_bf16 v[132:135], a[152:155], a[104:107], v[132:135]
    ds_read_b128 a[36:39], v241 offset:8192
    v_mfma_f32_16x16x32_bf16 v[132:135], a[156:159], a[108:111], v[132:135]
    v_mfma_f32_16x16x32_bf16 v[136:139], a[152:155], a[112:115], v[136:139]
    v_mfma_f32_16x16x32_bf16 v[136:139], a[156:159], a[116:119], v[136:139]
    v_mfma_f32_16x16x32_bf16 v[140:143], a[152:155], a[120:123], v[140:143]
    v_mfma_f32_16x16x32_bf16 v[140:143], a[156:159], a[124:127], v[140:143]
    s_waitcnt lgkmcnt(9)
    v_mfma_f32_16x16x32_bf16 v[144:147], a[128:131], a[64:67], v[144:147]
    ds_read_b64_tr_b16 a[144:145], v244 offset:40960
    v_mfma_f32_16x16x32_bf16 v[144:147], a[132:135], a[68:71], v[144:147]
    v_mfma_f32_16x16x32_bf16 v[148:151], a[128:131], a[72:75], v[148:151]
    ds_read_b64_tr_b16 a[146:147], v244 offset:41472
    v_mfma_f32_16x16x32_bf16 v[148:151], a[132:135], a[76:79], v[148:151]
    v_mfma_f32_16x16x32_bf16 v[152:155], a[128:131], a[80:83], v[152:155]
    ds_read_b64_tr_b16 a[148:149], v244 offset:45056
    v_mfma_f32_16x16x32_bf16 v[152:155], a[132:135], a[84:87], v[152:155]
    v_mfma_f32_16x16x32_bf16 v[156:159], a[128:131], a[88:91], v[156:159]
    ds_read_b64_tr_b16 a[150:151], v244 offset:45568
    v_mfma_f32_16x16x32_bf16 v[156:159], a[132:135], a[92:95], v[156:159]
    v_mfma_f32_16x16x32_bf16 v[160:163], a[128:131], a[96:99], v[160:163]
    ds_read_b128 a[40:43], v240 offset:10240
    v_mfma_f32_16x16x32_bf16 v[160:163], a[132:135], a[100:103], v[160:163]
    v_mfma_f32_16x16x32_bf16 v[164:167], a[128:131], a[104:107], v[164:167]
    ds_read_b128 a[44:47], v241 offset:10240
    v_mfma_f32_16x16x32_bf16 v[164:167], a[132:135], a[108:111], v[164:167]
    v_mfma_f32_16x16x32_bf16 v[168:171], a[128:131], a[112:115], v[168:171]
    ds_read_b128 a[48:51], v240 offset:12288
    v_mfma_f32_16x16x32_bf16 v[168:171], a[132:135], a[116:119], v[168:171]
    v_mfma_f32_16x16x32_bf16 v[172:175], a[128:131], a[120:123], v[172:175]
    v_mfma_f32_16x16x32_bf16 v[172:175], a[132:135], a[124:127], v[172:175]
    s_waitcnt lgkmcnt(9)
    v_mfma_f32_16x16x32_bf16 v[176:179], a[136:139], a[64:67], v[176:179]
    ds_read_b64_tr_b16 a[152:153], v245 offset:40960
    v_mfma_f32_16x16x32_bf16 v[176:179], a[140:143], a[68:71], v[176:179]
    v_mfma_f32_16x16x32_bf16 v[180:183], a[136:139], a[72:75], v[180:183]
    ds_read_b64_tr_b16 a[154:155], v245 offset:41472
    v_mfma_f32_16x16x32_bf16 v[180:183], a[140:143], a[76:79], v[180:183]
    v_mfma_f32_16x16x32_bf16 v[184:187], a[136:139], a[80:83], v[184:187]
    ds_read_b64_tr_b16 a[156:157], v245 offset:45056
    v_mfma_f32_16x16x32_bf16 v[184:187], a[140:143], a[84:87], v[184:187]
    v_mfma_f32_16x16x32_bf16 v[188:191], a[136:139], a[88:91], v[188:191]
    ds_read_b64_tr_b16 a[158:159], v245 offset:45568
    v_mfma_f32_16x16x32_bf16 v[188:191], a[140:143], a[92:95], v[188:191]
    v_mfma_f32_16x16x32_bf16 v[192:195], a[136:139], a[96:99], v[192:195]
    ds_read_b128 a[52:55], v241 offset:12288
    v_mfma_f32_16x16x32_bf16 v[192:195], a[140:143], a[100:103], v[192:195]
    v_mfma_f32_16x16x32_bf16 v[196:199], a[136:139], a[104:107], v[196:199]
    ds_read_b128 a[56:59], v240 offset:14336
    v_mfma_f32_16x16x32_bf16 v[196:199], a[140:143], a[108:111], v[196:199]
    v_mfma_f32_16x16x32_bf16 v[200:203], a[136:139], a[112:115], v[200:203]
    ds_read_b128 a[60:63], v241 offset:14336
    v_mfma_f32_16x16x32_bf16 v[200:203], a[140:143], a[116:119], v[200:203]
    v_mfma_f32_16x16x32_bf16 v[204:207], a[136:139], a[120:123], v[204:207]
    v_mfma_f32_16x16x32_bf16 v[204:207], a[140:143], a[124:127], v[204:207]
    s_waitcnt vmcnt(0) lgkmcnt(0)
    s_barrier
    v_mfma_f32_16x16x32_bf16 v[208:211], a[144:147], a[64:67], v[208:211]
    s_add_u32 m0, s61, 32768
    ds_read_b64_tr_b16 a[128:129], v242 offset:0
    v_mfma_f32_16x16x32_bf16 v[208:211], a[148:151], a[68:71], v[208:211]
    buffer_load_dwordx4 v248, s[40:43], s52 offen offset:0 lds
    v_mfma_f32_16x16x32_bf16 v[212:215], a[144:147], a[72:75], v[212:215]
    v_mfma_f32_16x16x32_bf16 v[212:215], a[148:151], a[76:79], v[212:215]
    ds_read_b64_tr_b16 a[130:131], v242 offset:512
    v_mfma_f32_16x16x32_bf16 v[216:219], a[144:147], a[80:83], v[216:219]
    v_mfma_f32_16x16x32_bf16 v[216:219], a[148:151], a[84:87], v[216:219]
    buffer_load_dwordx4 v249, s[40:43], s53 offen offset:1024 lds
    v_mfma_f32_16x16x32_bf16 v[220:223], a[144:147], a[88:91], v[220:223]
    ds_read_b64_tr_b16 a[132:133], v242 offset:4096
    v_mfma_f32_16x16x32_bf16 v[220:223], a[148:151], a[92:95], v[220:223]
    v_mfma_f32_16x16x32_bf16 v[224:227], a[144:147], a[96:99], v[224:227]
    v_mfma_f32_16x16x32_bf16 v[224:227], a[148:151], a[100:103], v[224:227]
    ds_read_b64_tr_b16 a[134:135], v242 offset:4608
    buffer_load_dwordx4 v248, s[40:43], s54 offen offset:2048 lds
    v_mfma_f32_16x16x32_bf16 v[228:231], a[144:147], a[104:107], v[228:231]
    v_mfma_f32_16x16x32_bf16 v[228:231], a[148:151], a[108:111], v[228:231]
    v_mfma_f32_16x16x32_bf16 v[232:235], a[144:147], a[112:115], v[232:235]
    v_mfma_f32_16x16x32_bf16 v[232:235], a[148:151], a[116:119], v[232:235]
    buffer_load_dwordx4 v249, s[40:43], s55 offen offset:3072 lds
    v_mfma_f32_16x16x32_bf16 v[236:239], a[144:147], a[120:123], v[236:239]
    s_add_u32 m0, s61, 36864
    v_mfma_f32_16x16x32_bf16 v[236:239], a[148:151], a[124:127], v[236:239]
    v_mfma_f32_16x16x32_bf16 a[208:211], a[152:155], a[64:67], a[208:211]
    ds_read_b64_tr_b16 a[136:137], v243 offset:0
    v_mfma_f32_16x16x32_bf16 a[208:211], a[156:159], a[68:71], a[208:211]
    buffer_load_dwordx4 v248, s[40:43], s56 offen offset:0 lds
    v_mfma_f32_16x16x32_bf16 a[212:215], a[152:155], a[72:75], a[212:215]
    v_mfma_f32_16x16x32_bf16 a[212:215], a[156:159], a[76:79], a[212:215]
    ds_read_b64_tr_b16 a[138:139], v243 offset:512
    v_mfma_f32_16x16x32_bf16 a[216:219], a[152:155], a[80:83], a[216:219]
    v_mfma_f32_16x16x32_bf16 a[216:219], a[156:159], a[84:87], a[216:219]
    buffer_load_dwordx4 v249, s[40:43], s57 offen offset:1024 lds
    v_mfma_f32_16x16x32_bf16 a[220:223], a[152:155], a[88:91], a[220:223]
    ds_read_b64_tr_b16 a[140:141], v243 offset:4096
    v_mfma_f32_16x16x32_bf16 a[220:223], a[156:159], a[92:95], a[220:223]
    v_mfma_f32_16x16x32_bf16 a[224:227], a[152:155], a[96:99], a[224:227]
    v_mfma_f32_16x16x32_bf16 a[224:227], a[156:159], a[100:103], a[224:227]
    ds_read_b64_tr_b16 a[142:143], v243 offset:4608
    buffer_load_dwordx4 v248, s[40:43], s58 offen offset:2048 lds
    v_mfma_f32_16x16x32_bf16 a[228:231], a[152:155], a[104:107], a[228:231]
    v_mfma_f32_16x16x32_bf16 a[228:231], a[156:159], a[108:111], a[228:231]
    v_mfma_f32_16x16x32_bf16 a[232:235], a[152:155], a[112:115], a[232:235]
    v_mfma_f32_16x16x32_bf16 a[232:235], a[156:159], a[116:119], a[232:235]
    buffer_load_dwordx4 v249, s[40:43], s59 offen offset:3072 lds
    v_add_u32 v248, s63, v248
    v_mfma_f32_16x16x32_bf16 a[236:239], a[152:155], a[120:123], a[236:239]
    v_add_u32 v249, s63, v249
    v_mfma_f32_16x16x32_bf16 a[236:239], a[156:159], a[124:127], a[236:239]
    s_branch g1_N_ctl
g1_N_loop:
    s_waitcnt lgkmcnt(4)
    v_mfma_f32_16x16x32_bf16 v[16:19], a[128:131], a[0:3], v[16:19]
    s_add_u32 m0, s60, 0
    ds_read_b64_tr_b16 a[144:145], v244 offset:0
    v_mfma_f32_16x16x32_bf16 v[16:19], a[132:135], a[4:7], v[16:19]
    buffer_load_dwordx4 v246, s[36:39], s44 offen offset:0 lds
    v_mfma_f32_16x16x32_bf16 v[20:23], a[128:131], a[8:11], v[20:23]
    ds_read_b64_tr_b16 a[146:147], v244 offset:512
    v_mfma_f32_16x16x32_bf16 v[20:23], a[132:135], a[12:15], v[20:23]
    v_mfma_f32_16x16x32_bf16 v[24:27], a[128:131], a[16:19], v[24:27]
    ds_read_b64_tr_b16 a[148:149], v244 offset:4096
    v_mfma_f32_16x16x32_bf16 v[24:27], a[132:135], a[20:23], v[24:27]
    v_mfma_f32_16x16x32_bf16 v[28:31], a[128:131], a[24:27], v[28:31]
    ds_read_b64_tr_b16 a[150:151], v244 offset:4608
    buffer_load_dwordx4 v247, s[36:39], s45 offen offset:1024 lds
    v_mfma_f32_16x16x32_bf16 v[28:31], a[132:135], a[28:31], v[28:31]
    v_mfma_f32_16x16x32_bf16 v[32:35], a[128:131], a[32:35], v[32:35]
    ds_read_b128 a[64:67], v240 offset:32768
    v_mfma_f32_16x16x32_bf16 v[32:35], a[132:135], a[36:39], v[32:35]
    v_mfma_f32_16x16x32_bf16 v[36:39], a[128:131], a[40:43], v[36:39]
    ds_read_b128 a[68:71], v241 offset:32768
    v_mfma_f32_16x16x32_bf16 v[36:39], a[132:135], a[44:47], v[36:39]
    buffer_load_dwordx4 v246, s[36:39], s46 offen offset:2048 lds
    v_mfma_f32_16x16x32_bf16 v[40:43], a[128:131], a[48:51], v[40:43]
    v_mfma_f32_16x16x32_bf16 v[40:43], a[132:135], a[52:55], v[40:43]
    v_mfma_f32_16x16x32_bf16 v[44:47], a[128:131], a[56:59], v[44:47]
    v_mfma_f32_16x16x32_bf16 v[44:47], a[132:135], a[60:63], v[44:47]
    s_waitcnt lgkmcnt(6)
    v_mfma_f32_16x16x32_bf16 v[48:51], a[136:139], a[0:3], v[48:51]
    ds_read_b64_tr_b16 a[152:153], v245 offset:0
    buffer_load_dwordx4 v247, s[36:39], s47 offen offset:3072 lds
    v_mfma_f32_16x16x32_bf16 v[48:51], a[140:143], a[4:7], v[48:51]
    s_add_u32 m0, s60, 4096
    v_mfma_f32_16x16x32_bf16 v[52:55], a[136:139], a[8:11], v[52:55]
    ds_read_b64_tr_b16 a[154:155], v245 offset:512
    v_mfma_f32_16x16x32_bf16 v[52:55], a[140:143], a[12:15], v[52:55]
    v_mfma_f32_16x16x32_bf16 v[56:59], a[136:139], a[16:19], v[56:59]
    ds_read_b64_tr_b16 a[156:157], v245 offset:4096
    v_mfma_f32_16x16x32_bf16 v[56:59], a[140:143], a[20:23], v[56:59]
    buffer_load_dwordx4 v246, s[36:39], s48 offen offset:0 lds
    v_mfma_f32_16x16x32_bf16 v[60:63], a[136:139], a[24:27], v[60:63]
    ds_read_b64_tr_b16 a[158:159], v245 offset:4608
    v_mfma_f32_16x16x32_bf16 v[60:63], a[140:143], a[28:31], v[60:63]
    v_mfma_f32_16x16x32_bf16 v[64:67], a[136:139], a[32:35], v[64:67]
    ds_read_b128 a[72:75], v240 offset:34816
    v_mfma_f32_16x16x32_bf16 v[64:67], a[140:143], a[36:39], v[64:67]
    v_mfma_f32_16x16x32_bf16 v[68:71], a[136:139], a[40:43], v[68:71]
    ds_read_b128 a[76:79], v241 offset:34816
    buffer_load_dwordx4 v247, s[36:39], s49 offen offset:1024 lds
    v_mfma_f32_16x16x32_bf16 v[68:71], a[140:143], a[44:47], v[68:71]
    v_mfma_f32_16x16x32_bf16 v[72:75], a[136:139], a[48:51], v[72:75]
    ds_read_b128 a[80:83], v240 offset:36864
    v_mfma_f32_16x16x32_bf16 v[72:75], a[140:143], a[52:55], v[72:75]
    v_mfma_f32_16x16x32_bf16 v[76:79], a[136:139], a[56:59], v[76:79]
    v_mfma_f32_16x16x32_bf16 v[76:79], a[140:143], a[60:63], v[76:79]
    s_waitcnt lgkmcnt(9)
    buffer_load_dwordx4 v246, s[36:39], s50 offen offset:2048 lds
    v_mfma_f32_16x16x32_bf16 v[80:83], a[144:147], a[0:3], v[80:83]
    ds_read_b64_tr_b16 a[128:129], v242 offset:8192
    v_mfma_f32_16x16x32_bf16 v[80:83], a[148:151], a[4:7], v[80:83]
    v_mfma_f32_16x16x32_bf16 v[84:87], a[144:147], a[8:11], v[84:87]
    ds_read_b64_tr_b16 a[130:131], v242 offset:8704
    v_mfma_f32_16x16x32_bf16 v[84:87], a[148:151], a[12:15], v[84:87]
    v_mfma_f32_16x16x32_bf16 v[88:91], a[144:147], a[16:19], v[88:91]
    ds_read_b64_tr_b16 a[132:133], v242 offset:12288
    buffer_load_dwordx4 v247, s[36:39], s51 offen offset:3072 lds
    v_mfma_f32_16x16x32_bf16 v[88:91], a[148:151], a[20:23], v[88:91]
    v_add_u32 v246, s62, v246
    v_add_u32 v247, s62, v247
    v_mfma_f32_16x16x32_bf16 v[92:95], a[144:147], a[24:27], v[92:95]
    ds_read_b64_tr_b16 a[134:135], v242 offset:12800
    v_mfma_f32_16x16x32_bf16 v[92:95], a[148:151], a[28:31], v[92:95]
    v_mfma_f32_16x16x32_bf16 v[96:99], a[144:147], a[32:35], v[96:99]
    ds_read_b128 a[84:87], v241 offset:36864
    v_mfma_f32_16x16x32_bf16 v[96:99], a[148:151], a[36:39], v[96:99]
    buffer_load_dword v255, v254, s[76:79], 0 offen
    v_add_u32 v254, s20, v254
    v_mfma_f32_16x16x32_bf16 v[100:103], a[144:147], a[40:43], v[100:103]
    ds_read_b128 a[88:91], v240 offset:38912
    v_mfma_f32_16x16x32_bf16 v[100:103], a[148:151], a[44:47], v[100:103]
    v_mfma_f32_16x16x32_bf16 v[104:107], a[144:147], a[48:51], v[104:107]
    ds_read_b128 a[92:95], v241 offset:38912
    v_mfma_f32_16x16x32_bf16 v[104:107], a[148:151], a[52:55], v[104:107]
    v_mfma_f32_16x16x32_bf16 v[108:111], a[144:147], a[56:59], v[108:111]
    buffer_load_dword a240, v251, s[84:87], s90 offen sc1
    v_mfma_f32_16x16x32_bf16 v[108:111], a[148:151], a[60:63], v[108:111]
    s_waitcnt lgkmcnt(10)
    v_mfma_f32_16x16x32_bf16 v[112:115], a[152:155], a[0:3], v[112:115]
    ds_read_b64_tr_b16 a[136:137], v243 offset:8192
    v_mfma_f32_16x16x32_bf16 v[112:115], a[156:159], a[4:7], v[112:115]
    v_mfma_f32_16x16x32_bf16 v[116:119], a[152:155], a[8:11], v[116:119]
    ds_read_b64_tr_b16 a[138:139], v243 offset:8704
    v_mfma_f32_16x16x32_bf16 v[116:119], a[156:159], a[12:15], v[116:119]
    v_mfma_f32_16x16x32_bf16 v[120:123], a[152:155], a[16:19], v[120:123]
    ds_read_b64_tr_b16 a[140:141], v243 offset:12288
    v_mfma_f32_16x16x32_bf16 v[120:123], a[156:159], a[20:23], v[120:123]
    v_mfma_f32_16x16x32_bf16 v[124:127], a[152:155], a[24:27], v[124:127]
    ds_read_b64_tr_b16 a[142:143], v243 offset:12800
    v_mfma_f32_16x16x32_bf16 v[124:127], a[156:159], a[28:31], v[124:127]
    v_mfma_f32_16x16x32_bf16 v[128:131], a[152:155], a[32:35], v[128:131]
    ds_read_b128 a[96:99], v240 offset:40960
    v_mfma_f32_16x16x32_bf16 v[128:131], a[156:159], a[36:39], v[128:131]
    v_mfma_f32_16x16x32_bf16 v[132:135], a[152:155], a[40:43], v[132:135]
    ds_read_b128 a[100:103], v241 offset:40960
    v_mfma_f32_16x16x32_bf16 v[132:135], a[156:159], a[44:47], v[132:135]
    v_mfma_f32_16x16x32_bf16 v[136:139], a[152:155], a[48:51], v[136:139]
    v_mfma_f32_16x16x32_bf16 v[136:139], a[156:159], a[52:55], v[136:139]
    v_mfma_f32_16x16x32_bf16 v[140:143], a[152:155], a[56:59], v[140:143]
    v_mfma_f32_16x16x32_bf16 v[140:143], a[156:159], a[60:63], v[140:143]
    s_waitcnt lgkmcnt(9)
    v_mfma_f32_16x16x32_bf16 v[144:147], a[128:131], a[0:3], v[144:147]
    ds_read_b64_tr_b16 a[144:145], v244 offset:8192
    v_mfma_f32_16x16x32_bf16 v[144:147], a[132:135], a[4:7], v[144:147]
    v_mfma_f32_16x16x32_bf16 v[148:151], a[128:131], a[8:11], v[148:151]
    ds_read_b64_tr_b16 a[146:147], v244 offset:8704
    v_mfma_f32_16x16x32_bf16 v[148:151], a[132:135], a[12:15], v[148:151]
    v_mfma_f32_16x16x32_bf16 v[152:155], a[128:131], a[16:19], v[152:155]
    ds_read_b64_tr_b16 a[148:149], v244 offset:12288
    v_mfma_f32_16x16x32_bf16 v[152:155], a[132:135], a[20:23], v[152:155]
    v_mfma_f32_16x16x32_bf16 v[156:159], a[128:131], a[24:27], v[156:159]
    ds_read_b64_tr_b16 a[150:151], v244 offset:12800
    v_mfma_f32_16x16x32_bf16 v[156:159], a[132:135], a[28:31], v[156:159]
    v_mfma_f32_16x16x32_bf16 v[160:163], a[128:131], a[32:35], v[160:163]
    ds_read_b128 a[104:107], v240 offset:43008
    v_mfma_f32_16x16x32_bf16 v[160:163], a[132:135], a[36:39], v[160:163]
    v_mfma_f32_16x16x32_bf16 v[164:167], a[128:131], a[40:43], v[164:167]
    ds_read_b128 a[108:111], v241 offset:43008
    v_mfma_f32_16x16x32_bf16 v[164:167], a[132:135], a[44:47], v[164:167]
    v_mfma_f32_16x16x32_bf16 v[168:171], a[128:131], a[48:51], v[168:171]
    ds_read_b128 a[112:115], v240 offset:45056
    v_mfma_f32_16x16x32_bf16 v[168:171], a[132:135], a[52:55], v[168:171]
    v_mfma_f32_16x16x32_bf16 v[172:175], a[128:131], a[56:59], v[172:175]
    v_mfma_f32_16x16x32_bf16 v[172:175], a[132:135], a[60:63], v[172:175]
    s_waitcnt lgkmcnt(9)
    v_mfma_f32_16x16x32_bf16 v[176:179], a[136:139], a[0:3], v[176:179]
    ds_read_b64_tr_b16 a[152:153], v245 offset:8192
    v_mfma_f32_16x16x32_bf16 v[176:179], a[140:143], a[4:7], v[176:179]
    v_mfma_f32_16x16x32_bf16 v[180:183], a[136:139], a[8:11], v[180:183]
    ds_read_b64_tr_b16 a[154:155], v245 offset:8704
    v_mfma_f32_16x16x32_bf16 v[180:183], a[140:143], a[12:15], v[180:183]
    v_mfma_f32_16x16x32_bf16 v[184:187], a[136:139], a[16:19], v[184:187]
    ds_read_b64_tr_b16 a[156:157], v245 offset:12288
    v_mfma_f32_16x16x32_bf16 v[184:187], a[140:143], a[20:23], v[184:187]
    v_mfma_f32_16x16x32_bf16 v[188:191], a[136:139], a[24:27], v[188:191]
    ds_read_b64_tr_b16 a[158:159], v245 offset:12800
    v_mfma_f32_16x16x32_bf16 v[188:191], a[140:143], a[28:31], v[188:191]
    v_mfma_f32_16x16x32_bf16 v[192:195], a[136:139], a[32:35], v[192:195]
    ds_read_b128 a[116:119], v241 offset:45056
    v_mfma_f32_16x16x32_bf16 v[192:195], a[140:143], a[36:39], v[192:195]
    v_mfma_f32_16x16x32_bf16 v[196:199], a[136:139], a[40:43], v[196:199]
    ds_read_b128 a[120:123], v240 offset:47104
    v_mfma_f32_16x16x32_bf16 v[196:199], a[140:143], a[44:47], v[196:199]
    v_mfma_f32_16x16x32_bf16 v[200:203], a[136:139], a[48:51], v[200:203]
    ds_read_b128 a[124:127], v241 offset:47104
    v_mfma_f32_16x16x32_bf16 v[200:203], a[140:143], a[52:55], v[200:203]
    v_mfma_f32_16x16x32_bf16 v[204:207], a[136:139], a[56:59], v[204:207]
    v_mfma_f32_16x16x32_bf16 v[204:207], a[140:143], a[60:63], v[204:207]
    s_waitcnt vmcnt(2) lgkmcnt(0)
    s_barrier
    v_mfma_f32_16x16x32_bf16 v[208:211], a[144:147], a[0:3], v[208:211]
    s_add_u32 m0, s61, 0
    ds_read_b64_tr_b16 a[128:129], v242 offset:32768
    v_mfma_f32_16x16x32_bf16 v[208:211], a[148:151], a[4:7], v[208:211]
    buffer_load_dwordx4 v248, s[40:43], s52 offen offset:0 lds
    v_mfma_f32_16x16x32_bf16 v[212:215], a[144:147], a[8:11], v[212:215]
    v_mfma_f32_16x16x32_bf16 v[212:215], a[148:151], a[12:15], v[212:215]
    ds_read_b64_tr_b16 a[130:131], v242 offset:33280
    v_mfma_f32_16x16x32_bf16 v[216:219], a[144:147], a[16:19], v[216:219]
    v_mfma_f32_16x16x32_bf16 v[216:219], a[148:151], a[20:23], v[216:219]
    buffer_load_dwordx4 v249, s[40:43], s53 offen offset:1024 lds
    v_mfma_f32_16x16x32_bf16 v[220:223], a[144:147], a[24:27], v[220:223]
    ds_read_b64_tr_b16 a[132:133], v242 offset:36864
    v_mfma_f32_16x16x32_bf16 v[220:223], a[148:151], a[28:31], v[220:223]
    v_mfma_f32_16x16x32_bf16 v[224:227], a[144:147], a[32:35], v[224:227]
    v_mfma_f32_16x16x32_bf16 v[224:227], a[148:151], a[36:39], v[224:227]
    ds_read_b64_tr_b16 a[134:135], v242 offset:37376
    buffer_load_dwordx4 v248, s[40:43], s54 offen offset:2048 lds
    v_mfma_f32_16x16x32_bf16 v[228:231], a[144:147], a[40:43], v[228:231]
    v_mfma_f32_16x16x32_bf16 v[228:231], a[148:151], a[44:47], v[228:231]
    v_mfma_f32_16x16x32_bf16 v[232:235], a[144:147], a[48:51], v[232:235]
    v_mfma_f32_16x16x32_bf16 v[232:235], a[148:151], a[52:55], v[232:235]
    buffer_load_dwordx4 v249, s[40:43], s55 offen offset:3072 lds
    v_mfma_f32_16x16x32_bf16 v[236:239], a[144:147], a[56:59], v[236:239]
    s_add_u32 m0, s61, 4096
    v_mfma_f32_16x16x32_bf16 v[236:239], a[148:151], a[60:63], v[236:239]
    v_mfma_f32_16x16x32_bf16 a[208:211], a[152:155], a[0:3], a[208:211]
    ds_read_b64_tr_b16 a[136:137], v243 offset:32768
    v_mfma_f32_16x16x32_bf16 a[208:211], a[156:159], a[4:7], a[208:211]
    buffer_load_dwordx4 v248, s[40:43], s56 offen offset:0 lds
    v_mfma_f32_16x16x32_bf16 a[212:215], a[152:155], a[8:11], a[212:215]
    v_mfma_f32_16x16x32_bf16 a[212:215], a[156:159], a[12:15], a[212:215]
    ds_read_b64_tr_b16 a[138:139], v243 offset:33280
    v_mfma_f32_16x16x32_bf16 a[216:219], a[152:155], a[16:19], a[216:219]
    v_mfma_f32_16x16x32_bf16 a[216:219], a[156:159], a[20:23], a[216:219]
    buffer_load_dwordx4 v249, s[40:43], s57 offen offset:1024 lds
    v_mfma_f32_16x16x32_bf16 a[220:223], a[152:155], a[24:27], a[220:223]
    ds_read_b64_tr_b16 a[140:141], v243 offset:36864
    v_mfma_f32_16x16x32_bf16 a[220:223], a[156:159], a[28:31], a[220:223]
    v_mfma_f32_16x16x32_bf16 a[224:227], a[152:155], a[32:35], a[224:227]
    v_mfma_f32_16x16x32_bf16 a[224:227], a[156:159], a[36:39], a[224:227]
    ds_read_b64_tr_b16 a[142:143], v243 offset:37376
    buffer_load_dwordx4 v248, s[40:43], s58 offen offset:2048 lds
    v_mfma_f32_16x16x32_bf16 a[228:231], a[152:155], a[40:43], a[228:231]
    v_mfma_f32_16x16x32_bf16 a[228:231], a[156:159], a[44:47], a[228:231]
    v_mfma_f32_16x16x32_bf16 a[232:235], a[152:155], a[48:51], a[232:235]
    v_mfma_f32_16x16x32_bf16 a[232:235], a[156:159], a[52:55], a[232:235]
    buffer_load_dwordx4 v249, s[40:43], s59 offen offset:3072 lds
    v_add_u32 v248, s63, v248
    v_mfma_f32_16x16x32_bf16 a[236:239], a[152:155], a[56:59], a[236:239]
    v_add_u32 v249, s63, v249
    v_mfma_f32_16x16x32_bf16 a[236:239], a[156:159], a[60:63], a[236:239]
    s_waitcnt lgkmcnt(4)
    v_mfma_f32_16x16x32_bf16 v[16:19], a[128:131], a[64:67], v[16:19]
    s_add_u32 m0, s60, 32768
    ds_read_b64_tr_b16 a[144:145], v244 offset:32768
    v_mfma_f32_16x16x32_bf16 v[16:19], a[132:135], a[68:71], v[16:19]
    buffer_load_dwordx4 v246, s[36:39], s44 offen offset:0 lds
    v_mfma_f32_16x16x32_bf16 v[20:23], a[128:131], a[72:75], v[20:23]
    ds_read_b64_tr_b16 a[146:147], v244 offset:33280
    v_mfma_f32_16x16x32_bf16 v[20:23], a[132:135], a[76:79], v[20:23]
    v_mfma_f32_16x16x32_bf16 v[24:27], a[128:131], a[80:83], v[24:27]
    ds_read_b64_tr_b16 a[148:149], v244 offset:36864
    v_mfma_f32_16x16x32_bf16 v[24:27], a[132:135], a[84:87], v[24:27]
    v_mfma_f32_16x16x32_bf16 v[28:31], a[128:131], a[88:91], v[28:31]
    ds_read_b64_tr_b16 a[150:151], v244 offset:37376
    buffer_load_dwordx4 v247, s[36:39], s45 offen offset:1024 lds
    v_mfma_f32_16x16x32_bf16 v[28:31], a[132:135], a[92:95], v[28:31]
    v_mfma_f32_16x16x32_bf16 v[32:35], a[128:131], a[96:99], v[32:35]
    ds_read_b128 a[0:3], v240 offset:0
    v_mfma_f32_16x16x32_bf16 v[32:35], a[132:135], a[100:103], v[32:35]
    v_mfma_f32_16x16x32_bf16 v[36:39], a[128:131], a[104:107], v[36:39]
    ds_read_b128 a[4:7], v241 offset:0
    v_mfma_f32_16x16x32_bf16 v[36:39], a[132:135], a[108:111], v[36:39]
    buffer_load_dwordx4 v246, s[36:39], s46 offen offset:2048 lds
    v_mfma_f32_16x16x32_bf16 v[40:43], a[128:131], a[112:115], v[40:43]
    v_mfma_f32_16x16x32_bf16 v[40:43], a[132:135], a[116:119], v[40:43]
    v_mfma_f32_16x16x32_bf16 v[44:47], a[128:131], a[120:123], v[44:47]
    v_mfma_f32_16x16x32_bf16 v[44:47], a[132:135], a[124:127], v[44:47]
    s_waitcnt lgkmcnt(6)
    v_mfma_f32_16x16x32_bf16 v[48:51], a[136:139], a[64:67], v[48:51]
    ds_read_b64_tr_b16 a[152:153], v245 offset:32768
    buffer_load_dwordx4 v247, s[36:39], s47 offen offset:3072 lds
    v_mfma_f32_16x16x32_bf16 v[48:51], a[140:143], a[68:71], v[48:51]
    s_add_u32 m0, s60, 36864
    v_mfma_f32_16x16x32_bf16 v[52:55], a[136:139], a[72:75], v[52:55]
    ds_read_b64_tr_b16 a[154:155], v245 offset:33280
    v_mfma_f32_16x16x32_bf16 v[52:55], a[140:143], a[76:79], v[52:55]
    v_mfma_f32_16x16x32_bf16 v[56:59], a[136:139], a[80:83], v[56:59]
    ds_read_b64_tr_b16 a[156:157], v245 offset:36864
    v_mfma_f32_16x16x32_bf16 v[56:59], a[140:143], a[84:87], v[56:59]
    buffer_load_dwordx4 v246, s[36:39], s48 offen offset:0 lds
    v_mfma_f32_16x16x32_bf16 v[60:63], a[136:139], a[88:91], v[60:63]
    ds_read_b64_tr_b16 a[158:159], v245 offset:37376
    v_mfma_f32_16x16x32_bf16 v[60:63], a[140:143], a[92:95], v[60:63]
    v_mfma_f32_16x16x32_bf16 v[64:67], a[136:139], a[96:99], v[64:67]
    ds_read_b128 a[8:11], v240 offset:2048
    v_mfma_f32_16x16x32_bf16 v[64:67], a[140:143], a[100:103], v[64:67]
    v_mfma_f32_16x16x32_bf16 v[68:71], a[136:139], a[104:107], v[68:71]
    ds_read_b128 a[12:15], v241 offset:2048
    buffer_load_dwordx4 v247, s[36:39], s49 offen offset:1024 lds
    v_mfma_f32_16x16x32_bf16 v[68:71], a[140:143], a[108:111], v[68:71]
    v_mfma_f32_16x16x32_bf16 v[72:75], a[136:139], a[112:115], v[72:75]
    ds_read_b128 a[16:19], v240 offset:4096
    v_mfma_f32_16x16x32_bf16 v[72:75], a[140:143], a[116:119], v[72:75]
    v_mfma_f32_16x16x32_bf16 v[76:79], a[136:139], a[120:123], v[76:79]
    v_mfma_f32_16x16x32_bf16 v[76:79], a[140:143], a[124:127], v[76:79]
    s_waitcnt lgkmcnt(9)
    buffer_load_dwordx4 v246, s[36:39], s50 offen offset:2048 lds
    v_mfma_f32_16x16x32_bf16 v[80:83], a[144:147], a[64:67], v[80:83]
    ds_read_b64_tr_b16 a[128:129], v242 offset:40960
    v_mfma_f32_16x16x32_bf16 v[80:83], a[148:151], a[68:71], v[80:83]
    v_mfma_f32_16x16x32_bf16 v[84:87], a[144:147], a[72:75], v[84:87]
    ds_read_b64_tr_b16 a[130:131], v242 offset:41472
    v_mfma_f32_16x16x32_bf16 v[84:87], a[148:151], a[76:79], v[84:87]
    v_mfma_f32_16x16x32_bf16 v[88:91], a[144:147], a[80:83], v[88:91]
    ds_read_b64_tr_b16 a[132:133], v242 offset:45056
    buffer_load_dwordx4 v247, s[36:39], s51 offen offset:3072 lds
    v_mfma_f32_16x16x32_bf16 v[88:91], a[148:151], a[84:87], v[88:91]
    v_add_u32 v246, s62, v246
    v_add_u32 v247, s62, v247
    v_mfma_f32_16x16x32_bf16 v[92:95], a[144:147], a[88:91], v[92:95]
    ds_read_b64_tr_b16 a[134:135], v242 offset:45568
    v_mfma_f32_16x16x32_bf16 v[92:95], a[148:151], a[92:95], v[92:95]
    v_mfma_f32_16x16x32_bf16 v[96:99], a[144:147], a[96:99], v[96:99]
    ds_read_b128 a[20:23], v241 offset:4096
    v_mfma_f32_16x16x32_bf16 v[96:99], a[148:151], a[100:103], v[96:99]
    v_mfma_f32_16x16x32_bf16 v[100:103], a[144:147], a[104:107], v[100:103]
    ds_read_b128 a[24:27], v240 offset:6144
    v_mfma_f32_16x16x32_bf16 v[100:103], a[148:151], a[108:111], v[100:103]
    v_mfma_f32_16x16x32_bf16 v[104:107], a[144:147], a[112:115], v[104:107]
    ds_read_b128 a[28:31], v241 offset:6144
    v_mfma_f32_16x16x32_bf16 v[104:107], a[148:151], a[116:119], v[104:107]
    v_mfma_f32_16x16x32_bf16 v[108:111], a[144:147], a[120:123], v[108:111]
    v_mfma_f32_16x16x32_bf16 v[108:111], a[148:151], a[124:127], v[108:111]
    s_waitcnt lgkmcnt(10)
    v_mfma_f32_16x16x32_bf16 v[112:115], a[152:155], a[64:67], v[112:115]
    ds_read_b64_tr_b16 a[136:137], v243 offset:40960
    v_mfma_f32_16x16x32_bf16 v[112:115], a[156:159], a[68:71], v[112:115]
    v_mfma_f32_16x16x32_bf16 v[116:119], a[152:155], a[72:75], v[116:119]
    ds_read_b64_tr_b16 a[138:139], v243 offset:41472
    v_mfma_f32_16x16x32_bf16 v[116:119], a[156:159], a[76:79], v[116:119]
    v_mfma_f32_16x16x32_bf16 v[120:123], a[152:155], a[80:83], v[120:123]
    ds_read_b64_tr_b16 a[140:141], v243 offset:45056
    v_mfma_f32_16x16x32_bf16 v[120:123], a[156:159], a[84:87], v[120:123]
    v_mfma_f32_16x16x32_bf16 v[124:127], a[152:155], a[88:91], v[124:127]
    ds_read_b64_tr_b16 a[142:143], v243 offset:45568
    v_mfma_f32_16x16x32_bf16 v[124:127], a[156:159], a[92:95], v[124:127]
    v_mfma_f32_16x16x32_bf16 v[128:131], a[152:155], a[96:99], v[128:131]
    ds_read_b128 a[32:35], v240 offset:8192
    v_mfma_f32_16x16x32_bf16 v[128:131], a[156:159], a[100:103], v[128:131]
    v_mfma_f32_16x16x32_bf16 v[132:135], a[152:155], a[104:107], v[132:135]
    ds_read_b128 a[36:39], v241 offset:8192
    v_mfma_f32_16x16x32_bf16 v[132:135], a[156:159], a[108:111], v[132:135]
    v_mfma_f32_16x16x32_bf16 v[136:139], a[152:155], a[112:115], v[136:139]
    v_mfma_f32_16x16x32_bf16 v[136:139], a[156:159], a[116:119], v[136:139]
    v_mfma_f32_16x16x32_bf16 v[140:143], a[152:155], a[120:123], v[140:143]
    v_mfma_f32_16x16x32_bf16 v[140:143], a[156:159], a[124:127], v[140:143]
    s_waitcnt lgkmcnt(9)
    v_mfma_f32_16x16x32_bf16 v[144:147], a[128:131], a[64:67], v[144:147]
    ds_read_b64_tr_b16 a[144:145], v244 offset:40960
    v_mfma_f32_16x16x32_bf16 v[144:147], a[132:135], a[68:71], v[144:147]
    v_mfma_f32_16x16x32_bf16 v[148:151], a[128:131], a[72:75], v[148:151]
    ds_read_b64_tr_b16 a[146:147], v244 offset:41472
    v_mfma_f32_16x16x32_bf16 v[148:151], a[132:135], a[76:79], v[148:151]
    v_mfma_f32_16x16x32_bf16 v[152:155], a[128:131], a[80:83], v[152:155]
    ds_read_b64_tr_b16 a[148:149], v244 offset:45056
    v_mfma_f32_16x16x32_bf16 v[152:155], a[132:135], a[84:87], v[152:155]
    v_mfma_f32_16x16x32_bf16 v[156:159], a[128:131], a[88:91], v[156:159]
    ds_read_b64_tr_b16 a[150:151], v244 offset:45568
    v_mfma_f32_16x16x32_bf16 v[156:159], a[132:135], a[92:95], v[156:159]
    v_mfma_f32_16x16x32_bf16 v[160:163], a[128:131], a[96:99], v[160:163]
    ds_read_b128 a[40:43], v240 offset:10240
    v_mfma_f32_16x16x32_bf16 v[160:163], a[132:135], a[100:103], v[160:163]
    v_mfma_f32_16x16x32_bf16 v[164:167], a[128:131], a[104:107], v[164:167]
    ds_read_b128 a[44:47], v241 offset:10240
    v_mfma_f32_16x16x32_bf16 v[164:167], a[132:135], a[108:111], v[164:167]
    v_mfma_f32_16x16x32_bf16 v[168:171], a[128:131], a[112:115], v[168:171]
    ds_read_b128 a[48:51], v240 offset:12288
    v_mfma_f32_16x16x32_bf16 v[168:171], a[132:135], a[116:119], v[168:171]
    v_mfma_f32_16x16x32_bf16 v[172:175], a[128:131], a[120:123], v[172:175]
    v_mfma_f32_16x16x32_bf16 v[172:175], a[132:135], a[124:127], v[172:175]
    s_waitcnt lgkmcnt(9)
    v_mfma_f32_16x16x32_bf16 v[176:179], a[136:139], a[64:67], v[176:179]
    ds_read_b64_tr_b16 a[152:153], v245 offset:40960
    v_mfma_f32_16x16x32_bf16 v[176:179], a[140:143], a[68:71], v[176:179]
    v_mfma_f32_16x16x32_bf16 v[180:183], a[136:139], a[72:75], v[180:183]
    ds_read_b64_tr_b16 a[154:155], v245 offset:41472
    v_mfma_f32_16x16x32_bf16 v[180:183], a[140:143], a[76:79], v[180:183]
    v_mfma_f32_16x16x32_bf16 v[184:187], a[136:139], a[80:83], v[184:187]
    ds_read_b64_tr_b16 a[156:157], v245 offset:45056
    v_mfma_f32_16x16x32_bf16 v[184:187], a[140:143], a[84:87], v[184:187]
    v_mfma_f32_16x16x32_bf16 v[188:191], a[136:139], a[88:91], v[188:191]
    ds_read_b64_tr_b16 a[158:159], v245 offset:45568
    v_mfma_f32_16x16x32_bf16 v[188:191], a[140:143], a[92:95], v[188:191]
    v_mfma_f32_16x16x32_bf16 v[192:195], a[136:139], a[96:99], v[192:195]
    ds_read_b128 a[52:55], v241 offset:12288
    v_mfma_f32_16x16x32_bf16 v[192:195], a[140:143], a[100:103], v[192:195]
    v_mfma_f32_16x16x32_bf16 v[196:199], a[136:139], a[104:107], v[196:199]
    ds_read_b128 a[56:59], v240 offset:14336
    v_mfma_f32_16x16x32_bf16 v[196:199], a[140:143], a[108:111], v[196:199]
    v_mfma_f32_16x16x32_bf16 v[200:203], a[136:139], a[112:115], v[200:203]
    ds_read_b128 a[60:63], v241 offset:14336
    v_mfma_f32_16x16x32_bf16 v[200:203], a[140:143], a[116:119], v[200:203]
    v_mfma_f32_16x16x32_bf16 v[204:207], a[136:139], a[120:123], v[204:207]
    v_mfma_f32_16x16x32_bf16 v[204:207], a[140:143], a[124:127], v[204:207]
    s_waitcnt vmcnt(0) lgkmcnt(0)
    s_barrier
    v_mfma_f32_16x16x32_bf16 v[208:211], a[144:147], a[64:67], v[208:211]
    s_add_u32 m0, s61, 32768
    ds_read_b64_tr_b16 a[128:129], v242 offset:0
    v_mfma_f32_16x16x32_bf16 v[208:211], a[148:151], a[68:71], v[208:211]
    buffer_load_dwordx4 v248, s[40:43], s52 offen offset:0 lds
    v_mfma_f32_16x16x32_bf16 v[212:215], a[144:147], a[72:75], v[212:215]
    v_mfma_f32_16x16x32_bf16 v[212:215], a[148:151], a[76:79], v[212:215]
    ds_read_b64_tr_b16 a[130:131], v242 offset:512
    v_mfma_f32_16x16x32_bf16 v[216:219], a[144:147], a[80:83], v[216:219]
    v_mfma_f32_16x16x32_bf16 v[216:219], a[148:151], a[84:87], v[216:219]
    buffer_load_dwordx4 v249, s[40:43], s53 offen offset:1024 lds
    v_mfma_f32_16x16x32_bf16 v[220:223], a[144:147], a[88:91], v[220:223]
    ds_read_b64_tr_b16 a[132:133], v242 offset:4096
    v_mfma_f32_16x16x32_bf16 v[220:223], a[148:151], a[92:95], v[220:223]
    v_mfma_f32_16x16x32_bf16 v[224:227], a[144:147], a[96:99], v[224:227]
    v_mfma_f32_16x16x32_bf16 v[224:227], a[148:151], a[100:103], v[224:227]
    ds_read_b64_tr_b16 a[134:135], v242 offset:4608
    buffer_load_dwordx4 v248, s[40:43], s54 offen offset:2048 lds
    v_mfma_f32_16x16x32_bf16 v[228:231], a[144:147], a[104:107], v[228:231]
    v_mfma_f32_16x16x32_bf16 v[228:231], a[148:151], a[108:111], v[228:231]
    v_mfma_f32_16x16x32_bf16 v[232:235], a[144:147], a[112:115], v[232:235]
    v_mfma_f32_16x16x32_bf16 v[232:235], a[148:151], a[116:119], v[232:235]
    buffer_load_dwordx4 v249, s[40:43], s55 offen offset:3072 lds
    v_mfma_f32_16x16x32_bf16 v[236:239], a[144:147], a[120:123], v[236:239]
    s_add_u32 m0, s61, 36864
    v_mfma_f32_16x16x32_bf16 v[236:239], a[148:151], a[124:127], v[236:239]
    v_mfma_f32_16x16x32_bf16 a[208:211], a[152:155], a[64:67], a[208:211]
    ds_read_b64_tr_b16 a[136:137], v243 offset:0
    v_mfma_f32_16x16x32_bf16 a[208:211], a[156:159], a[68:71], a[208:211]
    buffer_load_dwordx4 v248, s[40:43], s56 offen offset:0 lds
    v_mfma_f32_16x16x32_bf16 a[212:215], a[152:155], a[72:75], a[212:215]
    v_mfma_f32_16x16x32_bf16 a[212:215], a[156:159], a[76:79], a[212:215]
    ds_read_b64_tr_b16 a[138:139], v243 offset:512
    v_mfma_f32_16x16x32_bf16 a[216:219], a[152:155], a[80:83], a[216:219]
    v_mfma_f32_16x16x32_bf16 a[216:219], a[156:159], a[84:87], a[216:219]
    buffer_load_dwordx4 v249, s[40:43], s57 offen offset:1024 lds
    v_mfma_f32_16x16x32_bf16 a[220:223], a[152:155], a[88:91], a[220:223]
    ds_read_b64_tr_b16 a[140:141], v243 offset:4096
    v_mfma_f32_16x16x32_bf16 a[220:223], a[156:159], a[92:95], a[220:223]
    v_mfma_f32_16x16x32_bf16 a[224:227], a[152:155], a[96:99], a[224:227]
    v_mfma_f32_16x16x32_bf16 a[224:227], a[156:159], a[100:103], a[224:227]
    ds_read_b64_tr_b16 a[142:143], v243 offset:4608
    buffer_load_dwordx4 v248, s[40:43], s58 offen offset:2048 lds
    v_mfma_f32_16x16x32_bf16 a[228:231], a[152:155], a[104:107], a[228:231]
    v_mfma_f32_16x16x32_bf16 a[228:231], a[156:159], a[108:111], a[228:231]
    v_mfma_f32_16x16x32_bf16 a[232:235], a[152:155], a[112:115], a[232:235]
    v_mfma_f32_16x16x32_bf16 a[232:235], a[156:159], a[116:119], a[232:235]
    buffer_load_dwordx4 v249, s[40:43], s59 offen offset:3072 lds
    v_add_u32 v248, s63, v248
    v_mfma_f32_16x16x32_bf16 a[236:239], a[152:155], a[120:123], a[236:239]
    v_add_u32 v249, s63, v249
    v_mfma_f32_16x16x32_bf16 a[236:239], a[156:159], a[124:127], a[236:239]
    s_sub_u32 s64, s64, 1
g1_N_ctl:
    s_cmp_gt_u32 s64, 3
    s_cbranch_scc1 g1_N_loop
    s_cmp_eq_u32 s64, 2
    s_cbranch_scc1 g1_N_loop
    s_cmp_eq_u32 s64, 0
    s_cbranch_scc1 g1_N_epi
    s_cmp_eq_u32 s64, 1
    s_cbranch_scc1 g1_N_sw
    s_bfe_u32 s5, s68, 0x20008
    s_bfe_u32 s6, s68, 0x50003
    s_cmp_eq_u32 s5, 3
    s_cbranch_scc1 g1_db4_gu
    s_mov_b32 s76, s12
    s_mov_b32 s77, s13
    s_mov_b32 s78, 8388608
    s_cmp_eq_u32 s5, 1
    s_cselect_b32 s76, s14, s76
    s_cselect_b32 s77, s15, s77
    s_cselect_b32 s78, 4194304, s78
    s_cmp_eq_u32 s5, 2
    s_cselect_b32 s76, s16, s76
    s_cselect_b32 s77, s17, s77
    s_cselect_b32 s78, 4194304, s78
    s_mov_b32 s30, 8192
    s_lshl_b32 s27, s6, 9
    s_lshl_b32 s3, s101, 7
    s_add_u32 s27, s27, s3
    s_branch g1_db4_src
g1_db4_gu:
    s_cmp_eq_u32 s66, 0
    s_cselect_b32 s76, s22, s24
    s_cselect_b32 s77, s23, s25
    s_mov_b32 s78, 7340032
    s_mov_b32 s30, 7168
    s_lshl_b32 s27, s6, 8
    s_lshl_b32 s3, s65, 7
    s_add_u32 s27, s27, s3
g1_db4_src:
    s_mov_b32 s79, 0x20000
    s_cmp_eq_u32 s68, 0
    s_cselect_b32 s78, 0, s78
    v_lshrrev_b32 v254, 3, v250
    v_lshlrev_b32 v254, 6, v254
    v_and_b32 v7, 7, v250
    s_and_b32 s3, s68, 7
    s_lshl_b32 s3, s3, 3
    v_add3_u32 v254, v254, v7, s3
    v_mul_lo_u32 v254, v254, s30
    v_add_u32 v254, s27, v254
    v_bfrev_b32 v7, 1
    v_cmp_gt_u32 vcc, 16, v250
    s_lshl_b32 s20, s30, 7
    s_nop 0
    v_cndmask_b32 v254, v7, v254, vcc
    s_branch g1_N_loop
g1_N_sw:
    s_and_b32 s6, s2, 7
    s_lshl_b32 s6, s6, 8
    s_cmp_lg_u32 s88, 0
    s_cselect_b32 s90, s6, 0
    s_cmp_eq_u32 s68, 0
    s_cbranch_scc0 g1_sp5_valid
    s_mov_b32 s38, 0
    s_mov_b32 s42, 0
    s_branch g1_sp5_done
g1_sp5_valid:
    s_bfe_u32 s5, s68, 0x20008
    s_bfe_u32 s6, s68, 0x50003
    s_sub_u32 s7, s5, 1
    s_cmp_lt_u32 s7, 2
    s_cselect_b32 s36, s10, s8
    s_cselect_b32 s37, s11, s9
    s_mov_b32 s7, 2097152
    s_cselect_b32 s38, s7, 4194304
    s_mov_b32 s39, 0x20000
    s_mov_b32 s7, 1024
    s_cselect_b32 s26, s7, 2048
    s_cmp_eq_u32 s5, 3
    s_cbranch_scc1 g1_db6_gu
    s_mov_b32 s40, s12
    s_mov_b32 s41, s13
    s_mov_b32 s42, 8388608
    s_cmp_eq_u32 s5, 1
    s_cselect_b32 s40, s14, s40
    s_cselect_b32 s41, s15, s41
    s_cselect_b32 s42, 4194304, s42
    s_cmp_eq_u32 s5, 2
    s_cselect_b32 s40, s16, s40
    s_cselect_b32 s41, s17, s41
    s_cselect_b32 s42, 4194304, s42
    s_mov_b32 s30, 8192
    s_lshl_b32 s27, s6, 9
    s_lshl_b32 s3, s101, 7
    s_add_u32 s27, s27, s3
    s_branch g1_db6_src
g1_db6_gu:
    s_cmp_eq_u32 s66, 0
    s_cselect_b32 s40, s22, s24
    s_cselect_b32 s41, s23, s25
    s_mov_b32 s42, 7340032
    s_mov_b32 s30, 7168
    s_lshl_b32 s27, s6, 8
    s_lshl_b32 s3, s65, 7
    s_add_u32 s27, s27, s3
g1_db6_src:
    s_mov_b32 s43, 0x20000
    s_and_b32 s3, s68, 7
    s_lshl_b32 s3, s3, 8
    s_mul_i32 s21, s3, s26
    v_lshrrev_b32 v4, 3, v250
    s_mul_i32 s3, s101, 64
    v_add_u32 v4, s3, v4
    v_mul_lo_u32 v4, v4, s26
    v_add_u32 v4, s21, v4
    v_and_b32 v5, 7, v250
    v_lshrrev_b32 v6, 4, v250
    v_xor_b32 v5, v5, v6
    v_lshl_add_u32 v246, v5, 4, v4
    v_xor_b32 v5, 4, v5
    v_lshl_add_u32 v247, v5, 4, v4
    s_mul_i32 s44, s26, 0
    s_mul_i32 s45, s26, 8
    s_sub_u32 s45, s45, 1024
    s_mul_i32 s46, s26, 16
    s_sub_u32 s46, s46, 2048
    s_mul_i32 s47, s26, 24
    s_sub_u32 s47, s47, 3072
    s_mul_i32 s48, s26, 32
    s_mul_i32 s49, s26, 40
    s_sub_u32 s49, s49, 1024
    s_mul_i32 s50, s26, 48
    s_sub_u32 s50, s50, 2048
    s_mul_i32 s51, s26, 56
    s_sub_u32 s51, s51, 3072
    s_mov_b32 s62, 128
    v_lshrrev_b32 v4, 3, v250
    v_mul_lo_u32 v4, v4, s30
    v_add_u32 v4, s27, v4
    v_and_b32 v5, 7, v250
    v_bfe_u32 v6, v250, 4, 1
    v_lshlrev_b32 v6, 1, v6
    v_xor_b32 v5, v5, v6
    v_lshl_add_u32 v248, v5, 4, v4
    v_xor_b32 v5, 4, v5
    v_lshl_add_u32 v249, v5, 4, v4
    s_mul_i32 s52, s30, 0
    s_mul_i32 s53, s30, 8
    s_sub_u32 s53, s53, 1024
    s_mul_i32 s54, s30, 16
    s_sub_u32 s54, s54, 2048
    s_mul_i32 s55, s30, 24
    s_sub_u32 s55, s55, 3072
    s_mul_i32 s56, s30, 32
    s_mul_i32 s57, s30, 40
    s_sub_u32 s57, s57, 1024
    s_mul_i32 s58, s30, 48
    s_sub_u32 s58, s58, 2048
    s_mul_i32 s59, s30, 56
    s_sub_u32 s59, s59, 3072
    s_lshl_b32 s63, s30, 6
g1_sp5_done:
    s_branch g1_N_loop
g1_N_epi:
    s_bfe_u32 s5, s67, 0x20008
    s_cmp_eq_u32 s5, 3
    s_cbranch_scc1 g1_epi_gu
    s_bfe_u32 s5, s67, 0x20008
    s_bfe_u32 s6, s67, 0x50003
    s_lshl_b32 s3, s6, 1
    s_add_u32 s3, s3, s66
    s_lshl_b32 s3, s3, 19
    s_and_b32 s7, s67, 7
    s_lshl_b32 s4, s7, 16
    s_add_u32 s3, s3, s4
    s_lshl_b32 s4, s65, 15
    s_add_u32 s3, s3, s4
    v_lshlrev_b32 v251, 4, v250
    v_add_u32 v251, s3, v251
    s_lshl_b32 s4, s5, 24
    s_add_u32 s72, s34, s4
    s_addc_u32 s73, s35, 0
    s_mov_b32 s74, 16777216
    s_mov_b32 s75, 0x20000
    s_lshl_b32 s3, s5, 3
    s_add_u32 s3, s3, s7
    s_lshl_b32 s3, s3, 2
    s_lshl_b32 s4, s6, 7
    s_add_u32 s3, s3, s4
    s_cmp_eq_u32 s101, 0
    s_cselect_b32 s70, s3, s70
    s_cmp_eq_u32 s5, 1
    s_cbranch_scc1 g1_epi_k
    s_mov_b32 s18, 0x3e0293ee
    s_mov_b32 s19, 0x3e0293ee
    v_pk_mul_f32 v[16:17], v[16:17], s[18:19]
    v_pk_mul_f32 v[18:19], v[18:19], s[18:19]
    v_pk_mul_f32 v[48:49], v[48:49], s[18:19]
    v_pk_mul_f32 v[50:51], v[50:51], s[18:19]
    v_cvt_pk_bf16_f32 v0, v16, v17
    v_cvt_pk_bf16_f32 v1, v18, v19
    v_cvt_pk_bf16_f32 v2, v48, v49
    v_cvt_pk_bf16_f32 v3, v50, v51
    s_mov_b32 s3, 0
    buffer_store_dwordx4 v[0:3], v251, s[72:75], s3 offen offset:0 sc1
    v_pk_mul_f32 v[20:21], v[20:21], s[18:19]
    v_pk_mul_f32 v[22:23], v[22:23], s[18:19]
    v_pk_mul_f32 v[52:53], v[52:53], s[18:19]
    v_pk_mul_f32 v[54:55], v[54:55], s[18:19]
    v_cvt_pk_bf16_f32 v4, v20, v21
    v_cvt_pk_bf16_f32 v5, v22, v23
    v_cvt_pk_bf16_f32 v6, v52, v53
    v_cvt_pk_bf16_f32 v7, v54, v55
    s_mov_b32 s3, 4096
    buffer_store_dwordx4 v[4:7], v251, s[72:75], s3 offen offset:0 sc1
    v_pk_mul_f32 v[24:25], v[24:25], s[18:19]
    v_pk_mul_f32 v[26:27], v[26:27], s[18:19]
    v_pk_mul_f32 v[56:57], v[56:57], s[18:19]
    v_pk_mul_f32 v[58:59], v[58:59], s[18:19]
    v_cvt_pk_bf16_f32 v0, v24, v25
    v_cvt_pk_bf16_f32 v1, v26, v27
    v_cvt_pk_bf16_f32 v2, v56, v57
    v_cvt_pk_bf16_f32 v3, v58, v59
    s_mov_b32 s3, 8192
    buffer_store_dwordx4 v[0:3], v251, s[72:75], s3 offen offset:0 sc1
    v_pk_mul_f32 v[28:29], v[28:29], s[18:19]
    v_pk_mul_f32 v[30:31], v[30:31], s[18:19]
    v_pk_mul_f32 v[60:61], v[60:61], s[18:19]
    v_pk_mul_f32 v[62:63], v[62:63], s[18:19]
    v_cvt_pk_bf16_f32 v4, v28, v29
    v_cvt_pk_bf16_f32 v5, v30, v31
    v_cvt_pk_bf16_f32 v6, v60, v61
    v_cvt_pk_bf16_f32 v7, v62, v63
    s_mov_b32 s3, 12288
    buffer_store_dwordx4 v[4:7], v251, s[72:75], s3 offen offset:0 sc1
    v_pk_mul_f32 v[32:33], v[32:33], s[18:19]
    v_pk_mul_f32 v[34:35], v[34:35], s[18:19]
    v_pk_mul_f32 v[64:65], v[64:65], s[18:19]
    v_pk_mul_f32 v[66:67], v[66:67], s[18:19]
    v_cvt_pk_bf16_f32 v0, v32, v33
    v_cvt_pk_bf16_f32 v1, v34, v35
    v_cvt_pk_bf16_f32 v2, v64, v65
    v_cvt_pk_bf16_f32 v3, v66, v67
    s_mov_b32 s3, 16384
    buffer_store_dwordx4 v[0:3], v251, s[72:75], s3 offen offset:0 sc1
    v_pk_mul_f32 v[36:37], v[36:37], s[18:19]
    v_pk_mul_f32 v[38:39], v[38:39], s[18:19]
    v_pk_mul_f32 v[68:69], v[68:69], s[18:19]
    v_pk_mul_f32 v[70:71], v[70:71], s[18:19]
    v_cvt_pk_bf16_f32 v4, v36, v37
    v_cvt_pk_bf16_f32 v5, v38, v39
    v_cvt_pk_bf16_f32 v6, v68, v69
    v_cvt_pk_bf16_f32 v7, v70, v71
    s_mov_b32 s3, 20480
    buffer_store_dwordx4 v[4:7], v251, s[72:75], s3 offen offset:0 sc1
    v_pk_mul_f32 v[40:41], v[40:41], s[18:19]
    v_pk_mul_f32 v[42:43], v[42:43], s[18:19]
    v_pk_mul_f32 v[72:73], v[72:73], s[18:19]
    v_pk_mul_f32 v[74:75], v[74:75], s[18:19]
    v_cvt_pk_bf16_f32 v0, v40, v41
    v_cvt_pk_bf16_f32 v1, v42, v43
    v_cvt_pk_bf16_f32 v2, v72, v73
    v_cvt_pk_bf16_f32 v3, v74, v75
    s_mov_b32 s3, 24576
    buffer_store_dwordx4 v[0:3], v251, s[72:75], s3 offen offset:0 sc1
    v_pk_mul_f32 v[44:45], v[44:45], s[18:19]
    v_pk_mul_f32 v[46:47], v[46:47], s[18:19]
    v_pk_mul_f32 v[76:77], v[76:77], s[18:19]
    v_pk_mul_f32 v[78:79], v[78:79], s[18:19]
    v_cvt_pk_bf16_f32 v4, v44, v45
    v_cvt_pk_bf16_f32 v5, v46, v47
    v_cvt_pk_bf16_f32 v6, v76, v77
    v_cvt_pk_bf16_f32 v7, v78, v79
    s_mov_b32 s3, 28672
    buffer_store_dwordx4 v[4:7], v251, s[72:75], s3 offen offset:0 sc1
    v_pk_mul_f32 v[80:81], v[80:81], s[18:19]
    v_pk_mul_f32 v[82:83], v[82:83], s[18:19]
    v_pk_mul_f32 v[112:113], v[112:113], s[18:19]
    v_pk_mul_f32 v[114:115], v[114:115], s[18:19]
    v_cvt_pk_bf16_f32 v0, v80, v81
    v_cvt_pk_bf16_f32 v1, v82, v83
    v_cvt_pk_bf16_f32 v2, v112, v113
    v_cvt_pk_bf16_f32 v3, v114, v115
    s_mov_b32 s3, 0
    buffer_store_dwordx4 v[0:3], v251, s[72:75], s3 offen offset:1024 sc1
    v_pk_mul_f32 v[84:85], v[84:85], s[18:19]
    v_pk_mul_f32 v[86:87], v[86:87], s[18:19]
    v_pk_mul_f32 v[116:117], v[116:117], s[18:19]
    v_pk_mul_f32 v[118:119], v[118:119], s[18:19]
    v_cvt_pk_bf16_f32 v4, v84, v85
    v_cvt_pk_bf16_f32 v5, v86, v87
    v_cvt_pk_bf16_f32 v6, v116, v117
    v_cvt_pk_bf16_f32 v7, v118, v119
    s_mov_b32 s3, 4096
    buffer_store_dwordx4 v[4:7], v251, s[72:75], s3 offen offset:1024 sc1
    v_pk_mul_f32 v[88:89], v[88:89], s[18:19]
    v_pk_mul_f32 v[90:91], v[90:91], s[18:19]
    v_pk_mul_f32 v[120:121], v[120:121], s[18:19]
    v_pk_mul_f32 v[122:123], v[122:123], s[18:19]
    v_cvt_pk_bf16_f32 v0, v88, v89
    v_cvt_pk_bf16_f32 v1, v90, v91
    v_cvt_pk_bf16_f32 v2, v120, v121
    v_cvt_pk_bf16_f32 v3, v122, v123
    s_mov_b32 s3, 8192
    buffer_store_dwordx4 v[0:3], v251, s[72:75], s3 offen offset:1024 sc1
    v_pk_mul_f32 v[92:93], v[92:93], s[18:19]
    v_pk_mul_f32 v[94:95], v[94:95], s[18:19]
    v_pk_mul_f32 v[124:125], v[124:125], s[18:19]
    v_pk_mul_f32 v[126:127], v[126:127], s[18:19]
    v_cvt_pk_bf16_f32 v4, v92, v93
    v_cvt_pk_bf16_f32 v5, v94, v95
    v_cvt_pk_bf16_f32 v6, v124, v125
    v_cvt_pk_bf16_f32 v7, v126, v127
    s_mov_b32 s3, 12288
    buffer_store_dwordx4 v[4:7], v251, s[72:75], s3 offen offset:1024 sc1
    v_pk_mul_f32 v[96:97], v[96:97], s[18:19]
    v_pk_mul_f32 v[98:99], v[98:99], s[18:19]
    v_pk_mul_f32 v[128:129], v[128:129], s[18:19]
    v_pk_mul_f32 v[130:131], v[130:131], s[18:19]
    v_cvt_pk_bf16_f32 v0, v96, v97
    v_cvt_pk_bf16_f32 v1, v98, v99
    v_cvt_pk_bf16_f32 v2, v128, v129
    v_cvt_pk_bf16_f32 v3, v130, v131
    s_mov_b32 s3, 16384
    buffer_store_dwordx4 v[0:3], v251, s[72:75], s3 offen offset:1024 sc1
    v_pk_mul_f32 v[100:101], v[100:101], s[18:19]
    v_pk_mul_f32 v[102:103], v[102:103], s[18:19]
    v_pk_mul_f32 v[132:133], v[132:133], s[18:19]
    v_pk_mul_f32 v[134:135], v[134:135], s[18:19]
    v_cvt_pk_bf16_f32 v4, v100, v101
    v_cvt_pk_bf16_f32 v5, v102, v103
    v_cvt_pk_bf16_f32 v6, v132, v133
    v_cvt_pk_bf16_f32 v7, v134, v135
    s_mov_b32 s3, 20480
    buffer_store_dwordx4 v[4:7], v251, s[72:75], s3 offen offset:1024 sc1
    v_pk_mul_f32 v[104:105], v[104:105], s[18:19]
    v_pk_mul_f32 v[106:107], v[106:107], s[18:19]
    v_pk_mul_f32 v[136:137], v[136:137], s[18:19]
    v_pk_mul_f32 v[138:139], v[138:139], s[18:19]
    v_cvt_pk_bf16_f32 v0, v104, v105
    v_cvt_pk_bf16_f32 v1, v106, v107
    v_cvt_pk_bf16_f32 v2, v136, v137
    v_cvt_pk_bf16_f32 v3, v138, v139
    s_mov_b32 s3, 24576
    buffer_store_dwordx4 v[0:3], v251, s[72:75], s3 offen offset:1024 sc1
    v_pk_mul_f32 v[108:109], v[108:109], s[18:19]
    v_pk_mul_f32 v[110:111], v[110:111], s[18:19]
    v_pk_mul_f32 v[140:141], v[140:141], s[18:19]
    v_pk_mul_f32 v[142:143], v[142:143], s[18:19]
    v_cvt_pk_bf16_f32 v4, v108, v109
    v_cvt_pk_bf16_f32 v5, v110, v111
    v_cvt_pk_bf16_f32 v6, v140, v141
    v_cvt_pk_bf16_f32 v7, v142, v143
    s_mov_b32 s3, 28672
    buffer_store_dwordx4 v[4:7], v251, s[72:75], s3 offen offset:1024 sc1
    v_pk_mul_f32 v[144:145], v[144:145], s[18:19]
    v_pk_mul_f32 v[146:147], v[146:147], s[18:19]
    v_pk_mul_f32 v[176:177], v[176:177], s[18:19]
    v_pk_mul_f32 v[178:179], v[178:179], s[18:19]
    v_cvt_pk_bf16_f32 v0, v144, v145
    v_cvt_pk_bf16_f32 v1, v146, v147
    v_cvt_pk_bf16_f32 v2, v176, v177
    v_cvt_pk_bf16_f32 v3, v178, v179
    s_mov_b32 s3, 0
    buffer_store_dwordx4 v[0:3], v251, s[72:75], s3 offen offset:2048 sc1
    v_pk_mul_f32 v[148:149], v[148:149], s[18:19]
    v_pk_mul_f32 v[150:151], v[150:151], s[18:19]
    v_pk_mul_f32 v[180:181], v[180:181], s[18:19]
    v_pk_mul_f32 v[182:183], v[182:183], s[18:19]
    v_cvt_pk_bf16_f32 v4, v148, v149
    v_cvt_pk_bf16_f32 v5, v150, v151
    v_cvt_pk_bf16_f32 v6, v180, v181
    v_cvt_pk_bf16_f32 v7, v182, v183
    s_mov_b32 s3, 4096
    buffer_store_dwordx4 v[4:7], v251, s[72:75], s3 offen offset:2048 sc1
    v_pk_mul_f32 v[152:153], v[152:153], s[18:19]
    v_pk_mul_f32 v[154:155], v[154:155], s[18:19]
    v_pk_mul_f32 v[184:185], v[184:185], s[18:19]
    v_pk_mul_f32 v[186:187], v[186:187], s[18:19]
    v_cvt_pk_bf16_f32 v0, v152, v153
    v_cvt_pk_bf16_f32 v1, v154, v155
    v_cvt_pk_bf16_f32 v2, v184, v185
    v_cvt_pk_bf16_f32 v3, v186, v187
    s_mov_b32 s3, 8192
    buffer_store_dwordx4 v[0:3], v251, s[72:75], s3 offen offset:2048 sc1
    v_pk_mul_f32 v[156:157], v[156:157], s[18:19]
    v_pk_mul_f32 v[158:159], v[158:159], s[18:19]
    v_pk_mul_f32 v[188:189], v[188:189], s[18:19]
    v_pk_mul_f32 v[190:191], v[190:191], s[18:19]
    v_cvt_pk_bf16_f32 v4, v156, v157
    v_cvt_pk_bf16_f32 v5, v158, v159
    v_cvt_pk_bf16_f32 v6, v188, v189
    v_cvt_pk_bf16_f32 v7, v190, v191
    s_mov_b32 s3, 12288
    buffer_store_dwordx4 v[4:7], v251, s[72:75], s3 offen offset:2048 sc1
    v_pk_mul_f32 v[160:161], v[160:161], s[18:19]
    v_pk_mul_f32 v[162:163], v[162:163], s[18:19]
    v_pk_mul_f32 v[192:193], v[192:193], s[18:19]
    v_pk_mul_f32 v[194:195], v[194:195], s[18:19]
    v_cvt_pk_bf16_f32 v0, v160, v161
    v_cvt_pk_bf16_f32 v1, v162, v163
    v_cvt_pk_bf16_f32 v2, v192, v193
    v_cvt_pk_bf16_f32 v3, v194, v195
    s_mov_b32 s3, 16384
    buffer_store_dwordx4 v[0:3], v251, s[72:75], s3 offen offset:2048 sc1
    v_pk_mul_f32 v[164:165], v[164:165], s[18:19]
    v_pk_mul_f32 v[166:167], v[166:167], s[18:19]
    v_pk_mul_f32 v[196:197], v[196:197], s[18:19]
    v_pk_mul_f32 v[198:199], v[198:199], s[18:19]
    v_cvt_pk_bf16_f32 v4, v164, v165
    v_cvt_pk_bf16_f32 v5, v166, v167
    v_cvt_pk_bf16_f32 v6, v196, v197
    v_cvt_pk_bf16_f32 v7, v198, v199
    s_mov_b32 s3, 20480
    buffer_store_dwordx4 v[4:7], v251, s[72:75], s3 offen offset:2048 sc1
    v_pk_mul_f32 v[168:169], v[168:169], s[18:19]
    v_pk_mul_f32 v[170:171], v[170:171], s[18:19]
    v_pk_mul_f32 v[200:201], v[200:201], s[18:19]
    v_pk_mul_f32 v[202:203], v[202:203], s[18:19]
    v_cvt_pk_bf16_f32 v0, v168, v169
    v_cvt_pk_bf16_f32 v1, v170, v171
    v_cvt_pk_bf16_f32 v2, v200, v201
    v_cvt_pk_bf16_f32 v3, v202, v203
    s_mov_b32 s3, 24576
    buffer_store_dwordx4 v[0:3], v251, s[72:75], s3 offen offset:2048 sc1
    v_pk_mul_f32 v[172:173], v[172:173], s[18:19]
    v_pk_mul_f32 v[174:175], v[174:175], s[18:19]
    v_pk_mul_f32 v[204:205], v[204:205], s[18:19]
    v_pk_mul_f32 v[206:207], v[206:207], s[18:19]
    v_cvt_pk_bf16_f32 v4, v172, v173
    v_cvt_pk_bf16_f32 v5, v174, v175
    v_cvt_pk_bf16_f32 v6, v204, v205
    v_cvt_pk_bf16_f32 v7, v206, v207
    s_mov_b32 s3, 28672
    buffer_store_dwordx4 v[4:7], v251, s[72:75], s3 offen offset:2048 sc1
    v_accvgpr_read_b32 v12, a208
    v_accvgpr_read_b32 v13, a209
    v_accvgpr_read_b32 v14, a210
    v_accvgpr_read_b32 v15, a211
    v_pk_mul_f32 v[208:209], v[208:209], s[18:19]
    v_pk_mul_f32 v[210:211], v[210:211], s[18:19]
    v_pk_mul_f32 v[12:13], v[12:13], s[18:19]
    v_pk_mul_f32 v[14:15], v[14:15], s[18:19]
    v_cvt_pk_bf16_f32 v0, v208, v209
    v_cvt_pk_bf16_f32 v1, v210, v211
    v_cvt_pk_bf16_f32 v2, v12, v13
    v_cvt_pk_bf16_f32 v3, v14, v15
    s_mov_b32 s3, 0
    buffer_store_dwordx4 v[0:3], v251, s[72:75], s3 offen offset:3072 sc1
    v_accvgpr_read_b32 v12, a212
    v_accvgpr_read_b32 v13, a213
    v_accvgpr_read_b32 v14, a214
    v_accvgpr_read_b32 v15, a215
    v_pk_mul_f32 v[212:213], v[212:213], s[18:19]
    v_pk_mul_f32 v[214:215], v[214:215], s[18:19]
    v_pk_mul_f32 v[12:13], v[12:13], s[18:19]
    v_pk_mul_f32 v[14:15], v[14:15], s[18:19]
    v_cvt_pk_bf16_f32 v4, v212, v213
    v_cvt_pk_bf16_f32 v5, v214, v215
    v_cvt_pk_bf16_f32 v6, v12, v13
    v_cvt_pk_bf16_f32 v7, v14, v15
    s_mov_b32 s3, 4096
    buffer_store_dwordx4 v[4:7], v251, s[72:75], s3 offen offset:3072 sc1
    v_accvgpr_read_b32 v12, a216
    v_accvgpr_read_b32 v13, a217
    v_accvgpr_read_b32 v14, a218
    v_accvgpr_read_b32 v15, a219
    v_pk_mul_f32 v[216:217], v[216:217], s[18:19]
    v_pk_mul_f32 v[218:219], v[218:219], s[18:19]
    v_pk_mul_f32 v[12:13], v[12:13], s[18:19]
    v_pk_mul_f32 v[14:15], v[14:15], s[18:19]
    v_cvt_pk_bf16_f32 v0, v216, v217
    v_cvt_pk_bf16_f32 v1, v218, v219
    v_cvt_pk_bf16_f32 v2, v12, v13
    v_cvt_pk_bf16_f32 v3, v14, v15
    s_mov_b32 s3, 8192
    buffer_store_dwordx4 v[0:3], v251, s[72:75], s3 offen offset:3072 sc1
    v_accvgpr_read_b32 v12, a220
    v_accvgpr_read_b32 v13, a221
    v_accvgpr_read_b32 v14, a222
    v_accvgpr_read_b32 v15, a223
    v_pk_mul_f32 v[220:221], v[220:221], s[18:19]
    v_pk_mul_f32 v[222:223], v[222:223], s[18:19]
    v_pk_mul_f32 v[12:13], v[12:13], s[18:19]
    v_pk_mul_f32 v[14:15], v[14:15], s[18:19]
    v_cvt_pk_bf16_f32 v4, v220, v221
    v_cvt_pk_bf16_f32 v5, v222, v223
    v_cvt_pk_bf16_f32 v6, v12, v13
    v_cvt_pk_bf16_f32 v7, v14, v15
    s_mov_b32 s3, 12288
    buffer_store_dwordx4 v[4:7], v251, s[72:75], s3 offen offset:3072 sc1
    v_accvgpr_read_b32 v12, a224
    v_accvgpr_read_b32 v13, a225
    v_accvgpr_read_b32 v14, a226
    v_accvgpr_read_b32 v15, a227
    v_pk_mul_f32 v[224:225], v[224:225], s[18:19]
    v_pk_mul_f32 v[226:227], v[226:227], s[18:19]
    v_pk_mul_f32 v[12:13], v[12:13], s[18:19]
    v_pk_mul_f32 v[14:15], v[14:15], s[18:19]
    v_cvt_pk_bf16_f32 v0, v224, v225
    v_cvt_pk_bf16_f32 v1, v226, v227
    v_cvt_pk_bf16_f32 v2, v12, v13
    v_cvt_pk_bf16_f32 v3, v14, v15
    s_mov_b32 s3, 16384
    buffer_store_dwordx4 v[0:3], v251, s[72:75], s3 offen offset:3072 sc1
    v_accvgpr_read_b32 v12, a228
    v_accvgpr_read_b32 v13, a229
    v_accvgpr_read_b32 v14, a230
    v_accvgpr_read_b32 v15, a231
    v_pk_mul_f32 v[228:229], v[228:229], s[18:19]
    v_pk_mul_f32 v[230:231], v[230:231], s[18:19]
    v_pk_mul_f32 v[12:13], v[12:13], s[18:19]
    v_pk_mul_f32 v[14:15], v[14:15], s[18:19]
    v_cvt_pk_bf16_f32 v4, v228, v229
    v_cvt_pk_bf16_f32 v5, v230, v231
    v_cvt_pk_bf16_f32 v6, v12, v13
    v_cvt_pk_bf16_f32 v7, v14, v15
    s_mov_b32 s3, 20480
    buffer_store_dwordx4 v[4:7], v251, s[72:75], s3 offen offset:3072 sc1
    v_accvgpr_read_b32 v12, a232
    v_accvgpr_read_b32 v13, a233
    v_accvgpr_read_b32 v14, a234
    v_accvgpr_read_b32 v15, a235
    v_pk_mul_f32 v[232:233], v[232:233], s[18:19]
    v_pk_mul_f32 v[234:235], v[234:235], s[18:19]
    v_pk_mul_f32 v[12:13], v[12:13], s[18:19]
    v_pk_mul_f32 v[14:15], v[14:15], s[18:19]
    v_cvt_pk_bf16_f32 v0, v232, v233
    v_cvt_pk_bf16_f32 v1, v234, v235
    v_cvt_pk_bf16_f32 v2, v12, v13
    v_cvt_pk_bf16_f32 v3, v14, v15
    s_mov_b32 s3, 24576
    buffer_store_dwordx4 v[0:3], v251, s[72:75], s3 offen offset:3072 sc1
    v_accvgpr_read_b32 v12, a236
    v_accvgpr_read_b32 v13, a237
    v_accvgpr_read_b32 v14, a238
    v_accvgpr_read_b32 v15, a239
    v_pk_mul_f32 v[236:237], v[236:237], s[18:19]
    v_pk_mul_f32 v[238:239], v[238:239], s[18:19]
    v_pk_mul_f32 v[12:13], v[12:13], s[18:19]
    v_pk_mul_f32 v[14:15], v[14:15], s[18:19]
    v_cvt_pk_bf16_f32 v4, v236, v237
    v_cvt_pk_bf16_f32 v5, v238, v239
    v_cvt_pk_bf16_f32 v6, v12, v13
    v_cvt_pk_bf16_f32 v7, v14, v15
    s_mov_b32 s3, 28672
    buffer_store_dwordx4 v[4:7], v251, s[72:75], s3 offen offset:3072 sc1
    s_branch g1_next
g1_epi_k:
    v_cvt_pk_bf16_f32 v0, v16, v17
    v_cvt_pk_bf16_f32 v1, v18, v19
    v_cvt_pk_bf16_f32 v2, v48, v49
    v_cvt_pk_bf16_f32 v3, v50, v51
    s_mov_b32 s3, 0
    buffer_store_dwordx4 v[0:3], v251, s[72:75], s3 offen offset:0 sc1
    v_cvt_pk_bf16_f32 v4, v20, v21
    v_cvt_pk_bf16_f32 v5, v22, v23
    v_cvt_pk_bf16_f32 v6, v52, v53
    v_cvt_pk_bf16_f32 v7, v54, v55
    s_mov_b32 s3, 4096
    buffer_store_dwordx4 v[4:7], v251, s[72:75], s3 offen offset:0 sc1
    v_cvt_pk_bf16_f32 v0, v24, v25
    v_cvt_pk_bf16_f32 v1, v26, v27
    v_cvt_pk_bf16_f32 v2, v56, v57
    v_cvt_pk_bf16_f32 v3, v58, v59
    s_mov_b32 s3, 8192
    buffer_store_dwordx4 v[0:3], v251, s[72:75], s3 offen offset:0 sc1
    v_cvt_pk_bf16_f32 v4, v28, v29
    v_cvt_pk_bf16_f32 v5, v30, v31
    v_cvt_pk_bf16_f32 v6, v60, v61
    v_cvt_pk_bf16_f32 v7, v62, v63
    s_mov_b32 s3, 12288
    buffer_store_dwordx4 v[4:7], v251, s[72:75], s3 offen offset:0 sc1
    v_cvt_pk_bf16_f32 v0, v32, v33
    v_cvt_pk_bf16_f32 v1, v34, v35
    v_cvt_pk_bf16_f32 v2, v64, v65
    v_cvt_pk_bf16_f32 v3, v66, v67
    s_mov_b32 s3, 16384
    buffer_store_dwordx4 v[0:3], v251, s[72:75], s3 offen offset:0 sc1
    v_cvt_pk_bf16_f32 v4, v36, v37
    v_cvt_pk_bf16_f32 v5, v38, v39
    v_cvt_pk_bf16_f32 v6, v68, v69
    v_cvt_pk_bf16_f32 v7, v70, v71
    s_mov_b32 s3, 20480
    buffer_store_dwordx4 v[4:7], v251, s[72:75], s3 offen offset:0 sc1
    v_cvt_pk_bf16_f32 v0, v40, v41
    v_cvt_pk_bf16_f32 v1, v42, v43
    v_cvt_pk_bf16_f32 v2, v72, v73
    v_cvt_pk_bf16_f32 v3, v74, v75
    s_mov_b32 s3, 24576
    buffer_store_dwordx4 v[0:3], v251, s[72:75], s3 offen offset:0 sc1
    v_cvt_pk_bf16_f32 v4, v44, v45
    v_cvt_pk_bf16_f32 v5, v46, v47
    v_cvt_pk_bf16_f32 v6, v76, v77
    v_cvt_pk_bf16_f32 v7, v78, v79
    s_mov_b32 s3, 28672
    buffer_store_dwordx4 v[4:7], v251, s[72:75], s3 offen offset:0 sc1
    v_cvt_pk_bf16_f32 v0, v80, v81
    v_cvt_pk_bf16_f32 v1, v82, v83
    v_cvt_pk_bf16_f32 v2, v112, v113
    v_cvt_pk_bf16_f32 v3, v114, v115
    s_mov_b32 s3, 0
    buffer_store_dwordx4 v[0:3], v251, s[72:75], s3 offen offset:1024 sc1
    v_cvt_pk_bf16_f32 v4, v84, v85
    v_cvt_pk_bf16_f32 v5, v86, v87
    v_cvt_pk_bf16_f32 v6, v116, v117
    v_cvt_pk_bf16_f32 v7, v118, v119
    s_mov_b32 s3, 4096
    buffer_store_dwordx4 v[4:7], v251, s[72:75], s3 offen offset:1024 sc1
    v_cvt_pk_bf16_f32 v0, v88, v89
    v_cvt_pk_bf16_f32 v1, v90, v91
    v_cvt_pk_bf16_f32 v2, v120, v121
    v_cvt_pk_bf16_f32 v3, v122, v123
    s_mov_b32 s3, 8192
    buffer_store_dwordx4 v[0:3], v251, s[72:75], s3 offen offset:1024 sc1
    v_cvt_pk_bf16_f32 v4, v92, v93
    v_cvt_pk_bf16_f32 v5, v94, v95
    v_cvt_pk_bf16_f32 v6, v124, v125
    v_cvt_pk_bf16_f32 v7, v126, v127
    s_mov_b32 s3, 12288
    buffer_store_dwordx4 v[4:7], v251, s[72:75], s3 offen offset:1024 sc1
    v_cvt_pk_bf16_f32 v0, v96, v97
    v_cvt_pk_bf16_f32 v1, v98, v99
    v_cvt_pk_bf16_f32 v2, v128, v129
    v_cvt_pk_bf16_f32 v3, v130, v131
    s_mov_b32 s3, 16384
    buffer_store_dwordx4 v[0:3], v251, s[72:75], s3 offen offset:1024 sc1
    v_cvt_pk_bf16_f32 v4, v100, v101
    v_cvt_pk_bf16_f32 v5, v102, v103
    v_cvt_pk_bf16_f32 v6, v132, v133
    v_cvt_pk_bf16_f32 v7, v134, v135
    s_mov_b32 s3, 20480
    buffer_store_dwordx4 v[4:7], v251, s[72:75], s3 offen offset:1024 sc1
    v_cvt_pk_bf16_f32 v0, v104, v105
    v_cvt_pk_bf16_f32 v1, v106, v107
    v_cvt_pk_bf16_f32 v2, v136, v137
    v_cvt_pk_bf16_f32 v3, v138, v139
    s_mov_b32 s3, 24576
    buffer_store_dwordx4 v[0:3], v251, s[72:75], s3 offen offset:1024 sc1
    v_cvt_pk_bf16_f32 v4, v108, v109
    v_cvt_pk_bf16_f32 v5, v110, v111
    v_cvt_pk_bf16_f32 v6, v140, v141
    v_cvt_pk_bf16_f32 v7, v142, v143
    s_mov_b32 s3, 28672
    buffer_store_dwordx4 v[4:7], v251, s[72:75], s3 offen offset:1024 sc1
    v_cvt_pk_bf16_f32 v0, v144, v145
    v_cvt_pk_bf16_f32 v1, v146, v147
    v_cvt_pk_bf16_f32 v2, v176, v177
    v_cvt_pk_bf16_f32 v3, v178, v179
    s_mov_b32 s3, 0
    buffer_store_dwordx4 v[0:3], v251, s[72:75], s3 offen offset:2048 sc1
    v_cvt_pk_bf16_f32 v4, v148, v149
    v_cvt_pk_bf16_f32 v5, v150, v151
    v_cvt_pk_bf16_f32 v6, v180, v181
    v_cvt_pk_bf16_f32 v7, v182, v183
    s_mov_b32 s3, 4096
    buffer_store_dwordx4 v[4:7], v251, s[72:75], s3 offen offset:2048 sc1
    v_cvt_pk_bf16_f32 v0, v152, v153
    v_cvt_pk_bf16_f32 v1, v154, v155
    v_cvt_pk_bf16_f32 v2, v184, v185
    v_cvt_pk_bf16_f32 v3, v186, v187
    s_mov_b32 s3, 8192
    buffer_store_dwordx4 v[0:3], v251, s[72:75], s3 offen offset:2048 sc1
    v_cvt_pk_bf16_f32 v4, v156, v157
    v_cvt_pk_bf16_f32 v5, v158, v159
    v_cvt_pk_bf16_f32 v6, v188, v189
    v_cvt_pk_bf16_f32 v7, v190, v191
    s_mov_b32 s3, 12288
    buffer_store_dwordx4 v[4:7], v251, s[72:75], s3 offen offset:2048 sc1
    v_cvt_pk_bf16_f32 v0, v160, v161
    v_cvt_pk_bf16_f32 v1, v162, v163
    v_cvt_pk_bf16_f32 v2, v192, v193
    v_cvt_pk_bf16_f32 v3, v194, v195
    s_mov_b32 s3, 16384
    buffer_store_dwordx4 v[0:3], v251, s[72:75], s3 offen offset:2048 sc1
    v_cvt_pk_bf16_f32 v4, v164, v165
    v_cvt_pk_bf16_f32 v5, v166, v167
    v_cvt_pk_bf16_f32 v6, v196, v197
    v_cvt_pk_bf16_f32 v7, v198, v199
    s_mov_b32 s3, 20480
    buffer_store_dwordx4 v[4:7], v251, s[72:75], s3 offen offset:2048 sc1
    v_cvt_pk_bf16_f32 v0, v168, v169
    v_cvt_pk_bf16_f32 v1, v170, v171
    v_cvt_pk_bf16_f32 v2, v200, v201
    v_cvt_pk_bf16_f32 v3, v202, v203
    s_mov_b32 s3, 24576
    buffer_store_dwordx4 v[0:3], v251, s[72:75], s3 offen offset:2048 sc1
    v_cvt_pk_bf16_f32 v4, v172, v173
    v_cvt_pk_bf16_f32 v5, v174, v175
    v_cvt_pk_bf16_f32 v6, v204, v205
    v_cvt_pk_bf16_f32 v7, v206, v207
    s_mov_b32 s3, 28672
    buffer_store_dwordx4 v[4:7], v251, s[72:75], s3 offen offset:2048 sc1
    v_accvgpr_read_b32 v12, a208
    v_accvgpr_read_b32 v13, a209
    v_accvgpr_read_b32 v14, a210
    v_accvgpr_read_b32 v15, a211
    v_cvt_pk_bf16_f32 v0, v208, v209
    v_cvt_pk_bf16_f32 v1, v210, v211
    v_cvt_pk_bf16_f32 v2, v12, v13
    v_cvt_pk_bf16_f32 v3, v14, v15
    s_mov_b32 s3, 0
    buffer_store_dwordx4 v[0:3], v251, s[72:75], s3 offen offset:3072 sc1
    v_accvgpr_read_b32 v12, a212
    v_accvgpr_read_b32 v13, a213
    v_accvgpr_read_b32 v14, a214
    v_accvgpr_read_b32 v15, a215
    v_cvt_pk_bf16_f32 v4, v212, v213
    v_cvt_pk_bf16_f32 v5, v214, v215
    v_cvt_pk_bf16_f32 v6, v12, v13
    v_cvt_pk_bf16_f32 v7, v14, v15
    s_mov_b32 s3, 4096
    buffer_store_dwordx4 v[4:7], v251, s[72:75], s3 offen offset:3072 sc1
    v_accvgpr_read_b32 v12, a216
    v_accvgpr_read_b32 v13, a217
    v_accvgpr_read_b32 v14, a218
    v_accvgpr_read_b32 v15, a219
    v_cvt_pk_bf16_f32 v0, v216, v217
    v_cvt_pk_bf16_f32 v1, v218, v219
    v_cvt_pk_bf16_f32 v2, v12, v13
    v_cvt_pk_bf16_f32 v3, v14, v15
    s_mov_b32 s3, 8192
    buffer_store_dwordx4 v[0:3], v251, s[72:75], s3 offen offset:3072 sc1
    v_accvgpr_read_b32 v12, a220
    v_accvgpr_read_b32 v13, a221
    v_accvgpr_read_b32 v14, a222
    v_accvgpr_read_b32 v15, a223
    v_cvt_pk_bf16_f32 v4, v220, v221
    v_cvt_pk_bf16_f32 v5, v222, v223
    v_cvt_pk_bf16_f32 v6, v12, v13
    v_cvt_pk_bf16_f32 v7, v14, v15
    s_mov_b32 s3, 12288
    buffer_store_dwordx4 v[4:7], v251, s[72:75], s3 offen offset:3072 sc1
    v_accvgpr_read_b32 v12, a224
    v_accvgpr_read_b32 v13, a225
    v_accvgpr_read_b32 v14, a226
    v_accvgpr_read_b32 v15, a227
    v_cvt_pk_bf16_f32 v0, v224, v225
    v_cvt_pk_bf16_f32 v1, v226, v227
    v_cvt_pk_bf16_f32 v2, v12, v13
    v_cvt_pk_bf16_f32 v3, v14, v15
    s_mov_b32 s3, 16384
    buffer_store_dwordx4 v[0:3], v251, s[72:75], s3 offen offset:3072 sc1
    v_accvgpr_read_b32 v12, a228
    v_accvgpr_read_b32 v13, a229
    v_accvgpr_read_b32 v14, a230
    v_accvgpr_read_b32 v15, a231
    v_cvt_pk_bf16_f32 v4, v228, v229
    v_cvt_pk_bf16_f32 v5, v230, v231
    v_cvt_pk_bf16_f32 v6, v12, v13
    v_cvt_pk_bf16_f32 v7, v14, v15
    s_mov_b32 s3, 20480
    buffer_store_dwordx4 v[4:7], v251, s[72:75], s3 offen offset:3072 sc1
    v_accvgpr_read_b32 v12, a232
    v_accvgpr_read_b32 v13, a233
    v_accvgpr_read_b32 v14, a234
    v_accvgpr_read_b32 v15, a235
    v_cvt_pk_bf16_f32 v0, v232, v233
    v_cvt_pk_bf16_f32 v1, v234, v235
    v_cvt_pk_bf16_f32 v2, v12, v13
    v_cvt_pk_bf16_f32 v3, v14, v15
    s_mov_b32 s3, 24576
    buffer_store_dwordx4 v[0:3], v251, s[72:75], s3 offen offset:3072 sc1
    v_accvgpr_read_b32 v12, a236
    v_accvgpr_read_b32 v13, a237
    v_accvgpr_read_b32 v14, a238
    v_accvgpr_read_b32 v15, a239
    v_cvt_pk_bf16_f32 v4, v236, v237
    v_cvt_pk_bf16_f32 v5, v238, v239
    v_cvt_pk_bf16_f32 v6, v12, v13
    v_cvt_pk_bf16_f32 v7, v14, v15
    s_mov_b32 s3, 28672
    buffer_store_dwordx4 v[4:7], v251, s[72:75], s3 offen offset:3072 sc1
    s_branch g1_next
g1_epi_gu:
    s_waitcnt vmcnt(0) lgkmcnt(0)
    s_barrier
    v_accvgpr_read_b32 v0, a240
    v_cmp_eq_u32 vcc, 0, v0
    s_or_b32 vcc_lo, vcc_lo, vcc_hi
    s_and_b32 vcc_lo, vcc_lo, 0xffffff
    s_cbranch_scc0 g1_wq2_ok
    v_lshlrev_b32 v2, 2, v250
    s_mov_b32 s3, 0
g1_wq2:
    buffer_load_dword v0, v2, s[80:83], s90 offen sc1
    s_waitcnt vmcnt(0)
    v_cmp_eq_u32 vcc, 0, v0
    s_mov_b32 s4, 16777215
    s_mov_b32 s5, 16777215
    s_and_b64 vcc, vcc, s[4:5]
    s_cbranch_scc0 g1_wq2_ok
    s_sleep 8
    s_add_u32 s3, s3, 1
    s_cmp_lt_u32 s3, 100000
    s_cbranch_scc1 g1_wq2
g1_wq2_ok:
    s_add_u32 s36, s34, 16777216
    s_addc_u32 s37, s35, 0
    s_mov_b32 s38, 16777216
    s_mov_b32 s39, 0x20000
    s_add_u32 s40, s34, 33554432
    s_addc_u32 s41, s35, 0
    s_mov_b32 s42, 16777216
    s_mov_b32 s43, 0x20000
    s_mov_b32 s76, s34
    s_mov_b32 s77, s35
    s_mov_b32 s78, 16777216
    s_mov_b32 s79, 0x20000
    s_lshr_b32 s4, s2, 3
    s_mov_b32 s5, 0
    s_cmp_eq_u32 s4, 0
    s_cselect_b32 s5, 8270, s5
    s_cmp_eq_u32 s4, 1
    s_cselect_b32 s5, 10334, s5
    s_cmp_eq_u32 s4, 2
    s_cselect_b32 s5, 12398, s5
    s_cmp_eq_u32 s4, 3
    s_cselect_b32 s5, 14462, s5
    s_cmp_eq_u32 s4, 4
    s_cselect_b32 s5, 8397, s5
    s_cmp_eq_u32 s4, 5
    s_cselect_b32 s5, 10461, s5
    s_cmp_eq_u32 s4, 6
    s_cselect_b32 s5, 12525, s5
    s_cmp_eq_u32 s4, 7
    s_cselect_b32 s5, 14589, s5
    s_cmp_eq_u32 s4, 8
    s_cselect_b32 s5, 8524, s5
    s_cmp_eq_u32 s4, 9
    s_cselect_b32 s5, 10588, s5
    s_cmp_eq_u32 s4, 10
    s_cselect_b32 s5, 12652, s5
    s_cmp_eq_u32 s4, 11
    s_cselect_b32 s5, 14716, s5
    s_cmp_eq_u32 s4, 12
    s_cselect_b32 s5, 8651, s5
    s_cmp_eq_u32 s4, 13
    s_cselect_b32 s5, 10715, s5
    s_cmp_eq_u32 s4, 14
    s_cselect_b32 s5, 12779, s5
    s_cmp_eq_u32 s4, 15
    s_cselect_b32 s5, 14843, s5
    s_cmp_eq_u32 s4, 16
    s_cselect_b32 s5, 8778, s5
    s_cmp_eq_u32 s4, 17
    s_cselect_b32 s5, 10842, s5
    s_cmp_eq_u32 s4, 18
    s_cselect_b32 s5, 12906, s5
    s_cmp_eq_u32 s4, 19
    s_cselect_b32 s5, 14970, s5
    s_cmp_eq_u32 s4, 20
    s_cselect_b32 s5, 8905, s5
    s_cmp_eq_u32 s4, 21
    s_cselect_b32 s5, 10969, s5
    s_cmp_eq_u32 s4, 22
    s_cselect_b32 s5, 13033, s5
    s_cmp_eq_u32 s4, 23
    s_cselect_b32 s5, 15097, s5
    s_cmp_eq_u32 s4, 24
    s_cselect_b32 s5, 9032, s5
    s_cmp_eq_u32 s4, 25
    s_cselect_b32 s5, 11096, s5
    s_cmp_eq_u32 s4, 26
    s_cselect_b32 s5, 13160, s5
    s_cmp_eq_u32 s4, 27
    s_cselect_b32 s5, 15224, s5
    s_cmp_eq_u32 s4, 28
    s_cselect_b32 s5, 9167, s5
    s_cmp_eq_u32 s4, 29
    s_cselect_b32 s5, 11231, s5
    s_cmp_eq_u32 s4, 30
    s_cselect_b32 s5, 13295, s5
    s_cmp_eq_u32 s4, 31
    s_cselect_b32 s5, 15359, s5
    s_and_b32 s3, s2, 7
    s_lshl_b32 s3, s3, 2
    s_bfe_u32 s4, s5, 0x20004
    s_add_u32 s3, s3, s4
    s_lshl_b32 s3, s3, 19
    s_and_b32 s5, s5, 15
    s_lshl_b32 s6, s101, 13
    v_lshlrev_b32 v0, 4, v250
    s_lshl_b32 s5, s5, 15
    s_and_b32 s7, s101, 1
    s_lshl_b32 s7, s7, 14
    s_add_u32 s5, s5, s7
    s_add_u32 s5, s5, s3
    v_add_u32 v1, s5, v0
    s_add_u32 s3, s3, s6
    v_add_u32 v0, s3, v0
    s_add_u32 m0, s6, 0
    s_mov_b32 s7, 0
    buffer_load_dwordx4 v0, s[36:39], s7 offen offset:0 lds
    buffer_load_dwordx4 v0, s[36:39], s7 offen offset:1024 lds
    buffer_load_dwordx4 v0, s[36:39], s7 offen offset:2048 lds
    buffer_load_dwordx4 v0, s[36:39], s7 offen offset:3072 lds
    s_add_u32 m0, s6, 4096
    s_mov_b32 s7, 4096
    buffer_load_dwordx4 v0, s[36:39], s7 offen offset:0 lds
    buffer_load_dwordx4 v0, s[36:39], s7 offen offset:1024 lds
    buffer_load_dwordx4 v0, s[36:39], s7 offen offset:2048 lds
    buffer_load_dwordx4 v0, s[36:39], s7 offen offset:3072 lds
    s_mov_b32 s7, 0
    buffer_load_dwordx4 a[144:147], v1, s[76:79], s7 offen offset:0
    buffer_load_dwordx4 a[148:151], v1, s[76:79], s7 offen offset:1024
    buffer_load_dwordx4 a[152:155], v1, s[76:79], s7 offen offset:2048
    buffer_load_dwordx4 a[156:159], v1, s[76:79], s7 offen offset:3072
    s_mov_b32 s7, 4096
    buffer_load_dwordx4 a[160:163], v1, s[76:79], s7 offen offset:0
    buffer_load_dwordx4 a[164:167], v1, s[76:79], s7 offen offset:1024
    buffer_load_dwordx4 a[168:171], v1, s[76:79], s7 offen offset:2048
    buffer_load_dwordx4 a[172:175], v1, s[76:79], s7 offen offset:3072
    s_mov_b32 s7, 8192
    buffer_load_dwordx4 a[176:179], v1, s[76:79], s7 offen offset:0
    buffer_load_dwordx4 a[180:183], v1, s[76:79], s7 offen offset:1024
    buffer_load_dwordx4 a[184:187], v1, s[76:79], s7 offen offset:2048
    buffer_load_dwordx4 a[188:191], v1, s[76:79], s7 offen offset:3072
    s_mov_b32 s7, 12288
    buffer_load_dwordx4 a[192:195], v1, s[76:79], s7 offen offset:0
    buffer_load_dwordx4 a[196:199], v1, s[76:79], s7 offen offset:1024
    buffer_load_dwordx4 a[200:203], v1, s[76:79], s7 offen offset:2048
    buffer_load_dwordx4 a[204:207], v1, s[76:79], s7 offen offset:3072
    s_add_u32 m0, s6, 65536
    s_mov_b32 s7, 0
    buffer_load_dwordx4 v0, s[40:43], s7 offen offset:0 lds
    buffer_load_dwordx4 v0, s[40:43], s7 offen offset:1024 lds
    buffer_load_dwordx4 v0, s[40:43], s7 offen offset:2048 lds
    buffer_load_dwordx4 v0, s[40:43], s7 offen offset:3072 lds
    s_add_u32 m0, s6, 69632
    s_mov_b32 s7, 4096
    buffer_load_dwordx4 v0, s[40:43], s7 offen offset:0 lds
    buffer_load_dwordx4 v0, s[40:43], s7 offen offset:1024 lds
    buffer_load_dwordx4 v0, s[40:43], s7 offen offset:2048 lds
    buffer_load_dwordx4 v0, s[40:43], s7 offen offset:3072 lds
    s_add_u32 m0, s6, 32768
    s_mov_b32 s7, 32768
    buffer_load_dwordx4 v0, s[36:39], s7 offen offset:0 lds
    buffer_load_dwordx4 v0, s[36:39], s7 offen offset:1024 lds
    buffer_load_dwordx4 v0, s[36:39], s7 offen offset:2048 lds
    buffer_load_dwordx4 v0, s[36:39], s7 offen offset:3072 lds
    s_add_u32 m0, s6, 36864
    s_mov_b32 s7, 36864
    buffer_load_dwordx4 v0, s[36:39], s7 offen offset:0 lds
    buffer_load_dwordx4 v0, s[36:39], s7 offen offset:1024 lds
    buffer_load_dwordx4 v0, s[36:39], s7 offen offset:2048 lds
    buffer_load_dwordx4 v0, s[36:39], s7 offen offset:3072 lds
    s_bfe_u32 s5, s67, 0x20008
    s_bfe_u32 s6, s67, 0x50003
    s_and_b32 s7, s67, 7
    s_lshl_b32 s3, s7, 4
    s_lshl_b32 s4, s65, 3
    s_add_u32 s3, s3, s4
    s_mul_i32 s3, s3, 245760
    s_lshl_b32 s4, s6, 12
    s_add_u32 s3, s3, s4
    s_lshl_b32 s4, s66, 11
    s_add_u32 s3, s3, s4
    v_lshlrev_b32 v251, 4, v250
    v_add_u32 v251, s3, v251
    s_add_u32 s72, s34, 50331648
    s_addc_u32 s73, s35, 0
    s_mov_b32 s74, 31457280
    s_mov_b32 s75, 0x20000
    s_lshl_b32 s3, s6, 2
    s_lshl_b32 s4, s7, 7
    s_add_u32 s3, s3, s4
    s_add_u32 s3, s3, 2048
    s_cmp_eq_u32 s101, 0
    s_cselect_b32 s70, s3, s70
    s_mov_b32 s18, 0xbdd2d3e8
    s_mov_b32 s19, 0xbdd2d3e8
    v_pk_mul_f32 v[8:9], v[16:17], v[16:17]
    v_pk_mul_f32 v[10:11], v[18:19], v[18:19]
    v_pk_mul_f32 v[12:13], v[48:49], v[48:49]
    v_pk_mul_f32 v[14:15], v[50:51], v[50:51]
    v_pk_fma_f32 v[8:9], v[8:9], s[18:19], v[252:253]
    v_pk_fma_f32 v[10:11], v[10:11], s[18:19], v[252:253]
    v_pk_fma_f32 v[12:13], v[12:13], s[18:19], v[252:253]
    v_pk_fma_f32 v[14:15], v[14:15], s[18:19], v[252:253]
    v_pk_mul_f32 v[8:9], v[8:9], v[16:17]
    v_pk_mul_f32 v[10:11], v[10:11], v[18:19]
    v_pk_mul_f32 v[12:13], v[12:13], v[48:49]
    v_pk_mul_f32 v[14:15], v[14:15], v[50:51]
    v_exp_f32 v8, v8
    v_exp_f32 v9, v9
    v_exp_f32 v10, v10
    v_exp_f32 v11, v11
    v_exp_f32 v12, v12
    v_exp_f32 v13, v13
    v_exp_f32 v14, v14
    v_exp_f32 v15, v15
    v_pk_mul_f32 v[16:17], v[16:17], v[144:145]
    v_pk_mul_f32 v[18:19], v[18:19], v[146:147]
    v_pk_mul_f32 v[48:49], v[48:49], v[176:177]
    v_pk_mul_f32 v[50:51], v[50:51], v[178:179]
    v_pk_add_f32 v[8:9], v[8:9], 1.0 op_sel_hi:[1,0]
    v_pk_add_f32 v[10:11], v[10:11], 1.0 op_sel_hi:[1,0]
    v_pk_add_f32 v[12:13], v[12:13], 1.0 op_sel_hi:[1,0]
    v_pk_add_f32 v[14:15], v[14:15], 1.0 op_sel_hi:[1,0]
    v_rcp_f32 v8, v8
    v_rcp_f32 v9, v9
    v_rcp_f32 v10, v10
    v_rcp_f32 v11, v11
    v_rcp_f32 v12, v12
    v_rcp_f32 v13, v13
    v_rcp_f32 v14, v14
    v_rcp_f32 v15, v15
    s_mov_b32 s3, 0
    v_pk_mul_f32 v[16:17], v[16:17], v[8:9]
    v_pk_mul_f32 v[18:19], v[18:19], v[10:11]
    v_pk_mul_f32 v[48:49], v[48:49], v[12:13]
    v_pk_mul_f32 v[50:51], v[50:51], v[14:15]
    v_cvt_pk_bf16_f32 v0, v16, v17
    v_cvt_pk_bf16_f32 v1, v18, v19
    v_cvt_pk_bf16_f32 v2, v48, v49
    v_cvt_pk_bf16_f32 v3, v50, v51
    buffer_store_dwordx4 v[0:3], v251, s[72:75], s3 offen offset:0 sc1
    v_pk_mul_f32 v[8:9], v[20:21], v[20:21]
    v_pk_mul_f32 v[10:11], v[22:23], v[22:23]
    v_pk_mul_f32 v[12:13], v[52:53], v[52:53]
    v_pk_mul_f32 v[14:15], v[54:55], v[54:55]
    v_pk_fma_f32 v[8:9], v[8:9], s[18:19], v[252:253]
    v_pk_fma_f32 v[10:11], v[10:11], s[18:19], v[252:253]
    v_pk_fma_f32 v[12:13], v[12:13], s[18:19], v[252:253]
    v_pk_fma_f32 v[14:15], v[14:15], s[18:19], v[252:253]
    v_pk_mul_f32 v[8:9], v[8:9], v[20:21]
    v_pk_mul_f32 v[10:11], v[10:11], v[22:23]
    v_pk_mul_f32 v[12:13], v[12:13], v[52:53]
    v_pk_mul_f32 v[14:15], v[14:15], v[54:55]
    v_exp_f32 v8, v8
    v_exp_f32 v9, v9
    v_exp_f32 v10, v10
    v_exp_f32 v11, v11
    v_exp_f32 v12, v12
    v_exp_f32 v13, v13
    v_exp_f32 v14, v14
    v_exp_f32 v15, v15
    v_pk_mul_f32 v[20:21], v[20:21], v[148:149]
    v_pk_mul_f32 v[22:23], v[22:23], v[150:151]
    v_pk_mul_f32 v[52:53], v[52:53], v[180:181]
    v_pk_mul_f32 v[54:55], v[54:55], v[182:183]
    v_pk_add_f32 v[8:9], v[8:9], 1.0 op_sel_hi:[1,0]
    v_pk_add_f32 v[10:11], v[10:11], 1.0 op_sel_hi:[1,0]
    v_pk_add_f32 v[12:13], v[12:13], 1.0 op_sel_hi:[1,0]
    v_pk_add_f32 v[14:15], v[14:15], 1.0 op_sel_hi:[1,0]
    v_rcp_f32 v8, v8
    v_rcp_f32 v9, v9
    v_rcp_f32 v10, v10
    v_rcp_f32 v11, v11
    v_rcp_f32 v12, v12
    v_rcp_f32 v13, v13
    v_rcp_f32 v14, v14
    v_rcp_f32 v15, v15
    s_mov_b32 s3, 245760
    v_pk_mul_f32 v[20:21], v[20:21], v[8:9]
    v_pk_mul_f32 v[22:23], v[22:23], v[10:11]
    v_pk_mul_f32 v[52:53], v[52:53], v[12:13]
    v_pk_mul_f32 v[54:55], v[54:55], v[14:15]
    v_cvt_pk_bf16_f32 v4, v20, v21
    v_cvt_pk_bf16_f32 v5, v22, v23
    v_cvt_pk_bf16_f32 v6, v52, v53
    v_cvt_pk_bf16_f32 v7, v54, v55
    buffer_store_dwordx4 v[4:7], v251, s[72:75], s3 offen offset:0 sc1
    v_pk_mul_f32 v[8:9], v[24:25], v[24:25]
    v_pk_mul_f32 v[10:11], v[26:27], v[26:27]
    v_pk_mul_f32 v[12:13], v[56:57], v[56:57]
    v_pk_mul_f32 v[14:15], v[58:59], v[58:59]
    v_pk_fma_f32 v[8:9], v[8:9], s[18:19], v[252:253]
    v_pk_fma_f32 v[10:11], v[10:11], s[18:19], v[252:253]
    v_pk_fma_f32 v[12:13], v[12:13], s[18:19], v[252:253]
    v_pk_fma_f32 v[14:15], v[14:15], s[18:19], v[252:253]
    v_pk_mul_f32 v[8:9], v[8:9], v[24:25]
    v_pk_mul_f32 v[10:11], v[10:11], v[26:27]
    v_pk_mul_f32 v[12:13], v[12:13], v[56:57]
    v_pk_mul_f32 v[14:15], v[14:15], v[58:59]
    v_exp_f32 v8, v8
    v_exp_f32 v9, v9
    v_exp_f32 v10, v10
    v_exp_f32 v11, v11
    v_exp_f32 v12, v12
    v_exp_f32 v13, v13
    v_exp_f32 v14, v14
    v_exp_f32 v15, v15
    v_pk_mul_f32 v[24:25], v[24:25], v[152:153]
    v_pk_mul_f32 v[26:27], v[26:27], v[154:155]
    v_pk_mul_f32 v[56:57], v[56:57], v[184:185]
    v_pk_mul_f32 v[58:59], v[58:59], v[186:187]
    v_pk_add_f32 v[8:9], v[8:9], 1.0 op_sel_hi:[1,0]
    v_pk_add_f32 v[10:11], v[10:11], 1.0 op_sel_hi:[1,0]
    v_pk_add_f32 v[12:13], v[12:13], 1.0 op_sel_hi:[1,0]
    v_pk_add_f32 v[14:15], v[14:15], 1.0 op_sel_hi:[1,0]
    v_rcp_f32 v8, v8
    v_rcp_f32 v9, v9
    v_rcp_f32 v10, v10
    v_rcp_f32 v11, v11
    v_rcp_f32 v12, v12
    v_rcp_f32 v13, v13
    v_rcp_f32 v14, v14
    v_rcp_f32 v15, v15
    s_mov_b32 s3, 491520
    v_pk_mul_f32 v[24:25], v[24:25], v[8:9]
    v_pk_mul_f32 v[26:27], v[26:27], v[10:11]
    v_pk_mul_f32 v[56:57], v[56:57], v[12:13]
    v_pk_mul_f32 v[58:59], v[58:59], v[14:15]
    v_cvt_pk_bf16_f32 v0, v24, v25
    v_cvt_pk_bf16_f32 v1, v26, v27
    v_cvt_pk_bf16_f32 v2, v56, v57
    v_cvt_pk_bf16_f32 v3, v58, v59
    buffer_store_dwordx4 v[0:3], v251, s[72:75], s3 offen offset:0 sc1
    v_pk_mul_f32 v[8:9], v[28:29], v[28:29]
    v_pk_mul_f32 v[10:11], v[30:31], v[30:31]
    v_pk_mul_f32 v[12:13], v[60:61], v[60:61]
    v_pk_mul_f32 v[14:15], v[62:63], v[62:63]
    v_pk_fma_f32 v[8:9], v[8:9], s[18:19], v[252:253]
    v_pk_fma_f32 v[10:11], v[10:11], s[18:19], v[252:253]
    v_pk_fma_f32 v[12:13], v[12:13], s[18:19], v[252:253]
    v_pk_fma_f32 v[14:15], v[14:15], s[18:19], v[252:253]
    v_pk_mul_f32 v[8:9], v[8:9], v[28:29]
    v_pk_mul_f32 v[10:11], v[10:11], v[30:31]
    v_pk_mul_f32 v[12:13], v[12:13], v[60:61]
    v_pk_mul_f32 v[14:15], v[14:15], v[62:63]
    v_exp_f32 v8, v8
    v_exp_f32 v9, v9
    v_exp_f32 v10, v10
    v_exp_f32 v11, v11
    v_exp_f32 v12, v12
    v_exp_f32 v13, v13
    v_exp_f32 v14, v14
    v_exp_f32 v15, v15
    v_pk_mul_f32 v[28:29], v[28:29], v[156:157]
    v_pk_mul_f32 v[30:31], v[30:31], v[158:159]
    v_pk_mul_f32 v[60:61], v[60:61], v[188:189]
    v_pk_mul_f32 v[62:63], v[62:63], v[190:191]
    v_pk_add_f32 v[8:9], v[8:9], 1.0 op_sel_hi:[1,0]
    v_pk_add_f32 v[10:11], v[10:11], 1.0 op_sel_hi:[1,0]
    v_pk_add_f32 v[12:13], v[12:13], 1.0 op_sel_hi:[1,0]
    v_pk_add_f32 v[14:15], v[14:15], 1.0 op_sel_hi:[1,0]
    v_rcp_f32 v8, v8
    v_rcp_f32 v9, v9
    v_rcp_f32 v10, v10
    v_rcp_f32 v11, v11
    v_rcp_f32 v12, v12
    v_rcp_f32 v13, v13
    v_rcp_f32 v14, v14
    v_rcp_f32 v15, v15
    s_mov_b32 s3, 737280
    v_pk_mul_f32 v[28:29], v[28:29], v[8:9]
    v_pk_mul_f32 v[30:31], v[30:31], v[10:11]
    v_pk_mul_f32 v[60:61], v[60:61], v[12:13]
    v_pk_mul_f32 v[62:63], v[62:63], v[14:15]
    v_cvt_pk_bf16_f32 v4, v28, v29
    v_cvt_pk_bf16_f32 v5, v30, v31
    v_cvt_pk_bf16_f32 v6, v60, v61
    v_cvt_pk_bf16_f32 v7, v62, v63
    buffer_store_dwordx4 v[4:7], v251, s[72:75], s3 offen offset:0 sc1
    v_pk_mul_f32 v[8:9], v[32:33], v[32:33]
    v_pk_mul_f32 v[10:11], v[34:35], v[34:35]
    v_pk_mul_f32 v[12:13], v[64:65], v[64:65]
    v_pk_mul_f32 v[14:15], v[66:67], v[66:67]
    v_pk_fma_f32 v[8:9], v[8:9], s[18:19], v[252:253]
    v_pk_fma_f32 v[10:11], v[10:11], s[18:19], v[252:253]
    v_pk_fma_f32 v[12:13], v[12:13], s[18:19], v[252:253]
    v_pk_fma_f32 v[14:15], v[14:15], s[18:19], v[252:253]
    v_pk_mul_f32 v[8:9], v[8:9], v[32:33]
    v_pk_mul_f32 v[10:11], v[10:11], v[34:35]
    v_pk_mul_f32 v[12:13], v[12:13], v[64:65]
    v_pk_mul_f32 v[14:15], v[14:15], v[66:67]
    v_exp_f32 v8, v8
    v_exp_f32 v9, v9
    v_exp_f32 v10, v10
    v_exp_f32 v11, v11
    v_exp_f32 v12, v12
    v_exp_f32 v13, v13
    v_exp_f32 v14, v14
    v_exp_f32 v15, v15
    v_pk_mul_f32 v[32:33], v[32:33], v[160:161]
    v_pk_mul_f32 v[34:35], v[34:35], v[162:163]
    v_pk_mul_f32 v[64:65], v[64:65], v[192:193]
    v_pk_mul_f32 v[66:67], v[66:67], v[194:195]
    v_pk_add_f32 v[8:9], v[8:9], 1.0 op_sel_hi:[1,0]
    v_pk_add_f32 v[10:11], v[10:11], 1.0 op_sel_hi:[1,0]
    v_pk_add_f32 v[12:13], v[12:13], 1.0 op_sel_hi:[1,0]
    v_pk_add_f32 v[14:15], v[14:15], 1.0 op_sel_hi:[1,0]
    v_rcp_f32 v8, v8
    v_rcp_f32 v9, v9
    v_rcp_f32 v10, v10
    v_rcp_f32 v11, v11
    v_rcp_f32 v12, v12
    v_rcp_f32 v13, v13
    v_rcp_f32 v14, v14
    v_rcp_f32 v15, v15
    s_mov_b32 s3, 983040
    v_pk_mul_f32 v[32:33], v[32:33], v[8:9]
    v_pk_mul_f32 v[34:35], v[34:35], v[10:11]
    v_pk_mul_f32 v[64:65], v[64:65], v[12:13]
    v_pk_mul_f32 v[66:67], v[66:67], v[14:15]
    v_cvt_pk_bf16_f32 v0, v32, v33
    v_cvt_pk_bf16_f32 v1, v34, v35
    v_cvt_pk_bf16_f32 v2, v64, v65
    v_cvt_pk_bf16_f32 v3, v66, v67
    buffer_store_dwordx4 v[0:3], v251, s[72:75], s3 offen offset:0 sc1
    v_pk_mul_f32 v[8:9], v[36:37], v[36:37]
    v_pk_mul_f32 v[10:11], v[38:39], v[38:39]
    v_pk_mul_f32 v[12:13], v[68:69], v[68:69]
    v_pk_mul_f32 v[14:15], v[70:71], v[70:71]
    v_pk_fma_f32 v[8:9], v[8:9], s[18:19], v[252:253]
    v_pk_fma_f32 v[10:11], v[10:11], s[18:19], v[252:253]
    v_pk_fma_f32 v[12:13], v[12:13], s[18:19], v[252:253]
    v_pk_fma_f32 v[14:15], v[14:15], s[18:19], v[252:253]
    v_pk_mul_f32 v[8:9], v[8:9], v[36:37]
    v_pk_mul_f32 v[10:11], v[10:11], v[38:39]
    v_pk_mul_f32 v[12:13], v[12:13], v[68:69]
    v_pk_mul_f32 v[14:15], v[14:15], v[70:71]
    v_exp_f32 v8, v8
    v_exp_f32 v9, v9
    v_exp_f32 v10, v10
    v_exp_f32 v11, v11
    v_exp_f32 v12, v12
    v_exp_f32 v13, v13
    v_exp_f32 v14, v14
    v_exp_f32 v15, v15
    v_pk_mul_f32 v[36:37], v[36:37], v[164:165]
    v_pk_mul_f32 v[38:39], v[38:39], v[166:167]
    v_pk_mul_f32 v[68:69], v[68:69], v[196:197]
    v_pk_mul_f32 v[70:71], v[70:71], v[198:199]
    v_pk_add_f32 v[8:9], v[8:9], 1.0 op_sel_hi:[1,0]
    v_pk_add_f32 v[10:11], v[10:11], 1.0 op_sel_hi:[1,0]
    v_pk_add_f32 v[12:13], v[12:13], 1.0 op_sel_hi:[1,0]
    v_pk_add_f32 v[14:15], v[14:15], 1.0 op_sel_hi:[1,0]
    v_rcp_f32 v8, v8
    v_rcp_f32 v9, v9
    v_rcp_f32 v10, v10
    v_rcp_f32 v11, v11
    v_rcp_f32 v12, v12
    v_rcp_f32 v13, v13
    v_rcp_f32 v14, v14
    v_rcp_f32 v15, v15
    s_mov_b32 s3, 1228800
    v_pk_mul_f32 v[36:37], v[36:37], v[8:9]
    v_pk_mul_f32 v[38:39], v[38:39], v[10:11]
    v_pk_mul_f32 v[68:69], v[68:69], v[12:13]
    v_pk_mul_f32 v[70:71], v[70:71], v[14:15]
    v_cvt_pk_bf16_f32 v4, v36, v37
    v_cvt_pk_bf16_f32 v5, v38, v39
    v_cvt_pk_bf16_f32 v6, v68, v69
    v_cvt_pk_bf16_f32 v7, v70, v71
    buffer_store_dwordx4 v[4:7], v251, s[72:75], s3 offen offset:0 sc1
    v_pk_mul_f32 v[8:9], v[40:41], v[40:41]
    v_pk_mul_f32 v[10:11], v[42:43], v[42:43]
    v_pk_mul_f32 v[12:13], v[72:73], v[72:73]
    v_pk_mul_f32 v[14:15], v[74:75], v[74:75]
    v_pk_fma_f32 v[8:9], v[8:9], s[18:19], v[252:253]
    v_pk_fma_f32 v[10:11], v[10:11], s[18:19], v[252:253]
    v_pk_fma_f32 v[12:13], v[12:13], s[18:19], v[252:253]
    v_pk_fma_f32 v[14:15], v[14:15], s[18:19], v[252:253]
    v_pk_mul_f32 v[8:9], v[8:9], v[40:41]
    v_pk_mul_f32 v[10:11], v[10:11], v[42:43]
    v_pk_mul_f32 v[12:13], v[12:13], v[72:73]
    v_pk_mul_f32 v[14:15], v[14:15], v[74:75]
    v_exp_f32 v8, v8
    v_exp_f32 v9, v9
    v_exp_f32 v10, v10
    v_exp_f32 v11, v11
    v_exp_f32 v12, v12
    v_exp_f32 v13, v13
    v_exp_f32 v14, v14
    v_exp_f32 v15, v15
    v_pk_mul_f32 v[40:41], v[40:41], v[168:169]
    v_pk_mul_f32 v[42:43], v[42:43], v[170:171]
    v_pk_mul_f32 v[72:73], v[72:73], v[200:201]
    v_pk_mul_f32 v[74:75], v[74:75], v[202:203]
    v_pk_add_f32 v[8:9], v[8:9], 1.0 op_sel_hi:[1,0]
    v_pk_add_f32 v[10:11], v[10:11], 1.0 op_sel_hi:[1,0]
    v_pk_add_f32 v[12:13], v[12:13], 1.0 op_sel_hi:[1,0]
    v_pk_add_f32 v[14:15], v[14:15], 1.0 op_sel_hi:[1,0]
    v_rcp_f32 v8, v8
    v_rcp_f32 v9, v9
    v_rcp_f32 v10, v10
    v_rcp_f32 v11, v11
    v_rcp_f32 v12, v12
    v_rcp_f32 v13, v13
    v_rcp_f32 v14, v14
    v_rcp_f32 v15, v15
    s_mov_b32 s3, 1474560
    v_pk_mul_f32 v[40:41], v[40:41], v[8:9]
    v_pk_mul_f32 v[42:43], v[42:43], v[10:11]
    v_pk_mul_f32 v[72:73], v[72:73], v[12:13]
    v_pk_mul_f32 v[74:75], v[74:75], v[14:15]
    v_cvt_pk_bf16_f32 v0, v40, v41
    v_cvt_pk_bf16_f32 v1, v42, v43
    v_cvt_pk_bf16_f32 v2, v72, v73
    v_cvt_pk_bf16_f32 v3, v74, v75
    buffer_store_dwordx4 v[0:3], v251, s[72:75], s3 offen offset:0 sc1
    v_pk_mul_f32 v[8:9], v[44:45], v[44:45]
    v_pk_mul_f32 v[10:11], v[46:47], v[46:47]
    v_pk_mul_f32 v[12:13], v[76:77], v[76:77]
    v_pk_mul_f32 v[14:15], v[78:79], v[78:79]
    v_pk_fma_f32 v[8:9], v[8:9], s[18:19], v[252:253]
    v_pk_fma_f32 v[10:11], v[10:11], s[18:19], v[252:253]
    v_pk_fma_f32 v[12:13], v[12:13], s[18:19], v[252:253]
    v_pk_fma_f32 v[14:15], v[14:15], s[18:19], v[252:253]
    v_pk_mul_f32 v[8:9], v[8:9], v[44:45]
    v_pk_mul_f32 v[10:11], v[10:11], v[46:47]
    v_pk_mul_f32 v[12:13], v[12:13], v[76:77]
    v_pk_mul_f32 v[14:15], v[14:15], v[78:79]
    v_exp_f32 v8, v8
    v_exp_f32 v9, v9
    v_exp_f32 v10, v10
    v_exp_f32 v11, v11
    v_exp_f32 v12, v12
    v_exp_f32 v13, v13
    v_exp_f32 v14, v14
    v_exp_f32 v15, v15
    v_pk_mul_f32 v[44:45], v[44:45], v[172:173]
    v_pk_mul_f32 v[46:47], v[46:47], v[174:175]
    v_pk_mul_f32 v[76:77], v[76:77], v[204:205]
    v_pk_mul_f32 v[78:79], v[78:79], v[206:207]
    v_pk_add_f32 v[8:9], v[8:9], 1.0 op_sel_hi:[1,0]
    v_pk_add_f32 v[10:11], v[10:11], 1.0 op_sel_hi:[1,0]
    v_pk_add_f32 v[12:13], v[12:13], 1.0 op_sel_hi:[1,0]
    v_pk_add_f32 v[14:15], v[14:15], 1.0 op_sel_hi:[1,0]
    v_rcp_f32 v8, v8
    v_rcp_f32 v9, v9
    v_rcp_f32 v10, v10
    v_rcp_f32 v11, v11
    v_rcp_f32 v12, v12
    v_rcp_f32 v13, v13
    v_rcp_f32 v14, v14
    v_rcp_f32 v15, v15
    s_mov_b32 s3, 1720320
    v_pk_mul_f32 v[44:45], v[44:45], v[8:9]
    v_pk_mul_f32 v[46:47], v[46:47], v[10:11]
    v_pk_mul_f32 v[76:77], v[76:77], v[12:13]
    v_pk_mul_f32 v[78:79], v[78:79], v[14:15]
    v_cvt_pk_bf16_f32 v4, v44, v45
    v_cvt_pk_bf16_f32 v5, v46, v47
    v_cvt_pk_bf16_f32 v6, v76, v77
    v_cvt_pk_bf16_f32 v7, v78, v79
    buffer_store_dwordx4 v[4:7], v251, s[72:75], s3 offen offset:0 sc1
    v_pk_mul_f32 v[8:9], v[80:81], v[80:81]
    v_pk_mul_f32 v[10:11], v[82:83], v[82:83]
    v_pk_mul_f32 v[12:13], v[112:113], v[112:113]
    v_pk_mul_f32 v[14:15], v[114:115], v[114:115]
    v_pk_fma_f32 v[8:9], v[8:9], s[18:19], v[252:253]
    v_pk_fma_f32 v[10:11], v[10:11], s[18:19], v[252:253]
    v_pk_fma_f32 v[12:13], v[12:13], s[18:19], v[252:253]
    v_pk_fma_f32 v[14:15], v[14:15], s[18:19], v[252:253]
    v_pk_mul_f32 v[8:9], v[8:9], v[80:81]
    v_pk_mul_f32 v[10:11], v[10:11], v[82:83]
    v_pk_mul_f32 v[12:13], v[12:13], v[112:113]
    v_pk_mul_f32 v[14:15], v[14:15], v[114:115]
    v_exp_f32 v8, v8
    v_exp_f32 v9, v9
    v_exp_f32 v10, v10
    v_exp_f32 v11, v11
    v_exp_f32 v12, v12
    v_exp_f32 v13, v13
    v_exp_f32 v14, v14
    v_exp_f32 v15, v15
    v_pk_mul_f32 v[80:81], v[80:81], v[208:209]
    v_pk_mul_f32 v[82:83], v[82:83], v[210:211]
    v_accvgpr_read_b32 v208, a208
    v_accvgpr_read_b32 v209, a209
    v_accvgpr_read_b32 v210, a210
    v_accvgpr_read_b32 v211, a211
    v_pk_mul_f32 v[112:113], v[112:113], v[208:209]
    v_pk_mul_f32 v[114:115], v[114:115], v[210:211]
    v_pk_add_f32 v[8:9], v[8:9], 1.0 op_sel_hi:[1,0]
    v_pk_add_f32 v[10:11], v[10:11], 1.0 op_sel_hi:[1,0]
    v_pk_add_f32 v[12:13], v[12:13], 1.0 op_sel_hi:[1,0]
    v_pk_add_f32 v[14:15], v[14:15], 1.0 op_sel_hi:[1,0]
    v_rcp_f32 v8, v8
    v_rcp_f32 v9, v9
    v_rcp_f32 v10, v10
    v_rcp_f32 v11, v11
    v_rcp_f32 v12, v12
    v_rcp_f32 v13, v13
    v_rcp_f32 v14, v14
    v_rcp_f32 v15, v15
    s_mov_b32 s3, 0
    v_pk_mul_f32 v[80:81], v[80:81], v[8:9]
    v_pk_mul_f32 v[82:83], v[82:83], v[10:11]
    v_pk_mul_f32 v[112:113], v[112:113], v[12:13]
    v_pk_mul_f32 v[114:115], v[114:115], v[14:15]
    v_cvt_pk_bf16_f32 v0, v80, v81
    v_cvt_pk_bf16_f32 v1, v82, v83
    v_cvt_pk_bf16_f32 v2, v112, v113
    v_cvt_pk_bf16_f32 v3, v114, v115
    buffer_store_dwordx4 v[0:3], v251, s[72:75], s3 offen offset:1024 sc1
    v_pk_mul_f32 v[8:9], v[84:85], v[84:85]
    v_pk_mul_f32 v[10:11], v[86:87], v[86:87]
    v_pk_mul_f32 v[12:13], v[116:117], v[116:117]
    v_pk_mul_f32 v[14:15], v[118:119], v[118:119]
    v_pk_fma_f32 v[8:9], v[8:9], s[18:19], v[252:253]
    v_pk_fma_f32 v[10:11], v[10:11], s[18:19], v[252:253]
    v_pk_fma_f32 v[12:13], v[12:13], s[18:19], v[252:253]
    v_pk_fma_f32 v[14:15], v[14:15], s[18:19], v[252:253]
    v_pk_mul_f32 v[8:9], v[8:9], v[84:85]
    v_pk_mul_f32 v[10:11], v[10:11], v[86:87]
    v_pk_mul_f32 v[12:13], v[12:13], v[116:117]
    v_pk_mul_f32 v[14:15], v[14:15], v[118:119]
    v_exp_f32 v8, v8
    v_exp_f32 v9, v9
    v_exp_f32 v10, v10
    v_exp_f32 v11, v11
    v_exp_f32 v12, v12
    v_exp_f32 v13, v13
    v_exp_f32 v14, v14
    v_exp_f32 v15, v15
    v_pk_mul_f32 v[84:85], v[84:85], v[212:213]
    v_pk_mul_f32 v[86:87], v[86:87], v[214:215]
    v_accvgpr_read_b32 v212, a212
    v_accvgpr_read_b32 v213, a213
    v_accvgpr_read_b32 v214, a214
    v_accvgpr_read_b32 v215, a215
    v_pk_mul_f32 v[116:117], v[116:117], v[212:213]
    v_pk_mul_f32 v[118:119], v[118:119], v[214:215]
    v_pk_add_f32 v[8:9], v[8:9], 1.0 op_sel_hi:[1,0]
    v_pk_add_f32 v[10:11], v[10:11], 1.0 op_sel_hi:[1,0]
    v_pk_add_f32 v[12:13], v[12:13], 1.0 op_sel_hi:[1,0]
    v_pk_add_f32 v[14:15], v[14:15], 1.0 op_sel_hi:[1,0]
    v_rcp_f32 v8, v8
    v_rcp_f32 v9, v9
    v_rcp_f32 v10, v10
    v_rcp_f32 v11, v11
    v_rcp_f32 v12, v12
    v_rcp_f32 v13, v13
    v_rcp_f32 v14, v14
    v_rcp_f32 v15, v15
    s_mov_b32 s3, 245760
    v_pk_mul_f32 v[84:85], v[84:85], v[8:9]
    v_pk_mul_f32 v[86:87], v[86:87], v[10:11]
    v_pk_mul_f32 v[116:117], v[116:117], v[12:13]
    v_pk_mul_f32 v[118:119], v[118:119], v[14:15]
    v_cvt_pk_bf16_f32 v4, v84, v85
    v_cvt_pk_bf16_f32 v5, v86, v87
    v_cvt_pk_bf16_f32 v6, v116, v117
    v_cvt_pk_bf16_f32 v7, v118, v119
    buffer_store_dwordx4 v[4:7], v251, s[72:75], s3 offen offset:1024 sc1
    v_pk_mul_f32 v[8:9], v[88:89], v[88:89]
    v_pk_mul_f32 v[10:11], v[90:91], v[90:91]
    v_pk_mul_f32 v[12:13], v[120:121], v[120:121]
    v_pk_mul_f32 v[14:15], v[122:123], v[122:123]
    v_pk_fma_f32 v[8:9], v[8:9], s[18:19], v[252:253]
    v_pk_fma_f32 v[10:11], v[10:11], s[18:19], v[252:253]
    v_pk_fma_f32 v[12:13], v[12:13], s[18:19], v[252:253]
    v_pk_fma_f32 v[14:15], v[14:15], s[18:19], v[252:253]
    v_pk_mul_f32 v[8:9], v[8:9], v[88:89]
    v_pk_mul_f32 v[10:11], v[10:11], v[90:91]
    v_pk_mul_f32 v[12:13], v[12:13], v[120:121]
    v_pk_mul_f32 v[14:15], v[14:15], v[122:123]
    v_exp_f32 v8, v8
    v_exp_f32 v9, v9
    v_exp_f32 v10, v10
    v_exp_f32 v11, v11
    v_exp_f32 v12, v12
    v_exp_f32 v13, v13
    v_exp_f32 v14, v14
    v_exp_f32 v15, v15
    v_pk_mul_f32 v[88:89], v[88:89], v[216:217]
    v_pk_mul_f32 v[90:91], v[90:91], v[218:219]
    v_accvgpr_read_b32 v216, a216
    v_accvgpr_read_b32 v217, a217
    v_accvgpr_read_b32 v218, a218
    v_accvgpr_read_b32 v219, a219
    v_pk_mul_f32 v[120:121], v[120:121], v[216:217]
    v_pk_mul_f32 v[122:123], v[122:123], v[218:219]
    v_pk_add_f32 v[8:9], v[8:9], 1.0 op_sel_hi:[1,0]
    v_pk_add_f32 v[10:11], v[10:11], 1.0 op_sel_hi:[1,0]
    v_pk_add_f32 v[12:13], v[12:13], 1.0 op_sel_hi:[1,0]
    v_pk_add_f32 v[14:15], v[14:15], 1.0 op_sel_hi:[1,0]
    v_rcp_f32 v8, v8
    v_rcp_f32 v9, v9
    v_rcp_f32 v10, v10
    v_rcp_f32 v11, v11
    v_rcp_f32 v12, v12
    v_rcp_f32 v13, v13
    v_rcp_f32 v14, v14
    v_rcp_f32 v15, v15
    s_mov_b32 s3, 491520
    v_pk_mul_f32 v[88:89], v[88:89], v[8:9]
    v_pk_mul_f32 v[90:91], v[90:91], v[10:11]
    v_pk_mul_f32 v[120:121], v[120:121], v[12:13]
    v_pk_mul_f32 v[122:123], v[122:123], v[14:15]
    v_cvt_pk_bf16_f32 v0, v88, v89
    v_cvt_pk_bf16_f32 v1, v90, v91
    v_cvt_pk_bf16_f32 v2, v120, v121
    v_cvt_pk_bf16_f32 v3, v122, v123
    buffer_store_dwordx4 v[0:3], v251, s[72:75], s3 offen offset:1024 sc1
    v_pk_mul_f32 v[8:9], v[92:93], v[92:93]
    v_pk_mul_f32 v[10:11], v[94:95], v[94:95]
    v_pk_mul_f32 v[12:13], v[124:125], v[124:125]
    v_pk_mul_f32 v[14:15], v[126:127], v[126:127]
    v_pk_fma_f32 v[8:9], v[8:9], s[18:19], v[252:253]
    v_pk_fma_f32 v[10:11], v[10:11], s[18:19], v[252:253]
    v_pk_fma_f32 v[12:13], v[12:13], s[18:19], v[252:253]
    v_pk_fma_f32 v[14:15], v[14:15], s[18:19], v[252:253]
    v_pk_mul_f32 v[8:9], v[8:9], v[92:93]
    v_pk_mul_f32 v[10:11], v[10:11], v[94:95]
    v_pk_mul_f32 v[12:13], v[12:13], v[124:125]
    v_pk_mul_f32 v[14:15], v[14:15], v[126:127]
    v_exp_f32 v8, v8
    v_exp_f32 v9, v9
    v_exp_f32 v10, v10
    v_exp_f32 v11, v11
    v_exp_f32 v12, v12
    v_exp_f32 v13, v13
    v_exp_f32 v14, v14
    v_exp_f32 v15, v15
    v_pk_mul_f32 v[92:93], v[92:93], v[220:221]
    v_pk_mul_f32 v[94:95], v[94:95], v[222:223]
    v_accvgpr_read_b32 v220, a220
    v_accvgpr_read_b32 v221, a221
    v_accvgpr_read_b32 v222, a222
    v_accvgpr_read_b32 v223, a223
    v_pk_mul_f32 v[124:125], v[124:125], v[220:221]
    v_pk_mul_f32 v[126:127], v[126:127], v[222:223]
    v_pk_add_f32 v[8:9], v[8:9], 1.0 op_sel_hi:[1,0]
    v_pk_add_f32 v[10:11], v[10:11], 1.0 op_sel_hi:[1,0]
    v_pk_add_f32 v[12:13], v[12:13], 1.0 op_sel_hi:[1,0]
    v_pk_add_f32 v[14:15], v[14:15], 1.0 op_sel_hi:[1,0]
    v_rcp_f32 v8, v8
    v_rcp_f32 v9, v9
    v_rcp_f32 v10, v10
    v_rcp_f32 v11, v11
    v_rcp_f32 v12, v12
    v_rcp_f32 v13, v13
    v_rcp_f32 v14, v14
    v_rcp_f32 v15, v15
    s_mov_b32 s3, 737280
    v_pk_mul_f32 v[92:93], v[92:93], v[8:9]
    v_pk_mul_f32 v[94:95], v[94:95], v[10:11]
    v_pk_mul_f32 v[124:125], v[124:125], v[12:13]
    v_pk_mul_f32 v[126:127], v[126:127], v[14:15]
    v_cvt_pk_bf16_f32 v4, v92, v93
    v_cvt_pk_bf16_f32 v5, v94, v95
    v_cvt_pk_bf16_f32 v6, v124, v125
    v_cvt_pk_bf16_f32 v7, v126, v127
    buffer_store_dwordx4 v[4:7], v251, s[72:75], s3 offen offset:1024 sc1
    v_pk_mul_f32 v[8:9], v[96:97], v[96:97]
    v_pk_mul_f32 v[10:11], v[98:99], v[98:99]
    v_pk_mul_f32 v[12:13], v[128:129], v[128:129]
    v_pk_mul_f32 v[14:15], v[130:131], v[130:131]
    v_pk_fma_f32 v[8:9], v[8:9], s[18:19], v[252:253]
    v_pk_fma_f32 v[10:11], v[10:11], s[18:19], v[252:253]
    v_pk_fma_f32 v[12:13], v[12:13], s[18:19], v[252:253]
    v_pk_fma_f32 v[14:15], v[14:15], s[18:19], v[252:253]
    v_pk_mul_f32 v[8:9], v[8:9], v[96:97]
    v_pk_mul_f32 v[10:11], v[10:11], v[98:99]
    v_pk_mul_f32 v[12:13], v[12:13], v[128:129]
    v_pk_mul_f32 v[14:15], v[14:15], v[130:131]
    v_exp_f32 v8, v8
    v_exp_f32 v9, v9
    v_exp_f32 v10, v10
    v_exp_f32 v11, v11
    v_exp_f32 v12, v12
    v_exp_f32 v13, v13
    v_exp_f32 v14, v14
    v_exp_f32 v15, v15
    v_pk_mul_f32 v[96:97], v[96:97], v[224:225]
    v_pk_mul_f32 v[98:99], v[98:99], v[226:227]
    v_accvgpr_read_b32 v224, a224
    v_accvgpr_read_b32 v225, a225
    v_accvgpr_read_b32 v226, a226
    v_accvgpr_read_b32 v227, a227
    v_pk_mul_f32 v[128:129], v[128:129], v[224:225]
    v_pk_mul_f32 v[130:131], v[130:131], v[226:227]
    v_pk_add_f32 v[8:9], v[8:9], 1.0 op_sel_hi:[1,0]
    v_pk_add_f32 v[10:11], v[10:11], 1.0 op_sel_hi:[1,0]
    v_pk_add_f32 v[12:13], v[12:13], 1.0 op_sel_hi:[1,0]
    v_pk_add_f32 v[14:15], v[14:15], 1.0 op_sel_hi:[1,0]
    v_rcp_f32 v8, v8
    v_rcp_f32 v9, v9
    v_rcp_f32 v10, v10
    v_rcp_f32 v11, v11
    v_rcp_f32 v12, v12
    v_rcp_f32 v13, v13
    v_rcp_f32 v14, v14
    v_rcp_f32 v15, v15
    s_mov_b32 s3, 983040
    v_pk_mul_f32 v[96:97], v[96:97], v[8:9]
    v_pk_mul_f32 v[98:99], v[98:99], v[10:11]
    v_pk_mul_f32 v[128:129], v[128:129], v[12:13]
    v_pk_mul_f32 v[130:131], v[130:131], v[14:15]
    v_cvt_pk_bf16_f32 v0, v96, v97
    v_cvt_pk_bf16_f32 v1, v98, v99
    v_cvt_pk_bf16_f32 v2, v128, v129
    v_cvt_pk_bf16_f32 v3, v130, v131
    buffer_store_dwordx4 v[0:3], v251, s[72:75], s3 offen offset:1024 sc1
    v_pk_mul_f32 v[8:9], v[100:101], v[100:101]
    v_pk_mul_f32 v[10:11], v[102:103], v[102:103]
    v_pk_mul_f32 v[12:13], v[132:133], v[132:133]
    v_pk_mul_f32 v[14:15], v[134:135], v[134:135]
    v_pk_fma_f32 v[8:9], v[8:9], s[18:19], v[252:253]
    v_pk_fma_f32 v[10:11], v[10:11], s[18:19], v[252:253]
    v_pk_fma_f32 v[12:13], v[12:13], s[18:19], v[252:253]
    v_pk_fma_f32 v[14:15], v[14:15], s[18:19], v[252:253]
    v_pk_mul_f32 v[8:9], v[8:9], v[100:101]
    v_pk_mul_f32 v[10:11], v[10:11], v[102:103]
    v_pk_mul_f32 v[12:13], v[12:13], v[132:133]
    v_pk_mul_f32 v[14:15], v[14:15], v[134:135]
    v_exp_f32 v8, v8
    v_exp_f32 v9, v9
    v_exp_f32 v10, v10
    v_exp_f32 v11, v11
    v_exp_f32 v12, v12
    v_exp_f32 v13, v13
    v_exp_f32 v14, v14
    v_exp_f32 v15, v15
    v_pk_mul_f32 v[100:101], v[100:101], v[228:229]
    v_pk_mul_f32 v[102:103], v[102:103], v[230:231]
    v_accvgpr_read_b32 v228, a228
    v_accvgpr_read_b32 v229, a229
    v_accvgpr_read_b32 v230, a230
    v_accvgpr_read_b32 v231, a231
    v_pk_mul_f32 v[132:133], v[132:133], v[228:229]
    v_pk_mul_f32 v[134:135], v[134:135], v[230:231]
    v_pk_add_f32 v[8:9], v[8:9], 1.0 op_sel_hi:[1,0]
    v_pk_add_f32 v[10:11], v[10:11], 1.0 op_sel_hi:[1,0]
    v_pk_add_f32 v[12:13], v[12:13], 1.0 op_sel_hi:[1,0]
    v_pk_add_f32 v[14:15], v[14:15], 1.0 op_sel_hi:[1,0]
    v_rcp_f32 v8, v8
    v_rcp_f32 v9, v9
    v_rcp_f32 v10, v10
    v_rcp_f32 v11, v11
    v_rcp_f32 v12, v12
    v_rcp_f32 v13, v13
    v_rcp_f32 v14, v14
    v_rcp_f32 v15, v15
    s_mov_b32 s3, 1228800
    v_pk_mul_f32 v[100:101], v[100:101], v[8:9]
    v_pk_mul_f32 v[102:103], v[102:103], v[10:11]
    v_pk_mul_f32 v[132:133], v[132:133], v[12:13]
    v_pk_mul_f32 v[134:135], v[134:135], v[14:15]
    v_cvt_pk_bf16_f32 v4, v100, v101
    v_cvt_pk_bf16_f32 v5, v102, v103
    v_cvt_pk_bf16_f32 v6, v132, v133
    v_cvt_pk_bf16_f32 v7, v134, v135
    buffer_store_dwordx4 v[4:7], v251, s[72:75], s3 offen offset:1024 sc1
    v_pk_mul_f32 v[8:9], v[104:105], v[104:105]
    v_pk_mul_f32 v[10:11], v[106:107], v[106:107]
    v_pk_mul_f32 v[12:13], v[136:137], v[136:137]
    v_pk_mul_f32 v[14:15], v[138:139], v[138:139]
    v_pk_fma_f32 v[8:9], v[8:9], s[18:19], v[252:253]
    v_pk_fma_f32 v[10:11], v[10:11], s[18:19], v[252:253]
    v_pk_fma_f32 v[12:13], v[12:13], s[18:19], v[252:253]
    v_pk_fma_f32 v[14:15], v[14:15], s[18:19], v[252:253]
    v_pk_mul_f32 v[8:9], v[8:9], v[104:105]
    v_pk_mul_f32 v[10:11], v[10:11], v[106:107]
    v_pk_mul_f32 v[12:13], v[12:13], v[136:137]
    v_pk_mul_f32 v[14:15], v[14:15], v[138:139]
    v_exp_f32 v8, v8
    v_exp_f32 v9, v9
    v_exp_f32 v10, v10
    v_exp_f32 v11, v11
    v_exp_f32 v12, v12
    v_exp_f32 v13, v13
    v_exp_f32 v14, v14
    v_exp_f32 v15, v15
    v_pk_mul_f32 v[104:105], v[104:105], v[232:233]
    v_pk_mul_f32 v[106:107], v[106:107], v[234:235]
    v_accvgpr_read_b32 v232, a232
    v_accvgpr_read_b32 v233, a233
    v_accvgpr_read_b32 v234, a234
    v_accvgpr_read_b32 v235, a235
    v_pk_mul_f32 v[136:137], v[136:137], v[232:233]
    v_pk_mul_f32 v[138:139], v[138:139], v[234:235]
    v_pk_add_f32 v[8:9], v[8:9], 1.0 op_sel_hi:[1,0]
    v_pk_add_f32 v[10:11], v[10:11], 1.0 op_sel_hi:[1,0]
    v_pk_add_f32 v[12:13], v[12:13], 1.0 op_sel_hi:[1,0]
    v_pk_add_f32 v[14:15], v[14:15], 1.0 op_sel_hi:[1,0]
    v_rcp_f32 v8, v8
    v_rcp_f32 v9, v9
    v_rcp_f32 v10, v10
    v_rcp_f32 v11, v11
    v_rcp_f32 v12, v12
    v_rcp_f32 v13, v13
    v_rcp_f32 v14, v14
    v_rcp_f32 v15, v15
    s_mov_b32 s3, 1474560
    v_pk_mul_f32 v[104:105], v[104:105], v[8:9]
    v_pk_mul_f32 v[106:107], v[106:107], v[10:11]
    v_pk_mul_f32 v[136:137], v[136:137], v[12:13]
    v_pk_mul_f32 v[138:139], v[138:139], v[14:15]
    v_cvt_pk_bf16_f32 v0, v104, v105
    v_cvt_pk_bf16_f32 v1, v106, v107
    v_cvt_pk_bf16_f32 v2, v136, v137
    v_cvt_pk_bf16_f32 v3, v138, v139
    buffer_store_dwordx4 v[0:3], v251, s[72:75], s3 offen offset:1024 sc1
    v_pk_mul_f32 v[8:9], v[108:109], v[108:109]
    v_pk_mul_f32 v[10:11], v[110:111], v[110:111]
    v_pk_mul_f32 v[12:13], v[140:141], v[140:141]
    v_pk_mul_f32 v[14:15], v[142:143], v[142:143]
    v_pk_fma_f32 v[8:9], v[8:9], s[18:19], v[252:253]
    v_pk_fma_f32 v[10:11], v[10:11], s[18:19], v[252:253]
    v_pk_fma_f32 v[12:13], v[12:13], s[18:19], v[252:253]
    v_pk_fma_f32 v[14:15], v[14:15], s[18:19], v[252:253]
    v_pk_mul_f32 v[8:9], v[8:9], v[108:109]
    v_pk_mul_f32 v[10:11], v[10:11], v[110:111]
    v_pk_mul_f32 v[12:13], v[12:13], v[140:141]
    v_pk_mul_f32 v[14:15], v[14:15], v[142:143]
    v_exp_f32 v8, v8
    v_exp_f32 v9, v9
    v_exp_f32 v10, v10
    v_exp_f32 v11, v11
    v_exp_f32 v12, v12
    v_exp_f32 v13, v13
    v_exp_f32 v14, v14
    v_exp_f32 v15, v15
    v_pk_mul_f32 v[108:109], v[108:109], v[236:237]
    v_pk_mul_f32 v[110:111], v[110:111], v[238:239]
    v_accvgpr_read_b32 v236, a236
    v_accvgpr_read_b32 v237, a237
    v_accvgpr_read_b32 v238, a238
    v_accvgpr_read_b32 v239, a239
    v_pk_mul_f32 v[140:141], v[140:141], v[236:237]
    v_pk_mul_f32 v[142:143], v[142:143], v[238:239]
    v_pk_add_f32 v[8:9], v[8:9], 1.0 op_sel_hi:[1,0]
    v_pk_add_f32 v[10:11], v[10:11], 1.0 op_sel_hi:[1,0]
    v_pk_add_f32 v[12:13], v[12:13], 1.0 op_sel_hi:[1,0]
    v_pk_add_f32 v[14:15], v[14:15], 1.0 op_sel_hi:[1,0]
    v_rcp_f32 v8, v8
    v_rcp_f32 v9, v9
    v_rcp_f32 v10, v10
    v_rcp_f32 v11, v11
    v_rcp_f32 v12, v12
    v_rcp_f32 v13, v13
    v_rcp_f32 v14, v14
    v_rcp_f32 v15, v15
    s_mov_b32 s3, 1720320
    v_pk_mul_f32 v[108:109], v[108:109], v[8:9]
    v_pk_mul_f32 v[110:111], v[110:111], v[10:11]
    v_pk_mul_f32 v[140:141], v[140:141], v[12:13]
    v_pk_mul_f32 v[142:143], v[142:143], v[14:15]
    v_cvt_pk_bf16_f32 v4, v108, v109
    v_cvt_pk_bf16_f32 v5, v110, v111
    v_cvt_pk_bf16_f32 v6, v140, v141
    v_cvt_pk_bf16_f32 v7, v142, v143
    buffer_store_dwordx4 v[4:7], v251, s[72:75], s3 offen offset:1024 sc1
    s_mov_b32 s100, s70
    s_branch g1_exit
g1_S_first:
    s_waitcnt lgkmcnt(4)
    v_mfma_f32_16x16x32_bf16 v[16:19], a[0:3], a[128:131], 0
    s_add_u32 m0, s60, 0
    ds_read_b64_tr_b16 a[144:145], v244 offset:0
    v_mfma_f32_16x16x32_bf16 v[16:19], a[4:7], a[132:135], v[16:19]
    buffer_load_dwordx4 v246, s[36:39], s44 offen offset:0 lds
    v_mfma_f32_16x16x32_bf16 v[20:23], a[8:11], a[128:131], 0
    ds_read_b64_tr_b16 a[146:147], v244 offset:512
    v_mfma_f32_16x16x32_bf16 v[20:23], a[12:15], a[132:135], v[20:23]
    v_mfma_f32_16x16x32_bf16 v[24:27], a[16:19], a[128:131], 0
    ds_read_b64_tr_b16 a[148:149], v244 offset:4096
    v_mfma_f32_16x16x32_bf16 v[24:27], a[20:23], a[132:135], v[24:27]
    v_mfma_f32_16x16x32_bf16 v[28:31], a[24:27], a[128:131], 0
    ds_read_b64_tr_b16 a[150:151], v244 offset:4608
    buffer_load_dwordx4 v247, s[36:39], s45 offen offset:1024 lds
    v_mfma_f32_16x16x32_bf16 v[28:31], a[28:31], a[132:135], v[28:31]
    v_mfma_f32_16x16x32_bf16 v[32:35], a[32:35], a[128:131], 0
    ds_read_b128 a[64:67], v240 offset:32768
    v_mfma_f32_16x16x32_bf16 v[32:35], a[36:39], a[132:135], v[32:35]
    v_mfma_f32_16x16x32_bf16 v[36:39], a[40:43], a[128:131], 0
    ds_read_b128 a[68:71], v241 offset:32768
    v_mfma_f32_16x16x32_bf16 v[36:39], a[44:47], a[132:135], v[36:39]
    buffer_load_dwordx4 v246, s[36:39], s46 offen offset:2048 lds
    v_mfma_f32_16x16x32_bf16 v[40:43], a[48:51], a[128:131], 0
    v_mfma_f32_16x16x32_bf16 v[40:43], a[52:55], a[132:135], v[40:43]
    v_mfma_f32_16x16x32_bf16 v[44:47], a[56:59], a[128:131], 0
    v_mfma_f32_16x16x32_bf16 v[44:47], a[60:63], a[132:135], v[44:47]
    s_waitcnt lgkmcnt(6)
    v_mfma_f32_16x16x32_bf16 v[48:51], a[0:3], a[136:139], 0
    ds_read_b64_tr_b16 a[152:153], v245 offset:0
    buffer_load_dwordx4 v247, s[36:39], s47 offen offset:3072 lds
    v_mfma_f32_16x16x32_bf16 v[48:51], a[4:7], a[140:143], v[48:51]
    s_add_u32 m0, s60, 4096
    v_mfma_f32_16x16x32_bf16 v[52:55], a[8:11], a[136:139], 0
    ds_read_b64_tr_b16 a[154:155], v245 offset:512
    v_mfma_f32_16x16x32_bf16 v[52:55], a[12:15], a[140:143], v[52:55]
    v_mfma_f32_16x16x32_bf16 v[56:59], a[16:19], a[136:139], 0
    ds_read_b64_tr_b16 a[156:157], v245 offset:4096
    v_mfma_f32_16x16x32_bf16 v[56:59], a[20:23], a[140:143], v[56:59]
    buffer_load_dwordx4 v246, s[36:39], s48 offen offset:0 lds
    v_mfma_f32_16x16x32_bf16 v[60:63], a[24:27], a[136:139], 0
    ds_read_b64_tr_b16 a[158:159], v245 offset:4608
    v_mfma_f32_16x16x32_bf16 v[60:63], a[28:31], a[140:143], v[60:63]
    v_mfma_f32_16x16x32_bf16 v[64:67], a[32:35], a[136:139], 0
    ds_read_b128 a[72:75], v240 offset:34816
    v_mfma_f32_16x16x32_bf16 v[64:67], a[36:39], a[140:143], v[64:67]
    v_mfma_f32_16x16x32_bf16 v[68:71], a[40:43], a[136:139], 0
    ds_read_b128 a[76:79], v241 offset:34816
    buffer_load_dwordx4 v247, s[36:39], s49 offen offset:1024 lds
    v_mfma_f32_16x16x32_bf16 v[68:71], a[44:47], a[140:143], v[68:71]
    v_mfma_f32_16x16x32_bf16 v[72:75], a[48:51], a[136:139], 0
    ds_read_b128 a[80:83], v240 offset:36864
    v_mfma_f32_16x16x32_bf16 v[72:75], a[52:55], a[140:143], v[72:75]
    v_mfma_f32_16x16x32_bf16 v[76:79], a[56:59], a[136:139], 0
    v_mfma_f32_16x16x32_bf16 v[76:79], a[60:63], a[140:143], v[76:79]
    s_waitcnt lgkmcnt(9)
    buffer_load_dwordx4 v246, s[36:39], s50 offen offset:2048 lds
    v_mfma_f32_16x16x32_bf16 v[80:83], a[0:3], a[144:147], 0
    ds_read_b64_tr_b16 a[128:129], v242 offset:8192
    v_mfma_f32_16x16x32_bf16 v[80:83], a[4:7], a[148:151], v[80:83]
    v_mfma_f32_16x16x32_bf16 v[84:87], a[8:11], a[144:147], 0
    ds_read_b64_tr_b16 a[130:131], v242 offset:8704
    v_mfma_f32_16x16x32_bf16 v[84:87], a[12:15], a[148:151], v[84:87]
    v_mfma_f32_16x16x32_bf16 v[88:91], a[16:19], a[144:147], 0
    ds_read_b64_tr_b16 a[132:133], v242 offset:12288
    buffer_load_dwordx4 v247, s[36:39], s51 offen offset:3072 lds
    v_mfma_f32_16x16x32_bf16 v[88:91], a[20:23], a[148:151], v[88:91]
    v_add_u32 v246, s62, v246
    v_add_u32 v247, s62, v247
    v_mfma_f32_16x16x32_bf16 v[92:95], a[24:27], a[144:147], 0
    ds_read_b64_tr_b16 a[134:135], v242 offset:12800
    v_mfma_f32_16x16x32_bf16 v[92:95], a[28:31], a[148:151], v[92:95]
    v_mfma_f32_16x16x32_bf16 v[96:99], a[32:35], a[144:147], 0
    ds_read_b128 a[84:87], v241 offset:36864
    v_mfma_f32_16x16x32_bf16 v[96:99], a[36:39], a[148:151], v[96:99]
    buffer_load_dword v255, v254, s[76:79], 0 offen
    v_add_u32 v254, s20, v254
    v_mfma_f32_16x16x32_bf16 v[100:103], a[40:43], a[144:147], 0
    ds_read_b128 a[88:91], v240 offset:38912
    v_mfma_f32_16x16x32_bf16 v[100:103], a[44:47], a[148:151], v[100:103]
    v_mfma_f32_16x16x32_bf16 v[104:107], a[48:51], a[144:147], 0
    ds_read_b128 a[92:95], v241 offset:38912
    v_mfma_f32_16x16x32_bf16 v[104:107], a[52:55], a[148:151], v[104:107]
    v_mfma_f32_16x16x32_bf16 v[108:111], a[56:59], a[144:147], 0
    buffer_load_dword a240, v251, s[84:87], s90 offen sc1
    v_mfma_f32_16x16x32_bf16 v[108:111], a[60:63], a[148:151], v[108:111]
    s_waitcnt lgkmcnt(10)
    v_mfma_f32_16x16x32_bf16 v[112:115], a[0:3], a[152:155], 0
    ds_read_b64_tr_b16 a[136:137], v243 offset:8192
    v_mfma_f32_16x16x32_bf16 v[112:115], a[4:7], a[156:159], v[112:115]
    v_mfma_f32_16x16x32_bf16 v[116:119], a[8:11], a[152:155], 0
    ds_read_b64_tr_b16 a[138:139], v243 offset:8704
    v_mfma_f32_16x16x32_bf16 v[116:119], a[12:15], a[156:159], v[116:119]
    v_mfma_f32_16x16x32_bf16 v[120:123], a[16:19], a[152:155], 0
    ds_read_b64_tr_b16 a[140:141], v243 offset:12288
    v_mfma_f32_16x16x32_bf16 v[120:123], a[20:23], a[156:159], v[120:123]
    v_mfma_f32_16x16x32_bf16 v[124:127], a[24:27], a[152:155], 0
    ds_read_b64_tr_b16 a[142:143], v243 offset:12800
    v_mfma_f32_16x16x32_bf16 v[124:127], a[28:31], a[156:159], v[124:127]
    v_mfma_f32_16x16x32_bf16 v[128:131], a[32:35], a[152:155], 0
    ds_read_b128 a[96:99], v240 offset:40960
    v_mfma_f32_16x16x32_bf16 v[128:131], a[36:39], a[156:159], v[128:131]
    v_mfma_f32_16x16x32_bf16 v[132:135], a[40:43], a[152:155], 0
    ds_read_b128 a[100:103], v241 offset:40960
    v_mfma_f32_16x16x32_bf16 v[132:135], a[44:47], a[156:159], v[132:135]
    v_mfma_f32_16x16x32_bf16 v[136:139], a[48:51], a[152:155], 0
    v_mfma_f32_16x16x32_bf16 v[136:139], a[52:55], a[156:159], v[136:139]
    v_mfma_f32_16x16x32_bf16 v[140:143], a[56:59], a[152:155], 0
    v_mfma_f32_16x16x32_bf16 v[140:143], a[60:63], a[156:159], v[140:143]
    s_waitcnt lgkmcnt(9)
    v_mfma_f32_16x16x32_bf16 v[144:147], a[0:3], a[128:131], 0
    ds_read_b64_tr_b16 a[144:145], v244 offset:8192
    v_mfma_f32_16x16x32_bf16 v[144:147], a[4:7], a[132:135], v[144:147]
    v_mfma_f32_16x16x32_bf16 v[148:151], a[8:11], a[128:131], 0
    ds_read_b64_tr_b16 a[146:147], v244 offset:8704
    v_mfma_f32_16x16x32_bf16 v[148:151], a[12:15], a[132:135], v[148:151]
    v_mfma_f32_16x16x32_bf16 v[152:155], a[16:19], a[128:131], 0
    ds_read_b64_tr_b16 a[148:149], v244 offset:12288
    v_mfma_f32_16x16x32_bf16 v[152:155], a[20:23], a[132:135], v[152:155]
    v_mfma_f32_16x16x32_bf16 v[156:159], a[24:27], a[128:131], 0
    ds_read_b64_tr_b16 a[150:151], v244 offset:12800
    v_mfma_f32_16x16x32_bf16 v[156:159], a[28:31], a[132:135], v[156:159]
    v_mfma_f32_16x16x32_bf16 v[160:163], a[32:35], a[128:131], 0
    ds_read_b128 a[104:107], v240 offset:43008
    v_mfma_f32_16x16x32_bf16 v[160:163], a[36:39], a[132:135], v[160:163]
    v_mfma_f32_16x16x32_bf16 v[164:167], a[40:43], a[128:131], 0
    ds_read_b128 a[108:111], v241 offset:43008
    v_mfma_f32_16x16x32_bf16 v[164:167], a[44:47], a[132:135], v[164:167]
    v_mfma_f32_16x16x32_bf16 v[168:171], a[48:51], a[128:131], 0
    ds_read_b128 a[112:115], v240 offset:45056
    v_mfma_f32_16x16x32_bf16 v[168:171], a[52:55], a[132:135], v[168:171]
    v_mfma_f32_16x16x32_bf16 v[172:175], a[56:59], a[128:131], 0
    v_mfma_f32_16x16x32_bf16 v[172:175], a[60:63], a[132:135], v[172:175]
    s_waitcnt lgkmcnt(9)
    v_mfma_f32_16x16x32_bf16 v[176:179], a[0:3], a[136:139], 0
    ds_read_b64_tr_b16 a[152:153], v245 offset:8192
    v_mfma_f32_16x16x32_bf16 v[176:179], a[4:7], a[140:143], v[176:179]
    v_mfma_f32_16x16x32_bf16 v[180:183], a[8:11], a[136:139], 0
    ds_read_b64_tr_b16 a[154:155], v245 offset:8704
    v_mfma_f32_16x16x32_bf16 v[180:183], a[12:15], a[140:143], v[180:183]
    v_mfma_f32_16x16x32_bf16 v[184:187], a[16:19], a[136:139], 0
    ds_read_b64_tr_b16 a[156:157], v245 offset:12288
    v_mfma_f32_16x16x32_bf16 v[184:187], a[20:23], a[140:143], v[184:187]
    v_mfma_f32_16x16x32_bf16 v[188:191], a[24:27], a[136:139], 0
    ds_read_b64_tr_b16 a[158:159], v245 offset:12800
    v_mfma_f32_16x16x32_bf16 v[188:191], a[28:31], a[140:143], v[188:191]
    v_mfma_f32_16x16x32_bf16 v[192:195], a[32:35], a[136:139], 0
    ds_read_b128 a[116:119], v241 offset:45056
    v_mfma_f32_16x16x32_bf16 v[192:195], a[36:39], a[140:143], v[192:195]
    v_mfma_f32_16x16x32_bf16 v[196:199], a[40:43], a[136:139], 0
    ds_read_b128 a[120:123], v240 offset:47104
    v_mfma_f32_16x16x32_bf16 v[196:199], a[44:47], a[140:143], v[196:199]
    v_mfma_f32_16x16x32_bf16 v[200:203], a[48:51], a[136:139], 0
    ds_read_b128 a[124:127], v241 offset:47104
    v_mfma_f32_16x16x32_bf16 v[200:203], a[52:55], a[140:143], v[200:203]
    v_mfma_f32_16x16x32_bf16 v[204:207], a[56:59], a[136:139], 0
    v_mfma_f32_16x16x32_bf16 v[204:207], a[60:63], a[140:143], v[204:207]
    s_waitcnt vmcnt(2) lgkmcnt(0)
    s_barrier
    s_mov_b64 exec, 1
    buffer_store_dword v252, v250, s[80:83], s70 offen sc1
    buffer_store_byte v252, v250, s[84:87], s89 offen sc1
    s_mov_b64 exec, -1
    s_brev_b32 s89, 1
    v_mfma_f32_16x16x32_bf16 v[208:211], a[0:3], a[144:147], 0
    s_add_u32 m0, s61, 0
    ds_read_b64_tr_b16 a[128:129], v242 offset:32768
    v_mfma_f32_16x16x32_bf16 v[208:211], a[4:7], a[148:151], v[208:211]
    buffer_load_dwordx4 v248, s[40:43], s52 offen offset:0 lds
    v_mfma_f32_16x16x32_bf16 v[212:215], a[8:11], a[144:147], 0
    v_mfma_f32_16x16x32_bf16 v[212:215], a[12:15], a[148:151], v[212:215]
    ds_read_b64_tr_b16 a[130:131], v242 offset:33280
    v_mfma_f32_16x16x32_bf16 v[216:219], a[16:19], a[144:147], 0
    v_mfma_f32_16x16x32_bf16 v[216:219], a[20:23], a[148:151], v[216:219]
    buffer_load_dwordx4 v249, s[40:43], s53 offen offset:1024 lds
    v_mfma_f32_16x16x32_bf16 v[220:223], a[24:27], a[144:147], 0
    ds_read_b64_tr_b16 a[132:133], v242 offset:36864
    v_mfma_f32_16x16x32_bf16 v[220:223], a[28:31], a[148:151], v[220:223]
    v_mfma_f32_16x16x32_bf16 v[224:227], a[32:35], a[144:147], 0
    v_mfma_f32_16x16x32_bf16 v[224:227], a[36:39], a[148:151], v[224:227]
    ds_read_b64_tr_b16 a[134:135], v242 offset:37376
    buffer_load_dwordx4 v248, s[40:43], s54 offen offset:2048 lds
    v_mfma_f32_16x16x32_bf16 v[228:231], a[40:43], a[144:147], 0
    v_mfma_f32_16x16x32_bf16 v[228:231], a[44:47], a[148:151], v[228:231]
    v_mfma_f32_16x16x32_bf16 v[232:235], a[48:51], a[144:147], 0
    v_mfma_f32_16x16x32_bf16 v[232:235], a[52:55], a[148:151], v[232:235]
    buffer_load_dwordx4 v249, s[40:43], s55 offen offset:3072 lds
    v_mfma_f32_16x16x32_bf16 v[236:239], a[56:59], a[144:147], 0
    s_add_u32 m0, s61, 4096
    v_mfma_f32_16x16x32_bf16 v[236:239], a[60:63], a[148:151], v[236:239]
    v_mfma_f32_16x16x32_bf16 a[208:211], a[0:3], a[152:155], 0
    ds_read_b64_tr_b16 a[136:137], v243 offset:32768
    v_mfma_f32_16x16x32_bf16 a[208:211], a[4:7], a[156:159], a[208:211]
    buffer_load_dwordx4 v248, s[40:43], s56 offen offset:0 lds
    v_mfma_f32_16x16x32_bf16 a[212:215], a[8:11], a[152:155], 0
    v_mfma_f32_16x16x32_bf16 a[212:215], a[12:15], a[156:159], a[212:215]
    ds_read_b64_tr_b16 a[138:139], v243 offset:33280
    v_mfma_f32_16x16x32_bf16 a[216:219], a[16:19], a[152:155], 0
    v_mfma_f32_16x16x32_bf16 a[216:219], a[20:23], a[156:159], a[216:219]
    buffer_load_dwordx4 v249, s[40:43], s57 offen offset:1024 lds
    v_mfma_f32_16x16x32_bf16 a[220:223], a[24:27], a[152:155], 0
    ds_read_b64_tr_b16 a[140:141], v243 offset:36864
    v_mfma_f32_16x16x32_bf16 a[220:223], a[28:31], a[156:159], a[220:223]
    v_mfma_f32_16x16x32_bf16 a[224:227], a[32:35], a[152:155], 0
    v_mfma_f32_16x16x32_bf16 a[224:227], a[36:39], a[156:159], a[224:227]
    ds_read_b64_tr_b16 a[142:143], v243 offset:37376
    buffer_load_dwordx4 v248, s[40:43], s58 offen offset:2048 lds
    v_mfma_f32_16x16x32_bf16 a[228:231], a[40:43], a[152:155], 0
    v_mfma_f32_16x16x32_bf16 a[228:231], a[44:47], a[156:159], a[228:231]
    v_mfma_f32_16x16x32_bf16 a[232:235], a[48:51], a[152:155], 0
    v_mfma_f32_16x16x32_bf16 a[232:235], a[52:55], a[156:159], a[232:235]
    buffer_load_dwordx4 v249, s[40:43], s59 offen offset:3072 lds
    v_add_u32 v248, s63, v248
    v_mfma_f32_16x16x32_bf16 a[236:239], a[56:59], a[152:155], 0
    v_add_u32 v249, s63, v249
    v_mfma_f32_16x16x32_bf16 a[236:239], a[60:63], a[156:159], a[236:239]
    s_waitcnt lgkmcnt(4)
    v_mfma_f32_16x16x32_bf16 v[16:19], a[64:67], a[128:131], v[16:19]
    s_add_u32 m0, s60, 32768
    ds_read_b64_tr_b16 a[144:145], v244 offset:32768
    v_mfma_f32_16x16x32_bf16 v[16:19], a[68:71], a[132:135], v[16:19]
    buffer_load_dwordx4 v246, s[36:39], s44 offen offset:0 lds
    v_mfma_f32_16x16x32_bf16 v[20:23], a[72:75], a[128:131], v[20:23]
    ds_read_b64_tr_b16 a[146:147], v244 offset:33280
    v_mfma_f32_16x16x32_bf16 v[20:23], a[76:79], a[132:135], v[20:23]
    v_mfma_f32_16x16x32_bf16 v[24:27], a[80:83], a[128:131], v[24:27]
    ds_read_b64_tr_b16 a[148:149], v244 offset:36864
    v_mfma_f32_16x16x32_bf16 v[24:27], a[84:87], a[132:135], v[24:27]
    v_mfma_f32_16x16x32_bf16 v[28:31], a[88:91], a[128:131], v[28:31]
    ds_read_b64_tr_b16 a[150:151], v244 offset:37376
    buffer_load_dwordx4 v247, s[36:39], s45 offen offset:1024 lds
    v_mfma_f32_16x16x32_bf16 v[28:31], a[92:95], a[132:135], v[28:31]
    v_mfma_f32_16x16x32_bf16 v[32:35], a[96:99], a[128:131], v[32:35]
    ds_read_b128 a[0:3], v240 offset:0
    v_mfma_f32_16x16x32_bf16 v[32:35], a[100:103], a[132:135], v[32:35]
    v_mfma_f32_16x16x32_bf16 v[36:39], a[104:107], a[128:131], v[36:39]
    ds_read_b128 a[4:7], v241 offset:0
    v_mfma_f32_16x16x32_bf16 v[36:39], a[108:111], a[132:135], v[36:39]
    buffer_load_dwordx4 v246, s[36:39], s46 offen offset:2048 lds
    v_mfma_f32_16x16x32_bf16 v[40:43], a[112:115], a[128:131], v[40:43]
    v_mfma_f32_16x16x32_bf16 v[40:43], a[116:119], a[132:135], v[40:43]
    v_mfma_f32_16x16x32_bf16 v[44:47], a[120:123], a[128:131], v[44:47]
    v_mfma_f32_16x16x32_bf16 v[44:47], a[124:127], a[132:135], v[44:47]
    s_waitcnt lgkmcnt(6)
    v_mfma_f32_16x16x32_bf16 v[48:51], a[64:67], a[136:139], v[48:51]
    ds_read_b64_tr_b16 a[152:153], v245 offset:32768
    buffer_load_dwordx4 v247, s[36:39], s47 offen offset:3072 lds
    v_mfma_f32_16x16x32_bf16 v[48:51], a[68:71], a[140:143], v[48:51]
    s_add_u32 m0, s60, 36864
    v_mfma_f32_16x16x32_bf16 v[52:55], a[72:75], a[136:139], v[52:55]
    ds_read_b64_tr_b16 a[154:155], v245 offset:33280
    v_mfma_f32_16x16x32_bf16 v[52:55], a[76:79], a[140:143], v[52:55]
    v_mfma_f32_16x16x32_bf16 v[56:59], a[80:83], a[136:139], v[56:59]
    ds_read_b64_tr_b16 a[156:157], v245 offset:36864
    v_mfma_f32_16x16x32_bf16 v[56:59], a[84:87], a[140:143], v[56:59]
    buffer_load_dwordx4 v246, s[36:39], s48 offen offset:0 lds
    v_mfma_f32_16x16x32_bf16 v[60:63], a[88:91], a[136:139], v[60:63]
    ds_read_b64_tr_b16 a[158:159], v245 offset:37376
    v_mfma_f32_16x16x32_bf16 v[60:63], a[92:95], a[140:143], v[60:63]
    v_mfma_f32_16x16x32_bf16 v[64:67], a[96:99], a[136:139], v[64:67]
    ds_read_b128 a[8:11], v240 offset:2048
    v_mfma_f32_16x16x32_bf16 v[64:67], a[100:103], a[140:143], v[64:67]
    v_mfma_f32_16x16x32_bf16 v[68:71], a[104:107], a[136:139], v[68:71]
    ds_read_b128 a[12:15], v241 offset:2048
    buffer_load_dwordx4 v247, s[36:39], s49 offen offset:1024 lds
    v_mfma_f32_16x16x32_bf16 v[68:71], a[108:111], a[140:143], v[68:71]
    v_mfma_f32_16x16x32_bf16 v[72:75], a[112:115], a[136:139], v[72:75]
    ds_read_b128 a[16:19], v240 offset:4096
    v_mfma_f32_16x16x32_bf16 v[72:75], a[116:119], a[140:143], v[72:75]
    v_mfma_f32_16x16x32_bf16 v[76:79], a[120:123], a[136:139], v[76:79]
    v_mfma_f32_16x16x32_bf16 v[76:79], a[124:127], a[140:143], v[76:79]
    s_waitcnt lgkmcnt(9)
    buffer_load_dwordx4 v246, s[36:39], s50 offen offset:2048 lds
    v_mfma_f32_16x16x32_bf16 v[80:83], a[64:67], a[144:147], v[80:83]
    ds_read_b64_tr_b16 a[128:129], v242 offset:40960
    v_mfma_f32_16x16x32_bf16 v[80:83], a[68:71], a[148:151], v[80:83]
    v_mfma_f32_16x16x32_bf16 v[84:87], a[72:75], a[144:147], v[84:87]
    ds_read_b64_tr_b16 a[130:131], v242 offset:41472
    v_mfma_f32_16x16x32_bf16 v[84:87], a[76:79], a[148:151], v[84:87]
    v_mfma_f32_16x16x32_bf16 v[88:91], a[80:83], a[144:147], v[88:91]
    ds_read_b64_tr_b16 a[132:133], v242 offset:45056
    buffer_load_dwordx4 v247, s[36:39], s51 offen offset:3072 lds
    v_mfma_f32_16x16x32_bf16 v[88:91], a[84:87], a[148:151], v[88:91]
    v_add_u32 v246, s62, v246
    v_add_u32 v247, s62, v247
    v_mfma_f32_16x16x32_bf16 v[92:95], a[88:91], a[144:147], v[92:95]
    ds_read_b64_tr_b16 a[134:135], v242 offset:45568
    v_mfma_f32_16x16x32_bf16 v[92:95], a[92:95], a[148:151], v[92:95]
    v_mfma_f32_16x16x32_bf16 v[96:99], a[96:99], a[144:147], v[96:99]
    ds_read_b128 a[20:23], v241 offset:4096
    v_mfma_f32_16x16x32_bf16 v[96:99], a[100:103], a[148:151], v[96:99]
    v_mfma_f32_16x16x32_bf16 v[100:103], a[104:107], a[144:147], v[100:103]
    ds_read_b128 a[24:27], v240 offset:6144
    v_mfma_f32_16x16x32_bf16 v[100:103], a[108:111], a[148:151], v[100:103]
    v_mfma_f32_16x16x32_bf16 v[104:107], a[112:115], a[144:147], v[104:107]
    ds_read_b128 a[28:31], v241 offset:6144
    v_mfma_f32_16x16x32_bf16 v[104:107], a[116:119], a[148:151], v[104:107]
    v_mfma_f32_16x16x32_bf16 v[108:111], a[120:123], a[144:147], v[108:111]
    v_mfma_f32_16x16x32_bf16 v[108:111], a[124:127], a[148:151], v[108:111]
    s_waitcnt lgkmcnt(10)
    v_mfma_f32_16x16x32_bf16 v[112:115], a[64:67], a[152:155], v[112:115]
    ds_read_b64_tr_b16 a[136:137], v243 offset:40960
    v_mfma_f32_16x16x32_bf16 v[112:115], a[68:71], a[156:159], v[112:115]
    v_mfma_f32_16x16x32_bf16 v[116:119], a[72:75], a[152:155], v[116:119]
    ds_read_b64_tr_b16 a[138:139], v243 offset:41472
    v_mfma_f32_16x16x32_bf16 v[116:119], a[76:79], a[156:159], v[116:119]
    v_mfma_f32_16x16x32_bf16 v[120:123], a[80:83], a[152:155], v[120:123]
    ds_read_b64_tr_b16 a[140:141], v243 offset:45056
    v_mfma_f32_16x16x32_bf16 v[120:123], a[84:87], a[156:159], v[120:123]
    v_mfma_f32_16x16x32_bf16 v[124:127], a[88:91], a[152:155], v[124:127]
    ds_read_b64_tr_b16 a[142:143], v243 offset:45568
    v_mfma_f32_16x16x32_bf16 v[124:127], a[92:95], a[156:159], v[124:127]
    v_mfma_f32_16x16x32_bf16 v[128:131], a[96:99], a[152:155], v[128:131]
    ds_read_b128 a[32:35], v240 offset:8192
    v_mfma_f32_16x16x32_bf16 v[128:131], a[100:103], a[156:159], v[128:131]
    v_mfma_f32_16x16x32_bf16 v[132:135], a[104:107], a[152:155], v[132:135]
    ds_read_b128 a[36:39], v241 offset:8192
    v_mfma_f32_16x16x32_bf16 v[132:135], a[108:111], a[156:159], v[132:135]
    v_mfma_f32_16x16x32_bf16 v[136:139], a[112:115], a[152:155], v[136:139]
    v_mfma_f32_16x16x32_bf16 v[136:139], a[116:119], a[156:159], v[136:139]
    v_mfma_f32_16x16x32_bf16 v[140:143], a[120:123], a[152:155], v[140:143]
    v_mfma_f32_16x16x32_bf16 v[140:143], a[124:127], a[156:159], v[140:143]
    s_waitcnt lgkmcnt(9)
    v_mfma_f32_16x16x32_bf16 v[144:147], a[64:67], a[128:131], v[144:147]
    ds_read_b64_tr_b16 a[144:145], v244 offset:40960
    v_mfma_f32_16x16x32_bf16 v[144:147], a[68:71], a[132:135], v[144:147]
    v_mfma_f32_16x16x32_bf16 v[148:151], a[72:75], a[128:131], v[148:151]
    ds_read_b64_tr_b16 a[146:147], v244 offset:41472
    v_mfma_f32_16x16x32_bf16 v[148:151], a[76:79], a[132:135], v[148:151]
    v_mfma_f32_16x16x32_bf16 v[152:155], a[80:83], a[128:131], v[152:155]
    ds_read_b64_tr_b16 a[148:149], v244 offset:45056
    v_mfma_f32_16x16x32_bf16 v[152:155], a[84:87], a[132:135], v[152:155]
    v_mfma_f32_16x16x32_bf16 v[156:159], a[88:91], a[128:131], v[156:159]
    ds_read_b64_tr_b16 a[150:151], v244 offset:45568
    v_mfma_f32_16x16x32_bf16 v[156:159], a[92:95], a[132:135], v[156:159]
    v_mfma_f32_16x16x32_bf16 v[160:163], a[96:99], a[128:131], v[160:163]
    ds_read_b128 a[40:43], v240 offset:10240
    v_mfma_f32_16x16x32_bf16 v[160:163], a[100:103], a[132:135], v[160:163]
    v_mfma_f32_16x16x32_bf16 v[164:167], a[104:107], a[128:131], v[164:167]
    ds_read_b128 a[44:47], v241 offset:10240
    v_mfma_f32_16x16x32_bf16 v[164:167], a[108:111], a[132:135], v[164:167]
    v_mfma_f32_16x16x32_bf16 v[168:171], a[112:115], a[128:131], v[168:171]
    ds_read_b128 a[48:51], v240 offset:12288
    v_mfma_f32_16x16x32_bf16 v[168:171], a[116:119], a[132:135], v[168:171]
    v_mfma_f32_16x16x32_bf16 v[172:175], a[120:123], a[128:131], v[172:175]
    v_mfma_f32_16x16x32_bf16 v[172:175], a[124:127], a[132:135], v[172:175]
    s_waitcnt lgkmcnt(9)
    v_mfma_f32_16x16x32_bf16 v[176:179], a[64:67], a[136:139], v[176:179]
    ds_read_b64_tr_b16 a[152:153], v245 offset:40960
    v_mfma_f32_16x16x32_bf16 v[176:179], a[68:71], a[140:143], v[176:179]
    v_mfma_f32_16x16x32_bf16 v[180:183], a[72:75], a[136:139], v[180:183]
    ds_read_b64_tr_b16 a[154:155], v245 offset:41472
    v_mfma_f32_16x16x32_bf16 v[180:183], a[76:79], a[140:143], v[180:183]
    v_mfma_f32_16x16x32_bf16 v[184:187], a[80:83], a[136:139], v[184:187]
    ds_read_b64_tr_b16 a[156:157], v245 offset:45056
    v_mfma_f32_16x16x32_bf16 v[184:187], a[84:87], a[140:143], v[184:187]
    v_mfma_f32_16x16x32_bf16 v[188:191], a[88:91], a[136:139], v[188:191]
    ds_read_b64_tr_b16 a[158:159], v245 offset:45568
    v_mfma_f32_16x16x32_bf16 v[188:191], a[92:95], a[140:143], v[188:191]
    v_mfma_f32_16x16x32_bf16 v[192:195], a[96:99], a[136:139], v[192:195]
    ds_read_b128 a[52:55], v241 offset:12288
    v_mfma_f32_16x16x32_bf16 v[192:195], a[100:103], a[140:143], v[192:195]
    v_mfma_f32_16x16x32_bf16 v[196:199], a[104:107], a[136:139], v[196:199]
    ds_read_b128 a[56:59], v240 offset:14336
    v_mfma_f32_16x16x32_bf16 v[196:199], a[108:111], a[140:143], v[196:199]
    v_mfma_f32_16x16x32_bf16 v[200:203], a[112:115], a[136:139], v[200:203]
    ds_read_b128 a[60:63], v241 offset:14336
    v_mfma_f32_16x16x32_bf16 v[200:203], a[116:119], a[140:143], v[200:203]
    v_mfma_f32_16x16x32_bf16 v[204:207], a[120:123], a[136:139], v[204:207]
    v_mfma_f32_16x16x32_bf16 v[204:207], a[124:127], a[140:143], v[204:207]
    s_waitcnt vmcnt(0) lgkmcnt(0)
    s_barrier
    v_mfma_f32_16x16x32_bf16 v[208:211], a[64:67], a[144:147], v[208:211]
    s_add_u32 m0, s61, 32768
    ds_read_b64_tr_b16 a[128:129], v242 offset:0
    v_mfma_f32_16x16x32_bf16 v[208:211], a[68:71], a[148:151], v[208:211]
    buffer_load_dwordx4 v248, s[40:43], s52 offen offset:0 lds
    v_mfma_f32_16x16x32_bf16 v[212:215], a[72:75], a[144:147], v[212:215]
    v_mfma_f32_16x16x32_bf16 v[212:215], a[76:79], a[148:151], v[212:215]
    ds_read_b64_tr_b16 a[130:131], v242 offset:512
    v_mfma_f32_16x16x32_bf16 v[216:219], a[80:83], a[144:147], v[216:219]
    v_mfma_f32_16x16x32_bf16 v[216:219], a[84:87], a[148:151], v[216:219]
    buffer_load_dwordx4 v249, s[40:43], s53 offen offset:1024 lds
    v_mfma_f32_16x16x32_bf16 v[220:223], a[88:91], a[144:147], v[220:223]
    ds_read_b64_tr_b16 a[132:133], v242 offset:4096
    v_mfma_f32_16x16x32_bf16 v[220:223], a[92:95], a[148:151], v[220:223]
    v_mfma_f32_16x16x32_bf16 v[224:227], a[96:99], a[144:147], v[224:227]
    v_mfma_f32_16x16x32_bf16 v[224:227], a[100:103], a[148:151], v[224:227]
    ds_read_b64_tr_b16 a[134:135], v242 offset:4608
    buffer_load_dwordx4 v248, s[40:43], s54 offen offset:2048 lds
    v_mfma_f32_16x16x32_bf16 v[228:231], a[104:107], a[144:147], v[228:231]
    v_mfma_f32_16x16x32_bf16 v[228:231], a[108:111], a[148:151], v[228:231]
    v_mfma_f32_16x16x32_bf16 v[232:235], a[112:115], a[144:147], v[232:235]
    v_mfma_f32_16x16x32_bf16 v[232:235], a[116:119], a[148:151], v[232:235]
    buffer_load_dwordx4 v249, s[40:43], s55 offen offset:3072 lds
    v_mfma_f32_16x16x32_bf16 v[236:239], a[120:123], a[144:147], v[236:239]
    s_add_u32 m0, s61, 36864
    v_mfma_f32_16x16x32_bf16 v[236:239], a[124:127], a[148:151], v[236:239]
    v_mfma_f32_16x16x32_bf16 a[208:211], a[64:67], a[152:155], a[208:211]
    ds_read_b64_tr_b16 a[136:137], v243 offset:0
    v_mfma_f32_16x16x32_bf16 a[208:211], a[68:71], a[156:159], a[208:211]
    buffer_load_dwordx4 v248, s[40:43], s56 offen offset:0 lds
    v_mfma_f32_16x16x32_bf16 a[212:215], a[72:75], a[152:155], a[212:215]
    v_mfma_f32_16x16x32_bf16 a[212:215], a[76:79], a[156:159], a[212:215]
    ds_read_b64_tr_b16 a[138:139], v243 offset:512
    v_mfma_f32_16x16x32_bf16 a[216:219], a[80:83], a[152:155], a[216:219]
    v_mfma_f32_16x16x32_bf16 a[216:219], a[84:87], a[156:159], a[216:219]
    buffer_load_dwordx4 v249, s[40:43], s57 offen offset:1024 lds
    v_mfma_f32_16x16x32_bf16 a[220:223], a[88:91], a[152:155], a[220:223]
    ds_read_b64_tr_b16 a[140:141], v243 offset:4096
    v_mfma_f32_16x16x32_bf16 a[220:223], a[92:95], a[156:159], a[220:223]
    v_mfma_f32_16x16x32_bf16 a[224:227], a[96:99], a[152:155], a[224:227]
    v_mfma_f32_16x16x32_bf16 a[224:227], a[100:103], a[156:159], a[224:227]
    ds_read_b64_tr_b16 a[142:143], v243 offset:4608
    buffer_load_dwordx4 v248, s[40:43], s58 offen offset:2048 lds
    v_mfma_f32_16x16x32_bf16 a[228:231], a[104:107], a[152:155], a[228:231]
    v_mfma_f32_16x16x32_bf16 a[228:231], a[108:111], a[156:159], a[228:231]
    v_mfma_f32_16x16x32_bf16 a[232:235], a[112:115], a[152:155], a[232:235]
    v_mfma_f32_16x16x32_bf16 a[232:235], a[116:119], a[156:159], a[232:235]
    buffer_load_dwordx4 v249, s[40:43], s59 offen offset:3072 lds
    v_add_u32 v248, s63, v248
    v_mfma_f32_16x16x32_bf16 a[236:239], a[120:123], a[152:155], a[236:239]
    v_add_u32 v249, s63, v249
    v_mfma_f32_16x16x32_bf16 a[236:239], a[124:127], a[156:159], a[236:239]
    s_branch g1_S_ctl
g1_S_loop:
    s_waitcnt lgkmcnt(4)
    v_mfma_f32_16x16x32_bf16 v[16:19], a[0:3], a[128:131], v[16:19]
    s_add_u32 m0, s60, 0
    ds_read_b64_tr_b16 a[144:145], v244 offset:0
    v_mfma_f32_16x16x32_bf16 v[16:19], a[4:7], a[132:135], v[16:19]
    buffer_load_dwordx4 v246, s[36:39], s44 offen offset:0 lds
    v_mfma_f32_16x16x32_bf16 v[20:23], a[8:11], a[128:131], v[20:23]
    ds_read_b64_tr_b16 a[146:147], v244 offset:512
    v_mfma_f32_16x16x32_bf16 v[20:23], a[12:15], a[132:135], v[20:23]
    v_mfma_f32_16x16x32_bf16 v[24:27], a[16:19], a[128:131], v[24:27]
    ds_read_b64_tr_b16 a[148:149], v244 offset:4096
    v_mfma_f32_16x16x32_bf16 v[24:27], a[20:23], a[132:135], v[24:27]
    v_mfma_f32_16x16x32_bf16 v[28:31], a[24:27], a[128:131], v[28:31]
    ds_read_b64_tr_b16 a[150:151], v244 offset:4608
    buffer_load_dwordx4 v247, s[36:39], s45 offen offset:1024 lds
    v_mfma_f32_16x16x32_bf16 v[28:31], a[28:31], a[132:135], v[28:31]
    v_mfma_f32_16x16x32_bf16 v[32:35], a[32:35], a[128:131], v[32:35]
    ds_read_b128 a[64:67], v240 offset:32768
    v_mfma_f32_16x16x32_bf16 v[32:35], a[36:39], a[132:135], v[32:35]
    v_mfma_f32_16x16x32_bf16 v[36:39], a[40:43], a[128:131], v[36:39]
    ds_read_b128 a[68:71], v241 offset:32768
    v_mfma_f32_16x16x32_bf16 v[36:39], a[44:47], a[132:135], v[36:39]
    buffer_load_dwordx4 v246, s[36:39], s46 offen offset:2048 lds
    v_mfma_f32_16x16x32_bf16 v[40:43], a[48:51], a[128:131], v[40:43]
    v_mfma_f32_16x16x32_bf16 v[40:43], a[52:55], a[132:135], v[40:43]
    v_mfma_f32_16x16x32_bf16 v[44:47], a[56:59], a[128:131], v[44:47]
    v_mfma_f32_16x16x32_bf16 v[44:47], a[60:63], a[132:135], v[44:47]
    s_waitcnt lgkmcnt(6)
    v_mfma_f32_16x16x32_bf16 v[48:51], a[0:3], a[136:139], v[48:51]
    ds_read_b64_tr_b16 a[152:153], v245 offset:0
    buffer_load_dwordx4 v247, s[36:39], s47 offen offset:3072 lds
    v_mfma_f32_16x16x32_bf16 v[48:51], a[4:7], a[140:143], v[48:51]
    s_add_u32 m0, s60, 4096
    v_mfma_f32_16x16x32_bf16 v[52:55], a[8:11], a[136:139], v[52:55]
    ds_read_b64_tr_b16 a[154:155], v245 offset:512
    v_mfma_f32_16x16x32_bf16 v[52:55], a[12:15], a[140:143], v[52:55]
    v_mfma_f32_16x16x32_bf16 v[56:59], a[16:19], a[136:139], v[56:59]
    ds_read_b64_tr_b16 a[156:157], v245 offset:4096
    v_mfma_f32_16x16x32_bf16 v[56:59], a[20:23], a[140:143], v[56:59]
    buffer_load_dwordx4 v246, s[36:39], s48 offen offset:0 lds
    v_mfma_f32_16x16x32_bf16 v[60:63], a[24:27], a[136:139], v[60:63]
    ds_read_b64_tr_b16 a[158:159], v245 offset:4608
    v_mfma_f32_16x16x32_bf16 v[60:63], a[28:31], a[140:143], v[60:63]
    v_mfma_f32_16x16x32_bf16 v[64:67], a[32:35], a[136:139], v[64:67]
    ds_read_b128 a[72:75], v240 offset:34816
    v_mfma_f32_16x16x32_bf16 v[64:67], a[36:39], a[140:143], v[64:67]
    v_mfma_f32_16x16x32_bf16 v[68:71], a[40:43], a[136:139], v[68:71]
    ds_read_b128 a[76:79], v241 offset:34816
    buffer_load_dwordx4 v247, s[36:39], s49 offen offset:1024 lds
    v_mfma_f32_16x16x32_bf16 v[68:71], a[44:47], a[140:143], v[68:71]
    v_mfma_f32_16x16x32_bf16 v[72:75], a[48:51], a[136:139], v[72:75]
    ds_read_b128 a[80:83], v240 offset:36864
    v_mfma_f32_16x16x32_bf16 v[72:75], a[52:55], a[140:143], v[72:75]
    v_mfma_f32_16x16x32_bf16 v[76:79], a[56:59], a[136:139], v[76:79]
    v_mfma_f32_16x16x32_bf16 v[76:79], a[60:63], a[140:143], v[76:79]
    s_waitcnt lgkmcnt(9)
    buffer_load_dwordx4 v246, s[36:39], s50 offen offset:2048 lds
    v_mfma_f32_16x16x32_bf16 v[80:83], a[0:3], a[144:147], v[80:83]
    ds_read_b64_tr_b16 a[128:129], v242 offset:8192
    v_mfma_f32_16x16x32_bf16 v[80:83], a[4:7], a[148:151], v[80:83]
    v_mfma_f32_16x16x32_bf16 v[84:87], a[8:11], a[144:147], v[84:87]
    ds_read_b64_tr_b16 a[130:131], v242 offset:8704
    v_mfma_f32_16x16x32_bf16 v[84:87], a[12:15], a[148:151], v[84:87]
    v_mfma_f32_16x16x32_bf16 v[88:91], a[16:19], a[144:147], v[88:91]
    ds_read_b64_tr_b16 a[132:133], v242 offset:12288
    buffer_load_dwordx4 v247, s[36:39], s51 offen offset:3072 lds
    v_mfma_f32_16x16x32_bf16 v[88:91], a[20:23], a[148:151], v[88:91]
    v_add_u32 v246, s62, v246
    v_add_u32 v247, s62, v247
    v_mfma_f32_16x16x32_bf16 v[92:95], a[24:27], a[144:147], v[92:95]
    ds_read_b64_tr_b16 a[134:135], v242 offset:12800
    v_mfma_f32_16x16x32_bf16 v[92:95], a[28:31], a[148:151], v[92:95]
    v_mfma_f32_16x16x32_bf16 v[96:99], a[32:35], a[144:147], v[96:99]
    ds_read_b128 a[84:87], v241 offset:36864
    v_mfma_f32_16x16x32_bf16 v[96:99], a[36:39], a[148:151], v[96:99]
    buffer_load_dword v255, v254, s[76:79], 0 offen
    v_add_u32 v254, s20, v254
    v_mfma_f32_16x16x32_bf16 v[100:103], a[40:43], a[144:147], v[100:103]
    ds_read_b128 a[88:91], v240 offset:38912
    v_mfma_f32_16x16x32_bf16 v[100:103], a[44:47], a[148:151], v[100:103]
    v_mfma_f32_16x16x32_bf16 v[104:107], a[48:51], a[144:147], v[104:107]
    ds_read_b128 a[92:95], v241 offset:38912
    v_mfma_f32_16x16x32_bf16 v[104:107], a[52:55], a[148:151], v[104:107]
    v_mfma_f32_16x16x32_bf16 v[108:111], a[56:59], a[144:147], v[108:111]
    buffer_load_dword a240, v251, s[84:87], s90 offen sc1
    v_mfma_f32_16x16x32_bf16 v[108:111], a[60:63], a[148:151], v[108:111]
    s_waitcnt lgkmcnt(10)
    v_mfma_f32_16x16x32_bf16 v[112:115], a[0:3], a[152:155], v[112:115]
    ds_read_b64_tr_b16 a[136:137], v243 offset:8192
    v_mfma_f32_16x16x32_bf16 v[112:115], a[4:7], a[156:159], v[112:115]
    v_mfma_f32_16x16x32_bf16 v[116:119], a[8:11], a[152:155], v[116:119]
    ds_read_b64_tr_b16 a[138:139], v243 offset:8704
    v_mfma_f32_16x16x32_bf16 v[116:119], a[12:15], a[156:159], v[116:119]
    v_mfma_f32_16x16x32_bf16 v[120:123], a[16:19], a[152:155], v[120:123]
    ds_read_b64_tr_b16 a[140:141], v243 offset:12288
    v_mfma_f32_16x16x32_bf16 v[120:123], a[20:23], a[156:159], v[120:123]
    v_mfma_f32_16x16x32_bf16 v[124:127], a[24:27], a[152:155], v[124:127]
    ds_read_b64_tr_b16 a[142:143], v243 offset:12800
    v_mfma_f32_16x16x32_bf16 v[124:127], a[28:31], a[156:159], v[124:127]
    v_mfma_f32_16x16x32_bf16 v[128:131], a[32:35], a[152:155], v[128:131]
    ds_read_b128 a[96:99], v240 offset:40960
    v_mfma_f32_16x16x32_bf16 v[128:131], a[36:39], a[156:159], v[128:131]
    v_mfma_f32_16x16x32_bf16 v[132:135], a[40:43], a[152:155], v[132:135]
    ds_read_b128 a[100:103], v241 offset:40960
    v_mfma_f32_16x16x32_bf16 v[132:135], a[44:47], a[156:159], v[132:135]
    v_mfma_f32_16x16x32_bf16 v[136:139], a[48:51], a[152:155], v[136:139]
    v_mfma_f32_16x16x32_bf16 v[136:139], a[52:55], a[156:159], v[136:139]
    v_mfma_f32_16x16x32_bf16 v[140:143], a[56:59], a[152:155], v[140:143]
    v_mfma_f32_16x16x32_bf16 v[140:143], a[60:63], a[156:159], v[140:143]
    s_waitcnt lgkmcnt(9)
    v_mfma_f32_16x16x32_bf16 v[144:147], a[0:3], a[128:131], v[144:147]
    ds_read_b64_tr_b16 a[144:145], v244 offset:8192
    v_mfma_f32_16x16x32_bf16 v[144:147], a[4:7], a[132:135], v[144:147]
    v_mfma_f32_16x16x32_bf16 v[148:151], a[8:11], a[128:131], v[148:151]
    ds_read_b64_tr_b16 a[146:147], v244 offset:8704
    v_mfma_f32_16x16x32_bf16 v[148:151], a[12:15], a[132:135], v[148:151]
    v_mfma_f32_16x16x32_bf16 v[152:155], a[16:19], a[128:131], v[152:155]
    ds_read_b64_tr_b16 a[148:149], v244 offset:12288
    v_mfma_f32_16x16x32_bf16 v[152:155], a[20:23], a[132:135], v[152:155]
    v_mfma_f32_16x16x32_bf16 v[156:159], a[24:27], a[128:131], v[156:159]
    ds_read_b64_tr_b16 a[150:151], v244 offset:12800
    v_mfma_f32_16x16x32_bf16 v[156:159], a[28:31], a[132:135], v[156:159]
    v_mfma_f32_16x16x32_bf16 v[160:163], a[32:35], a[128:131], v[160:163]
    ds_read_b128 a[104:107], v240 offset:43008
    v_mfma_f32_16x16x32_bf16 v[160:163], a[36:39], a[132:135], v[160:163]
    v_mfma_f32_16x16x32_bf16 v[164:167], a[40:43], a[128:131], v[164:167]
    ds_read_b128 a[108:111], v241 offset:43008
    v_mfma_f32_16x16x32_bf16 v[164:167], a[44:47], a[132:135], v[164:167]
    v_mfma_f32_16x16x32_bf16 v[168:171], a[48:51], a[128:131], v[168:171]
    ds_read_b128 a[112:115], v240 offset:45056
    v_mfma_f32_16x16x32_bf16 v[168:171], a[52:55], a[132:135], v[168:171]
    v_mfma_f32_16x16x32_bf16 v[172:175], a[56:59], a[128:131], v[172:175]
    v_mfma_f32_16x16x32_bf16 v[172:175], a[60:63], a[132:135], v[172:175]
    s_waitcnt lgkmcnt(9)
    v_mfma_f32_16x16x32_bf16 v[176:179], a[0:3], a[136:139], v[176:179]
    ds_read_b64_tr_b16 a[152:153], v245 offset:8192
    v_mfma_f32_16x16x32_bf16 v[176:179], a[4:7], a[140:143], v[176:179]
    v_mfma_f32_16x16x32_bf16 v[180:183], a[8:11], a[136:139], v[180:183]
    ds_read_b64_tr_b16 a[154:155], v245 offset:8704
    v_mfma_f32_16x16x32_bf16 v[180:183], a[12:15], a[140:143], v[180:183]
    v_mfma_f32_16x16x32_bf16 v[184:187], a[16:19], a[136:139], v[184:187]
    ds_read_b64_tr_b16 a[156:157], v245 offset:12288
    v_mfma_f32_16x16x32_bf16 v[184:187], a[20:23], a[140:143], v[184:187]
    v_mfma_f32_16x16x32_bf16 v[188:191], a[24:27], a[136:139], v[188:191]
    ds_read_b64_tr_b16 a[158:159], v245 offset:12800
    v_mfma_f32_16x16x32_bf16 v[188:191], a[28:31], a[140:143], v[188:191]
    v_mfma_f32_16x16x32_bf16 v[192:195], a[32:35], a[136:139], v[192:195]
    ds_read_b128 a[116:119], v241 offset:45056
    v_mfma_f32_16x16x32_bf16 v[192:195], a[36:39], a[140:143], v[192:195]
    v_mfma_f32_16x16x32_bf16 v[196:199], a[40:43], a[136:139], v[196:199]
    ds_read_b128 a[120:123], v240 offset:47104
    v_mfma_f32_16x16x32_bf16 v[196:199], a[44:47], a[140:143], v[196:199]
    v_mfma_f32_16x16x32_bf16 v[200:203], a[48:51], a[136:139], v[200:203]
    ds_read_b128 a[124:127], v241 offset:47104
    v_mfma_f32_16x16x32_bf16 v[200:203], a[52:55], a[140:143], v[200:203]
    v_mfma_f32_16x16x32_bf16 v[204:207], a[56:59], a[136:139], v[204:207]
    v_mfma_f32_16x16x32_bf16 v[204:207], a[60:63], a[140:143], v[204:207]
    s_waitcnt vmcnt(2) lgkmcnt(0)
    s_barrier
    v_mfma_f32_16x16x32_bf16 v[208:211], a[0:3], a[144:147], v[208:211]
    s_add_u32 m0, s61, 0
    ds_read_b64_tr_b16 a[128:129], v242 offset:32768
    v_mfma_f32_16x16x32_bf16 v[208:211], a[4:7], a[148:151], v[208:211]
    buffer_load_dwordx4 v248, s[40:43], s52 offen offset:0 lds
    v_mfma_f32_16x16x32_bf16 v[212:215], a[8:11], a[144:147], v[212:215]
    v_mfma_f32_16x16x32_bf16 v[212:215], a[12:15], a[148:151], v[212:215]
    ds_read_b64_tr_b16 a[130:131], v242 offset:33280
    v_mfma_f32_16x16x32_bf16 v[216:219], a[16:19], a[144:147], v[216:219]
    v_mfma_f32_16x16x32_bf16 v[216:219], a[20:23], a[148:151], v[216:219]
    buffer_load_dwordx4 v249, s[40:43], s53 offen offset:1024 lds
    v_mfma_f32_16x16x32_bf16 v[220:223], a[24:27], a[144:147], v[220:223]
    ds_read_b64_tr_b16 a[132:133], v242 offset:36864
    v_mfma_f32_16x16x32_bf16 v[220:223], a[28:31], a[148:151], v[220:223]
    v_mfma_f32_16x16x32_bf16 v[224:227], a[32:35], a[144:147], v[224:227]
    v_mfma_f32_16x16x32_bf16 v[224:227], a[36:39], a[148:151], v[224:227]
    ds_read_b64_tr_b16 a[134:135], v242 offset:37376
    buffer_load_dwordx4 v248, s[40:43], s54 offen offset:2048 lds
    v_mfma_f32_16x16x32_bf16 v[228:231], a[40:43], a[144:147], v[228:231]
    v_mfma_f32_16x16x32_bf16 v[228:231], a[44:47], a[148:151], v[228:231]
    v_mfma_f32_16x16x32_bf16 v[232:235], a[48:51], a[144:147], v[232:235]
    v_mfma_f32_16x16x32_bf16 v[232:235], a[52:55], a[148:151], v[232:235]
    buffer_load_dwordx4 v249, s[40:43], s55 offen offset:3072 lds
    v_mfma_f32_16x16x32_bf16 v[236:239], a[56:59], a[144:147], v[236:239]
    s_add_u32 m0, s61, 4096
    v_mfma_f32_16x16x32_bf16 v[236:239], a[60:63], a[148:151], v[236:239]
    v_mfma_f32_16x16x32_bf16 a[208:211], a[0:3], a[152:155], a[208:211]
    ds_read_b64_tr_b16 a[136:137], v243 offset:32768
    v_mfma_f32_16x16x32_bf16 a[208:211], a[4:7], a[156:159], a[208:211]
    buffer_load_dwordx4 v248, s[40:43], s56 offen offset:0 lds
    v_mfma_f32_16x16x32_bf16 a[212:215], a[8:11], a[152:155], a[212:215]
    v_mfma_f32_16x16x32_bf16 a[212:215], a[12:15], a[156:159], a[212:215]
    ds_read_b64_tr_b16 a[138:139], v243 offset:33280
    v_mfma_f32_16x16x32_bf16 a[216:219], a[16:19], a[152:155], a[216:219]
    v_mfma_f32_16x16x32_bf16 a[216:219], a[20:23], a[156:159], a[216:219]
    buffer_load_dwordx4 v249, s[40:43], s57 offen offset:1024 lds
    v_mfma_f32_16x16x32_bf16 a[220:223], a[24:27], a[152:155], a[220:223]
    ds_read_b64_tr_b16 a[140:141], v243 offset:36864
    v_mfma_f32_16x16x32_bf16 a[220:223], a[28:31], a[156:159], a[220:223]
    v_mfma_f32_16x16x32_bf16 a[224:227], a[32:35], a[152:155], a[224:227]
    v_mfma_f32_16x16x32_bf16 a[224:227], a[36:39], a[156:159], a[224:227]
    ds_read_b64_tr_b16 a[142:143], v243 offset:37376
    buffer_load_dwordx4 v248, s[40:43], s58 offen offset:2048 lds
    v_mfma_f32_16x16x32_bf16 a[228:231], a[40:43], a[152:155], a[228:231]
    v_mfma_f32_16x16x32_bf16 a[228:231], a[44:47], a[156:159], a[228:231]
    v_mfma_f32_16x16x32_bf16 a[232:235], a[48:51], a[152:155], a[232:235]
    v_mfma_f32_16x16x32_bf16 a[232:235], a[52:55], a[156:159], a[232:235]
    buffer_load_dwordx4 v249, s[40:43], s59 offen offset:3072 lds
    v_add_u32 v248, s63, v248
    v_mfma_f32_16x16x32_bf16 a[236:239], a[56:59], a[152:155], a[236:239]
    v_add_u32 v249, s63, v249
    v_mfma_f32_16x16x32_bf16 a[236:239], a[60:63], a[156:159], a[236:239]
    s_waitcnt lgkmcnt(4)
    v_mfma_f32_16x16x32_bf16 v[16:19], a[64:67], a[128:131], v[16:19]
    s_add_u32 m0, s60, 32768
    ds_read_b64_tr_b16 a[144:145], v244 offset:32768
    v_mfma_f32_16x16x32_bf16 v[16:19], a[68:71], a[132:135], v[16:19]
    buffer_load_dwordx4 v246, s[36:39], s44 offen offset:0 lds
    v_mfma_f32_16x16x32_bf16 v[20:23], a[72:75], a[128:131], v[20:23]
    ds_read_b64_tr_b16 a[146:147], v244 offset:33280
    v_mfma_f32_16x16x32_bf16 v[20:23], a[76:79], a[132:135], v[20:23]
    v_mfma_f32_16x16x32_bf16 v[24:27], a[80:83], a[128:131], v[24:27]
    ds_read_b64_tr_b16 a[148:149], v244 offset:36864
    v_mfma_f32_16x16x32_bf16 v[24:27], a[84:87], a[132:135], v[24:27]
    v_mfma_f32_16x16x32_bf16 v[28:31], a[88:91], a[128:131], v[28:31]
    ds_read_b64_tr_b16 a[150:151], v244 offset:37376
    buffer_load_dwordx4 v247, s[36:39], s45 offen offset:1024 lds
    v_mfma_f32_16x16x32_bf16 v[28:31], a[92:95], a[132:135], v[28:31]
    v_mfma_f32_16x16x32_bf16 v[32:35], a[96:99], a[128:131], v[32:35]
    ds_read_b128 a[0:3], v240 offset:0
    v_mfma_f32_16x16x32_bf16 v[32:35], a[100:103], a[132:135], v[32:35]
    v_mfma_f32_16x16x32_bf16 v[36:39], a[104:107], a[128:131], v[36:39]
    ds_read_b128 a[4:7], v241 offset:0
    v_mfma_f32_16x16x32_bf16 v[36:39], a[108:111], a[132:135], v[36:39]
    buffer_load_dwordx4 v246, s[36:39], s46 offen offset:2048 lds
    v_mfma_f32_16x16x32_bf16 v[40:43], a[112:115], a[128:131], v[40:43]
    v_mfma_f32_16x16x32_bf16 v[40:43], a[116:119], a[132:135], v[40:43]
    v_mfma_f32_16x16x32_bf16 v[44:47], a[120:123], a[128:131], v[44:47]
    v_mfma_f32_16x16x32_bf16 v[44:47], a[124:127], a[132:135], v[44:47]
    s_waitcnt lgkmcnt(6)
    v_mfma_f32_16x16x32_bf16 v[48:51], a[64:67], a[136:139], v[48:51]
    ds_read_b64_tr_b16 a[152:153], v245 offset:32768
    buffer_load_dwordx4 v247, s[36:39], s47 offen offset:3072 lds
    v_mfma_f32_16x16x32_bf16 v[48:51], a[68:71], a[140:143], v[48:51]
    s_add_u32 m0, s60, 36864
    v_mfma_f32_16x16x32_bf16 v[52:55], a[72:75], a[136:139], v[52:55]
    ds_read_b64_tr_b16 a[154:155], v245 offset:33280
    v_mfma_f32_16x16x32_bf16 v[52:55], a[76:79], a[140:143], v[52:55]
    v_mfma_f32_16x16x32_bf16 v[56:59], a[80:83], a[136:139], v[56:59]
    ds_read_b64_tr_b16 a[156:157], v245 offset:36864
    v_mfma_f32_16x16x32_bf16 v[56:59], a[84:87], a[140:143], v[56:59]
    buffer_load_dwordx4 v246, s[36:39], s48 offen offset:0 lds
    v_mfma_f32_16x16x32_bf16 v[60:63], a[88:91], a[136:139], v[60:63]
    ds_read_b64_tr_b16 a[158:159], v245 offset:37376
    v_mfma_f32_16x16x32_bf16 v[60:63], a[92:95], a[140:143], v[60:63]
    v_mfma_f32_16x16x32_bf16 v[64:67], a[96:99], a[136:139], v[64:67]
    ds_read_b128 a[8:11], v240 offset:2048
    v_mfma_f32_16x16x32_bf16 v[64:67], a[100:103], a[140:143], v[64:67]
    v_mfma_f32_16x16x32_bf16 v[68:71], a[104:107], a[136:139], v[68:71]
    ds_read_b128 a[12:15], v241 offset:2048
    buffer_load_dwordx4 v247, s[36:39], s49 offen offset:1024 lds
    v_mfma_f32_16x16x32_bf16 v[68:71], a[108:111], a[140:143], v[68:71]
    v_mfma_f32_16x16x32_bf16 v[72:75], a[112:115], a[136:139], v[72:75]
    ds_read_b128 a[16:19], v240 offset:4096
    v_mfma_f32_16x16x32_bf16 v[72:75], a[116:119], a[140:143], v[72:75]
    v_mfma_f32_16x16x32_bf16 v[76:79], a[120:123], a[136:139], v[76:79]
    v_mfma_f32_16x16x32_bf16 v[76:79], a[124:127], a[140:143], v[76:79]
    s_waitcnt lgkmcnt(9)
    buffer_load_dwordx4 v246, s[36:39], s50 offen offset:2048 lds
    v_mfma_f32_16x16x32_bf16 v[80:83], a[64:67], a[144:147], v[80:83]
    ds_read_b64_tr_b16 a[128:129], v242 offset:40960
    v_mfma_f32_16x16x32_bf16 v[80:83], a[68:71], a[148:151], v[80:83]
    v_mfma_f32_16x16x32_bf16 v[84:87], a[72:75], a[144:147], v[84:87]
    ds_read_b64_tr_b16 a[130:131], v242 offset:41472
    v_mfma_f32_16x16x32_bf16 v[84:87], a[76:79], a[148:151], v[84:87]
    v_mfma_f32_16x16x32_bf16 v[88:91], a[80:83], a[144:147], v[88:91]
    ds_read_b64_tr_b16 a[132:133], v242 offset:45056
    buffer_load_dwordx4 v247, s[36:39], s51 offen offset:3072 lds
    v_mfma_f32_16x16x32_bf16 v[88:91], a[84:87], a[148:151], v[88:91]
    v_add_u32 v246, s62, v246
    v_add_u32 v247, s62, v247
    v_mfma_f32_16x16x32_bf16 v[92:95], a[88:91], a[144:147], v[92:95]
    ds_read_b64_tr_b16 a[134:135], v242 offset:45568
    v_mfma_f32_16x16x32_bf16 v[92:95], a[92:95], a[148:151], v[92:95]
    v_mfma_f32_16x16x32_bf16 v[96:99], a[96:99], a[144:147], v[96:99]
    ds_read_b128 a[20:23], v241 offset:4096
    v_mfma_f32_16x16x32_bf16 v[96:99], a[100:103], a[148:151], v[96:99]
    v_mfma_f32_16x16x32_bf16 v[100:103], a[104:107], a[144:147], v[100:103]
    ds_read_b128 a[24:27], v240 offset:6144
    v_mfma_f32_16x16x32_bf16 v[100:103], a[108:111], a[148:151], v[100:103]
    v_mfma_f32_16x16x32_bf16 v[104:107], a[112:115], a[144:147], v[104:107]
    ds_read_b128 a[28:31], v241 offset:6144
    v_mfma_f32_16x16x32_bf16 v[104:107], a[116:119], a[148:151], v[104:107]
    v_mfma_f32_16x16x32_bf16 v[108:111], a[120:123], a[144:147], v[108:111]
    v_mfma_f32_16x16x32_bf16 v[108:111], a[124:127], a[148:151], v[108:111]
    s_waitcnt lgkmcnt(10)
    v_mfma_f32_16x16x32_bf16 v[112:115], a[64:67], a[152:155], v[112:115]
    ds_read_b64_tr_b16 a[136:137], v243 offset:40960
    v_mfma_f32_16x16x32_bf16 v[112:115], a[68:71], a[156:159], v[112:115]
    v_mfma_f32_16x16x32_bf16 v[116:119], a[72:75], a[152:155], v[116:119]
    ds_read_b64_tr_b16 a[138:139], v243 offset:41472
    v_mfma_f32_16x16x32_bf16 v[116:119], a[76:79], a[156:159], v[116:119]
    v_mfma_f32_16x16x32_bf16 v[120:123], a[80:83], a[152:155], v[120:123]
    ds_read_b64_tr_b16 a[140:141], v243 offset:45056
    v_mfma_f32_16x16x32_bf16 v[120:123], a[84:87], a[156:159], v[120:123]
    v_mfma_f32_16x16x32_bf16 v[124:127], a[88:91], a[152:155], v[124:127]
    ds_read_b64_tr_b16 a[142:143], v243 offset:45568
    v_mfma_f32_16x16x32_bf16 v[124:127], a[92:95], a[156:159], v[124:127]
    v_mfma_f32_16x16x32_bf16 v[128:131], a[96:99], a[152:155], v[128:131]
    ds_read_b128 a[32:35], v240 offset:8192
    v_mfma_f32_16x16x32_bf16 v[128:131], a[100:103], a[156:159], v[128:131]
    v_mfma_f32_16x16x32_bf16 v[132:135], a[104:107], a[152:155], v[132:135]
    ds_read_b128 a[36:39], v241 offset:8192
    v_mfma_f32_16x16x32_bf16 v[132:135], a[108:111], a[156:159], v[132:135]
    v_mfma_f32_16x16x32_bf16 v[136:139], a[112:115], a[152:155], v[136:139]
    v_mfma_f32_16x16x32_bf16 v[136:139], a[116:119], a[156:159], v[136:139]
    v_mfma_f32_16x16x32_bf16 v[140:143], a[120:123], a[152:155], v[140:143]
    v_mfma_f32_16x16x32_bf16 v[140:143], a[124:127], a[156:159], v[140:143]
    s_waitcnt lgkmcnt(9)
    v_mfma_f32_16x16x32_bf16 v[144:147], a[64:67], a[128:131], v[144:147]
    ds_read_b64_tr_b16 a[144:145], v244 offset:40960
    v_mfma_f32_16x16x32_bf16 v[144:147], a[68:71], a[132:135], v[144:147]
    v_mfma_f32_16x16x32_bf16 v[148:151], a[72:75], a[128:131], v[148:151]
    ds_read_b64_tr_b16 a[146:147], v244 offset:41472
    v_mfma_f32_16x16x32_bf16 v[148:151], a[76:79], a[132:135], v[148:151]
    v_mfma_f32_16x16x32_bf16 v[152:155], a[80:83], a[128:131], v[152:155]
    ds_read_b64_tr_b16 a[148:149], v244 offset:45056
    v_mfma_f32_16x16x32_bf16 v[152:155], a[84:87], a[132:135], v[152:155]
    v_mfma_f32_16x16x32_bf16 v[156:159], a[88:91], a[128:131], v[156:159]
    ds_read_b64_tr_b16 a[150:151], v244 offset:45568
    v_mfma_f32_16x16x32_bf16 v[156:159], a[92:95], a[132:135], v[156:159]
    v_mfma_f32_16x16x32_bf16 v[160:163], a[96:99], a[128:131], v[160:163]
    ds_read_b128 a[40:43], v240 offset:10240
    v_mfma_f32_16x16x32_bf16 v[160:163], a[100:103], a[132:135], v[160:163]
    v_mfma_f32_16x16x32_bf16 v[164:167], a[104:107], a[128:131], v[164:167]
    ds_read_b128 a[44:47], v241 offset:10240
    v_mfma_f32_16x16x32_bf16 v[164:167], a[108:111], a[132:135], v[164:167]
    v_mfma_f32_16x16x32_bf16 v[168:171], a[112:115], a[128:131], v[168:171]
    ds_read_b128 a[48:51], v240 offset:12288
    v_mfma_f32_16x16x32_bf16 v[168:171], a[116:119], a[132:135], v[168:171]
    v_mfma_f32_16x16x32_bf16 v[172:175], a[120:123], a[128:131], v[172:175]
    v_mfma_f32_16x16x32_bf16 v[172:175], a[124:127], a[132:135], v[172:175]
    s_waitcnt lgkmcnt(9)
    v_mfma_f32_16x16x32_bf16 v[176:179], a[64:67], a[136:139], v[176:179]
    ds_read_b64_tr_b16 a[152:153], v245 offset:40960
    v_mfma_f32_16x16x32_bf16 v[176:179], a[68:71], a[140:143], v[176:179]
    v_mfma_f32_16x16x32_bf16 v[180:183], a[72:75], a[136:139], v[180:183]
    ds_read_b64_tr_b16 a[154:155], v245 offset:41472
    v_mfma_f32_16x16x32_bf16 v[180:183], a[76:79], a[140:143], v[180:183]
    v_mfma_f32_16x16x32_bf16 v[184:187], a[80:83], a[136:139], v[184:187]
    ds_read_b64_tr_b16 a[156:157], v245 offset:45056
    v_mfma_f32_16x16x32_bf16 v[184:187], a[84:87], a[140:143], v[184:187]
    v_mfma_f32_16x16x32_bf16 v[188:191], a[88:91], a[136:139], v[188:191]
    ds_read_b64_tr_b16 a[158:159], v245 offset:45568
    v_mfma_f32_16x16x32_bf16 v[188:191], a[92:95], a[140:143], v[188:191]
    v_mfma_f32_16x16x32_bf16 v[192:195], a[96:99], a[136:139], v[192:195]
    ds_read_b128 a[52:55], v241 offset:12288
    v_mfma_f32_16x16x32_bf16 v[192:195], a[100:103], a[140:143], v[192:195]
    v_mfma_f32_16x16x32_bf16 v[196:199], a[104:107], a[136:139], v[196:199]
    ds_read_b128 a[56:59], v240 offset:14336
    v_mfma_f32_16x16x32_bf16 v[196:199], a[108:111], a[140:143], v[196:199]
    v_mfma_f32_16x16x32_bf16 v[200:203], a[112:115], a[136:139], v[200:203]
    ds_read_b128 a[60:63], v241 offset:14336
    v_mfma_f32_16x16x32_bf16 v[200:203], a[116:119], a[140:143], v[200:203]
    v_mfma_f32_16x16x32_bf16 v[204:207], a[120:123], a[136:139], v[204:207]
    v_mfma_f32_16x16x32_bf16 v[204:207], a[124:127], a[140:143], v[204:207]
    s_waitcnt vmcnt(0) lgkmcnt(0)
    s_barrier
    v_mfma_f32_16x16x32_bf16 v[208:211], a[64:67], a[144:147], v[208:211]
    s_add_u32 m0, s61, 32768
    ds_read_b64_tr_b16 a[128:129], v242 offset:0
    v_mfma_f32_16x16x32_bf16 v[208:211], a[68:71], a[148:151], v[208:211]
    buffer_load_dwordx4 v248, s[40:43], s52 offen offset:0 lds
    v_mfma_f32_16x16x32_bf16 v[212:215], a[72:75], a[144:147], v[212:215]
    v_mfma_f32_16x16x32_bf16 v[212:215], a[76:79], a[148:151], v[212:215]
    ds_read_b64_tr_b16 a[130:131], v242 offset:512
    v_mfma_f32_16x16x32_bf16 v[216:219], a[80:83], a[144:147], v[216:219]
    v_mfma_f32_16x16x32_bf16 v[216:219], a[84:87], a[148:151], v[216:219]
    buffer_load_dwordx4 v249, s[40:43], s53 offen offset:1024 lds
    v_mfma_f32_16x16x32_bf16 v[220:223], a[88:91], a[144:147], v[220:223]
    ds_read_b64_tr_b16 a[132:133], v242 offset:4096
    v_mfma_f32_16x16x32_bf16 v[220:223], a[92:95], a[148:151], v[220:223]
    v_mfma_f32_16x16x32_bf16 v[224:227], a[96:99], a[144:147], v[224:227]
    v_mfma_f32_16x16x32_bf16 v[224:227], a[100:103], a[148:151], v[224:227]
    ds_read_b64_tr_b16 a[134:135], v242 offset:4608
    buffer_load_dwordx4 v248, s[40:43], s54 offen offset:2048 lds
    v_mfma_f32_16x16x32_bf16 v[228:231], a[104:107], a[144:147], v[228:231]
    v_mfma_f32_16x16x32_bf16 v[228:231], a[108:111], a[148:151], v[228:231]
    v_mfma_f32_16x16x32_bf16 v[232:235], a[112:115], a[144:147], v[232:235]
    v_mfma_f32_16x16x32_bf16 v[232:235], a[116:119], a[148:151], v[232:235]
    buffer_load_dwordx4 v249, s[40:43], s55 offen offset:3072 lds
    v_mfma_f32_16x16x32_bf16 v[236:239], a[120:123], a[144:147], v[236:239]
    s_add_u32 m0, s61, 36864
    v_mfma_f32_16x16x32_bf16 v[236:239], a[124:127], a[148:151], v[236:239]
    v_mfma_f32_16x16x32_bf16 a[208:211], a[64:67], a[152:155], a[208:211]
    ds_read_b64_tr_b16 a[136:137], v243 offset:0
    v_mfma_f32_16x16x32_bf16 a[208:211], a[68:71], a[156:159], a[208:211]
    buffer_load_dwordx4 v248, s[40:43], s56 offen offset:0 lds
    v_mfma_f32_16x16x32_bf16 a[212:215], a[72:75], a[152:155], a[212:215]
    v_mfma_f32_16x16x32_bf16 a[212:215], a[76:79], a[156:159], a[212:215]
    ds_read_b64_tr_b16 a[138:139], v243 offset:512
    v_mfma_f32_16x16x32_bf16 a[216:219], a[80:83], a[152:155], a[216:219]
    v_mfma_f32_16x16x32_bf16 a[216:219], a[84:87], a[156:159], a[216:219]
    buffer_load_dwordx4 v249, s[40:43], s57 offen offset:1024 lds
    v_mfma_f32_16x16x32_bf16 a[220:223], a[88:91], a[152:155], a[220:223]
    ds_read_b64_tr_b16 a[140:141], v243 offset:4096
    v_mfma_f32_16x16x32_bf16 a[220:223], a[92:95], a[156:159], a[220:223]
    v_mfma_f32_16x16x32_bf16 a[224:227], a[96:99], a[152:155], a[224:227]
    v_mfma_f32_16x16x32_bf16 a[224:227], a[100:103], a[156:159], a[224:227]
    ds_read_b64_tr_b16 a[142:143], v243 offset:4608
    buffer_load_dwordx4 v248, s[40:43], s58 offen offset:2048 lds
    v_mfma_f32_16x16x32_bf16 a[228:231], a[104:107], a[152:155], a[228:231]
    v_mfma_f32_16x16x32_bf16 a[228:231], a[108:111], a[156:159], a[228:231]
    v_mfma_f32_16x16x32_bf16 a[232:235], a[112:115], a[152:155], a[232:235]
    v_mfma_f32_16x16x32_bf16 a[232:235], a[116:119], a[156:159], a[232:235]
    buffer_load_dwordx4 v249, s[40:43], s59 offen offset:3072 lds
    v_add_u32 v248, s63, v248
    v_mfma_f32_16x16x32_bf16 a[236:239], a[120:123], a[152:155], a[236:239]
    v_add_u32 v249, s63, v249
    v_mfma_f32_16x16x32_bf16 a[236:239], a[124:127], a[156:159], a[236:239]
    s_sub_u32 s64, s64, 1
g1_S_ctl:
    s_cmp_gt_u32 s64, 3
    s_cbranch_scc1 g1_S_loop
    s_cmp_eq_u32 s64, 2
    s_cbranch_scc1 g1_S_loop
    s_cmp_eq_u32 s64, 0
    s_cbranch_scc1 g1_S_epi
    s_cmp_eq_u32 s64, 1
    s_cbranch_scc1 g1_S_sw
    s_bfe_u32 s5, s68, 0x20008
    s_bfe_u32 s6, s68, 0x50003
    s_cmp_eq_u32 s5, 3
    s_cbranch_scc1 g1_db7_gu
    s_mov_b32 s76, s12
    s_mov_b32 s77, s13
    s_mov_b32 s78, 8388608
    s_cmp_eq_u32 s5, 1
    s_cselect_b32 s76, s14, s76
    s_cselect_b32 s77, s15, s77
    s_cselect_b32 s78, 4194304, s78
    s_cmp_eq_u32 s5, 2
    s_cselect_b32 s76, s16, s76
    s_cselect_b32 s77, s17, s77
    s_cselect_b32 s78, 4194304, s78
    s_mov_b32 s30, 8192
    s_lshl_b32 s27, s6, 9
    s_lshl_b32 s3, s101, 7
    s_add_u32 s27, s27, s3
    s_branch g1_db7_src
g1_db7_gu:
    s_cmp_eq_u32 s66, 0
    s_cselect_b32 s76, s22, s24
    s_cselect_b32 s77, s23, s25
    s_mov_b32 s78, 7340032
    s_mov_b32 s30, 7168
    s_lshl_b32 s27, s6, 8
    s_lshl_b32 s3, s65, 7
    s_add_u32 s27, s27, s3
g1_db7_src:
    s_mov_b32 s79, 0x20000
    s_cmp_eq_u32 s68, 0
    s_cselect_b32 s78, 0, s78
    v_lshrrev_b32 v254, 3, v250
    v_lshlrev_b32 v254, 6, v254
    v_and_b32 v7, 7, v250
    s_and_b32 s3, s68, 7
    s_lshl_b32 s3, s3, 3
    v_add3_u32 v254, v254, v7, s3
    v_mul_lo_u32 v254, v254, s30
    v_add_u32 v254, s27, v254
    v_bfrev_b32 v7, 1
    v_cmp_gt_u32 vcc, 16, v250
    s_lshl_b32 s20, s30, 7
    s_nop 0
    v_cndmask_b32 v254, v7, v254, vcc
    s_branch g1_S_loop
g1_S_sw:
    s_and_b32 s6, s2, 7
    s_lshl_b32 s6, s6, 8
    s_cmp_lg_u32 s88, 0
    s_cselect_b32 s90, s6, 0
    s_cmp_eq_u32 s68, 0
    s_cbranch_scc0 g1_sp8_valid
    s_mov_b32 s38, 0
    s_mov_b32 s42, 0
    s_branch g1_sp8_done
g1_sp8_valid:
    s_bfe_u32 s5, s68, 0x20008
    s_bfe_u32 s6, s68, 0x50003
    s_sub_u32 s7, s5, 1
    s_cmp_lt_u32 s7, 2
    s_cselect_b32 s36, s10, s8
    s_cselect_b32 s37, s11, s9
    s_mov_b32 s7, 2097152
    s_cselect_b32 s38, s7, 4194304
    s_mov_b32 s39, 0x20000
    s_mov_b32 s7, 1024
    s_cselect_b32 s26, s7, 2048
    s_cmp_eq_u32 s5, 3
    s_cbranch_scc1 g1_db9_gu
    s_mov_b32 s40, s12
    s_mov_b32 s41, s13
    s_mov_b32 s42, 8388608
    s_cmp_eq_u32 s5, 1
    s_cselect_b32 s40, s14, s40
    s_cselect_b32 s41, s15, s41
    s_cselect_b32 s42, 4194304, s42
    s_cmp_eq_u32 s5, 2
    s_cselect_b32 s40, s16, s40
    s_cselect_b32 s41, s17, s41
    s_cselect_b32 s42, 4194304, s42
    s_mov_b32 s30, 8192
    s_lshl_b32 s27, s6, 9
    s_lshl_b32 s3, s101, 7
    s_add_u32 s27, s27, s3
    s_branch g1_db9_src
g1_db9_gu:
    s_cmp_eq_u32 s66, 0
    s_cselect_b32 s40, s22, s24
    s_cselect_b32 s41, s23, s25
    s_mov_b32 s42, 7340032
    s_mov_b32 s30, 7168
    s_lshl_b32 s27, s6, 8
    s_lshl_b32 s3, s65, 7
    s_add_u32 s27, s27, s3
g1_db9_src:
    s_mov_b32 s43, 0x20000
    s_and_b32 s3, s68, 7
    s_lshl_b32 s3, s3, 8
    s_mul_i32 s21, s3, s26
    v_lshrrev_b32 v4, 3, v250
    s_mul_i32 s3, s101, 64
    v_add_u32 v4, s3, v4
    v_mul_lo_u32 v4, v4, s26
    v_add_u32 v4, s21, v4
    v_and_b32 v5, 7, v250
    v_lshrrev_b32 v6, 4, v250
    v_xor_b32 v5, v5, v6
    v_lshl_add_u32 v246, v5, 4, v4
    v_xor_b32 v5, 4, v5
    v_lshl_add_u32 v247, v5, 4, v4
    s_mul_i32 s44, s26, 0
    s_mul_i32 s45, s26, 8
    s_sub_u32 s45, s45, 1024
    s_mul_i32 s46, s26, 16
    s_sub_u32 s46, s46, 2048
    s_mul_i32 s47, s26, 24
    s_sub_u32 s47, s47, 3072
    s_mul_i32 s48, s26, 32
    s_mul_i32 s49, s26, 40
    s_sub_u32 s49, s49, 1024
    s_mul_i32 s50, s26, 48
    s_sub_u32 s50, s50, 2048
    s_mul_i32 s51, s26, 56
    s_sub_u32 s51, s51, 3072
    s_mov_b32 s62, 128
    v_lshrrev_b32 v4, 3, v250
    v_mul_lo_u32 v4, v4, s30
    v_add_u32 v4, s27, v4
    v_and_b32 v5, 7, v250
    v_bfe_u32 v6, v250, 4, 1
    v_lshlrev_b32 v6, 1, v6
    v_xor_b32 v5, v5, v6
    v_lshl_add_u32 v248, v5, 4, v4
    v_xor_b32 v5, 4, v5
    v_lshl_add_u32 v249, v5, 4, v4
    s_mul_i32 s52, s30, 0
    s_mul_i32 s53, s30, 8
    s_sub_u32 s53, s53, 1024
    s_mul_i32 s54, s30, 16
    s_sub_u32 s54, s54, 2048
    s_mul_i32 s55, s30, 24
    s_sub_u32 s55, s55, 3072
    s_mul_i32 s56, s30, 32
    s_mul_i32 s57, s30, 40
    s_sub_u32 s57, s57, 1024
    s_mul_i32 s58, s30, 48
    s_sub_u32 s58, s58, 2048
    s_mul_i32 s59, s30, 56
    s_sub_u32 s59, s59, 3072
    s_lshl_b32 s63, s30, 6
g1_sp8_done:
    s_branch g1_S_loop
g1_S_epi:
    s_bfe_u32 s5, s67, 0x20008
    s_bfe_u32 s6, s67, 0x50003
    s_lshl_b32 s3, s6, 1
    s_add_u32 s3, s3, s66
    s_lshl_b32 s3, s3, 19
    s_and_b32 s7, s67, 7
    s_lshl_b32 s4, s7, 16
    s_add_u32 s3, s3, s4
    s_lshl_b32 s4, s65, 15
    s_add_u32 s3, s3, s4
    v_lshlrev_b32 v251, 4, v250
    v_add_u32 v251, s3, v251
    s_lshl_b32 s4, s5, 24
    s_add_u32 s72, s34, s4
    s_addc_u32 s73, s35, 0
    s_mov_b32 s74, 16777216
    s_mov_b32 s75, 0x20000
    s_lshl_b32 s3, s5, 3
    s_add_u32 s3, s3, s7
    s_lshl_b32 s3, s3, 2
    s_lshl_b32 s4, s6, 7
    s_add_u32 s3, s3, s4
    s_cmp_eq_u32 s101, 0
    s_cselect_b32 s70, s3, s70
    v_cvt_pk_bf16_f32 v0, v16, v17
    v_cvt_pk_bf16_f32 v1, v18, v19
    v_cvt_pk_bf16_f32 v2, v20, v21
    v_cvt_pk_bf16_f32 v3, v22, v23
    s_mov_b32 s3, 0
    buffer_store_dwordx4 v[0:3], v251, s[72:75], s3 offen offset:0 sc1
    v_cvt_pk_bf16_f32 v4, v24, v25
    v_cvt_pk_bf16_f32 v5, v26, v27
    v_cvt_pk_bf16_f32 v6, v28, v29
    v_cvt_pk_bf16_f32 v7, v30, v31
    s_mov_b32 s3, 8192
    buffer_store_dwordx4 v[4:7], v251, s[72:75], s3 offen offset:0 sc1
    v_cvt_pk_bf16_f32 v0, v32, v33
    v_cvt_pk_bf16_f32 v1, v34, v35
    v_cvt_pk_bf16_f32 v2, v36, v37
    v_cvt_pk_bf16_f32 v3, v38, v39
    s_mov_b32 s3, 16384
    buffer_store_dwordx4 v[0:3], v251, s[72:75], s3 offen offset:0 sc1
    v_cvt_pk_bf16_f32 v4, v40, v41
    v_cvt_pk_bf16_f32 v5, v42, v43
    v_cvt_pk_bf16_f32 v6, v44, v45
    v_cvt_pk_bf16_f32 v7, v46, v47
    s_mov_b32 s3, 24576
    buffer_store_dwordx4 v[4:7], v251, s[72:75], s3 offen offset:0 sc1
    v_cvt_pk_bf16_f32 v0, v48, v49
    v_cvt_pk_bf16_f32 v1, v50, v51
    v_cvt_pk_bf16_f32 v2, v52, v53
    v_cvt_pk_bf16_f32 v3, v54, v55
    s_mov_b32 s3, 0
    buffer_store_dwordx4 v[0:3], v251, s[72:75], s3 offen offset:1024 sc1
    v_cvt_pk_bf16_f32 v4, v56, v57
    v_cvt_pk_bf16_f32 v5, v58, v59
    v_cvt_pk_bf16_f32 v6, v60, v61
    v_cvt_pk_bf16_f32 v7, v62, v63
    s_mov_b32 s3, 8192
    buffer_store_dwordx4 v[4:7], v251, s[72:75], s3 offen offset:1024 sc1
    v_cvt_pk_bf16_f32 v0, v64, v65
    v_cvt_pk_bf16_f32 v1, v66, v67
    v_cvt_pk_bf16_f32 v2, v68, v69
    v_cvt_pk_bf16_f32 v3, v70, v71
    s_mov_b32 s3, 16384
    buffer_store_dwordx4 v[0:3], v251, s[72:75], s3 offen offset:1024 sc1
    v_cvt_pk_bf16_f32 v4, v72, v73
    v_cvt_pk_bf16_f32 v5, v74, v75
    v_cvt_pk_bf16_f32 v6, v76, v77
    v_cvt_pk_bf16_f32 v7, v78, v79
    s_mov_b32 s3, 24576
    buffer_store_dwordx4 v[4:7], v251, s[72:75], s3 offen offset:1024 sc1
    v_cvt_pk_bf16_f32 v0, v80, v81
    v_cvt_pk_bf16_f32 v1, v82, v83
    v_cvt_pk_bf16_f32 v2, v84, v85
    v_cvt_pk_bf16_f32 v3, v86, v87
    s_mov_b32 s3, 0
    buffer_store_dwordx4 v[0:3], v251, s[72:75], s3 offen offset:2048 sc1
    v_cvt_pk_bf16_f32 v4, v88, v89
    v_cvt_pk_bf16_f32 v5, v90, v91
    v_cvt_pk_bf16_f32 v6, v92, v93
    v_cvt_pk_bf16_f32 v7, v94, v95
    s_mov_b32 s3, 8192
    buffer_store_dwordx4 v[4:7], v251, s[72:75], s3 offen offset:2048 sc1
    v_cvt_pk_bf16_f32 v0, v96, v97
    v_cvt_pk_bf16_f32 v1, v98, v99
    v_cvt_pk_bf16_f32 v2, v100, v101
    v_cvt_pk_bf16_f32 v3, v102, v103
    s_mov_b32 s3, 16384
    buffer_store_dwordx4 v[0:3], v251, s[72:75], s3 offen offset:2048 sc1
    v_cvt_pk_bf16_f32 v4, v104, v105
    v_cvt_pk_bf16_f32 v5, v106, v107
    v_cvt_pk_bf16_f32 v6, v108, v109
    v_cvt_pk_bf16_f32 v7, v110, v111
    s_mov_b32 s3, 24576
    buffer_store_dwordx4 v[4:7], v251, s[72:75], s3 offen offset:2048 sc1
    v_cvt_pk_bf16_f32 v0, v112, v113
    v_cvt_pk_bf16_f32 v1, v114, v115
    v_cvt_pk_bf16_f32 v2, v116, v117
    v_cvt_pk_bf16_f32 v3, v118, v119
    s_mov_b32 s3, 0
    buffer_store_dwordx4 v[0:3], v251, s[72:75], s3 offen offset:3072 sc1
    v_cvt_pk_bf16_f32 v4, v120, v121
    v_cvt_pk_bf16_f32 v5, v122, v123
    v_cvt_pk_bf16_f32 v6, v124, v125
    v_cvt_pk_bf16_f32 v7, v126, v127
    s_mov_b32 s3, 8192
    buffer_store_dwordx4 v[4:7], v251, s[72:75], s3 offen offset:3072 sc1
    v_cvt_pk_bf16_f32 v0, v128, v129
    v_cvt_pk_bf16_f32 v1, v130, v131
    v_cvt_pk_bf16_f32 v2, v132, v133
    v_cvt_pk_bf16_f32 v3, v134, v135
    s_mov_b32 s3, 16384
    buffer_store_dwordx4 v[0:3], v251, s[72:75], s3 offen offset:3072 sc1
    v_cvt_pk_bf16_f32 v4, v136, v137
    v_cvt_pk_bf16_f32 v5, v138, v139
    v_cvt_pk_bf16_f32 v6, v140, v141
    v_cvt_pk_bf16_f32 v7, v142, v143
    s_mov_b32 s3, 24576
    buffer_store_dwordx4 v[4:7], v251, s[72:75], s3 offen offset:3072 sc1
    v_cvt_pk_bf16_f32 v0, v144, v145
    v_cvt_pk_bf16_f32 v1, v146, v147
    v_cvt_pk_bf16_f32 v2, v148, v149
    v_cvt_pk_bf16_f32 v3, v150, v151
    s_mov_b32 s3, 4096
    buffer_store_dwordx4 v[0:3], v251, s[72:75], s3 offen offset:0 sc1
    v_cvt_pk_bf16_f32 v4, v152, v153
    v_cvt_pk_bf16_f32 v5, v154, v155
    v_cvt_pk_bf16_f32 v6, v156, v157
    v_cvt_pk_bf16_f32 v7, v158, v159
    s_mov_b32 s3, 12288
    buffer_store_dwordx4 v[4:7], v251, s[72:75], s3 offen offset:0 sc1
    v_cvt_pk_bf16_f32 v0, v160, v161
    v_cvt_pk_bf16_f32 v1, v162, v163
    v_cvt_pk_bf16_f32 v2, v164, v165
    v_cvt_pk_bf16_f32 v3, v166, v167
    s_mov_b32 s3, 20480
    buffer_store_dwordx4 v[0:3], v251, s[72:75], s3 offen offset:0 sc1
    v_cvt_pk_bf16_f32 v4, v168, v169
    v_cvt_pk_bf16_f32 v5, v170, v171
    v_cvt_pk_bf16_f32 v6, v172, v173
    v_cvt_pk_bf16_f32 v7, v174, v175
    s_mov_b32 s3, 28672
    buffer_store_dwordx4 v[4:7], v251, s[72:75], s3 offen offset:0 sc1
    v_cvt_pk_bf16_f32 v0, v176, v177
    v_cvt_pk_bf16_f32 v1, v178, v179
    v_cvt_pk_bf16_f32 v2, v180, v181
    v_cvt_pk_bf16_f32 v3, v182, v183
    s_mov_b32 s3, 4096
    buffer_store_dwordx4 v[0:3], v251, s[72:75], s3 offen offset:1024 sc1
    v_cvt_pk_bf16_f32 v4, v184, v185
    v_cvt_pk_bf16_f32 v5, v186, v187
    v_cvt_pk_bf16_f32 v6, v188, v189
    v_cvt_pk_bf16_f32 v7, v190, v191
    s_mov_b32 s3, 12288
    buffer_store_dwordx4 v[4:7], v251, s[72:75], s3 offen offset:1024 sc1
    v_cvt_pk_bf16_f32 v0, v192, v193
    v_cvt_pk_bf16_f32 v1, v194, v195
    v_cvt_pk_bf16_f32 v2, v196, v197
    v_cvt_pk_bf16_f32 v3, v198, v199
    s_mov_b32 s3, 20480
    buffer_store_dwordx4 v[0:3], v251, s[72:75], s3 offen offset:1024 sc1
    v_cvt_pk_bf16_f32 v4, v200, v201
    v_cvt_pk_bf16_f32 v5, v202, v203
    v_cvt_pk_bf16_f32 v6, v204, v205
    v_cvt_pk_bf16_f32 v7, v206, v207
    s_mov_b32 s3, 28672
    buffer_store_dwordx4 v[4:7], v251, s[72:75], s3 offen offset:1024 sc1
    v_cvt_pk_bf16_f32 v0, v208, v209
    v_cvt_pk_bf16_f32 v1, v210, v211
    v_cvt_pk_bf16_f32 v2, v212, v213
    v_cvt_pk_bf16_f32 v3, v214, v215
    s_mov_b32 s3, 4096
    buffer_store_dwordx4 v[0:3], v251, s[72:75], s3 offen offset:2048 sc1
    v_cvt_pk_bf16_f32 v4, v216, v217
    v_cvt_pk_bf16_f32 v5, v218, v219
    v_cvt_pk_bf16_f32 v6, v220, v221
    v_cvt_pk_bf16_f32 v7, v222, v223
    s_mov_b32 s3, 12288
    buffer_store_dwordx4 v[4:7], v251, s[72:75], s3 offen offset:2048 sc1
    v_cvt_pk_bf16_f32 v0, v224, v225
    v_cvt_pk_bf16_f32 v1, v226, v227
    v_cvt_pk_bf16_f32 v2, v228, v229
    v_cvt_pk_bf16_f32 v3, v230, v231
    s_mov_b32 s3, 20480
    buffer_store_dwordx4 v[0:3], v251, s[72:75], s3 offen offset:2048 sc1
    v_cvt_pk_bf16_f32 v4, v232, v233
    v_cvt_pk_bf16_f32 v5, v234, v235
    v_cvt_pk_bf16_f32 v6, v236, v237
    v_cvt_pk_bf16_f32 v7, v238, v239
    s_mov_b32 s3, 28672
    buffer_store_dwordx4 v[4:7], v251, s[72:75], s3 offen offset:2048 sc1
    v_accvgpr_read_b32 v8, a208
    v_accvgpr_read_b32 v9, a209
    v_accvgpr_read_b32 v10, a210
    v_accvgpr_read_b32 v11, a211
    v_accvgpr_read_b32 v12, a212
    v_accvgpr_read_b32 v13, a213
    v_accvgpr_read_b32 v14, a214
    v_accvgpr_read_b32 v15, a215
    v_cvt_pk_bf16_f32 v0, v8, v9
    v_cvt_pk_bf16_f32 v1, v10, v11
    v_cvt_pk_bf16_f32 v2, v12, v13
    v_cvt_pk_bf16_f32 v3, v14, v15
    s_mov_b32 s3, 4096
    buffer_store_dwordx4 v[0:3], v251, s[72:75], s3 offen offset:3072 sc1
    v_accvgpr_read_b32 v8, a216
    v_accvgpr_read_b32 v9, a217
    v_accvgpr_read_b32 v10, a218
    v_accvgpr_read_b32 v11, a219
    v_accvgpr_read_b32 v12, a220
    v_accvgpr_read_b32 v13, a221
    v_accvgpr_read_b32 v14, a222
    v_accvgpr_read_b32 v15, a223
    v_cvt_pk_bf16_f32 v4, v8, v9
    v_cvt_pk_bf16_f32 v5, v10, v11
    v_cvt_pk_bf16_f32 v6, v12, v13
    v_cvt_pk_bf16_f32 v7, v14, v15
    s_mov_b32 s3, 12288
    buffer_store_dwordx4 v[4:7], v251, s[72:75], s3 offen offset:3072 sc1
    v_accvgpr_read_b32 v8, a224
    v_accvgpr_read_b32 v9, a225
    v_accvgpr_read_b32 v10, a226
    v_accvgpr_read_b32 v11, a227
    v_accvgpr_read_b32 v12, a228
    v_accvgpr_read_b32 v13, a229
    v_accvgpr_read_b32 v14, a230
    v_accvgpr_read_b32 v15, a231
    v_cvt_pk_bf16_f32 v0, v8, v9
    v_cvt_pk_bf16_f32 v1, v10, v11
    v_cvt_pk_bf16_f32 v2, v12, v13
    v_cvt_pk_bf16_f32 v3, v14, v15
    s_mov_b32 s3, 20480
    buffer_store_dwordx4 v[0:3], v251, s[72:75], s3 offen offset:3072 sc1
    v_accvgpr_read_b32 v8, a232
    v_accvgpr_read_b32 v9, a233
    v_accvgpr_read_b32 v10, a234
    v_accvgpr_read_b32 v11, a235
    v_accvgpr_read_b32 v12, a236
    v_accvgpr_read_b32 v13, a237
    v_accvgpr_read_b32 v14, a238
    v_accvgpr_read_b32 v15, a239
    v_cvt_pk_bf16_f32 v4, v8, v9
    v_cvt_pk_bf16_f32 v5, v10, v11
    v_cvt_pk_bf16_f32 v6, v12, v13
    v_cvt_pk_bf16_f32 v7, v14, v15
    s_mov_b32 s3, 28672
    buffer_store_dwordx4 v[4:7], v251, s[72:75], s3 offen offset:3072 sc1
g1_next:
    s_cmp_lg_u32 s88, 0
    s_cbranch_scc1 g1_iok
    v_accvgpr_read_b32 v8, a240
    s_mov_b32 s3, 0
g1_ichk:
    v_subrev_u32 v9, 0x01010101, v8
    v_not_b32 v8, v8
    v_and_b32 v8, v8, v9
    v_and_b32 v8, 0x80808080, v8
    v_cmp_ne_u32 vcc, 0, v8
    s_and_b32 vcc_lo, vcc_lo, 0xff
    s_cbranch_scc0 g1_iset
    s_sleep 4
    v_lshlrev_b32 v9, 2, v250
    buffer_load_dword v8, v9, s[84:87], 0 offen sc1
    s_waitcnt vmcnt(0)
    s_add_u32 s3, s3, 1
    s_cmp_lt_u32 s3, 100000
    s_cbranch_scc1 g1_ichk
g1_iset:
    s_mov_b32 s88, 1
    s_mov_b32 s84, s80
    s_mov_b32 s85, s81
    s_mov_b32 s86, s82
g1_iok:
    s_brev_b32 s90, 1
    s_mov_b32 s67, s68
    s_mov_b32 s68, s69
    s_mov_b32 s69, 0
    s_cmp_lg_u32 s67, 0
    s_cbranch_scc1 g1_tile
    s_waitcnt vmcnt(0) lgkmcnt(0)
    s_barrier
    s_mov_b64 exec, 1
    buffer_store_dword v252, v250, s[80:83], s70 offen sc1
    buffer_store_byte v252, v250, s[84:87], s89 offen sc1
    s_mov_b64 exec, -1
    s_brev_b32 s89, 1
    s_lshr_b32 s4, s2, 3
    s_and_b32 s3, s2, 7
    s_sub_u32 s4, s4, 28
    s_add_u32 s5, s4, 28
    s_lshl_b32 s5, s5, 2
    s_lshl_b32 s6, s3, 7
    s_add_u32 s5, s5, s6
    s_add_u32 s5, s5, 2048
    s_cmp_eq_u32 s101, 0
    s_cselect_b32 s70, s5, s70
    s_lshl_b32 s3, s3, 2
    s_add_u32 s3, s3, s4
    s_lshl_b32 s3, s3, 6
    s_lshl_b32 s4, s101, 4
    s_add_u32 s3, s3, s4
    s_mov_b32 s36, s8
    s_mov_b32 s37, s9
    s_mov_b32 s38, 4194304
    s_mov_b32 s39, 0x20000
    s_mov_b32 s40, s28
    s_mov_b32 s41, s29
    s_mov_b32 s42, 2048
    s_mov_b32 s43, 0x20000
    s_add_u32 s72, s34, 83886080
    s_addc_u32 s73, s35, 0
    s_mov_b32 s74, 8192
    s_mov_b32 s75, 0x20000
    v_lshlrev_b32 v2, 5, v250
    buffer_load_dwordx4 v[8:11], v2, s[40:43], 0 offen
    buffer_load_dwordx4 v[12:15], v2, s[40:43], 0 offen offset:16
    s_lshl_b32 s4, s3, 11
    v_add_u32 v3, s4, v2
    s_mov_b32 s5, 0
    buffer_load_dwordx4 v[32:35], v3, s[36:39], s5 offen
    buffer_load_dwordx4 v[36:39], v3, s[36:39], s5 offen offset:16
    s_mov_b32 s5, 2048
    buffer_load_dwordx4 v[40:43], v3, s[36:39], s5 offen
    buffer_load_dwordx4 v[44:47], v3, s[36:39], s5 offen offset:16
    s_mov_b32 s5, 4096
    buffer_load_dwordx4 v[48:51], v3, s[36:39], s5 offen
    buffer_load_dwordx4 v[52:55], v3, s[36:39], s5 offen offset:16
    s_mov_b32 s5, 6144
    buffer_load_dwordx4 v[56:59], v3, s[36:39], s5 offen
    buffer_load_dwordx4 v[60:63], v3, s[36:39], s5 offen offset:16
    s_mov_b32 s5, 8192
    buffer_load_dwordx4 v[64:67], v3, s[36:39], s5 offen
    buffer_load_dwordx4 v[68:71], v3, s[36:39], s5 offen offset:16
    s_mov_b32 s5, 10240
    buffer_load_dwordx4 v[72:75], v3, s[36:39], s5 offen
    buffer_load_dwordx4 v[76:79], v3, s[36:39], s5 offen offset:16
    s_mov_b32 s5, 12288
    buffer_load_dwordx4 v[80:83], v3, s[36:39], s5 offen
    buffer_load_dwordx4 v[84:87], v3, s[36:39], s5 offen offset:16
    s_mov_b32 s5, 14336
    buffer_load_dwordx4 v[88:91], v3, s[36:39], s5 offen
    buffer_load_dwordx4 v[92:95], v3, s[36:39], s5 offen offset:16
    s_mov_b32 s5, 16384
    buffer_load_dwordx4 v[96:99], v3, s[36:39], s5 offen
    buffer_load_dwordx4 v[100:103], v3, s[36:39], s5 offen offset:16
    s_mov_b32 s5, 18432
    buffer_load_dwordx4 v[104:107], v3, s[36:39], s5 offen
    buffer_load_dwordx4 v[108:111], v3, s[36:39], s5 offen offset:16
    s_mov_b32 s5, 20480
    buffer_load_dwordx4 v[112:115], v3, s[36:39], s5 offen
    buffer_load_dwordx4 v[116:119], v3, s[36:39], s5 offen offset:16
    s_mov_b32 s5, 22528
    buffer_load_dwordx4 v[120:123], v3, s[36:39], s5 offen
    buffer_load_dwordx4 v[124:127], v3, s[36:39], s5 offen offset:16
    s_mov_b32 s5, 24576
    buffer_load_dwordx4 v[128:131], v3, s[36:39], s5 offen
    buffer_load_dwordx4 v[132:135], v3, s[36:39], s5 offen offset:16
    s_mov_b32 s5, 26624
    buffer_load_dwordx4 v[136:139], v3, s[36:39], s5 offen
    buffer_load_dwordx4 v[140:143], v3, s[36:39], s5 offen offset:16
    s_mov_b32 s5, 28672
    buffer_load_dwordx4 v[144:147], v3, s[36:39], s5 offen
    buffer_load_dwordx4 v[148:151], v3, s[36:39], s5 offen offset:16
    s_mov_b32 s5, 30720
    buffer_load_dwordx4 v[152:155], v3, s[36:39], s5 offen
    buffer_load_dwordx4 v[156:159], v3, s[36:39], s5 offen offset:16
    s_waitcnt vmcnt(32)
    v_lshlrev_b32 v16, 16, v8
    v_and_b32 v17, 0xffff0000, v8
    v_lshlrev_b32 v18, 16, v9
    v_and_b32 v19, 0xffff0000, v9
    v_lshlrev_b32 v20, 16, v10
    v_and_b32 v21, 0xffff0000, v10
    v_lshlrev_b32 v22, 16, v11
    v_and_b32 v23, 0xffff0000, v11
    v_lshlrev_b32 v24, 16, v12
    v_and_b32 v25, 0xffff0000, v12
    v_lshlrev_b32 v26, 16, v13
    v_and_b32 v27, 0xffff0000, v13
    v_lshlrev_b32 v28, 16, v14
    v_and_b32 v29, 0xffff0000, v14
    v_lshlrev_b32 v30, 16, v15
    v_and_b32 v31, 0xffff0000, v15
    v_mov_b32 v6, 0
    s_waitcnt vmcnt(30)
    v_lshlrev_b32 v5, 16, v32
    v_mul_f32 v4, v5, v16
    v_and_b32 v5, 0xffff0000, v32
    v_fmac_f32 v4, v5, v17
    v_lshlrev_b32 v5, 16, v33
    v_fmac_f32 v4, v5, v18
    v_and_b32 v5, 0xffff0000, v33
    v_fmac_f32 v4, v5, v19
    v_lshlrev_b32 v5, 16, v34
    v_fmac_f32 v4, v5, v20
    v_and_b32 v5, 0xffff0000, v34
    v_fmac_f32 v4, v5, v21
    v_lshlrev_b32 v5, 16, v35
    v_fmac_f32 v4, v5, v22
    v_and_b32 v5, 0xffff0000, v35
    v_fmac_f32 v4, v5, v23
    v_lshlrev_b32 v5, 16, v36
    v_fmac_f32 v4, v5, v24
    v_and_b32 v5, 0xffff0000, v36
    v_fmac_f32 v4, v5, v25
    v_lshlrev_b32 v5, 16, v37
    v_fmac_f32 v4, v5, v26
    v_and_b32 v5, 0xffff0000, v37
    v_fmac_f32 v4, v5, v27
    v_lshlrev_b32 v5, 16, v38
    v_fmac_f32 v4, v5, v28
    v_and_b32 v5, 0xffff0000, v38
    v_fmac_f32 v4, v5, v29
    v_lshlrev_b32 v5, 16, v39
    v_fmac_f32 v4, v5, v30
    v_and_b32 v5, 0xffff0000, v39
    v_fmac_f32 v4, v5, v31
    s_nop 1
    v_add_f32_dpp v4, v4, v4 quad_perm:[1,0,3,2] row_mask:0xf bank_mask:0xf
    s_nop 1
    v_add_f32_dpp v4, v4, v4 quad_perm:[2,3,0,1] row_mask:0xf bank_mask:0xf
    s_nop 1
    v_add_f32_dpp v4, v4, v4 row_half_mirror row_mask:0xf bank_mask:0xf
    s_nop 1
    v_add_f32_dpp v4, v4, v4 row_mirror row_mask:0xf bank_mask:0xf
    s_nop 1
    v_readlane_b32 s4, v4, 0
    v_readlane_b32 s5, v4, 16
    v_readlane_b32 s6, v4, 32
    v_readlane_b32 s7, v4, 48
    s_nop 1
    v_mov_b32 v5, s4
    v_add_f32 v5, s5, v5
    v_add_f32 v5, s6, v5
    v_add_f32 v5, s7, v5
    v_cmp_eq_u32 vcc, 0, v250
    s_nop 1
    v_cndmask_b32 v6, v6, v5, vcc
    s_waitcnt vmcnt(28)
    v_lshlrev_b32 v5, 16, v40
    v_mul_f32 v4, v5, v16
    v_and_b32 v5, 0xffff0000, v40
    v_fmac_f32 v4, v5, v17
    v_lshlrev_b32 v5, 16, v41
    v_fmac_f32 v4, v5, v18
    v_and_b32 v5, 0xffff0000, v41
    v_fmac_f32 v4, v5, v19
    v_lshlrev_b32 v5, 16, v42
    v_fmac_f32 v4, v5, v20
    v_and_b32 v5, 0xffff0000, v42
    v_fmac_f32 v4, v5, v21
    v_lshlrev_b32 v5, 16, v43
    v_fmac_f32 v4, v5, v22
    v_and_b32 v5, 0xffff0000, v43
    v_fmac_f32 v4, v5, v23
    v_lshlrev_b32 v5, 16, v44
    v_fmac_f32 v4, v5, v24
    v_and_b32 v5, 0xffff0000, v44
    v_fmac_f32 v4, v5, v25
    v_lshlrev_b32 v5, 16, v45
    v_fmac_f32 v4, v5, v26
    v_and_b32 v5, 0xffff0000, v45
    v_fmac_f32 v4, v5, v27
    v_lshlrev_b32 v5, 16, v46
    v_fmac_f32 v4, v5, v28
    v_and_b32 v5, 0xffff0000, v46
    v_fmac_f32 v4, v5, v29
    v_lshlrev_b32 v5, 16, v47
    v_fmac_f32 v4, v5, v30
    v_and_b32 v5, 0xffff0000, v47
    v_fmac_f32 v4, v5, v31
    s_nop 1
    v_add_f32_dpp v4, v4, v4 quad_perm:[1,0,3,2] row_mask:0xf bank_mask:0xf
    s_nop 1
    v_add_f32_dpp v4, v4, v4 quad_perm:[2,3,0,1] row_mask:0xf bank_mask:0xf
    s_nop 1
    v_add_f32_dpp v4, v4, v4 row_half_mirror row_mask:0xf bank_mask:0xf
    s_nop 1
    v_add_f32_dpp v4, v4, v4 row_mirror row_mask:0xf bank_mask:0xf
    s_nop 1
    v_readlane_b32 s4, v4, 0
    v_readlane_b32 s5, v4, 16
    v_readlane_b32 s6, v4, 32
    v_readlane_b32 s7, v4, 48
    s_nop 1
    v_mov_b32 v5, s4
    v_add_f32 v5, s5, v5
    v_add_f32 v5, s6, v5
    v_add_f32 v5, s7, v5
    v_cmp_eq_u32 vcc, 1, v250
    s_nop 1
    v_cndmask_b32 v6, v6, v5, vcc
    s_waitcnt vmcnt(26)
    v_lshlrev_b32 v5, 16, v48
    v_mul_f32 v4, v5, v16
    v_and_b32 v5, 0xffff0000, v48
    v_fmac_f32 v4, v5, v17
    v_lshlrev_b32 v5, 16, v49
    v_fmac_f32 v4, v5, v18
    v_and_b32 v5, 0xffff0000, v49
    v_fmac_f32 v4, v5, v19
    v_lshlrev_b32 v5, 16, v50
    v_fmac_f32 v4, v5, v20
    v_and_b32 v5, 0xffff0000, v50
    v_fmac_f32 v4, v5, v21
    v_lshlrev_b32 v5, 16, v51
    v_fmac_f32 v4, v5, v22
    v_and_b32 v5, 0xffff0000, v51
    v_fmac_f32 v4, v5, v23
    v_lshlrev_b32 v5, 16, v52
    v_fmac_f32 v4, v5, v24
    v_and_b32 v5, 0xffff0000, v52
    v_fmac_f32 v4, v5, v25
    v_lshlrev_b32 v5, 16, v53
    v_fmac_f32 v4, v5, v26
    v_and_b32 v5, 0xffff0000, v53
    v_fmac_f32 v4, v5, v27
    v_lshlrev_b32 v5, 16, v54
    v_fmac_f32 v4, v5, v28
    v_and_b32 v5, 0xffff0000, v54
    v_fmac_f32 v4, v5, v29
    v_lshlrev_b32 v5, 16, v55
    v_fmac_f32 v4, v5, v30
    v_and_b32 v5, 0xffff0000, v55
    v_fmac_f32 v4, v5, v31
    s_nop 1
    v_add_f32_dpp v4, v4, v4 quad_perm:[1,0,3,2] row_mask:0xf bank_mask:0xf
    s_nop 1
    v_add_f32_dpp v4, v4, v4 quad_perm:[2,3,0,1] row_mask:0xf bank_mask:0xf
    s_nop 1
    v_add_f32_dpp v4, v4, v4 row_half_mirror row_mask:0xf bank_mask:0xf
    s_nop 1
    v_add_f32_dpp v4, v4, v4 row_mirror row_mask:0xf bank_mask:0xf
    s_nop 1
    v_readlane_b32 s4, v4, 0
    v_readlane_b32 s5, v4, 16
    v_readlane_b32 s6, v4, 32
    v_readlane_b32 s7, v4, 48
    s_nop 1
    v_mov_b32 v5, s4
    v_add_f32 v5, s5, v5
    v_add_f32 v5, s6, v5
    v_add_f32 v5, s7, v5
    v_cmp_eq_u32 vcc, 2, v250
    s_nop 1
    v_cndmask_b32 v6, v6, v5, vcc
    s_waitcnt vmcnt(24)
    v_lshlrev_b32 v5, 16, v56
    v_mul_f32 v4, v5, v16
    v_and_b32 v5, 0xffff0000, v56
    v_fmac_f32 v4, v5, v17
    v_lshlrev_b32 v5, 16, v57
    v_fmac_f32 v4, v5, v18
    v_and_b32 v5, 0xffff0000, v57
    v_fmac_f32 v4, v5, v19
    v_lshlrev_b32 v5, 16, v58
    v_fmac_f32 v4, v5, v20
    v_and_b32 v5, 0xffff0000, v58
    v_fmac_f32 v4, v5, v21
    v_lshlrev_b32 v5, 16, v59
    v_fmac_f32 v4, v5, v22
    v_and_b32 v5, 0xffff0000, v59
    v_fmac_f32 v4, v5, v23
    v_lshlrev_b32 v5, 16, v60
    v_fmac_f32 v4, v5, v24
    v_and_b32 v5, 0xffff0000, v60
    v_fmac_f32 v4, v5, v25
    v_lshlrev_b32 v5, 16, v61
    v_fmac_f32 v4, v5, v26
    v_and_b32 v5, 0xffff0000, v61
    v_fmac_f32 v4, v5, v27
    v_lshlrev_b32 v5, 16, v62
    v_fmac_f32 v4, v5, v28
    v_and_b32 v5, 0xffff0000, v62
    v_fmac_f32 v4, v5, v29
    v_lshlrev_b32 v5, 16, v63
    v_fmac_f32 v4, v5, v30
    v_and_b32 v5, 0xffff0000, v63
    v_fmac_f32 v4, v5, v31
    s_nop 1
    v_add_f32_dpp v4, v4, v4 quad_perm:[1,0,3,2] row_mask:0xf bank_mask:0xf
    s_nop 1
    v_add_f32_dpp v4, v4, v4 quad_perm:[2,3,0,1] row_mask:0xf bank_mask:0xf
    s_nop 1
    v_add_f32_dpp v4, v4, v4 row_half_mirror row_mask:0xf bank_mask:0xf
    s_nop 1
    v_add_f32_dpp v4, v4, v4 row_mirror row_mask:0xf bank_mask:0xf
    s_nop 1
    v_readlane_b32 s4, v4, 0
    v_readlane_b32 s5, v4, 16
    v_readlane_b32 s6, v4, 32
    v_readlane_b32 s7, v4, 48
    s_nop 1
    v_mov_b32 v5, s4
    v_add_f32 v5, s5, v5
    v_add_f32 v5, s6, v5
    v_add_f32 v5, s7, v5
    v_cmp_eq_u32 vcc, 3, v250
    s_nop 1
    v_cndmask_b32 v6, v6, v5, vcc
    s_waitcnt vmcnt(22)
    v_lshlrev_b32 v5, 16, v64
    v_mul_f32 v4, v5, v16
    v_and_b32 v5, 0xffff0000, v64
    v_fmac_f32 v4, v5, v17
    v_lshlrev_b32 v5, 16, v65
    v_fmac_f32 v4, v5, v18
    v_and_b32 v5, 0xffff0000, v65
    v_fmac_f32 v4, v5, v19
    v_lshlrev_b32 v5, 16, v66
    v_fmac_f32 v4, v5, v20
    v_and_b32 v5, 0xffff0000, v66
    v_fmac_f32 v4, v5, v21
    v_lshlrev_b32 v5, 16, v67
    v_fmac_f32 v4, v5, v22
    v_and_b32 v5, 0xffff0000, v67
    v_fmac_f32 v4, v5, v23
    v_lshlrev_b32 v5, 16, v68
    v_fmac_f32 v4, v5, v24
    v_and_b32 v5, 0xffff0000, v68
    v_fmac_f32 v4, v5, v25
    v_lshlrev_b32 v5, 16, v69
    v_fmac_f32 v4, v5, v26
    v_and_b32 v5, 0xffff0000, v69
    v_fmac_f32 v4, v5, v27
    v_lshlrev_b32 v5, 16, v70
    v_fmac_f32 v4, v5, v28
    v_and_b32 v5, 0xffff0000, v70
    v_fmac_f32 v4, v5, v29
    v_lshlrev_b32 v5, 16, v71
    v_fmac_f32 v4, v5, v30
    v_and_b32 v5, 0xffff0000, v71
    v_fmac_f32 v4, v5, v31
    s_nop 1
    v_add_f32_dpp v4, v4, v4 quad_perm:[1,0,3,2] row_mask:0xf bank_mask:0xf
    s_nop 1
    v_add_f32_dpp v4, v4, v4 quad_perm:[2,3,0,1] row_mask:0xf bank_mask:0xf
    s_nop 1
    v_add_f32_dpp v4, v4, v4 row_half_mirror row_mask:0xf bank_mask:0xf
    s_nop 1
    v_add_f32_dpp v4, v4, v4 row_mirror row_mask:0xf bank_mask:0xf
    s_nop 1
    v_readlane_b32 s4, v4, 0
    v_readlane_b32 s5, v4, 16
    v_readlane_b32 s6, v4, 32
    v_readlane_b32 s7, v4, 48
    s_nop 1
    v_mov_b32 v5, s4
    v_add_f32 v5, s5, v5
    v_add_f32 v5, s6, v5
    v_add_f32 v5, s7, v5
    v_cmp_eq_u32 vcc, 4, v250
    s_nop 1
    v_cndmask_b32 v6, v6, v5, vcc
    s_waitcnt vmcnt(20)
    v_lshlrev_b32 v5, 16, v72
    v_mul_f32 v4, v5, v16
    v_and_b32 v5, 0xffff0000, v72
    v_fmac_f32 v4, v5, v17
    v_lshlrev_b32 v5, 16, v73
    v_fmac_f32 v4, v5, v18
    v_and_b32 v5, 0xffff0000, v73
    v_fmac_f32 v4, v5, v19
    v_lshlrev_b32 v5, 16, v74
    v_fmac_f32 v4, v5, v20
    v_and_b32 v5, 0xffff0000, v74
    v_fmac_f32 v4, v5, v21
    v_lshlrev_b32 v5, 16, v75
    v_fmac_f32 v4, v5, v22
    v_and_b32 v5, 0xffff0000, v75
    v_fmac_f32 v4, v5, v23
    v_lshlrev_b32 v5, 16, v76
    v_fmac_f32 v4, v5, v24
    v_and_b32 v5, 0xffff0000, v76
    v_fmac_f32 v4, v5, v25
    v_lshlrev_b32 v5, 16, v77
    v_fmac_f32 v4, v5, v26
    v_and_b32 v5, 0xffff0000, v77
    v_fmac_f32 v4, v5, v27
    v_lshlrev_b32 v5, 16, v78
    v_fmac_f32 v4, v5, v28
    v_and_b32 v5, 0xffff0000, v78
    v_fmac_f32 v4, v5, v29
    v_lshlrev_b32 v5, 16, v79
    v_fmac_f32 v4, v5, v30
    v_and_b32 v5, 0xffff0000, v79
    v_fmac_f32 v4, v5, v31
    s_nop 1
    v_add_f32_dpp v4, v4, v4 quad_perm:[1,0,3,2] row_mask:0xf bank_mask:0xf
    s_nop 1
    v_add_f32_dpp v4, v4, v4 quad_perm:[2,3,0,1] row_mask:0xf bank_mask:0xf
    s_nop 1
    v_add_f32_dpp v4, v4, v4 row_half_mirror row_mask:0xf bank_mask:0xf
    s_nop 1
    v_add_f32_dpp v4, v4, v4 row_mirror row_mask:0xf bank_mask:0xf
    s_nop 1
    v_readlane_b32 s4, v4, 0
    v_readlane_b32 s5, v4, 16
    v_readlane_b32 s6, v4, 32
    v_readlane_b32 s7, v4, 48
    s_nop 1
    v_mov_b32 v5, s4
    v_add_f32 v5, s5, v5
    v_add_f32 v5, s6, v5
    v_add_f32 v5, s7, v5
    v_cmp_eq_u32 vcc, 5, v250
    s_nop 1
    v_cndmask_b32 v6, v6, v5, vcc
    s_waitcnt vmcnt(18)
    v_lshlrev_b32 v5, 16, v80
    v_mul_f32 v4, v5, v16
    v_and_b32 v5, 0xffff0000, v80
    v_fmac_f32 v4, v5, v17
    v_lshlrev_b32 v5, 16, v81
    v_fmac_f32 v4, v5, v18
    v_and_b32 v5, 0xffff0000, v81
    v_fmac_f32 v4, v5, v19
    v_lshlrev_b32 v5, 16, v82
    v_fmac_f32 v4, v5, v20
    v_and_b32 v5, 0xffff0000, v82
    v_fmac_f32 v4, v5, v21
    v_lshlrev_b32 v5, 16, v83
    v_fmac_f32 v4, v5, v22
    v_and_b32 v5, 0xffff0000, v83
    v_fmac_f32 v4, v5, v23
    v_lshlrev_b32 v5, 16, v84
    v_fmac_f32 v4, v5, v24
    v_and_b32 v5, 0xffff0000, v84
    v_fmac_f32 v4, v5, v25
    v_lshlrev_b32 v5, 16, v85
    v_fmac_f32 v4, v5, v26
    v_and_b32 v5, 0xffff0000, v85
    v_fmac_f32 v4, v5, v27
    v_lshlrev_b32 v5, 16, v86
    v_fmac_f32 v4, v5, v28
    v_and_b32 v5, 0xffff0000, v86
    v_fmac_f32 v4, v5, v29
    v_lshlrev_b32 v5, 16, v87
    v_fmac_f32 v4, v5, v30
    v_and_b32 v5, 0xffff0000, v87
    v_fmac_f32 v4, v5, v31
    s_nop 1
    v_add_f32_dpp v4, v4, v4 quad_perm:[1,0,3,2] row_mask:0xf bank_mask:0xf
    s_nop 1
    v_add_f32_dpp v4, v4, v4 quad_perm:[2,3,0,1] row_mask:0xf bank_mask:0xf
    s_nop 1
    v_add_f32_dpp v4, v4, v4 row_half_mirror row_mask:0xf bank_mask:0xf
    s_nop 1
    v_add_f32_dpp v4, v4, v4 row_mirror row_mask:0xf bank_mask:0xf
    s_nop 1
    v_readlane_b32 s4, v4, 0
    v_readlane_b32 s5, v4, 16
    v_readlane_b32 s6, v4, 32
    v_readlane_b32 s7, v4, 48
    s_nop 1
    v_mov_b32 v5, s4
    v_add_f32 v5, s5, v5
    v_add_f32 v5, s6, v5
    v_add_f32 v5, s7, v5
    v_cmp_eq_u32 vcc, 6, v250
    s_nop 1
    v_cndmask_b32 v6, v6, v5, vcc
    s_waitcnt vmcnt(16)
    v_lshlrev_b32 v5, 16, v88
    v_mul_f32 v4, v5, v16
    v_and_b32 v5, 0xffff0000, v88
    v_fmac_f32 v4, v5, v17
    v_lshlrev_b32 v5, 16, v89
    v_fmac_f32 v4, v5, v18
    v_and_b32 v5, 0xffff0000, v89
    v_fmac_f32 v4, v5, v19
    v_lshlrev_b32 v5, 16, v90
    v_fmac_f32 v4, v5, v20
    v_and_b32 v5, 0xffff0000, v90
    v_fmac_f32 v4, v5, v21
    v_lshlrev_b32 v5, 16, v91
    v_fmac_f32 v4, v5, v22
    v_and_b32 v5, 0xffff0000, v91
    v_fmac_f32 v4, v5, v23
    v_lshlrev_b32 v5, 16, v92
    v_fmac_f32 v4, v5, v24
    v_and_b32 v5, 0xffff0000, v92
    v_fmac_f32 v4, v5, v25
    v_lshlrev_b32 v5, 16, v93
    v_fmac_f32 v4, v5, v26
    v_and_b32 v5, 0xffff0000, v93
    v_fmac_f32 v4, v5, v27
    v_lshlrev_b32 v5, 16, v94
    v_fmac_f32 v4, v5, v28
    v_and_b32 v5, 0xffff0000, v94
    v_fmac_f32 v4, v5, v29
    v_lshlrev_b32 v5, 16, v95
    v_fmac_f32 v4, v5, v30
    v_and_b32 v5, 0xffff0000, v95
    v_fmac_f32 v4, v5, v31
    s_nop 1
    v_add_f32_dpp v4, v4, v4 quad_perm:[1,0,3,2] row_mask:0xf bank_mask:0xf
    s_nop 1
    v_add_f32_dpp v4, v4, v4 quad_perm:[2,3,0,1] row_mask:0xf bank_mask:0xf
    s_nop 1
    v_add_f32_dpp v4, v4, v4 row_half_mirror row_mask:0xf bank_mask:0xf
    s_nop 1
    v_add_f32_dpp v4, v4, v4 row_mirror row_mask:0xf bank_mask:0xf
    s_nop 1
    v_readlane_b32 s4, v4, 0
    v_readlane_b32 s5, v4, 16
    v_readlane_b32 s6, v4, 32
    v_readlane_b32 s7, v4, 48
    s_nop 1
    v_mov_b32 v5, s4
    v_add_f32 v5, s5, v5
    v_add_f32 v5, s6, v5
    v_add_f32 v5, s7, v5
    v_cmp_eq_u32 vcc, 7, v250
    s_nop 1
    v_cndmask_b32 v6, v6, v5, vcc
    s_waitcnt vmcnt(14)
    v_lshlrev_b32 v5, 16, v96
    v_mul_f32 v4, v5, v16
    v_and_b32 v5, 0xffff0000, v96
    v_fmac_f32 v4, v5, v17
    v_lshlrev_b32 v5, 16, v97
    v_fmac_f32 v4, v5, v18
    v_and_b32 v5, 0xffff0000, v97
    v_fmac_f32 v4, v5, v19
    v_lshlrev_b32 v5, 16, v98
    v_fmac_f32 v4, v5, v20
    v_and_b32 v5, 0xffff0000, v98
    v_fmac_f32 v4, v5, v21
    v_lshlrev_b32 v5, 16, v99
    v_fmac_f32 v4, v5, v22
    v_and_b32 v5, 0xffff0000, v99
    v_fmac_f32 v4, v5, v23
    v_lshlrev_b32 v5, 16, v100
    v_fmac_f32 v4, v5, v24
    v_and_b32 v5, 0xffff0000, v100
    v_fmac_f32 v4, v5, v25
    v_lshlrev_b32 v5, 16, v101
    v_fmac_f32 v4, v5, v26
    v_and_b32 v5, 0xffff0000, v101
    v_fmac_f32 v4, v5, v27
    v_lshlrev_b32 v5, 16, v102
    v_fmac_f32 v4, v5, v28
    v_and_b32 v5, 0xffff0000, v102
    v_fmac_f32 v4, v5, v29
    v_lshlrev_b32 v5, 16, v103
    v_fmac_f32 v4, v5, v30
    v_and_b32 v5, 0xffff0000, v103
    v_fmac_f32 v4, v5, v31
    s_nop 1
    v_add_f32_dpp v4, v4, v4 quad_perm:[1,0,3,2] row_mask:0xf bank_mask:0xf
    s_nop 1
    v_add_f32_dpp v4, v4, v4 quad_perm:[2,3,0,1] row_mask:0xf bank_mask:0xf
    s_nop 1
    v_add_f32_dpp v4, v4, v4 row_half_mirror row_mask:0xf bank_mask:0xf
    s_nop 1
    v_add_f32_dpp v4, v4, v4 row_mirror row_mask:0xf bank_mask:0xf
    s_nop 1
    v_readlane_b32 s4, v4, 0
    v_readlane_b32 s5, v4, 16
    v_readlane_b32 s6, v4, 32
    v_readlane_b32 s7, v4, 48
    s_nop 1
    v_mov_b32 v5, s4
    v_add_f32 v5, s5, v5
    v_add_f32 v5, s6, v5
    v_add_f32 v5, s7, v5
    v_cmp_eq_u32 vcc, 8, v250
    s_nop 1
    v_cndmask_b32 v6, v6, v5, vcc
    s_waitcnt vmcnt(12)
    v_lshlrev_b32 v5, 16, v104
    v_mul_f32 v4, v5, v16
    v_and_b32 v5, 0xffff0000, v104
    v_fmac_f32 v4, v5, v17
    v_lshlrev_b32 v5, 16, v105
    v_fmac_f32 v4, v5, v18
    v_and_b32 v5, 0xffff0000, v105
    v_fmac_f32 v4, v5, v19
    v_lshlrev_b32 v5, 16, v106
    v_fmac_f32 v4, v5, v20
    v_and_b32 v5, 0xffff0000, v106
    v_fmac_f32 v4, v5, v21
    v_lshlrev_b32 v5, 16, v107
    v_fmac_f32 v4, v5, v22
    v_and_b32 v5, 0xffff0000, v107
    v_fmac_f32 v4, v5, v23
    v_lshlrev_b32 v5, 16, v108
    v_fmac_f32 v4, v5, v24
    v_and_b32 v5, 0xffff0000, v108
    v_fmac_f32 v4, v5, v25
    v_lshlrev_b32 v5, 16, v109
    v_fmac_f32 v4, v5, v26
    v_and_b32 v5, 0xffff0000, v109
    v_fmac_f32 v4, v5, v27
    v_lshlrev_b32 v5, 16, v110
    v_fmac_f32 v4, v5, v28
    v_and_b32 v5, 0xffff0000, v110
    v_fmac_f32 v4, v5, v29
    v_lshlrev_b32 v5, 16, v111
    v_fmac_f32 v4, v5, v30
    v_and_b32 v5, 0xffff0000, v111
    v_fmac_f32 v4, v5, v31
    s_nop 1
    v_add_f32_dpp v4, v4, v4 quad_perm:[1,0,3,2] row_mask:0xf bank_mask:0xf
    s_nop 1
    v_add_f32_dpp v4, v4, v4 quad_perm:[2,3,0,1] row_mask:0xf bank_mask:0xf
    s_nop 1
    v_add_f32_dpp v4, v4, v4 row_half_mirror row_mask:0xf bank_mask:0xf
    s_nop 1
    v_add_f32_dpp v4, v4, v4 row_mirror row_mask:0xf bank_mask:0xf
    s_nop 1
    v_readlane_b32 s4, v4, 0
    v_readlane_b32 s5, v4, 16
    v_readlane_b32 s6, v4, 32
    v_readlane_b32 s7, v4, 48
    s_nop 1
    v_mov_b32 v5, s4
    v_add_f32 v5, s5, v5
    v_add_f32 v5, s6, v5
    v_add_f32 v5, s7, v5
    v_cmp_eq_u32 vcc, 9, v250
    s_nop 1
    v_cndmask_b32 v6, v6, v5, vcc
    s_waitcnt vmcnt(10)
    v_lshlrev_b32 v5, 16, v112
    v_mul_f32 v4, v5, v16
    v_and_b32 v5, 0xffff0000, v112
    v_fmac_f32 v4, v5, v17
    v_lshlrev_b32 v5, 16, v113
    v_fmac_f32 v4, v5, v18
    v_and_b32 v5, 0xffff0000, v113
    v_fmac_f32 v4, v5, v19
    v_lshlrev_b32 v5, 16, v114
    v_fmac_f32 v4, v5, v20
    v_and_b32 v5, 0xffff0000, v114
    v_fmac_f32 v4, v5, v21
    v_lshlrev_b32 v5, 16, v115
    v_fmac_f32 v4, v5, v22
    v_and_b32 v5, 0xffff0000, v115
    v_fmac_f32 v4, v5, v23
    v_lshlrev_b32 v5, 16, v116
    v_fmac_f32 v4, v5, v24
    v_and_b32 v5, 0xffff0000, v116
    v_fmac_f32 v4, v5, v25
    v_lshlrev_b32 v5, 16, v117
    v_fmac_f32 v4, v5, v26
    v_and_b32 v5, 0xffff0000, v117
    v_fmac_f32 v4, v5, v27
    v_lshlrev_b32 v5, 16, v118
    v_fmac_f32 v4, v5, v28
    v_and_b32 v5, 0xffff0000, v118
    v_fmac_f32 v4, v5, v29
    v_lshlrev_b32 v5, 16, v119
    v_fmac_f32 v4, v5, v30
    v_and_b32 v5, 0xffff0000, v119
    v_fmac_f32 v4, v5, v31
    s_nop 1
    v_add_f32_dpp v4, v4, v4 quad_perm:[1,0,3,2] row_mask:0xf bank_mask:0xf
    s_nop 1
    v_add_f32_dpp v4, v4, v4 quad_perm:[2,3,0,1] row_mask:0xf bank_mask:0xf
    s_nop 1
    v_add_f32_dpp v4, v4, v4 row_half_mirror row_mask:0xf bank_mask:0xf
    s_nop 1
    v_add_f32_dpp v4, v4, v4 row_mirror row_mask:0xf bank_mask:0xf
    s_nop 1
    v_readlane_b32 s4, v4, 0
    v_readlane_b32 s5, v4, 16
    v_readlane_b32 s6, v4, 32
    v_readlane_b32 s7, v4, 48
    s_nop 1
    v_mov_b32 v5, s4
    v_add_f32 v5, s5, v5
    v_add_f32 v5, s6, v5
    v_add_f32 v5, s7, v5
    v_cmp_eq_u32 vcc, 10, v250
    s_nop 1
    v_cndmask_b32 v6, v6, v5, vcc
    s_waitcnt vmcnt(8)
    v_lshlrev_b32 v5, 16, v120
    v_mul_f32 v4, v5, v16
    v_and_b32 v5, 0xffff0000, v120
    v_fmac_f32 v4, v5, v17
    v_lshlrev_b32 v5, 16, v121
    v_fmac_f32 v4, v5, v18
    v_and_b32 v5, 0xffff0000, v121
    v_fmac_f32 v4, v5, v19
    v_lshlrev_b32 v5, 16, v122
    v_fmac_f32 v4, v5, v20
    v_and_b32 v5, 0xffff0000, v122
    v_fmac_f32 v4, v5, v21
    v_lshlrev_b32 v5, 16, v123
    v_fmac_f32 v4, v5, v22
    v_and_b32 v5, 0xffff0000, v123
    v_fmac_f32 v4, v5, v23
    v_lshlrev_b32 v5, 16, v124
    v_fmac_f32 v4, v5, v24
    v_and_b32 v5, 0xffff0000, v124
    v_fmac_f32 v4, v5, v25
    v_lshlrev_b32 v5, 16, v125
    v_fmac_f32 v4, v5, v26
    v_and_b32 v5, 0xffff0000, v125
    v_fmac_f32 v4, v5, v27
    v_lshlrev_b32 v5, 16, v126
    v_fmac_f32 v4, v5, v28
    v_and_b32 v5, 0xffff0000, v126
    v_fmac_f32 v4, v5, v29
    v_lshlrev_b32 v5, 16, v127
    v_fmac_f32 v4, v5, v30
    v_and_b32 v5, 0xffff0000, v127
    v_fmac_f32 v4, v5, v31
    s_nop 1
    v_add_f32_dpp v4, v4, v4 quad_perm:[1,0,3,2] row_mask:0xf bank_mask:0xf
    s_nop 1
    v_add_f32_dpp v4, v4, v4 quad_perm:[2,3,0,1] row_mask:0xf bank_mask:0xf
    s_nop 1
    v_add_f32_dpp v4, v4, v4 row_half_mirror row_mask:0xf bank_mask:0xf
    s_nop 1
    v_add_f32_dpp v4, v4, v4 row_mirror row_mask:0xf bank_mask:0xf
    s_nop 1
    v_readlane_b32 s4, v4, 0
    v_readlane_b32 s5, v4, 16
    v_readlane_b32 s6, v4, 32
    v_readlane_b32 s7, v4, 48
    s_nop 1
    v_mov_b32 v5, s4
    v_add_f32 v5, s5, v5
    v_add_f32 v5, s6, v5
    v_add_f32 v5, s7, v5
    v_cmp_eq_u32 vcc, 11, v250
    s_nop 1
    v_cndmask_b32 v6, v6, v5, vcc
    s_waitcnt vmcnt(6)
    v_lshlrev_b32 v5, 16, v128
    v_mul_f32 v4, v5, v16
    v_and_b32 v5, 0xffff0000, v128
    v_fmac_f32 v4, v5, v17
    v_lshlrev_b32 v5, 16, v129
    v_fmac_f32 v4, v5, v18
    v_and_b32 v5, 0xffff0000, v129
    v_fmac_f32 v4, v5, v19
    v_lshlrev_b32 v5, 16, v130
    v_fmac_f32 v4, v5, v20
    v_and_b32 v5, 0xffff0000, v130
    v_fmac_f32 v4, v5, v21
    v_lshlrev_b32 v5, 16, v131
    v_fmac_f32 v4, v5, v22
    v_and_b32 v5, 0xffff0000, v131
    v_fmac_f32 v4, v5, v23
    v_lshlrev_b32 v5, 16, v132
    v_fmac_f32 v4, v5, v24
    v_and_b32 v5, 0xffff0000, v132
    v_fmac_f32 v4, v5, v25
    v_lshlrev_b32 v5, 16, v133
    v_fmac_f32 v4, v5, v26
    v_and_b32 v5, 0xffff0000, v133
    v_fmac_f32 v4, v5, v27
    v_lshlrev_b32 v5, 16, v134
    v_fmac_f32 v4, v5, v28
    v_and_b32 v5, 0xffff0000, v134
    v_fmac_f32 v4, v5, v29
    v_lshlrev_b32 v5, 16, v135
    v_fmac_f32 v4, v5, v30
    v_and_b32 v5, 0xffff0000, v135
    v_fmac_f32 v4, v5, v31
    s_nop 1
    v_add_f32_dpp v4, v4, v4 quad_perm:[1,0,3,2] row_mask:0xf bank_mask:0xf
    s_nop 1
    v_add_f32_dpp v4, v4, v4 quad_perm:[2,3,0,1] row_mask:0xf bank_mask:0xf
    s_nop 1
    v_add_f32_dpp v4, v4, v4 row_half_mirror row_mask:0xf bank_mask:0xf
    s_nop 1
    v_add_f32_dpp v4, v4, v4 row_mirror row_mask:0xf bank_mask:0xf
    s_nop 1
    v_readlane_b32 s4, v4, 0
    v_readlane_b32 s5, v4, 16
    v_readlane_b32 s6, v4, 32
    v_readlane_b32 s7, v4, 48
    s_nop 1
    v_mov_b32 v5, s4
    v_add_f32 v5, s5, v5
    v_add_f32 v5, s6, v5
    v_add_f32 v5, s7, v5
    v_cmp_eq_u32 vcc, 12, v250
    s_nop 1
    v_cndmask_b32 v6, v6, v5, vcc
    s_waitcnt vmcnt(4)
    v_lshlrev_b32 v5, 16, v136
    v_mul_f32 v4, v5, v16
    v_and_b32 v5, 0xffff0000, v136
    v_fmac_f32 v4, v5, v17
    v_lshlrev_b32 v5, 16, v137
    v_fmac_f32 v4, v5, v18
    v_and_b32 v5, 0xffff0000, v137
    v_fmac_f32 v4, v5, v19
    v_lshlrev_b32 v5, 16, v138
    v_fmac_f32 v4, v5, v20
    v_and_b32 v5, 0xffff0000, v138
    v_fmac_f32 v4, v5, v21
    v_lshlrev_b32 v5, 16, v139
    v_fmac_f32 v4, v5, v22
    v_and_b32 v5, 0xffff0000, v139
    v_fmac_f32 v4, v5, v23
    v_lshlrev_b32 v5, 16, v140
    v_fmac_f32 v4, v5, v24
    v_and_b32 v5, 0xffff0000, v140
    v_fmac_f32 v4, v5, v25
    v_lshlrev_b32 v5, 16, v141
    v_fmac_f32 v4, v5, v26
    v_and_b32 v5, 0xffff0000, v141
    v_fmac_f32 v4, v5, v27
    v_lshlrev_b32 v5, 16, v142
    v_fmac_f32 v4, v5, v28
    v_and_b32 v5, 0xffff0000, v142
    v_fmac_f32 v4, v5, v29
    v_lshlrev_b32 v5, 16, v143
    v_fmac_f32 v4, v5, v30
    v_and_b32 v5, 0xffff0000, v143
    v_fmac_f32 v4, v5, v31
    s_nop 1
    v_add_f32_dpp v4, v4, v4 quad_perm:[1,0,3,2] row_mask:0xf bank_mask:0xf
    s_nop 1
    v_add_f32_dpp v4, v4, v4 quad_perm:[2,3,0,1] row_mask:0xf bank_mask:0xf
    s_nop 1
    v_add_f32_dpp v4, v4, v4 row_half_mirror row_mask:0xf bank_mask:0xf
    s_nop 1
    v_add_f32_dpp v4, v4, v4 row_mirror row_mask:0xf bank_mask:0xf
    s_nop 1
    v_readlane_b32 s4, v4, 0
    v_readlane_b32 s5, v4, 16
    v_readlane_b32 s6, v4, 32
    v_readlane_b32 s7, v4, 48
    s_nop 1
    v_mov_b32 v5, s4
    v_add_f32 v5, s5, v5
    v_add_f32 v5, s6, v5
    v_add_f32 v5, s7, v5
    v_cmp_eq_u32 vcc, 13, v250
    s_nop 1
    v_cndmask_b32 v6, v6, v5, vcc
    s_waitcnt vmcnt(2)
    v_lshlrev_b32 v5, 16, v144
    v_mul_f32 v4, v5, v16
    v_and_b32 v5, 0xffff0000, v144
    v_fmac_f32 v4, v5, v17
    v_lshlrev_b32 v5, 16, v145
    v_fmac_f32 v4, v5, v18
    v_and_b32 v5, 0xffff0000, v145
    v_fmac_f32 v4, v5, v19
    v_lshlrev_b32 v5, 16, v146
    v_fmac_f32 v4, v5, v20
    v_and_b32 v5, 0xffff0000, v146
    v_fmac_f32 v4, v5, v21
    v_lshlrev_b32 v5, 16, v147
    v_fmac_f32 v4, v5, v22
    v_and_b32 v5, 0xffff0000, v147
    v_fmac_f32 v4, v5, v23
    v_lshlrev_b32 v5, 16, v148
    v_fmac_f32 v4, v5, v24
    v_and_b32 v5, 0xffff0000, v148
    v_fmac_f32 v4, v5, v25
    v_lshlrev_b32 v5, 16, v149
    v_fmac_f32 v4, v5, v26
    v_and_b32 v5, 0xffff0000, v149
    v_fmac_f32 v4, v5, v27
    v_lshlrev_b32 v5, 16, v150
    v_fmac_f32 v4, v5, v28
    v_and_b32 v5, 0xffff0000, v150
    v_fmac_f32 v4, v5, v29
    v_lshlrev_b32 v5, 16, v151
    v_fmac_f32 v4, v5, v30
    v_and_b32 v5, 0xffff0000, v151
    v_fmac_f32 v4, v5, v31
    s_nop 1
    v_add_f32_dpp v4, v4, v4 quad_perm:[1,0,3,2] row_mask:0xf bank_mask:0xf
    s_nop 1
    v_add_f32_dpp v4, v4, v4 quad_perm:[2,3,0,1] row_mask:0xf bank_mask:0xf
    s_nop 1
    v_add_f32_dpp v4, v4, v4 row_half_mirror row_mask:0xf bank_mask:0xf
    s_nop 1
    v_add_f32_dpp v4, v4, v4 row_mirror row_mask:0xf bank_mask:0xf
    s_nop 1
    v_readlane_b32 s4, v4, 0
    v_readlane_b32 s5, v4, 16
    v_readlane_b32 s6, v4, 32
    v_readlane_b32 s7, v4, 48
    s_nop 1
    v_mov_b32 v5, s4
    v_add_f32 v5, s5, v5
    v_add_f32 v5, s6, v5
    v_add_f32 v5, s7, v5
    v_cmp_eq_u32 vcc, 14, v250
    s_nop 1
    v_cndmask_b32 v6, v6, v5, vcc
    s_waitcnt vmcnt(0)
    v_lshlrev_b32 v5, 16, v152
    v_mul_f32 v4, v5, v16
    v_and_b32 v5, 0xffff0000, v152
    v_fmac_f32 v4, v5, v17
    v_lshlrev_b32 v5, 16, v153
    v_fmac_f32 v4, v5, v18
    v_and_b32 v5, 0xffff0000, v153
    v_fmac_f32 v4, v5, v19
    v_lshlrev_b32 v5, 16, v154
    v_fmac_f32 v4, v5, v20
    v_and_b32 v5, 0xffff0000, v154
    v_fmac_f32 v4, v5, v21
    v_lshlrev_b32 v5, 16, v155
    v_fmac_f32 v4, v5, v22
    v_and_b32 v5, 0xffff0000, v155
    v_fmac_f32 v4, v5, v23
    v_lshlrev_b32 v5, 16, v156
    v_fmac_f32 v4, v5, v24
    v_and_b32 v5, 0xffff0000, v156
    v_fmac_f32 v4, v5, v25
    v_lshlrev_b32 v5, 16, v157
    v_fmac_f32 v4, v5, v26
    v_and_b32 v5, 0xffff0000, v157
    v_fmac_f32 v4, v5, v27
    v_lshlrev_b32 v5, 16, v158
    v_fmac_f32 v4, v5, v28
    v_and_b32 v5, 0xffff0000, v158
    v_fmac_f32 v4, v5, v29
    v_lshlrev_b32 v5, 16, v159
    v_fmac_f32 v4, v5, v30
    v_and_b32 v5, 0xffff0000, v159
    v_fmac_f32 v4, v5, v31
    s_nop 1
    v_add_f32_dpp v4, v4, v4 quad_perm:[1,0,3,2] row_mask:0xf bank_mask:0xf
    s_nop 1
    v_add_f32_dpp v4, v4, v4 quad_perm:[2,3,0,1] row_mask:0xf bank_mask:0xf
    s_nop 1
    v_add_f32_dpp v4, v4, v4 row_half_mirror row_mask:0xf bank_mask:0xf
    s_nop 1
    v_add_f32_dpp v4, v4, v4 row_mirror row_mask:0xf bank_mask:0xf
    s_nop 1
    v_readlane_b32 s4, v4, 0
    v_readlane_b32 s5, v4, 16
    v_readlane_b32 s6, v4, 32
    v_readlane_b32 s7, v4, 48
    s_nop 1
    v_mov_b32 v5, s4
    v_add_f32 v5, s5, v5
    v_add_f32 v5, s6, v5
    v_add_f32 v5, s7, v5
    v_cmp_eq_u32 vcc, 15, v250
    s_nop 1
    v_cndmask_b32 v6, v6, v5, vcc
    v_mul_f32 v6, 0xbfb8aa3b, v6
    v_exp_f32 v6, v6
    s_nop 0
    v_add_f32 v6, 1.0, v6
    v_rcp_f32 v6, v6
    v_add_u32 v7, s3, v250
    v_lshlrev_b32 v7, 2, v7
    s_mov_b64 exec, 0xffff
    buffer_store_dword v6, v7, s[72:75], 0 offen sc1
    s_mov_b64 exec, -1
    s_waitcnt vmcnt(0)
    s_barrier
    s_mov_b64 exec, 1
    buffer_store_dword v252, v250, s[80:83], s70 offen sc1
    buffer_store_byte v252, v250, s[84:87], s89 offen sc1
    s_mov_b64 exec, -1
    s_brev_b32 s89, 1
g1_nog:
    s_and_b32 s6, s2, 7
    s_lshl_b32 s6, s6, 8
    v_lshlrev_b32 v2, 2, v250
    s_mov_b32 s3, 0
g1_wq:
    buffer_load_dword v0, v2, s[80:83], s6 offen sc1
    s_waitcnt vmcnt(0)
    v_cmp_eq_u32 vcc, 0, v0
    s_mov_b32 s4, 16777215
    s_mov_b32 s5, 16777215
    s_and_b64 vcc, vcc, s[4:5]
    s_cbranch_scc0 g1_wq_ok
    s_sleep 8
    s_add_u32 s3, s3, 1
    s_cmp_lt_u32 s3, 100000
    s_cbranch_scc1 g1_wq
g1_wq_ok:
    s_add_u32 s36, s34, 16777216
    s_addc_u32 s37, s35, 0
    s_mov_b32 s38, 16777216
    s_mov_b32 s39, 0x20000
    s_add_u32 s40, s34, 33554432
    s_addc_u32 s41, s35, 0
    s_mov_b32 s42, 16777216
    s_mov_b32 s43, 0x20000
    s_mov_b32 s76, s34
    s_mov_b32 s77, s35
    s_mov_b32 s78, 16777216
    s_mov_b32 s79, 0x20000
    s_lshr_b32 s4, s2, 3
    s_mov_b32 s5, 0
    s_cmp_eq_u32 s4, 0
    s_cselect_b32 s5, 8270, s5
    s_cmp_eq_u32 s4, 1
    s_cselect_b32 s5, 10334, s5
    s_cmp_eq_u32 s4, 2
    s_cselect_b32 s5, 12398, s5
    s_cmp_eq_u32 s4, 3
    s_cselect_b32 s5, 14462, s5
    s_cmp_eq_u32 s4, 4
    s_cselect_b32 s5, 8397, s5
    s_cmp_eq_u32 s4, 5
    s_cselect_b32 s5, 10461, s5
    s_cmp_eq_u32 s4, 6
    s_cselect_b32 s5, 12525, s5
    s_cmp_eq_u32 s4, 7
    s_cselect_b32 s5, 14589, s5
    s_cmp_eq_u32 s4, 8
    s_cselect_b32 s5, 8524, s5
    s_cmp_eq_u32 s4, 9
    s_cselect_b32 s5, 10588, s5
    s_cmp_eq_u32 s4, 10
    s_cselect_b32 s5, 12652, s5
    s_cmp_eq_u32 s4, 11
    s_cselect_b32 s5, 14716, s5
    s_cmp_eq_u32 s4, 12
    s_cselect_b32 s5, 8651, s5
    s_cmp_eq_u32 s4, 13
    s_cselect_b32 s5, 10715, s5
    s_cmp_eq_u32 s4, 14
    s_cselect_b32 s5, 12779, s5
    s_cmp_eq_u32 s4, 15
    s_cselect_b32 s5, 14843, s5
    s_cmp_eq_u32 s4, 16
    s_cselect_b32 s5, 8778, s5
    s_cmp_eq_u32 s4, 17
    s_cselect_b32 s5, 10842, s5
    s_cmp_eq_u32 s4, 18
    s_cselect_b32 s5, 12906, s5
    s_cmp_eq_u32 s4, 19
    s_cselect_b32 s5, 14970, s5
    s_cmp_eq_u32 s4, 20
    s_cselect_b32 s5, 8905, s5
    s_cmp_eq_u32 s4, 21
    s_cselect_b32 s5, 10969, s5
    s_cmp_eq_u32 s4, 22
    s_cselect_b32 s5, 13033, s5
    s_cmp_eq_u32 s4, 23
    s_cselect_b32 s5, 15097, s5
    s_cmp_eq_u32 s4, 24
    s_cselect_b32 s5, 9032, s5
    s_cmp_eq_u32 s4, 25
    s_cselect_b32 s5, 11096, s5
    s_cmp_eq_u32 s4, 26
    s_cselect_b32 s5, 13160, s5
    s_cmp_eq_u32 s4, 27
    s_cselect_b32 s5, 15224, s5
    s_cmp_eq_u32 s4, 28
    s_cselect_b32 s5, 9167, s5
    s_cmp_eq_u32 s4, 29
    s_cselect_b32 s5, 11231, s5
    s_cmp_eq_u32 s4, 30
    s_cselect_b32 s5, 13295, s5
    s_cmp_eq_u32 s4, 31
    s_cselect_b32 s5, 15359, s5
    s_and_b32 s3, s2, 7
    s_lshl_b32 s3, s3, 2
    s_bfe_u32 s4, s5, 0x20004
    s_add_u32 s3, s3, s4
    s_lshl_b32 s3, s3, 19
    s_and_b32 s5, s5, 15
    s_lshl_b32 s6, s101, 13
    v_lshlrev_b32 v0, 4, v250
    s_lshl_b32 s5, s5, 15
    s_and_b32 s7, s101, 1
    s_lshl_b32 s7, s7, 14
    s_add_u32 s5, s5, s7
    s_add_u32 s5, s5, s3
    v_add_u32 v1, s5, v0
    s_add_u32 s3, s3, s6
    v_add_u32 v0, s3, v0
    s_add_u32 m0, s6, 0
    s_mov_b32 s7, 0
    buffer_load_dwordx4 v0, s[36:39], s7 offen offset:0 lds
    buffer_load_dwordx4 v0, s[36:39], s7 offen offset:1024 lds
    buffer_load_dwordx4 v0, s[36:39], s7 offen offset:2048 lds
    buffer_load_dwordx4 v0, s[36:39], s7 offen offset:3072 lds
    s_add_u32 m0, s6, 4096
    s_mov_b32 s7, 4096
    buffer_load_dwordx4 v0, s[36:39], s7 offen offset:0 lds
    buffer_load_dwordx4 v0, s[36:39], s7 offen offset:1024 lds
    buffer_load_dwordx4 v0, s[36:39], s7 offen offset:2048 lds
    buffer_load_dwordx4 v0, s[36:39], s7 offen offset:3072 lds
    s_mov_b32 s7, 0
    buffer_load_dwordx4 a[144:147], v1, s[76:79], s7 offen offset:0
    buffer_load_dwordx4 a[148:151], v1, s[76:79], s7 offen offset:1024
    buffer_load_dwordx4 a[152:155], v1, s[76:79], s7 offen offset:2048
    buffer_load_dwordx4 a[156:159], v1, s[76:79], s7 offen offset:3072
    s_mov_b32 s7, 4096
    buffer_load_dwordx4 a[160:163], v1, s[76:79], s7 offen offset:0
    buffer_load_dwordx4 a[164:167], v1, s[76:79], s7 offen offset:1024
    buffer_load_dwordx4 a[168:171], v1, s[76:79], s7 offen offset:2048
    buffer_load_dwordx4 a[172:175], v1, s[76:79], s7 offen offset:3072
    s_mov_b32 s7, 8192
    buffer_load_dwordx4 a[176:179], v1, s[76:79], s7 offen offset:0
    buffer_load_dwordx4 a[180:183], v1, s[76:79], s7 offen offset:1024
    buffer_load_dwordx4 a[184:187], v1, s[76:79], s7 offen offset:2048
    buffer_load_dwordx4 a[188:191], v1, s[76:79], s7 offen offset:3072
    s_mov_b32 s7, 12288
    buffer_load_dwordx4 a[192:195], v1, s[76:79], s7 offen offset:0
    buffer_load_dwordx4 a[196:199], v1, s[76:79], s7 offen offset:1024
    buffer_load_dwordx4 a[200:203], v1, s[76:79], s7 offen offset:2048
    buffer_load_dwordx4 a[204:207], v1, s[76:79], s7 offen offset:3072
    s_add_u32 m0, s6, 65536
    s_mov_b32 s7, 0
    buffer_load_dwordx4 v0, s[40:43], s7 offen offset:0 lds
    buffer_load_dwordx4 v0, s[40:43], s7 offen offset:1024 lds
    buffer_load_dwordx4 v0, s[40:43], s7 offen offset:2048 lds
    buffer_load_dwordx4 v0, s[40:43], s7 offen offset:3072 lds
    s_add_u32 m0, s6, 69632
    s_mov_b32 s7, 4096
    buffer_load_dwordx4 v0, s[40:43], s7 offen offset:0 lds
    buffer_load_dwordx4 v0, s[40:43], s7 offen offset:1024 lds
    buffer_load_dwordx4 v0, s[40:43], s7 offen offset:2048 lds
    buffer_load_dwordx4 v0, s[40:43], s7 offen offset:3072 lds
    s_add_u32 m0, s6, 32768
    s_mov_b32 s7, 32768
    buffer_load_dwordx4 v0, s[36:39], s7 offen offset:0 lds
    buffer_load_dwordx4 v0, s[36:39], s7 offen offset:1024 lds
    buffer_load_dwordx4 v0, s[36:39], s7 offen offset:2048 lds
    buffer_load_dwordx4 v0, s[36:39], s7 offen offset:3072 lds
    s_add_u32 m0, s6, 36864
    s_mov_b32 s7, 36864
    buffer_load_dwordx4 v0, s[36:39], s7 offen offset:0 lds
    buffer_load_dwordx4 v0, s[36:39], s7 offen offset:1024 lds
    buffer_load_dwordx4 v0, s[36:39], s7 offen offset:2048 lds
    buffer_load_dwordx4 v0, s[36:39], s7 offen offset:3072 lds
    s_brev_b32 s100, 1
g1_exit:
    s_load_dwordx2 s[4:5], s[0:1], 104
    s_load_dwordx2 s[8:9], s[0:1], 40
    s_load_dwordx2 s[10:11], s[0:1], 72
    v_mbcnt_lo_u32_b32 v236, -1, 0
    v_mbcnt_hi_u32_b32 v236, -1, v236
    s_and_b32 s50, s101, 1
    s_lshr_b32 s51, s101, 1
    s_lshr_b32 s53, s2, 3
    s_mov_b32 s71, 0
    s_cmp_eq_u32 s53, 0
    s_cselect_b32 s71, 8270, s71
    s_cmp_eq_u32 s53, 1
    s_cselect_b32 s71, 10334, s71
    s_cmp_eq_u32 s53, 2
    s_cselect_b32 s71, 12398, s71
    s_cmp_eq_u32 s53, 3
    s_cselect_b32 s71, 14462, s71
    s_cmp_eq_u32 s53, 4
    s_cselect_b32 s71, 8397, s71
    s_cmp_eq_u32 s53, 5
    s_cselect_b32 s71, 10461, s71
    s_cmp_eq_u32 s53, 6
    s_cselect_b32 s71, 12525, s71
    s_cmp_eq_u32 s53, 7
    s_cselect_b32 s71, 14589, s71
    s_cmp_eq_u32 s53, 8
    s_cselect_b32 s71, 8524, s71
    s_cmp_eq_u32 s53, 9
    s_cselect_b32 s71, 10588, s71
    s_cmp_eq_u32 s53, 10
    s_cselect_b32 s71, 12652, s71
    s_cmp_eq_u32 s53, 11
    s_cselect_b32 s71, 14716, s71
    s_cmp_eq_u32 s53, 12
    s_cselect_b32 s71, 8651, s71
    s_cmp_eq_u32 s53, 13
    s_cselect_b32 s71, 10715, s71
    s_cmp_eq_u32 s53, 14
    s_cselect_b32 s71, 12779, s71
    s_cmp_eq_u32 s53, 15
    s_cselect_b32 s71, 14843, s71
    s_cmp_eq_u32 s53, 16
    s_cselect_b32 s71, 8778, s71
    s_cmp_eq_u32 s53, 17
    s_cselect_b32 s71, 10842, s71
    s_cmp_eq_u32 s53, 18
    s_cselect_b32 s71, 12906, s71
    s_cmp_eq_u32 s53, 19
    s_cselect_b32 s71, 14970, s71
    s_cmp_eq_u32 s53, 20
    s_cselect_b32 s71, 8905, s71
    s_cmp_eq_u32 s53, 21
    s_cselect_b32 s71, 10969, s71
    s_cmp_eq_u32 s53, 22
    s_cselect_b32 s71, 13033, s71
    s_cmp_eq_u32 s53, 23
    s_cselect_b32 s71, 15097, s71
    s_cmp_eq_u32 s53, 24
    s_cselect_b32 s71, 9032, s71
    s_cmp_eq_u32 s53, 25
    s_cselect_b32 s71, 11096, s71
    s_cmp_eq_u32 s53, 26
    s_cselect_b32 s71, 13160, s71
    s_cmp_eq_u32 s53, 27
    s_cselect_b32 s71, 15224, s71
    s_cmp_eq_u32 s53, 28
    s_cselect_b32 s71, 9167, s71
    s_cmp_eq_u32 s53, 29
    s_cselect_b32 s71, 11231, s71
    s_cmp_eq_u32 s53, 30
    s_cselect_b32 s71, 13295, s71
    s_cmp_eq_u32 s53, 31
    s_cselect_b32 s71, 15359, s71
    s_and_b32 s53, s2, 7
    s_lshl_b32 s53, s53, 2
    s_bfe_u32 s6, s71, 0x20004
    s_add_u32 s52, s53, s6
    s_mov_b32 s72, s100
    s_lshl_b32 s59, s53, 19
    s_lshl_b32 s58, s101, 13
    s_and_b32 s54, s71, 15
    s_waitcnt lgkmcnt(0)
    s_mov_b32 s12, s4
    s_mov_b32 s13, s5
    s_mov_b32 s14, 16777216
    s_mov_b32 s15, 0x20000
    s_add_u32 s16, s4, 16777216
    s_addc_u32 s17, s5, 0
    s_mov_b32 s18, 16777216
    s_mov_b32 s19, 0x20000
    s_add_u32 s20, s4, 33554432
    s_addc_u32 s21, s5, 0
    s_mov_b32 s22, 16777216
    s_mov_b32 s23, 0x20000
    s_add_u32 s24, s4, 50331648
    s_addc_u32 s25, s5, 0
    s_mov_b32 s26, 31457280
    s_mov_b32 s27, 0x20000
    s_mov_b32 s32, s4
    s_mov_b32 s33, s5
    s_mov_b32 s34, 50331648
    s_mov_b32 s35, 0x20000
    s_add_u32 s36, s4, 84934656
    s_addc_u32 s37, s5, 0
    s_mov_b32 s38, 16384
    s_mov_b32 s39, 0x20000
    s_mov_b32 s76, s71
    s_and_b32 s3, s71, 0x30
    s_lshl_b32 s77, s3, 15
    s_and_b32 s3, s71, 63
    s_lshl_b32 s78, s3, 15
    s_mov_b32 s79, s77
    s_mov_b32 s22, s18
    s_add_u32 s77, s77, 32768
    s_lshr_b32 s67, s76, 7
    s_and_b32 s68, s67, 0x30
    s_lshl_b32 s68, s68, 15
    s_cmp_gt_u32 s77, s78
    s_cselect_b32 s76, s67, s76
    s_cselect_b32 s77, s68, s77
    s_and_b32 s67, s76, 63
    s_lshl_b32 s78, s67, 15
    s_cmp_eq_u32 s76, 0
    s_cselect_b32 s18, 0, s18
    s_mov_b32 s79, s77
    s_mov_b32 s22, s18
    s_add_u32 s77, s77, 32768
    s_lshr_b32 s67, s76, 7
    s_and_b32 s68, s67, 0x30
    s_lshl_b32 s68, s68, 15
    s_cmp_gt_u32 s77, s78
    s_cselect_b32 s76, s67, s76
    s_cselect_b32 s77, s68, s77
    s_and_b32 s67, s76, 63
    s_lshl_b32 s78, s67, 15
    s_cmp_eq_u32 s76, 0
    s_cselect_b32 s18, 0, s18
    s_lshr_b32 s71, s71, 7
    s_lshl_b32 s3, s2, 2
    s_add_u32 s3, s3, s101
    s_mul_i32 s6, s3, 7168
    s_add_u32 s60, s10, s6
    s_addc_u32 s61, s11, 0
    s_mov_b32 s62, 7168
    s_lshl_b32 s6, s3, 13
    s_add_u32 s63, s8, s6
    s_addc_u32 s64, s9, 0
    s_mov_b32 s65, 8192
    s_mov_b32 s31, 0x20000
    s_and_b32 s66, s101, 1
    v_lshlrev_b32 v248, 7, v236
    v_lshlrev_b32 v240, 4, v236
    s_lshl_b32 s3, s51, 14
    v_add_u32 v237, s3, v240
    v_add_u32 v238, 0x10000, v237
    s_add_u32 s3, s59, s58
    v_add_u32 v239, s3, v240
    v_add_u32 v250, 0x1000, v239
    v_xor_b32 v241, 16, v236
    v_lshlrev_b32 v241, 2, v241
    v_xor_b32 v242, 32, v236
    v_lshlrev_b32 v242, 2, v242
    v_mov_b32 v243, 0xf149f2ca
    v_lshrrev_b32 v213, 4, v236
    v_lshlrev_b32 v213, 2, v213
    v_and_b32 v214, 15, v236
    v_add_u32 v215, 0, v213
    v_cmp_gt_u32 s[40:41], v215, v214
    v_add_u32 v215, 1, v213
    v_cmp_gt_u32 s[42:43], v215, v214
    v_add_u32 v215, 2, v213
    v_cmp_gt_u32 s[44:45], v215, v214
    v_add_u32 v215, 3, v213
    v_cmp_gt_u32 s[46:47], v215, v214
    v_mov_b32 v212, 0x3f803f80
    v_accvgpr_write_b32 a208, v212
    v_accvgpr_write_b32 a209, v212
    v_accvgpr_write_b32 a210, v212
    v_accvgpr_write_b32 a211, v212
    v_accvgpr_write_b32 a244, 0
    v_accvgpr_write_b32 a245, 0
    v_accvgpr_write_b32 a246, 0
    v_accvgpr_write_b32 a247, 0
    s_cmp_eq_u32 s50, s51
    s_cselect_b64 s[40:41], s[40:41], 0
    s_cselect_b64 s[42:43], s[42:43], 0
    s_cselect_b64 s[44:45], s[44:45], 0
    s_cselect_b64 s[46:47], s[46:47], 0
    s_cselect_b64 s[48:49], -1, 0
    s_mov_b32 s57, 0
    s_mov_b32 s56, 0
    v_accvgpr_write_b32 a0, 0
    v_accvgpr_write_b32 a1, 0
    v_accvgpr_write_b32 a2, 0
    v_accvgpr_write_b32 a3, 0
    v_accvgpr_write_b32 a4, 0
    v_accvgpr_write_b32 a5, 0
    v_accvgpr_write_b32 a6, 0
    v_accvgpr_write_b32 a7, 0
    v_accvgpr_write_b32 a8, 0
    v_accvgpr_write_b32 a9, 0
    v_accvgpr_write_b32 a10, 0
    v_accvgpr_write_b32 a11, 0
    v_accvgpr_write_b32 a12, 0
    v_accvgpr_write_b32 a13, 0
    v_accvgpr_write_b32 a14, 0
    v_accvgpr_write_b32 a15, 0
    v_accvgpr_write_b32 a16, 0
    v_accvgpr_write_b32 a17, 0
    v_accvgpr_write_b32 a18, 0
    v_accvgpr_write_b32 a19, 0
    v_accvgpr_write_b32 a20, 0
    v_accvgpr_write_b32 a21, 0
    v_accvgpr_write_b32 a22, 0
    v_accvgpr_write_b32 a23, 0
    v_accvgpr_write_b32 a24, 0
    v_accvgpr_write_b32 a25, 0
    v_accvgpr_write_b32 a26, 0
    v_accvgpr_write_b32 a27, 0
    v_accvgpr_write_b32 a28, 0
    v_accvgpr_write_b32 a29, 0
    v_accvgpr_write_b32 a30, 0
    v_accvgpr_write_b32 a31, 0
    v_accvgpr_write_b32 a32, 0
    v_accvgpr_write_b32 a33, 0
    v_accvgpr_write_b32 a34, 0
    v_accvgpr_write_b32 a35, 0
    v_accvgpr_write_b32 a36, 0
    v_accvgpr_write_b32 a37, 0
    v_accvgpr_write_b32 a38, 0
    v_accvgpr_write_b32 a39, 0
    v_accvgpr_write_b32 a40, 0
    v_accvgpr_write_b32 a41, 0
    v_accvgpr_write_b32 a42, 0
    v_accvgpr_write_b32 a43, 0
    v_accvgpr_write_b32 a44, 0
    v_accvgpr_write_b32 a45, 0
    v_accvgpr_write_b32 a46, 0
    v_accvgpr_write_b32 a47, 0
    v_accvgpr_write_b32 a48, 0
    v_accvgpr_write_b32 a49, 0
    v_accvgpr_write_b32 a50, 0
    v_accvgpr_write_b32 a51, 0
    v_accvgpr_write_b32 a52, 0
    v_accvgpr_write_b32 a53, 0
    v_accvgpr_write_b32 a54, 0
    v_accvgpr_write_b32 a55, 0
    v_accvgpr_write_b32 a56, 0
    v_accvgpr_write_b32 a57, 0
    v_accvgpr_write_b32 a58, 0
    v_accvgpr_write_b32 a59, 0
    v_accvgpr_write_b32 a60, 0
    v_accvgpr_write_b32 a61, 0
    v_accvgpr_write_b32 a62, 0
    v_accvgpr_write_b32 a63, 0
    v_accvgpr_write_b32 a64, 0
    v_accvgpr_write_b32 a65, 0
    v_accvgpr_write_b32 a66, 0
    v_accvgpr_write_b32 a67, 0
    v_accvgpr_write_b32 a68, 0
    v_accvgpr_write_b32 a69, 0
    v_accvgpr_write_b32 a70, 0
    v_accvgpr_write_b32 a71, 0
    v_accvgpr_write_b32 a72, 0
    v_accvgpr_write_b32 a73, 0
    v_accvgpr_write_b32 a74, 0
    v_accvgpr_write_b32 a75, 0
    v_accvgpr_write_b32 a76, 0
    v_accvgpr_write_b32 a77, 0
    v_accvgpr_write_b32 a78, 0
    v_accvgpr_write_b32 a79, 0
    v_accvgpr_write_b32 a80, 0
    v_accvgpr_write_b32 a81, 0
    v_accvgpr_write_b32 a82, 0
    v_accvgpr_write_b32 a83, 0
    v_accvgpr_write_b32 a84, 0
    v_accvgpr_write_b32 a85, 0
    v_accvgpr_write_b32 a86, 0
    v_accvgpr_write_b32 a87, 0
    v_accvgpr_write_b32 a88, 0
    v_accvgpr_write_b32 a89, 0
    v_accvgpr_write_b32 a90, 0
    v_accvgpr_write_b32 a91, 0
    v_accvgpr_write_b32 a92, 0
    v_accvgpr_write_b32 a93, 0
    v_accvgpr_write_b32 a94, 0
    v_accvgpr_write_b32 a95, 0
    v_accvgpr_write_b32 a96, 0
    v_accvgpr_write_b32 a97, 0
    v_accvgpr_write_b32 a98, 0
    v_accvgpr_write_b32 a99, 0
    v_accvgpr_write_b32 a100, 0
    v_accvgpr_write_b32 a101, 0
    v_accvgpr_write_b32 a102, 0
    v_accvgpr_write_b32 a103, 0
    v_accvgpr_write_b32 a104, 0
    v_accvgpr_write_b32 a105, 0
    v_accvgpr_write_b32 a106, 0
    v_accvgpr_write_b32 a107, 0
    v_accvgpr_write_b32 a108, 0
    v_accvgpr_write_b32 a109, 0
    v_accvgpr_write_b32 a110, 0
    v_accvgpr_write_b32 a111, 0
    v_accvgpr_write_b32 a112, 0
    v_accvgpr_write_b32 a113, 0
    v_accvgpr_write_b32 a114, 0
    v_accvgpr_write_b32 a115, 0
    v_accvgpr_write_b32 a116, 0
    v_accvgpr_write_b32 a117, 0
    v_accvgpr_write_b32 a118, 0
    v_accvgpr_write_b32 a119, 0
    v_accvgpr_write_b32 a120, 0
    v_accvgpr_write_b32 a121, 0
    v_accvgpr_write_b32 a122, 0
    v_accvgpr_write_b32 a123, 0
    v_accvgpr_write_b32 a124, 0
    v_accvgpr_write_b32 a125, 0
    v_accvgpr_write_b32 a126, 0
    v_accvgpr_write_b32 a127, 0
    v_accvgpr_write_b32 a128, 0
    v_accvgpr_write_b32 a129, 0
    v_accvgpr_write_b32 a130, 0
    v_accvgpr_write_b32 a131, 0
    v_accvgpr_write_b32 a132, 0
    v_accvgpr_write_b32 a133, 0
    v_accvgpr_write_b32 a134, 0
    v_accvgpr_write_b32 a135, 0
    v_accvgpr_write_b32 a136, 0
    v_accvgpr_write_b32 a137, 0
    v_accvgpr_write_b32 a138, 0
    v_accvgpr_write_b32 a139, 0
    v_accvgpr_write_b32 a140, 0
    v_accvgpr_write_b32 a141, 0
    v_accvgpr_write_b32 a142, 0
    v_accvgpr_write_b32 a143, 0
    v_mov_b32 v228, v243
    v_mov_b32 v229, v243
    v_mov_b32 v230, v243
    v_mov_b32 v231, v243
    s_cmp_eq_u32 s71, 0
    s_cselect_b32 s55, 99, s54
    s_waitcnt vmcnt(16)
    s_barrier
    s_mov_b32 s28, s60
    s_mov_b32 s29, s61
    s_mov_b32 s30, s62
    buffer_load_dword v249, v248, s[28:31], 0 offen
    s_mov_b32 s60, s63
    s_mov_b32 s61, s64
    s_mov_b32 s62, s65
    s_mov_b32 s65, 0
    s_add_u32 s28, s24, 35651584
    s_addc_u32 s29, s25, 0
    s_mov_b32 s30, 8388608
    s_bfe_u32 s3, s2, 0x10002
    s_lshl_b32 s3, s3, 3
    s_bfe_u32 s4, s2, 0x30003
    s_add_u32 s3, s3, s4
    s_bfe_u32 s5, s2, 0x10001
    s_lshl_b32 s5, s5, 2
    s_lshr_b32 s6, s2, 6
    s_add_u32 s5, s5, s6
    s_lshl_b32 s3, s3, 3
    s_add_u32 s3, s3, s5
    s_lshl_b32 s3, s3, 2
    s_add_u32 s3, s3, s101
    s_lshl_b32 s3, s3, 14
    s_and_b32 s4, s2, 1
    s_xor_b32 s4, s4, 1
    s_lshl_b32 s4, s4, 13
    s_add_u32 s3, s3, s4
    v_add_u32 v245, s3, v240
    v_mov_b32 v132, -1
    v_mov_b32 v133, -1
    v_mov_b32 v134, -1
    v_mov_b32 v135, -1
    s_mov_b32 s6, 4096
    buffer_store_dwordx4 v[132:135], v245, s[28:31], 0 offen offset:0 sc1
    buffer_store_dwordx4 v[132:135], v245, s[28:31], 0 offen offset:1024 sc1
    buffer_store_dwordx4 v[132:135], v245, s[28:31], 0 offen offset:2048 sc1
    buffer_store_dwordx4 v[132:135], v245, s[28:31], 0 offen offset:3072 sc1
    buffer_store_dwordx4 v[132:135], v245, s[28:31], s6 offen offset:0 sc1
    buffer_store_dwordx4 v[132:135], v245, s[28:31], s6 offen offset:1024 sc1
    buffer_store_dwordx4 v[132:135], v245, s[28:31], s6 offen offset:2048 sc1
    buffer_store_dwordx4 v[132:135], v245, s[28:31], s6 offen offset:3072 sc1
    ds_read_b128 v[164:167], v237 offset:0
    ds_read_b128 v[168:171], v237 offset:1024
    ds_read_b128 v[172:175], v237 offset:2048
    ds_read_b128 v[176:179], v237 offset:3072
    ds_read_b128 v[180:183], v237 offset:4096
    ds_read_b128 v[184:187], v237 offset:5120
    ds_read_b128 v[188:191], v237 offset:6144
    ds_read_b128 v[192:195], v237 offset:7168
    s_waitcnt lgkmcnt(4)
    v_mfma_f32_16x16x32_bf16 v[4:7], v[164:167], a[144:147], 0
    v_mfma_f32_16x16x32_bf16 v[4:7], v[168:171], a[148:151], v[4:7]
    v_mfma_f32_16x16x32_bf16 v[4:7], v[172:175], a[152:155], v[4:7]
    v_mfma_f32_16x16x32_bf16 v[4:7], v[176:179], a[156:159], v[4:7]
    v_mfma_f32_16x16x32_bf16 v[8:11], v[164:167], a[160:163], 0
    v_mfma_f32_16x16x32_bf16 v[8:11], v[168:171], a[164:167], v[8:11]
    v_mfma_f32_16x16x32_bf16 v[8:11], v[172:175], a[168:171], v[8:11]
    v_mfma_f32_16x16x32_bf16 v[8:11], v[176:179], a[172:175], v[8:11]
    v_mfma_f32_16x16x32_bf16 v[12:15], v[164:167], a[176:179], 0
    v_mfma_f32_16x16x32_bf16 v[12:15], v[168:171], a[180:183], v[12:15]
    v_mfma_f32_16x16x32_bf16 v[12:15], v[172:175], a[184:187], v[12:15]
    v_mfma_f32_16x16x32_bf16 v[12:15], v[176:179], a[188:191], v[12:15]
    v_mfma_f32_16x16x32_bf16 v[16:19], v[164:167], a[192:195], 0
    v_mfma_f32_16x16x32_bf16 v[16:19], v[168:171], a[196:199], v[16:19]
    v_mfma_f32_16x16x32_bf16 v[16:19], v[172:175], a[200:203], v[16:19]
    v_mfma_f32_16x16x32_bf16 v[16:19], v[176:179], a[204:207], v[16:19]
    s_waitcnt lgkmcnt(0)
    v_mfma_f32_16x16x32_bf16 v[20:23], v[180:183], a[144:147], 0
    ds_read_b128 v[164:167], v237 offset:8192
    v_mfma_f32_16x16x32_bf16 v[20:23], v[184:187], a[148:151], v[20:23]
    v_mfma_f32_16x16x32_bf16 v[20:23], v[188:191], a[152:155], v[20:23]
    ds_read_b128 v[168:171], v237 offset:9216
    v_mfma_f32_16x16x32_bf16 v[20:23], v[192:195], a[156:159], v[20:23]
    v_mfma_f32_16x16x32_bf16 v[24:27], v[180:183], a[160:163], 0
    ds_read_b128 v[172:175], v237 offset:10240
    v_mfma_f32_16x16x32_bf16 v[24:27], v[184:187], a[164:167], v[24:27]
    v_mfma_f32_16x16x32_bf16 v[24:27], v[188:191], a[168:171], v[24:27]
    ds_read_b128 v[176:179], v237 offset:11264
    v_mfma_f32_16x16x32_bf16 v[24:27], v[192:195], a[172:175], v[24:27]
    v_mfma_f32_16x16x32_bf16 v[28:31], v[180:183], a[176:179], 0
    v_mfma_f32_16x16x32_bf16 v[28:31], v[184:187], a[180:183], v[28:31]
    v_mfma_f32_16x16x32_bf16 v[28:31], v[188:191], a[184:187], v[28:31]
    v_mfma_f32_16x16x32_bf16 v[28:31], v[192:195], a[188:191], v[28:31]
    v_mfma_f32_16x16x32_bf16 v[32:35], v[180:183], a[192:195], 0
    v_mfma_f32_16x16x32_bf16 v[32:35], v[184:187], a[196:199], v[32:35]
    v_mfma_f32_16x16x32_bf16 v[32:35], v[188:191], a[200:203], v[32:35]
    v_mfma_f32_16x16x32_bf16 v[32:35], v[192:195], a[204:207], v[32:35]
    s_waitcnt lgkmcnt(0)
    v_mfma_f32_16x16x32_bf16 v[36:39], v[164:167], a[144:147], 0
    ds_read_b128 v[180:183], v237 offset:12288
    v_mfma_f32_16x16x32_bf16 v[36:39], v[168:171], a[148:151], v[36:39]
    v_mfma_f32_16x16x32_bf16 v[36:39], v[172:175], a[152:155], v[36:39]
    ds_read_b128 v[184:187], v237 offset:13312
    v_mfma_f32_16x16x32_bf16 v[36:39], v[176:179], a[156:159], v[36:39]
    v_mfma_f32_16x16x32_bf16 v[40:43], v[164:167], a[160:163], 0
    ds_read_b128 v[188:191], v237 offset:14336
    v_mfma_f32_16x16x32_bf16 v[40:43], v[168:171], a[164:167], v[40:43]
    v_mfma_f32_16x16x32_bf16 v[40:43], v[172:175], a[168:171], v[40:43]
    ds_read_b128 v[192:195], v237 offset:15360
    v_mfma_f32_16x16x32_bf16 v[40:43], v[176:179], a[172:175], v[40:43]
    v_mfma_f32_16x16x32_bf16 v[44:47], v[164:167], a[176:179], 0
    v_mfma_f32_16x16x32_bf16 v[44:47], v[168:171], a[180:183], v[44:47]
    v_mfma_f32_16x16x32_bf16 v[44:47], v[172:175], a[184:187], v[44:47]
    v_mfma_f32_16x16x32_bf16 v[44:47], v[176:179], a[188:191], v[44:47]
    v_mfma_f32_16x16x32_bf16 v[48:51], v[164:167], a[192:195], 0
    v_mfma_f32_16x16x32_bf16 v[48:51], v[168:171], a[196:199], v[48:51]
    v_mfma_f32_16x16x32_bf16 v[48:51], v[172:175], a[200:203], v[48:51]
    v_mfma_f32_16x16x32_bf16 v[48:51], v[176:179], a[204:207], v[48:51]
    s_waitcnt lgkmcnt(0)
    v_mfma_f32_16x16x32_bf16 v[52:55], v[180:183], a[144:147], 0
    v_mfma_f32_16x16x32_bf16 v[52:55], v[184:187], a[148:151], v[52:55]
    v_mfma_f32_16x16x32_bf16 v[52:55], v[188:191], a[152:155], v[52:55]
    v_mfma_f32_16x16x32_bf16 v[52:55], v[192:195], a[156:159], v[52:55]
    v_mfma_f32_16x16x32_bf16 v[56:59], v[180:183], a[160:163], 0
    v_mfma_f32_16x16x32_bf16 v[56:59], v[184:187], a[164:167], v[56:59]
    v_mfma_f32_16x16x32_bf16 v[56:59], v[188:191], a[168:171], v[56:59]
    v_mfma_f32_16x16x32_bf16 v[56:59], v[192:195], a[172:175], v[56:59]
    v_mfma_f32_16x16x32_bf16 v[60:63], v[180:183], a[176:179], 0
    v_mfma_f32_16x16x32_bf16 v[60:63], v[184:187], a[180:183], v[60:63]
    v_mfma_f32_16x16x32_bf16 v[60:63], v[188:191], a[184:187], v[60:63]
    v_mfma_f32_16x16x32_bf16 v[60:63], v[192:195], a[188:191], v[60:63]
    v_mfma_f32_16x16x32_bf16 v[64:67], v[180:183], a[192:195], 0
    v_mfma_f32_16x16x32_bf16 v[64:67], v[184:187], a[196:199], v[64:67]
    v_mfma_f32_16x16x32_bf16 v[64:67], v[188:191], a[200:203], v[64:67]
    v_mfma_f32_16x16x32_bf16 v[64:67], v[192:195], a[204:207], v[64:67]
    s_waitcnt vmcnt(0) lgkmcnt(0)
    s_barrier
    ds_read_b128 v[164:167], v237 offset:32768
    ds_read_b128 v[168:171], v237 offset:33792
    ds_read_b128 v[172:175], v237 offset:34816
    ds_read_b128 v[176:179], v237 offset:35840
    ds_read_b128 v[180:183], v237 offset:36864
    ds_read_b128 v[184:187], v237 offset:37888
    ds_read_b128 v[188:191], v237 offset:38912
    ds_read_b128 v[192:195], v237 offset:39936
    s_nop 7
    s_waitcnt lgkmcnt(0)
    v_max3_f32 v232, v4, v5, v6
    v_max3_f32 v232, v232, v7, v20
    v_max3_f32 v232, v232, v21, v22
    v_max3_f32 v232, v232, v23, v36
    v_max3_f32 v232, v232, v37, v38
    v_max3_f32 v232, v232, v39, v52
    v_max3_f32 v232, v232, v53, v54
    v_max_f32 v232, v232, v55
    v_max3_f32 v233, v8, v9, v10
    v_max3_f32 v233, v233, v11, v24
    v_max3_f32 v233, v233, v25, v26
    v_max3_f32 v233, v233, v27, v40
    v_max3_f32 v233, v233, v41, v42
    v_max3_f32 v233, v233, v43, v56
    v_max3_f32 v233, v233, v57, v58
    v_max_f32 v233, v233, v59
    v_max3_f32 v234, v12, v13, v14
    v_max3_f32 v234, v234, v15, v28
    v_max3_f32 v234, v234, v29, v30
    v_max3_f32 v234, v234, v31, v44
    v_max3_f32 v234, v234, v45, v46
    v_max3_f32 v234, v234, v47, v60
    v_max3_f32 v234, v234, v61, v62
    v_max_f32 v234, v234, v63
    v_max3_f32 v235, v16, v17, v18
    v_max3_f32 v235, v235, v19, v32
    v_max3_f32 v235, v235, v33, v34
    v_max3_f32 v235, v235, v35, v48
    v_max3_f32 v235, v235, v49, v50
    v_max3_f32 v235, v235, v51, v64
    v_max3_f32 v235, v235, v65, v66
    v_max_f32 v235, v235, v67
    ds_bpermute_b32 v212, v241, v232
    ds_bpermute_b32 v213, v241, v233
    ds_bpermute_b32 v214, v241, v234
    ds_bpermute_b32 v215, v241, v235
    s_waitcnt lgkmcnt(0)
    v_max_f32 v232, v232, v212
    v_max_f32 v233, v233, v213
    v_max_f32 v234, v234, v214
    v_max_f32 v235, v235, v215
    ds_bpermute_b32 v212, v242, v232
    ds_bpermute_b32 v213, v242, v233
    ds_bpermute_b32 v214, v242, v234
    ds_bpermute_b32 v215, v242, v235
    s_waitcnt lgkmcnt(0)
    v_max_f32 v232, v232, v212
    v_max_f32 v233, v233, v213
    v_max_f32 v234, v234, v214
    v_max_f32 v235, v235, v215
    v_add_f32 v232, 0x40e00000, v232
    v_mov_b32 v228, v232
    v_sub_f32 v196, 0, v228
    v_sub_f32 v197, 0, v228
    v_sub_f32 v198, 0, v228
    v_sub_f32 v199, 0, v228
    v_add_f32 v233, 0x40e00000, v233
    v_mov_b32 v229, v233
    v_sub_f32 v200, 0, v229
    v_sub_f32 v201, 0, v229
    v_sub_f32 v202, 0, v229
    v_sub_f32 v203, 0, v229
    v_add_f32 v234, 0x40e00000, v234
    v_mov_b32 v230, v234
    v_sub_f32 v204, 0, v230
    v_sub_f32 v205, 0, v230
    v_sub_f32 v206, 0, v230
    v_sub_f32 v207, 0, v230
    v_add_f32 v235, 0x40e00000, v235
    v_mov_b32 v231, v235
    v_sub_f32 v208, 0, v231
    v_sub_f32 v209, 0, v231
    v_sub_f32 v210, 0, v231
    v_sub_f32 v211, 0, v231
    v_pk_add_f32 v[4:5], v[4:5], v[232:233] op_sel:[0,0] op_sel_hi:[1,0] neg_lo:[0,1] neg_hi:[0,1]
    v_pk_add_f32 v[6:7], v[6:7], v[232:233] op_sel:[0,0] op_sel_hi:[1,0] neg_lo:[0,1] neg_hi:[0,1]
    v_pk_add_f32 v[8:9], v[8:9], v[232:233] op_sel:[0,1] op_sel_hi:[1,1] neg_lo:[0,1] neg_hi:[0,1]
    v_pk_add_f32 v[10:11], v[10:11], v[232:233] op_sel:[0,1] op_sel_hi:[1,1] neg_lo:[0,1] neg_hi:[0,1]
    v_pk_add_f32 v[12:13], v[12:13], v[234:235] op_sel:[0,0] op_sel_hi:[1,0] neg_lo:[0,1] neg_hi:[0,1]
    v_pk_add_f32 v[14:15], v[14:15], v[234:235] op_sel:[0,0] op_sel_hi:[1,0] neg_lo:[0,1] neg_hi:[0,1]
    v_pk_add_f32 v[16:17], v[16:17], v[234:235] op_sel:[0,1] op_sel_hi:[1,1] neg_lo:[0,1] neg_hi:[0,1]
    v_pk_add_f32 v[18:19], v[18:19], v[234:235] op_sel:[0,1] op_sel_hi:[1,1] neg_lo:[0,1] neg_hi:[0,1]
    v_pk_add_f32 v[20:21], v[20:21], v[232:233] op_sel:[0,0] op_sel_hi:[1,0] neg_lo:[0,1] neg_hi:[0,1]
    v_pk_add_f32 v[22:23], v[22:23], v[232:233] op_sel:[0,0] op_sel_hi:[1,0] neg_lo:[0,1] neg_hi:[0,1]
    v_pk_add_f32 v[24:25], v[24:25], v[232:233] op_sel:[0,1] op_sel_hi:[1,1] neg_lo:[0,1] neg_hi:[0,1]
    v_pk_add_f32 v[26:27], v[26:27], v[232:233] op_sel:[0,1] op_sel_hi:[1,1] neg_lo:[0,1] neg_hi:[0,1]
    v_pk_add_f32 v[28:29], v[28:29], v[234:235] op_sel:[0,0] op_sel_hi:[1,0] neg_lo:[0,1] neg_hi:[0,1]
    v_pk_add_f32 v[30:31], v[30:31], v[234:235] op_sel:[0,0] op_sel_hi:[1,0] neg_lo:[0,1] neg_hi:[0,1]
    v_pk_add_f32 v[32:33], v[32:33], v[234:235] op_sel:[0,1] op_sel_hi:[1,1] neg_lo:[0,1] neg_hi:[0,1]
    v_pk_add_f32 v[34:35], v[34:35], v[234:235] op_sel:[0,1] op_sel_hi:[1,1] neg_lo:[0,1] neg_hi:[0,1]
    v_pk_add_f32 v[36:37], v[36:37], v[232:233] op_sel:[0,0] op_sel_hi:[1,0] neg_lo:[0,1] neg_hi:[0,1]
    v_pk_add_f32 v[38:39], v[38:39], v[232:233] op_sel:[0,0] op_sel_hi:[1,0] neg_lo:[0,1] neg_hi:[0,1]
    v_pk_add_f32 v[40:41], v[40:41], v[232:233] op_sel:[0,1] op_sel_hi:[1,1] neg_lo:[0,1] neg_hi:[0,1]
    v_pk_add_f32 v[42:43], v[42:43], v[232:233] op_sel:[0,1] op_sel_hi:[1,1] neg_lo:[0,1] neg_hi:[0,1]
    v_pk_add_f32 v[44:45], v[44:45], v[234:235] op_sel:[0,0] op_sel_hi:[1,0] neg_lo:[0,1] neg_hi:[0,1]
    v_pk_add_f32 v[46:47], v[46:47], v[234:235] op_sel:[0,0] op_sel_hi:[1,0] neg_lo:[0,1] neg_hi:[0,1]
    v_pk_add_f32 v[48:49], v[48:49], v[234:235] op_sel:[0,1] op_sel_hi:[1,1] neg_lo:[0,1] neg_hi:[0,1]
    v_pk_add_f32 v[50:51], v[50:51], v[234:235] op_sel:[0,1] op_sel_hi:[1,1] neg_lo:[0,1] neg_hi:[0,1]
    v_pk_add_f32 v[52:53], v[52:53], v[232:233] op_sel:[0,0] op_sel_hi:[1,0] neg_lo:[0,1] neg_hi:[0,1]
    v_pk_add_f32 v[54:55], v[54:55], v[232:233] op_sel:[0,0] op_sel_hi:[1,0] neg_lo:[0,1] neg_hi:[0,1]
    v_pk_add_f32 v[56:57], v[56:57], v[232:233] op_sel:[0,1] op_sel_hi:[1,1] neg_lo:[0,1] neg_hi:[0,1]
    v_pk_add_f32 v[58:59], v[58:59], v[232:233] op_sel:[0,1] op_sel_hi:[1,1] neg_lo:[0,1] neg_hi:[0,1]
    v_pk_add_f32 v[60:61], v[60:61], v[234:235] op_sel:[0,0] op_sel_hi:[1,0] neg_lo:[0,1] neg_hi:[0,1]
    v_pk_add_f32 v[62:63], v[62:63], v[234:235] op_sel:[0,0] op_sel_hi:[1,0] neg_lo:[0,1] neg_hi:[0,1]
    v_pk_add_f32 v[64:65], v[64:65], v[234:235] op_sel:[0,1] op_sel_hi:[1,1] neg_lo:[0,1] neg_hi:[0,1]
    v_pk_add_f32 v[66:67], v[66:67], v[234:235] op_sel:[0,1] op_sel_hi:[1,1] neg_lo:[0,1] neg_hi:[0,1]
    s_nop 1
    v_exp_f32 v212, v8
    v_exp_f32 v213, v9
    v_exp_f32 v214, v10
    v_exp_f32 v215, v11
    v_exp_f32 v216, v12
    v_exp_f32 v217, v13
    v_cvt_pk_bf16_f32 v136, v212, v213
    v_exp_f32 v218, v14
    v_cvt_pk_bf16_f32 v137, v214, v215
    v_exp_f32 v219, v15
    v_exp_f32 v212, v16
    v_exp_f32 v213, v17
    v_cvt_pk_bf16_f32 v140, v216, v217
    v_exp_f32 v214, v18
    v_cvt_pk_bf16_f32 v141, v218, v219
    v_exp_f32 v215, v19
    v_or_b32 v244, v136, v137
    v_exp_f32 v216, v28
    v_exp_f32 v217, v29
    v_cvt_pk_bf16_f32 v144, v212, v213
    v_exp_f32 v218, v30
    v_cvt_pk_bf16_f32 v145, v214, v215
    v_exp_f32 v219, v31
    v_or3_b32 v244, v244, v140, v141
    v_exp_f32 v212, v32
    v_exp_f32 v213, v33
    v_cvt_pk_bf16_f32 v142, v216, v217
    v_exp_f32 v214, v34
    v_cvt_pk_bf16_f32 v143, v218, v219
    v_exp_f32 v215, v35
    v_or3_b32 v244, v244, v144, v145
    v_cvt_pk_bf16_f32 v146, v212, v213
    v_cvt_pk_bf16_f32 v147, v214, v215
    v_or3_b32 v244, v244, v142, v143
    v_or3_b32 v244, v244, v146, v147
a2_it0:
    s_cmp_eq_u32 s56, s54
    s_cbranch_scc1 a2_l0
    s_waitcnt lgkmcnt(4)
    v_mfma_f32_16x16x32_bf16 v[68:71], v[164:167], a[144:147], v[196:199]
    s_add_u32 m0, s58, 0
    v_exp_f32 v212, v4
    v_mfma_f32_16x16x32_bf16 v[68:71], v[168:171], a[148:151], v[68:71]
    buffer_load_dwordx4 v239, s[16:19], s77 offen offset:0 lds
    v_mfma_f32_16x16x32_bf16 v[68:71], v[172:175], a[152:155], v[68:71]
    v_exp_f32 v213, v5
    v_mfma_f32_16x16x32_bf16 v[68:71], v[176:179], a[156:159], v[68:71]
    v_exp_f32 v214, v6
    v_mfma_f32_16x16x32_bf16 v[72:75], v[164:167], a[160:163], v[200:203]
    v_exp_f32 v215, v7
    v_mfma_f32_16x16x32_bf16 v[72:75], v[168:171], a[164:167], v[72:75]
    buffer_load_dwordx4 v239, s[16:19], s77 offen offset:1024 lds
    v_cvt_pk_bf16_f32 v132, v212, v213
    v_mfma_f32_16x16x32_bf16 v[72:75], v[172:175], a[168:171], v[72:75]
    v_exp_f32 v216, v20
    v_mfma_f32_16x16x32_bf16 v[72:75], v[176:179], a[172:175], v[72:75]
    v_exp_f32 v217, v21
    v_mfma_f32_16x16x32_bf16 v[76:79], v[164:167], a[176:179], v[204:207]
    v_exp_f32 v218, v22
    v_mfma_f32_16x16x32_bf16 v[76:79], v[168:171], a[180:183], v[76:79]
    buffer_load_dwordx4 v239, s[16:19], s77 offen offset:2048 lds
    v_cvt_pk_bf16_f32 v133, v214, v215
    v_mfma_f32_16x16x32_bf16 v[76:79], v[172:175], a[184:187], v[76:79]
    v_exp_f32 v219, v23
    v_mfma_f32_16x16x32_bf16 v[76:79], v[176:179], a[188:191], v[76:79]
    v_exp_f32 v220, v24
    v_mfma_f32_16x16x32_bf16 v[80:83], v[164:167], a[192:195], v[208:211]
    v_exp_f32 v221, v25
    v_mfma_f32_16x16x32_bf16 v[80:83], v[168:171], a[196:199], v[80:83]
    buffer_load_dwordx4 v239, s[16:19], s77 offen offset:3072 lds
    v_or3_b32 v244, v244, v132, v133
    v_mfma_f32_16x16x32_bf16 v[80:83], v[172:175], a[200:203], v[80:83]
    s_add_u32 m0, s58, 4096
    v_exp_f32 v222, v26
    v_mfma_f32_16x16x32_bf16 v[80:83], v[176:179], a[204:207], v[80:83]
    s_waitcnt lgkmcnt(0)
    v_exp_f32 v223, v27
    v_mfma_f32_16x16x32_bf16 v[84:87], v[180:183], a[144:147], v[196:199]
    ds_read_b128 v[164:167], v237 offset:40960
    v_cvt_pk_bf16_f32 v134, v216, v217
    v_mfma_f32_16x16x32_bf16 v[84:87], v[184:187], a[148:151], v[84:87]
    buffer_load_dwordx4 v250, s[16:19], s77 offen offset:0 lds
    v_cvt_pk_bf16_f32 v135, v218, v219
    v_mfma_f32_16x16x32_bf16 v[84:87], v[188:191], a[152:155], v[84:87]
    ds_read_b128 v[168:171], v237 offset:41984
    v_or3_b32 v244, v244, v134, v135
    v_mfma_f32_16x16x32_bf16 v[84:87], v[192:195], a[156:159], v[84:87]
    v_exp_f32 v224, v36
    v_mfma_f32_16x16x32_bf16 v[88:91], v[180:183], a[160:163], v[200:203]
    ds_read_b128 v[172:175], v237 offset:43008
    v_cvt_pk_bf16_f32 v138, v220, v221
    v_mfma_f32_16x16x32_bf16 v[88:91], v[184:187], a[164:167], v[88:91]
    buffer_load_dwordx4 v250, s[16:19], s77 offen offset:1024 lds
    v_cvt_pk_bf16_f32 v139, v222, v223
    v_mfma_f32_16x16x32_bf16 v[88:91], v[188:191], a[168:171], v[88:91]
    ds_read_b128 v[176:179], v237 offset:44032
    v_or3_b32 v244, v244, v138, v139
    v_mfma_f32_16x16x32_bf16 v[88:91], v[192:195], a[172:175], v[88:91]
    v_exp_f32 v225, v37
    v_mfma_f32_16x16x32_bf16 v[92:95], v[180:183], a[176:179], v[204:207]
    v_exp_f32 v226, v38
    v_mfma_f32_16x16x32_bf16 v[92:95], v[184:187], a[180:183], v[92:95]
    buffer_load_dwordx4 v250, s[16:19], s77 offen offset:2048 lds
    v_cvt_pk_bf16_f32 v148, v224, v225
    v_mfma_f32_16x16x32_bf16 v[92:95], v[188:191], a[184:187], v[92:95]
    v_exp_f32 v227, v39
    v_mfma_f32_16x16x32_bf16 v[92:95], v[192:195], a[188:191], v[92:95]
    v_exp_f32 v212, v40
    v_mfma_f32_16x16x32_bf16 v[96:99], v[180:183], a[192:195], v[208:211]
    v_exp_f32 v213, v41
    v_mfma_f32_16x16x32_bf16 v[96:99], v[184:187], a[196:199], v[96:99]
    buffer_load_dwordx4 v250, s[16:19], s77 offen offset:3072 lds
    v_cvt_pk_bf16_f32 v149, v226, v227
    v_mfma_f32_16x16x32_bf16 v[96:99], v[188:191], a[200:203], v[96:99]
    s_add_u32 m0, s58, 98304
    v_exp_f32 v214, v42
    v_mfma_f32_16x16x32_bf16 v[96:99], v[192:195], a[204:207], v[96:99]
    s_waitcnt lgkmcnt(0)
    v_exp_f32 v215, v43
    v_mfma_f32_16x16x32_bf16 v[100:103], v[164:167], a[144:147], v[196:199]
    ds_read_b128 v[180:183], v237 offset:45056
    v_or3_b32 v244, v244, v148, v149
    v_mfma_f32_16x16x32_bf16 v[100:103], v[168:171], a[148:151], v[100:103]
    buffer_load_dwordx4 v239, s[20:23], s79 offen offset:0 lds
    v_cvt_pk_bf16_f32 v152, v212, v213
    v_mfma_f32_16x16x32_bf16 v[100:103], v[172:175], a[152:155], v[100:103]
    ds_read_b128 v[184:187], v237 offset:46080
    v_cvt_pk_bf16_f32 v153, v214, v215
    v_mfma_f32_16x16x32_bf16 v[100:103], v[176:179], a[156:159], v[100:103]
    v_exp_f32 v216, v44
    v_mfma_f32_16x16x32_bf16 v[104:107], v[164:167], a[160:163], v[200:203]
    ds_read_b128 v[188:191], v237 offset:47104
    v_or3_b32 v244, v244, v152, v153
    v_mfma_f32_16x16x32_bf16 v[104:107], v[168:171], a[164:167], v[104:107]
    buffer_load_dwordx4 v239, s[20:23], s79 offen offset:1024 lds
    v_mfma_f32_16x16x32_bf16 v[104:107], v[172:175], a[168:171], v[104:107]
    ds_read_b128 v[192:195], v237 offset:48128
    v_mfma_f32_16x16x32_bf16 v[104:107], v[176:179], a[172:175], v[104:107]
    v_exp_f32 v217, v45
    v_mfma_f32_16x16x32_bf16 v[108:111], v[164:167], a[176:179], v[204:207]
    v_exp_f32 v218, v46
    v_mfma_f32_16x16x32_bf16 v[108:111], v[168:171], a[180:183], v[108:111]
    buffer_load_dwordx4 v239, s[20:23], s79 offen offset:2048 lds
    v_cvt_pk_bf16_f32 v156, v216, v217
    v_mfma_f32_16x16x32_bf16 v[108:111], v[172:175], a[184:187], v[108:111]
    v_exp_f32 v219, v47
    v_mfma_f32_16x16x32_bf16 v[108:111], v[176:179], a[188:191], v[108:111]
    v_exp_f32 v220, v48
    v_mfma_f32_16x16x32_bf16 v[112:115], v[164:167], a[192:195], v[208:211]
    v_exp_f32 v221, v49
    v_mfma_f32_16x16x32_bf16 v[112:115], v[168:171], a[196:199], v[112:115]
    buffer_load_dwordx4 v239, s[20:23], s79 offen offset:3072 lds
    v_cvt_pk_bf16_f32 v157, v218, v219
    v_mfma_f32_16x16x32_bf16 v[112:115], v[172:175], a[200:203], v[112:115]
    s_add_u32 m0, s58, 102400
    v_exp_f32 v222, v50
    v_mfma_f32_16x16x32_bf16 v[112:115], v[176:179], a[204:207], v[112:115]
    s_waitcnt lgkmcnt(0)
    v_exp_f32 v223, v51
    v_mfma_f32_16x16x32_bf16 v[116:119], v[180:183], a[144:147], v[196:199]
    ds_read_b128 a[212:215], v238 offset:0
    v_or3_b32 v244, v244, v156, v157
    v_mfma_f32_16x16x32_bf16 v[116:119], v[184:187], a[148:151], v[116:119]
    buffer_load_dwordx4 v250, s[20:23], s79 offen offset:0 lds
    v_cvt_pk_bf16_f32 v160, v220, v221
    v_mfma_f32_16x16x32_bf16 v[116:119], v[188:191], a[152:155], v[116:119]
    ds_read_b128 a[216:219], v238 offset:1024
    v_cvt_pk_bf16_f32 v161, v222, v223
    v_mfma_f32_16x16x32_bf16 v[116:119], v[192:195], a[156:159], v[116:119]
    v_or3_b32 v244, v244, v160, v161
    v_and_b32 v244, 0x40004000, v244
    v_mfma_f32_16x16x32_bf16 v[120:123], v[180:183], a[160:163], v[200:203]
    ds_read_b128 a[220:223], v238 offset:2048
    v_cmp_ne_u32 vcc, 0, v244
    v_mfma_f32_16x16x32_bf16 v[120:123], v[184:187], a[164:167], v[120:123]
    buffer_load_dwordx4 v250, s[20:23], s79 offen offset:1024 lds
    v_mfma_f32_16x16x32_bf16 v[120:123], v[188:191], a[168:171], v[120:123]
    ds_read_b128 a[224:227], v238 offset:3072
    v_mfma_f32_16x16x32_bf16 v[120:123], v[192:195], a[172:175], v[120:123]
    v_mfma_f32_16x16x32_bf16 v[124:127], v[180:183], a[176:179], v[204:207]
    v_mfma_f32_16x16x32_bf16 v[124:127], v[184:187], a[180:183], v[124:127]
    buffer_load_dwordx4 v250, s[20:23], s79 offen offset:2048 lds
    v_mfma_f32_16x16x32_bf16 v[124:127], v[188:191], a[184:187], v[124:127]
    v_mfma_f32_16x16x32_bf16 v[124:127], v[192:195], a[188:191], v[124:127]
    v_mfma_f32_16x16x32_bf16 v[128:131], v[180:183], a[192:195], v[208:211]
    v_mfma_f32_16x16x32_bf16 v[128:131], v[184:187], a[196:199], v[128:131]
    buffer_load_dwordx4 v250, s[20:23], s79 offen offset:3072 lds
    v_mfma_f32_16x16x32_bf16 v[128:131], v[188:191], a[200:203], v[128:131]
    v_mfma_f32_16x16x32_bf16 v[128:131], v[192:195], a[204:207], v[128:131]
    s_cbranch_vccnz a2_rn0a
a2_rn0a_ret:
    v_mfma_f32_16x16x32_bf16 a[128:131], a[208:211], v[132:135], a[128:131]
    s_mov_b32 s79, s77
    v_exp_f32 v212, v52
    v_mfma_f32_16x16x32_bf16 a[132:135], a[208:211], v[136:139], a[132:135]
    s_mov_b32 s22, s18
    v_exp_f32 v213, v53
    v_mfma_f32_16x16x32_bf16 a[136:139], a[208:211], v[140:143], a[136:139]
    v_exp_f32 v214, v54
    v_mfma_f32_16x16x32_bf16 a[140:143], a[208:211], v[144:147], a[140:143]
    s_waitcnt lgkmcnt(2)
    v_exp_f32 v215, v55
    v_mfma_f32_16x16x32_bf16 a[0:3], a[212:215], v[132:135], a[0:3]
    ds_read_b128 a[228:231], v238 offset:4096
    v_cvt_pk_bf16_f32 v150, v212, v213
    v_mfma_f32_16x16x32_bf16 a[4:7], a[212:215], v[136:139], a[4:7]
    s_add_u32 s77, s77, 32768
    v_exp_f32 v216, v56
    v_mfma_f32_16x16x32_bf16 a[8:11], a[212:215], v[140:143], a[8:11]
    v_exp_f32 v217, v57
    v_mfma_f32_16x16x32_bf16 a[12:15], a[212:215], v[144:147], a[12:15]
    v_exp_f32 v218, v58
    v_mfma_f32_16x16x32_bf16 a[16:19], a[216:219], v[132:135], a[16:19]
    s_lshr_b32 s67, s76, 7
    ds_read_b128 a[232:235], v238 offset:5120
    v_cvt_pk_bf16_f32 v151, v214, v215
    v_mfma_f32_16x16x32_bf16 a[20:23], a[216:219], v[136:139], a[20:23]
    v_exp_f32 v219, v59
    v_mfma_f32_16x16x32_bf16 a[24:27], a[216:219], v[140:143], a[24:27]
    v_exp_f32 v220, v60
    v_mfma_f32_16x16x32_bf16 a[28:31], a[216:219], v[144:147], a[28:31]
    s_waitcnt lgkmcnt(2)
    v_exp_f32 v221, v61
    v_mfma_f32_16x16x32_bf16 a[32:35], a[220:223], v[132:135], a[32:35]
    s_and_b32 s68, s67, 0x30
    ds_read_b128 a[236:239], v238 offset:6144
    v_or_b32 v244, v150, v151
    v_mfma_f32_16x16x32_bf16 a[36:39], a[220:223], v[136:139], a[36:39]
    v_exp_f32 v222, v62
    v_mfma_f32_16x16x32_bf16 a[40:43], a[220:223], v[140:143], a[40:43]
    v_exp_f32 v223, v63
    v_mfma_f32_16x16x32_bf16 a[44:47], a[220:223], v[144:147], a[44:47]
    s_lshl_b32 s68, s68, 15
    v_exp_f32 v224, v64
    v_mfma_f32_16x16x32_bf16 a[48:51], a[224:227], v[132:135], a[48:51]
    ds_read_b128 a[240:243], v238 offset:7168
    v_cvt_pk_bf16_f32 v154, v216, v217
    v_mfma_f32_16x16x32_bf16 a[52:55], a[224:227], v[136:139], a[52:55]
    v_exp_f32 v225, v65
    v_mfma_f32_16x16x32_bf16 a[56:59], a[224:227], v[140:143], a[56:59]
    v_exp_f32 v226, v66
    v_mfma_f32_16x16x32_bf16 a[60:63], a[224:227], v[144:147], a[60:63]
    s_waitcnt lgkmcnt(2)
    v_exp_f32 v227, v67
    v_mfma_f32_16x16x32_bf16 a[64:67], a[228:231], v[132:135], a[64:67]
    ds_read_b128 a[212:215], v238 offset:8192
    v_cvt_pk_bf16_f32 v155, v218, v219
    v_mfma_f32_16x16x32_bf16 a[68:71], a[228:231], v[136:139], a[68:71]
    s_cmp_gt_u32 s77, s78
    s_cselect_b32 s76, s67, s76
    s_cselect_b32 s77, s68, s77
    v_mfma_f32_16x16x32_bf16 a[72:75], a[228:231], v[140:143], a[72:75]
    v_or3_b32 v244, v244, v154, v155
    v_cvt_pk_bf16_f32 v158, v220, v221
    v_mfma_f32_16x16x32_bf16 a[76:79], a[228:231], v[144:147], a[76:79]
    s_and_b32 s67, s76, 63
    v_cvt_pk_bf16_f32 v159, v222, v223
    v_or3_b32 v244, v244, v158, v159
    v_mfma_f32_16x16x32_bf16 a[80:83], a[232:235], v[132:135], a[80:83]
    ds_read_b128 a[216:219], v238 offset:9216
    v_cvt_pk_bf16_f32 v162, v224, v225
    v_mfma_f32_16x16x32_bf16 a[84:87], a[232:235], v[136:139], a[84:87]
    v_cvt_pk_bf16_f32 v163, v226, v227
    v_or3_b32 v244, v244, v162, v163
    v_mfma_f32_16x16x32_bf16 a[88:91], a[232:235], v[140:143], a[88:91]
    s_lshl_b32 s78, s67, 15
    v_and_b32 v244, 0x40004000, v244
    v_cmp_ne_u32 vcc, 0, v244
    v_mfma_f32_16x16x32_bf16 a[92:95], a[232:235], v[144:147], a[92:95]
    s_waitcnt lgkmcnt(2)
    v_mfma_f32_16x16x32_bf16 a[96:99], a[236:239], v[132:135], a[96:99]
    ds_read_b128 a[220:223], v238 offset:10240
    v_mfma_f32_16x16x32_bf16 a[100:103], a[236:239], v[136:139], a[100:103]
    v_mfma_f32_16x16x32_bf16 a[104:107], a[236:239], v[140:143], a[104:107]
    s_cmp_eq_u32 s76, 0
    s_cselect_b32 s18, 0, s18
    v_mfma_f32_16x16x32_bf16 a[108:111], a[236:239], v[144:147], a[108:111]
    v_mfma_f32_16x16x32_bf16 a[112:115], a[240:243], v[132:135], a[112:115]
    ds_read_b128 a[224:227], v238 offset:11264
    v_mfma_f32_16x16x32_bf16 a[116:119], a[240:243], v[136:139], a[116:119]
    v_mfma_f32_16x16x32_bf16 a[120:123], a[240:243], v[140:143], a[120:123]
    v_mfma_f32_16x16x32_bf16 a[124:127], a[240:243], v[144:147], a[124:127]
    s_cbranch_vccnz a2_rn0b
a2_rn0b_ret:
    s_add_u32 s56, s56, 1
    s_cmp_lg_u32 s56, s55
    s_cbranch_scc1 a2_rn0_nq
    s_and_b32 s3, s71, 63
    s_lshl_b32 s3, s3, 15
    s_lshl_b32 s6, s50, 14
    s_add_u32 s3, s3, s6
    s_add_u32 s3, s3, s59
    v_add_u32 v245, s3, v240
    s_mov_b32 s3, 0
    buffer_load_dwordx4 a[144:147], v245, s[12:15], s3 offen offset:0
    buffer_load_dwordx4 a[148:151], v245, s[12:15], s3 offen offset:1024
    buffer_load_dwordx4 a[152:155], v245, s[12:15], s3 offen offset:2048
    buffer_load_dwordx4 a[156:159], v245, s[12:15], s3 offen offset:3072
    s_mov_b32 s3, 4096
    buffer_load_dwordx4 a[160:163], v245, s[12:15], s3 offen offset:0
    buffer_load_dwordx4 a[164:167], v245, s[12:15], s3 offen offset:1024
    buffer_load_dwordx4 a[168:171], v245, s[12:15], s3 offen offset:2048
    buffer_load_dwordx4 a[172:175], v245, s[12:15], s3 offen offset:3072
    s_mov_b32 s3, 8192
    buffer_load_dwordx4 a[176:179], v245, s[12:15], s3 offen offset:0
    buffer_load_dwordx4 a[180:183], v245, s[12:15], s3 offen offset:1024
    buffer_load_dwordx4 a[184:187], v245, s[12:15], s3 offen offset:2048
    buffer_load_dwordx4 a[188:191], v245, s[12:15], s3 offen offset:3072
    s_mov_b32 s3, 12288
    buffer_load_dwordx4 a[192:195], v245, s[12:15], s3 offen offset:0
    buffer_load_dwordx4 a[196:199], v245, s[12:15], s3 offen offset:1024
    buffer_load_dwordx4 a[200:203], v245, s[12:15], s3 offen offset:2048
    buffer_load_dwordx4 a[204:207], v245, s[12:15], s3 offen offset:3072
a2_rn0_nq:
    v_mfma_f32_16x16x32_bf16 a[128:131], a[208:211], v[148:151], a[128:131]
    v_exp_f32 v212, v72
    v_mfma_f32_16x16x32_bf16 a[132:135], a[208:211], v[152:155], a[132:135]
    v_exp_f32 v213, v73
    v_mfma_f32_16x16x32_bf16 a[136:139], a[208:211], v[156:159], a[136:139]
    v_exp_f32 v214, v74
    v_mfma_f32_16x16x32_bf16 a[140:143], a[208:211], v[160:163], a[140:143]
    s_waitcnt lgkmcnt(2)
    v_exp_f32 v215, v75
    v_mfma_f32_16x16x32_bf16 a[0:3], a[212:215], v[148:151], a[0:3]
    ds_read_b128 a[228:231], v238 offset:12288
    v_cvt_pk_bf16_f32 v136, v212, v213
    v_mfma_f32_16x16x32_bf16 a[4:7], a[212:215], v[152:155], a[4:7]
    v_exp_f32 v216, v76
    v_mfma_f32_16x16x32_bf16 a[8:11], a[212:215], v[156:159], a[8:11]
    v_exp_f32 v217, v77
    v_mfma_f32_16x16x32_bf16 a[12:15], a[212:215], v[160:163], a[12:15]
    v_exp_f32 v218, v78
    v_mfma_f32_16x16x32_bf16 a[16:19], a[216:219], v[148:151], a[16:19]
    ds_read_b128 a[232:235], v238 offset:13312
    v_cvt_pk_bf16_f32 v137, v214, v215
    v_mfma_f32_16x16x32_bf16 a[20:23], a[216:219], v[152:155], a[20:23]
    v_exp_f32 v219, v79
    v_mfma_f32_16x16x32_bf16 a[24:27], a[216:219], v[156:159], a[24:27]
    v_exp_f32 v220, v80
    v_mfma_f32_16x16x32_bf16 a[28:31], a[216:219], v[160:163], a[28:31]
    s_waitcnt lgkmcnt(2)
    v_exp_f32 v221, v81
    v_mfma_f32_16x16x32_bf16 a[32:35], a[220:223], v[148:151], a[32:35]
    ds_read_b128 a[236:239], v238 offset:14336
    v_or_b32 v244, v136, v137
    v_mfma_f32_16x16x32_bf16 a[36:39], a[220:223], v[152:155], a[36:39]
    v_exp_f32 v222, v82
    v_mfma_f32_16x16x32_bf16 a[40:43], a[220:223], v[156:159], a[40:43]
    v_exp_f32 v223, v83
    v_mfma_f32_16x16x32_bf16 a[44:47], a[220:223], v[160:163], a[44:47]
    v_exp_f32 v224, v92
    v_mfma_f32_16x16x32_bf16 a[48:51], a[224:227], v[148:151], a[48:51]
    ds_read_b128 a[240:243], v238 offset:15360
    v_cvt_pk_bf16_f32 v140, v216, v217
    v_mfma_f32_16x16x32_bf16 a[52:55], a[224:227], v[152:155], a[52:55]
    v_exp_f32 v225, v93
    v_mfma_f32_16x16x32_bf16 a[56:59], a[224:227], v[156:159], a[56:59]
    v_exp_f32 v226, v94
    v_mfma_f32_16x16x32_bf16 a[60:63], a[224:227], v[160:163], a[60:63]
    s_waitcnt lgkmcnt(2)
    v_exp_f32 v227, v95
    v_mfma_f32_16x16x32_bf16 a[64:67], a[228:231], v[148:151], a[64:67]
    v_exp_f32 v212, v96
    v_mfma_f32_16x16x32_bf16 a[68:71], a[228:231], v[152:155], a[68:71]
    v_exp_f32 v213, v97
    v_mfma_f32_16x16x32_bf16 a[72:75], a[228:231], v[156:159], a[72:75]
    v_exp_f32 v214, v98
    v_mfma_f32_16x16x32_bf16 a[76:79], a[228:231], v[160:163], a[76:79]
    v_exp_f32 v215, v99
    v_mfma_f32_16x16x32_bf16 a[80:83], a[232:235], v[148:151], a[80:83]
    v_cvt_pk_bf16_f32 v141, v218, v219
    v_or3_b32 v244, v244, v140, v141
    v_mfma_f32_16x16x32_bf16 a[84:87], a[232:235], v[152:155], a[84:87]
    v_cvt_pk_bf16_f32 v144, v220, v221
    v_cvt_pk_bf16_f32 v145, v222, v223
    v_mfma_f32_16x16x32_bf16 a[88:91], a[232:235], v[156:159], a[88:91]
    v_or3_b32 v244, v244, v144, v145
    v_cvt_pk_bf16_f32 v142, v224, v225
    v_mfma_f32_16x16x32_bf16 a[92:95], a[232:235], v[160:163], a[92:95]
    v_cvt_pk_bf16_f32 v143, v226, v227
    v_or3_b32 v244, v244, v142, v143
    s_waitcnt vmcnt(0) lgkmcnt(0)
    s_barrier
    v_mfma_f32_16x16x32_bf16 a[96:99], a[236:239], v[148:151], a[96:99]
    ds_read_b128 v[164:167], v237 offset:0
    v_cvt_pk_bf16_f32 v146, v212, v213
    v_mfma_f32_16x16x32_bf16 a[100:103], a[236:239], v[152:155], a[100:103]
    ds_read_b128 v[168:171], v237 offset:1024
    v_cvt_pk_bf16_f32 v147, v214, v215
    v_mfma_f32_16x16x32_bf16 a[104:107], a[236:239], v[156:159], a[104:107]
    ds_read_b128 v[172:175], v237 offset:2048
    v_or3_b32 v244, v244, v146, v147
    v_mfma_f32_16x16x32_bf16 a[108:111], a[236:239], v[160:163], a[108:111]
    ds_read_b128 v[176:179], v237 offset:3072
    v_mfma_f32_16x16x32_bf16 a[112:115], a[240:243], v[148:151], a[112:115]
    ds_read_b128 v[180:183], v237 offset:4096
    v_mfma_f32_16x16x32_bf16 a[116:119], a[240:243], v[152:155], a[116:119]
    ds_read_b128 v[184:187], v237 offset:5120
    v_mfma_f32_16x16x32_bf16 a[120:123], a[240:243], v[156:159], a[120:123]
    ds_read_b128 v[188:191], v237 offset:6144
    v_mfma_f32_16x16x32_bf16 a[124:127], a[240:243], v[160:163], a[124:127]
    ds_read_b128 v[192:195], v237 offset:7168
    s_cmp_lt_i32 s72, 0
    s_cbranch_scc1 a2_rn0_ns
    s_mov_b64 exec, 1
    buffer_store_dword v243, v236, s[36:39], s72 offen sc1
    s_mov_b64 exec, -1
    s_brev_b32 s72, 1
a2_rn0_ns:
a2_it1:
    s_cmp_eq_u32 s56, s54
    s_cbranch_scc1 a2_l1
    s_waitcnt lgkmcnt(4)
    v_mfma_f32_16x16x32_bf16 v[4:7], v[164:167], a[144:147], v[196:199]
    s_add_u32 m0, s58, 32768
    v_exp_f32 v212, v68
    v_mfma_f32_16x16x32_bf16 v[4:7], v[168:171], a[148:151], v[4:7]
    buffer_load_dwordx4 v239, s[16:19], s77 offen offset:0 lds
    v_mfma_f32_16x16x32_bf16 v[4:7], v[172:175], a[152:155], v[4:7]
    v_exp_f32 v213, v69
    v_mfma_f32_16x16x32_bf16 v[4:7], v[176:179], a[156:159], v[4:7]
    v_exp_f32 v214, v70
    v_mfma_f32_16x16x32_bf16 v[8:11], v[164:167], a[160:163], v[200:203]
    v_exp_f32 v215, v71
    v_mfma_f32_16x16x32_bf16 v[8:11], v[168:171], a[164:167], v[8:11]
    buffer_load_dwordx4 v239, s[16:19], s77 offen offset:1024 lds
    v_cvt_pk_bf16_f32 v132, v212, v213
    v_mfma_f32_16x16x32_bf16 v[8:11], v[172:175], a[168:171], v[8:11]
    v_exp_f32 v216, v84
    v_mfma_f32_16x16x32_bf16 v[8:11], v[176:179], a[172:175], v[8:11]
    v_exp_f32 v217, v85
    v_mfma_f32_16x16x32_bf16 v[12:15], v[164:167], a[176:179], v[204:207]
    v_exp_f32 v218, v86
    v_mfma_f32_16x16x32_bf16 v[12:15], v[168:171], a[180:183], v[12:15]
    buffer_load_dwordx4 v239, s[16:19], s77 offen offset:2048 lds
    v_cvt_pk_bf16_f32 v133, v214, v215
    v_mfma_f32_16x16x32_bf16 v[12:15], v[172:175], a[184:187], v[12:15]
    v_exp_f32 v219, v87
    v_mfma_f32_16x16x32_bf16 v[12:15], v[176:179], a[188:191], v[12:15]
    v_exp_f32 v220, v88
    v_mfma_f32_16x16x32_bf16 v[16:19], v[164:167], a[192:195], v[208:211]
    v_exp_f32 v221, v89
    v_mfma_f32_16x16x32_bf16 v[16:19], v[168:171], a[196:199], v[16:19]
    buffer_load_dwordx4 v239, s[16:19], s77 offen offset:3072 lds
    v_or3_b32 v244, v244, v132, v133
    v_mfma_f32_16x16x32_bf16 v[16:19], v[172:175], a[200:203], v[16:19]
    s_add_u32 m0, s58, 36864
    v_exp_f32 v222, v90
    v_mfma_f32_16x16x32_bf16 v[16:19], v[176:179], a[204:207], v[16:19]
    s_waitcnt lgkmcnt(0)
    v_exp_f32 v223, v91
    v_mfma_f32_16x16x32_bf16 v[20:23], v[180:183], a[144:147], v[196:199]
    ds_read_b128 v[164:167], v237 offset:8192
    v_cvt_pk_bf16_f32 v134, v216, v217
    v_mfma_f32_16x16x32_bf16 v[20:23], v[184:187], a[148:151], v[20:23]
    buffer_load_dwordx4 v250, s[16:19], s77 offen offset:0 lds
    v_cvt_pk_bf16_f32 v135, v218, v219
    v_mfma_f32_16x16x32_bf16 v[20:23], v[188:191], a[152:155], v[20:23]
    ds_read_b128 v[168:171], v237 offset:9216
    v_or3_b32 v244, v244, v134, v135
    v_mfma_f32_16x16x32_bf16 v[20:23], v[192:195], a[156:159], v[20:23]
    v_exp_f32 v224, v100
    v_mfma_f32_16x16x32_bf16 v[24:27], v[180:183], a[160:163], v[200:203]
    ds_read_b128 v[172:175], v237 offset:10240
    v_cvt_pk_bf16_f32 v138, v220, v221
    v_mfma_f32_16x16x32_bf16 v[24:27], v[184:187], a[164:167], v[24:27]
    buffer_load_dwordx4 v250, s[16:19], s77 offen offset:1024 lds
    v_cvt_pk_bf16_f32 v139, v222, v223
    v_mfma_f32_16x16x32_bf16 v[24:27], v[188:191], a[168:171], v[24:27]
    ds_read_b128 v[176:179], v237 offset:11264
    v_or3_b32 v244, v244, v138, v139
    v_mfma_f32_16x16x32_bf16 v[24:27], v[192:195], a[172:175], v[24:27]
    v_exp_f32 v225, v101
    v_mfma_f32_16x16x32_bf16 v[28:31], v[180:183], a[176:179], v[204:207]
    v_exp_f32 v226, v102
    v_mfma_f32_16x16x32_bf16 v[28:31], v[184:187], a[180:183], v[28:31]
    buffer_load_dwordx4 v250, s[16:19], s77 offen offset:2048 lds
    v_cvt_pk_bf16_f32 v148, v224, v225
    v_mfma_f32_16x16x32_bf16 v[28:31], v[188:191], a[184:187], v[28:31]
    v_exp_f32 v227, v103
    v_mfma_f32_16x16x32_bf16 v[28:31], v[192:195], a[188:191], v[28:31]
    v_exp_f32 v212, v104
    v_mfma_f32_16x16x32_bf16 v[32:35], v[180:183], a[192:195], v[208:211]
    v_exp_f32 v213, v105
    v_mfma_f32_16x16x32_bf16 v[32:35], v[184:187], a[196:199], v[32:35]
    buffer_load_dwordx4 v250, s[16:19], s77 offen offset:3072 lds
    v_cvt_pk_bf16_f32 v149, v226, v227
    v_mfma_f32_16x16x32_bf16 v[32:35], v[188:191], a[200:203], v[32:35]
    s_add_u32 m0, s58, 65536
    v_exp_f32 v214, v106
    v_mfma_f32_16x16x32_bf16 v[32:35], v[192:195], a[204:207], v[32:35]
    s_waitcnt lgkmcnt(0)
    v_exp_f32 v215, v107
    v_mfma_f32_16x16x32_bf16 v[36:39], v[164:167], a[144:147], v[196:199]
    ds_read_b128 v[180:183], v237 offset:12288
    v_or3_b32 v244, v244, v148, v149
    v_mfma_f32_16x16x32_bf16 v[36:39], v[168:171], a[148:151], v[36:39]
    buffer_load_dwordx4 v239, s[20:23], s79 offen offset:0 lds
    v_cvt_pk_bf16_f32 v152, v212, v213
    v_mfma_f32_16x16x32_bf16 v[36:39], v[172:175], a[152:155], v[36:39]
    ds_read_b128 v[184:187], v237 offset:13312
    v_cvt_pk_bf16_f32 v153, v214, v215
    v_mfma_f32_16x16x32_bf16 v[36:39], v[176:179], a[156:159], v[36:39]
    v_exp_f32 v216, v108
    v_mfma_f32_16x16x32_bf16 v[40:43], v[164:167], a[160:163], v[200:203]
    ds_read_b128 v[188:191], v237 offset:14336
    v_or3_b32 v244, v244, v152, v153
    v_mfma_f32_16x16x32_bf16 v[40:43], v[168:171], a[164:167], v[40:43]
    buffer_load_dwordx4 v239, s[20:23], s79 offen offset:1024 lds
    v_mfma_f32_16x16x32_bf16 v[40:43], v[172:175], a[168:171], v[40:43]
    ds_read_b128 v[192:195], v237 offset:15360
    v_mfma_f32_16x16x32_bf16 v[40:43], v[176:179], a[172:175], v[40:43]
    v_exp_f32 v217, v109
    v_mfma_f32_16x16x32_bf16 v[44:47], v[164:167], a[176:179], v[204:207]
    v_exp_f32 v218, v110
    v_mfma_f32_16x16x32_bf16 v[44:47], v[168:171], a[180:183], v[44:47]
    buffer_load_dwordx4 v239, s[20:23], s79 offen offset:2048 lds
    v_cvt_pk_bf16_f32 v156, v216, v217
    v_mfma_f32_16x16x32_bf16 v[44:47], v[172:175], a[184:187], v[44:47]
    v_exp_f32 v219, v111
    v_mfma_f32_16x16x32_bf16 v[44:47], v[176:179], a[188:191], v[44:47]
    v_exp_f32 v220, v112
    v_mfma_f32_16x16x32_bf16 v[48:51], v[164:167], a[192:195], v[208:211]
    v_exp_f32 v221, v113
    v_mfma_f32_16x16x32_bf16 v[48:51], v[168:171], a[196:199], v[48:51]
    buffer_load_dwordx4 v239, s[20:23], s79 offen offset:3072 lds
    v_cvt_pk_bf16_f32 v157, v218, v219
    v_mfma_f32_16x16x32_bf16 v[48:51], v[172:175], a[200:203], v[48:51]
    s_add_u32 m0, s58, 69632
    v_exp_f32 v222, v114
    v_mfma_f32_16x16x32_bf16 v[48:51], v[176:179], a[204:207], v[48:51]
    s_waitcnt lgkmcnt(0)
    v_exp_f32 v223, v115
    v_mfma_f32_16x16x32_bf16 v[52:55], v[180:183], a[144:147], v[196:199]
    ds_read_b128 a[212:215], v238 offset:32768
    v_or3_b32 v244, v244, v156, v157
    v_mfma_f32_16x16x32_bf16 v[52:55], v[184:187], a[148:151], v[52:55]
    buffer_load_dwordx4 v250, s[20:23], s79 offen offset:0 lds
    v_cvt_pk_bf16_f32 v160, v220, v221
    v_mfma_f32_16x16x32_bf16 v[52:55], v[188:191], a[152:155], v[52:55]
    ds_read_b128 a[216:219], v238 offset:33792
    v_cvt_pk_bf16_f32 v161, v222, v223
    v_mfma_f32_16x16x32_bf16 v[52:55], v[192:195], a[156:159], v[52:55]
    v_or3_b32 v244, v244, v160, v161
    v_and_b32 v244, 0x40004000, v244
    v_mfma_f32_16x16x32_bf16 v[56:59], v[180:183], a[160:163], v[200:203]
    ds_read_b128 a[220:223], v238 offset:34816
    v_cmp_ne_u32 vcc, 0, v244
    v_mfma_f32_16x16x32_bf16 v[56:59], v[184:187], a[164:167], v[56:59]
    buffer_load_dwordx4 v250, s[20:23], s79 offen offset:1024 lds
    v_mfma_f32_16x16x32_bf16 v[56:59], v[188:191], a[168:171], v[56:59]
    ds_read_b128 a[224:227], v238 offset:35840
    v_mfma_f32_16x16x32_bf16 v[56:59], v[192:195], a[172:175], v[56:59]
    v_mfma_f32_16x16x32_bf16 v[60:63], v[180:183], a[176:179], v[204:207]
    v_mfma_f32_16x16x32_bf16 v[60:63], v[184:187], a[180:183], v[60:63]
    buffer_load_dwordx4 v250, s[20:23], s79 offen offset:2048 lds
    v_mfma_f32_16x16x32_bf16 v[60:63], v[188:191], a[184:187], v[60:63]
    v_mfma_f32_16x16x32_bf16 v[60:63], v[192:195], a[188:191], v[60:63]
    v_mfma_f32_16x16x32_bf16 v[64:67], v[180:183], a[192:195], v[208:211]
    v_mfma_f32_16x16x32_bf16 v[64:67], v[184:187], a[196:199], v[64:67]
    buffer_load_dwordx4 v250, s[20:23], s79 offen offset:3072 lds
    v_mfma_f32_16x16x32_bf16 v[64:67], v[188:191], a[200:203], v[64:67]
    v_mfma_f32_16x16x32_bf16 v[64:67], v[192:195], a[204:207], v[64:67]
    s_cbranch_vccnz a2_rn1a
a2_rn1a_ret:
    v_mfma_f32_16x16x32_bf16 a[128:131], a[208:211], v[132:135], a[128:131]
    s_mov_b32 s79, s77
    v_exp_f32 v212, v116
    v_mfma_f32_16x16x32_bf16 a[132:135], a[208:211], v[136:139], a[132:135]
    s_mov_b32 s22, s18
    v_exp_f32 v213, v117
    v_mfma_f32_16x16x32_bf16 a[136:139], a[208:211], v[140:143], a[136:139]
    v_exp_f32 v214, v118
    v_mfma_f32_16x16x32_bf16 a[140:143], a[208:211], v[144:147], a[140:143]
    s_waitcnt lgkmcnt(2)
    v_exp_f32 v215, v119
    v_mfma_f32_16x16x32_bf16 a[0:3], a[212:215], v[132:135], a[0:3]
    ds_read_b128 a[228:231], v238 offset:36864
    v_cvt_pk_bf16_f32 v150, v212, v213
    v_mfma_f32_16x16x32_bf16 a[4:7], a[212:215], v[136:139], a[4:7]
    s_add_u32 s77, s77, 32768
    v_exp_f32 v216, v120
    v_mfma_f32_16x16x32_bf16 a[8:11], a[212:215], v[140:143], a[8:11]
    v_exp_f32 v217, v121
    v_mfma_f32_16x16x32_bf16 a[12:15], a[212:215], v[144:147], a[12:15]
    v_exp_f32 v218, v122
    v_mfma_f32_16x16x32_bf16 a[16:19], a[216:219], v[132:135], a[16:19]
    s_lshr_b32 s67, s76, 7
    ds_read_b128 a[232:235], v238 offset:37888
    v_cvt_pk_bf16_f32 v151, v214, v215
    v_mfma_f32_16x16x32_bf16 a[20:23], a[216:219], v[136:139], a[20:23]
    v_exp_f32 v219, v123
    v_mfma_f32_16x16x32_bf16 a[24:27], a[216:219], v[140:143], a[24:27]
    v_exp_f32 v220, v124
    v_mfma_f32_16x16x32_bf16 a[28:31], a[216:219], v[144:147], a[28:31]
    s_waitcnt lgkmcnt(2)
    v_exp_f32 v221, v125
    v_mfma_f32_16x16x32_bf16 a[32:35], a[220:223], v[132:135], a[32:35]
    s_and_b32 s68, s67, 0x30
    ds_read_b128 a[236:239], v238 offset:38912
    v_or_b32 v244, v150, v151
    v_mfma_f32_16x16x32_bf16 a[36:39], a[220:223], v[136:139], a[36:39]
    v_exp_f32 v222, v126
    v_mfma_f32_16x16x32_bf16 a[40:43], a[220:223], v[140:143], a[40:43]
    v_exp_f32 v223, v127
    v_mfma_f32_16x16x32_bf16 a[44:47], a[220:223], v[144:147], a[44:47]
    s_lshl_b32 s68, s68, 15
    v_exp_f32 v224, v128
    v_mfma_f32_16x16x32_bf16 a[48:51], a[224:227], v[132:135], a[48:51]
    ds_read_b128 a[240:243], v238 offset:39936
    v_cvt_pk_bf16_f32 v154, v216, v217
    v_mfma_f32_16x16x32_bf16 a[52:55], a[224:227], v[136:139], a[52:55]
    v_exp_f32 v225, v129
    v_mfma_f32_16x16x32_bf16 a[56:59], a[224:227], v[140:143], a[56:59]
    v_exp_f32 v226, v130
    v_mfma_f32_16x16x32_bf16 a[60:63], a[224:227], v[144:147], a[60:63]
    s_waitcnt lgkmcnt(2)
    v_exp_f32 v227, v131
    v_mfma_f32_16x16x32_bf16 a[64:67], a[228:231], v[132:135], a[64:67]
    ds_read_b128 a[212:215], v238 offset:40960
    v_cvt_pk_bf16_f32 v155, v218, v219
    v_mfma_f32_16x16x32_bf16 a[68:71], a[228:231], v[136:139], a[68:71]
    s_cmp_gt_u32 s77, s78
    s_cselect_b32 s76, s67, s76
    s_cselect_b32 s77, s68, s77
    v_mfma_f32_16x16x32_bf16 a[72:75], a[228:231], v[140:143], a[72:75]
    v_or3_b32 v244, v244, v154, v155
    v_cvt_pk_bf16_f32 v158, v220, v221
    v_mfma_f32_16x16x32_bf16 a[76:79], a[228:231], v[144:147], a[76:79]
    s_and_b32 s67, s76, 63
    v_cvt_pk_bf16_f32 v159, v222, v223
    v_or3_b32 v244, v244, v158, v159
    v_mfma_f32_16x16x32_bf16 a[80:83], a[232:235], v[132:135], a[80:83]
    ds_read_b128 a[216:219], v238 offset:41984
    v_cvt_pk_bf16_f32 v162, v224, v225
    v_mfma_f32_16x16x32_bf16 a[84:87], a[232:235], v[136:139], a[84:87]
    v_cvt_pk_bf16_f32 v163, v226, v227
    v_or3_b32 v244, v244, v162, v163
    v_mfma_f32_16x16x32_bf16 a[88:91], a[232:235], v[140:143], a[88:91]
    s_lshl_b32 s78, s67, 15
    v_and_b32 v244, 0x40004000, v244
    v_cmp_ne_u32 vcc, 0, v244
    v_mfma_f32_16x16x32_bf16 a[92:95], a[232:235], v[144:147], a[92:95]
    s_waitcnt lgkmcnt(2)
    v_mfma_f32_16x16x32_bf16 a[96:99], a[236:239], v[132:135], a[96:99]
    ds_read_b128 a[220:223], v238 offset:43008
    v_mfma_f32_16x16x32_bf16 a[100:103], a[236:239], v[136:139], a[100:103]
    v_mfma_f32_16x16x32_bf16 a[104:107], a[236:239], v[140:143], a[104:107]
    s_cmp_eq_u32 s76, 0
    s_cselect_b32 s18, 0, s18
    v_mfma_f32_16x16x32_bf16 a[108:111], a[236:239], v[144:147], a[108:111]
    v_mfma_f32_16x16x32_bf16 a[112:115], a[240:243], v[132:135], a[112:115]
    ds_read_b128 a[224:227], v238 offset:44032
    v_mfma_f32_16x16x32_bf16 a[116:119], a[240:243], v[136:139], a[116:119]
    v_mfma_f32_16x16x32_bf16 a[120:123], a[240:243], v[140:143], a[120:123]
    v_mfma_f32_16x16x32_bf16 a[124:127], a[240:243], v[144:147], a[124:127]
    s_cbranch_vccnz a2_rn1b
a2_rn1b_ret:
    s_add_u32 s56, s56, 1
    s_cmp_lg_u32 s56, s55
    s_cbranch_scc1 a2_rn1_nq
    s_and_b32 s3, s71, 63
    s_lshl_b32 s3, s3, 15
    s_lshl_b32 s6, s50, 14
    s_add_u32 s3, s3, s6
    s_add_u32 s3, s3, s59
    v_add_u32 v245, s3, v240
    s_mov_b32 s3, 0
    buffer_load_dwordx4 a[144:147], v245, s[12:15], s3 offen offset:0
    buffer_load_dwordx4 a[148:151], v245, s[12:15], s3 offen offset:1024
    buffer_load_dwordx4 a[152:155], v245, s[12:15], s3 offen offset:2048
    buffer_load_dwordx4 a[156:159], v245, s[12:15], s3 offen offset:3072
    s_mov_b32 s3, 4096
    buffer_load_dwordx4 a[160:163], v245, s[12:15], s3 offen offset:0
    buffer_load_dwordx4 a[164:167], v245, s[12:15], s3 offen offset:1024
    buffer_load_dwordx4 a[168:171], v245, s[12:15], s3 offen offset:2048
    buffer_load_dwordx4 a[172:175], v245, s[12:15], s3 offen offset:3072
    s_mov_b32 s3, 8192
    buffer_load_dwordx4 a[176:179], v245, s[12:15], s3 offen offset:0
    buffer_load_dwordx4 a[180:183], v245, s[12:15], s3 offen offset:1024
    buffer_load_dwordx4 a[184:187], v245, s[12:15], s3 offen offset:2048
    buffer_load_dwordx4 a[188:191], v245, s[12:15], s3 offen offset:3072
    s_mov_b32 s3, 12288
    buffer_load_dwordx4 a[192:195], v245, s[12:15], s3 offen offset:0
    buffer_load_dwordx4 a[196:199], v245, s[12:15], s3 offen offset:1024
    buffer_load_dwordx4 a[200:203], v245, s[12:15], s3 offen offset:2048
    buffer_load_dwordx4 a[204:207], v245, s[12:15], s3 offen offset:3072
a2_rn1_nq:
    v_mfma_f32_16x16x32_bf16 a[128:131], a[208:211], v[148:151], a[128:131]
    v_exp_f32 v212, v8
    v_mfma_f32_16x16x32_bf16 a[132:135], a[208:211], v[152:155], a[132:135]
    v_exp_f32 v213, v9
    v_mfma_f32_16x16x32_bf16 a[136:139], a[208:211], v[156:159], a[136:139]
    v_exp_f32 v214, v10
    v_mfma_f32_16x16x32_bf16 a[140:143], a[208:211], v[160:163], a[140:143]
    s_waitcnt lgkmcnt(2)
    v_exp_f32 v215, v11
    v_mfma_f32_16x16x32_bf16 a[0:3], a[212:215], v[148:151], a[0:3]
    ds_read_b128 a[228:231], v238 offset:45056
    v_cvt_pk_bf16_f32 v136, v212, v213
    v_mfma_f32_16x16x32_bf16 a[4:7], a[212:215], v[152:155], a[4:7]
    v_exp_f32 v216, v12
    v_mfma_f32_16x16x32_bf16 a[8:11], a[212:215], v[156:159], a[8:11]
    v_exp_f32 v217, v13
    v_mfma_f32_16x16x32_bf16 a[12:15], a[212:215], v[160:163], a[12:15]
    v_exp_f32 v218, v14
    v_mfma_f32_16x16x32_bf16 a[16:19], a[216:219], v[148:151], a[16:19]
    ds_read_b128 a[232:235], v238 offset:46080
    v_cvt_pk_bf16_f32 v137, v214, v215
    v_mfma_f32_16x16x32_bf16 a[20:23], a[216:219], v[152:155], a[20:23]
    v_exp_f32 v219, v15
    v_mfma_f32_16x16x32_bf16 a[24:27], a[216:219], v[156:159], a[24:27]
    v_exp_f32 v220, v16
    v_mfma_f32_16x16x32_bf16 a[28:31], a[216:219], v[160:163], a[28:31]
    s_waitcnt lgkmcnt(2)
    v_exp_f32 v221, v17
    v_mfma_f32_16x16x32_bf16 a[32:35], a[220:223], v[148:151], a[32:35]
    ds_read_b128 a[236:239], v238 offset:47104
    v_or_b32 v244, v136, v137
    v_mfma_f32_16x16x32_bf16 a[36:39], a[220:223], v[152:155], a[36:39]
    v_exp_f32 v222, v18
    v_mfma_f32_16x16x32_bf16 a[40:43], a[220:223], v[156:159], a[40:43]
    v_exp_f32 v223, v19
    v_mfma_f32_16x16x32_bf16 a[44:47], a[220:223], v[160:163], a[44:47]
    v_exp_f32 v224, v28
    v_mfma_f32_16x16x32_bf16 a[48:51], a[224:227], v[148:151], a[48:51]
    ds_read_b128 a[240:243], v238 offset:48128
    v_cvt_pk_bf16_f32 v140, v216, v217
    v_mfma_f32_16x16x32_bf16 a[52:55], a[224:227], v[152:155], a[52:55]
    v_exp_f32 v225, v29
    v_mfma_f32_16x16x32_bf16 a[56:59], a[224:227], v[156:159], a[56:59]
    v_exp_f32 v226, v30
    v_mfma_f32_16x16x32_bf16 a[60:63], a[224:227], v[160:163], a[60:63]
    s_waitcnt lgkmcnt(2)
    v_exp_f32 v227, v31
    v_mfma_f32_16x16x32_bf16 a[64:67], a[228:231], v[148:151], a[64:67]
    v_exp_f32 v212, v32
    v_mfma_f32_16x16x32_bf16 a[68:71], a[228:231], v[152:155], a[68:71]
    v_exp_f32 v213, v33
    v_mfma_f32_16x16x32_bf16 a[72:75], a[228:231], v[156:159], a[72:75]
    v_exp_f32 v214, v34
    v_mfma_f32_16x16x32_bf16 a[76:79], a[228:231], v[160:163], a[76:79]
    v_exp_f32 v215, v35
    v_mfma_f32_16x16x32_bf16 a[80:83], a[232:235], v[148:151], a[80:83]
    v_cvt_pk_bf16_f32 v141, v218, v219
    v_or3_b32 v244, v244, v140, v141
    v_mfma_f32_16x16x32_bf16 a[84:87], a[232:235], v[152:155], a[84:87]
    v_cvt_pk_bf16_f32 v144, v220, v221
    v_cvt_pk_bf16_f32 v145, v222, v223
    v_mfma_f32_16x16x32_bf16 a[88:91], a[232:235], v[156:159], a[88:91]
    v_or3_b32 v244, v244, v144, v145
    v_cvt_pk_bf16_f32 v142, v224, v225
    v_mfma_f32_16x16x32_bf16 a[92:95], a[232:235], v[160:163], a[92:95]
    v_cvt_pk_bf16_f32 v143, v226, v227
    v_or3_b32 v244, v244, v142, v143
    s_waitcnt vmcnt(0) lgkmcnt(0)
    s_barrier
    v_mfma_f32_16x16x32_bf16 a[96:99], a[236:239], v[148:151], a[96:99]
    ds_read_b128 v[164:167], v237 offset:32768
    v_cvt_pk_bf16_f32 v146, v212, v213
    v_mfma_f32_16x16x32_bf16 a[100:103], a[236:239], v[152:155], a[100:103]
    ds_read_b128 v[168:171], v237 offset:33792
    v_cvt_pk_bf16_f32 v147, v214, v215
    v_mfma_f32_16x16x32_bf16 a[104:107], a[236:239], v[156:159], a[104:107]
    ds_read_b128 v[172:175], v237 offset:34816
    v_or3_b32 v244, v244, v146, v147
    v_mfma_f32_16x16x32_bf16 a[108:111], a[236:239], v[160:163], a[108:111]
    ds_read_b128 v[176:179], v237 offset:35840
    v_mfma_f32_16x16x32_bf16 a[112:115], a[240:243], v[148:151], a[112:115]
    ds_read_b128 v[180:183], v237 offset:36864
    v_mfma_f32_16x16x32_bf16 a[116:119], a[240:243], v[152:155], a[116:119]
    ds_read_b128 v[184:187], v237 offset:37888
    v_mfma_f32_16x16x32_bf16 a[120:123], a[240:243], v[156:159], a[120:123]
    ds_read_b128 v[188:191], v237 offset:38912
    v_mfma_f32_16x16x32_bf16 a[124:127], a[240:243], v[160:163], a[124:127]
    ds_read_b128 v[192:195], v237 offset:39936
    s_cmp_lt_i32 s72, 0
    s_cbranch_scc1 a2_rn1_ns
    s_mov_b64 exec, 1
    buffer_store_dword v243, v236, s[36:39], s72 offen sc1
    s_mov_b64 exec, -1
    s_brev_b32 s72, 1
a2_rn1_ns:
    s_branch a2_it0
a2_l0:
    s_cmp_eq_u32 s71, 0
    s_cbranch_scc1 a2_lf0
    s_cmp_eq_u32 s101, 2
    s_cbranch_scc1 a2_rb0_w2
    s_waitcnt lgkmcnt(4)
    v_mfma_f32_16x16x32_bf16 v[68:71], v[164:167], a[144:147], 0
    s_add_u32 m0, s58, 0
    v_cndmask_b32 v4, v4, v243, s[40:41]
    v_cndmask_b32 v5, v5, v243, s[42:43]
    v_mfma_f32_16x16x32_bf16 v[68:71], v[168:171], a[148:151], v[68:71]
    buffer_load_dwordx4 v239, s[16:19], s77 offen offset:0 lds
    v_cndmask_b32 v6, v6, v243, s[44:45]
    v_mfma_f32_16x16x32_bf16 v[68:71], v[172:175], a[152:155], v[68:71]
    v_cndmask_b32 v7, v7, v243, s[46:47]
    v_cndmask_b32 v20, v20, v243, s[48:49]
    v_mfma_f32_16x16x32_bf16 v[68:71], v[176:179], a[156:159], v[68:71]
    v_cndmask_b32 v21, v21, v243, s[48:49]
    v_cndmask_b32 v22, v22, v243, s[48:49]
    v_mfma_f32_16x16x32_bf16 v[72:75], v[164:167], a[160:163], 0
    v_cndmask_b32 v23, v23, v243, s[48:49]
    v_cndmask_b32 v24, v24, v243, s[40:41]
    v_mfma_f32_16x16x32_bf16 v[72:75], v[168:171], a[164:167], v[72:75]
    buffer_load_dwordx4 v239, s[16:19], s77 offen offset:1024 lds
    v_cndmask_b32 v25, v25, v243, s[42:43]
    v_mfma_f32_16x16x32_bf16 v[72:75], v[172:175], a[168:171], v[72:75]
    v_cndmask_b32 v26, v26, v243, s[44:45]
    v_cndmask_b32 v27, v27, v243, s[46:47]
    v_mfma_f32_16x16x32_bf16 v[72:75], v[176:179], a[172:175], v[72:75]
    v_cndmask_b32 v36, v36, v243, s[48:49]
    v_cndmask_b32 v37, v37, v243, s[48:49]
    v_mfma_f32_16x16x32_bf16 v[76:79], v[164:167], a[176:179], 0
    v_cndmask_b32 v38, v38, v243, s[48:49]
    v_cndmask_b32 v39, v39, v243, s[48:49]
    v_mfma_f32_16x16x32_bf16 v[76:79], v[168:171], a[180:183], v[76:79]
    buffer_load_dwordx4 v239, s[16:19], s77 offen offset:2048 lds
    v_cndmask_b32 v40, v40, v243, s[48:49]
    v_mfma_f32_16x16x32_bf16 v[76:79], v[172:175], a[184:187], v[76:79]
    v_cndmask_b32 v41, v41, v243, s[48:49]
    v_cndmask_b32 v42, v42, v243, s[48:49]
    v_mfma_f32_16x16x32_bf16 v[76:79], v[176:179], a[188:191], v[76:79]
    v_cndmask_b32 v43, v43, v243, s[48:49]
    v_cndmask_b32 v44, v44, v243, s[40:41]
    v_mfma_f32_16x16x32_bf16 v[80:83], v[164:167], a[192:195], 0
    v_cndmask_b32 v45, v45, v243, s[42:43]
    v_cndmask_b32 v46, v46, v243, s[44:45]
    v_mfma_f32_16x16x32_bf16 v[80:83], v[168:171], a[196:199], v[80:83]
    buffer_load_dwordx4 v239, s[16:19], s77 offen offset:3072 lds
    v_cndmask_b32 v47, v47, v243, s[46:47]
    v_mfma_f32_16x16x32_bf16 v[80:83], v[172:175], a[200:203], v[80:83]
    s_add_u32 m0, s58, 4096
    v_cndmask_b32 v52, v52, v243, s[48:49]
    v_cndmask_b32 v53, v53, v243, s[48:49]
    v_mfma_f32_16x16x32_bf16 v[80:83], v[176:179], a[204:207], v[80:83]
    s_waitcnt lgkmcnt(0)
    v_cndmask_b32 v54, v54, v243, s[48:49]
    v_cndmask_b32 v55, v55, v243, s[48:49]
    v_mfma_f32_16x16x32_bf16 v[84:87], v[180:183], a[144:147], 0
    ds_read_b128 v[164:167], v237 offset:40960
    v_cndmask_b32 v56, v56, v243, s[48:49]
    v_mfma_f32_16x16x32_bf16 v[84:87], v[184:187], a[148:151], v[84:87]
    buffer_load_dwordx4 v250, s[16:19], s77 offen offset:0 lds
    v_cndmask_b32 v57, v57, v243, s[48:49]
    v_mfma_f32_16x16x32_bf16 v[84:87], v[188:191], a[152:155], v[84:87]
    ds_read_b128 v[168:171], v237 offset:41984
    v_cndmask_b32 v58, v58, v243, s[48:49]
    v_mfma_f32_16x16x32_bf16 v[84:87], v[192:195], a[156:159], v[84:87]
    v_cndmask_b32 v59, v59, v243, s[48:49]
    v_cndmask_b32 v60, v60, v243, s[48:49]
    v_mfma_f32_16x16x32_bf16 v[88:91], v[180:183], a[160:163], 0
    ds_read_b128 v[172:175], v237 offset:43008
    v_cndmask_b32 v61, v61, v243, s[48:49]
    v_mfma_f32_16x16x32_bf16 v[88:91], v[184:187], a[164:167], v[88:91]
    buffer_load_dwordx4 v250, s[16:19], s77 offen offset:1024 lds
    v_cndmask_b32 v62, v62, v243, s[48:49]
    v_mfma_f32_16x16x32_bf16 v[88:91], v[188:191], a[168:171], v[88:91]
    ds_read_b128 v[176:179], v237 offset:44032
    v_cndmask_b32 v63, v63, v243, s[48:49]
    v_mfma_f32_16x16x32_bf16 v[88:91], v[192:195], a[172:175], v[88:91]
    v_cndmask_b32 v64, v64, v243, s[40:41]
    v_cndmask_b32 v65, v65, v243, s[42:43]
    v_mfma_f32_16x16x32_bf16 v[92:95], v[180:183], a[176:179], 0
    v_cndmask_b32 v66, v66, v243, s[44:45]
    v_cndmask_b32 v67, v67, v243, s[46:47]
    v_mfma_f32_16x16x32_bf16 v[92:95], v[184:187], a[180:183], v[92:95]
    buffer_load_dwordx4 v250, s[16:19], s77 offen offset:2048 lds
    v_mfma_f32_16x16x32_bf16 v[92:95], v[188:191], a[184:187], v[92:95]
    v_exp_f32 v212, v4
    v_mfma_f32_16x16x32_bf16 v[92:95], v[192:195], a[188:191], v[92:95]
    v_exp_f32 v213, v5
    v_mfma_f32_16x16x32_bf16 v[96:99], v[180:183], a[192:195], 0
    v_exp_f32 v214, v6
    v_mfma_f32_16x16x32_bf16 v[96:99], v[184:187], a[196:199], v[96:99]
    buffer_load_dwordx4 v250, s[16:19], s77 offen offset:3072 lds
    v_cvt_pk_bf16_f32 v132, v212, v213
    v_mfma_f32_16x16x32_bf16 v[96:99], v[188:191], a[200:203], v[96:99]
    s_add_u32 m0, s58, 98304
    v_exp_f32 v215, v7
    v_mfma_f32_16x16x32_bf16 v[96:99], v[192:195], a[204:207], v[96:99]
    s_waitcnt lgkmcnt(0)
    v_exp_f32 v216, v20
    v_mfma_f32_16x16x32_bf16 v[100:103], v[164:167], a[144:147], 0
    ds_read_b128 v[180:183], v237 offset:45056
    v_cvt_pk_bf16_f32 v133, v214, v215
    v_mfma_f32_16x16x32_bf16 v[100:103], v[168:171], a[148:151], v[100:103]
    buffer_load_dwordx4 v239, s[20:23], s79 offen offset:0 lds
    v_or3_b32 v244, v244, v132, v133
    v_mfma_f32_16x16x32_bf16 v[100:103], v[172:175], a[152:155], v[100:103]
    ds_read_b128 v[184:187], v237 offset:46080
    v_mfma_f32_16x16x32_bf16 v[100:103], v[176:179], a[156:159], v[100:103]
    v_exp_f32 v217, v21
    v_mfma_f32_16x16x32_bf16 v[104:107], v[164:167], a[160:163], 0
    ds_read_b128 v[188:191], v237 offset:47104
    v_cvt_pk_bf16_f32 v134, v216, v217
    v_mfma_f32_16x16x32_bf16 v[104:107], v[168:171], a[164:167], v[104:107]
    buffer_load_dwordx4 v239, s[20:23], s79 offen offset:1024 lds
    v_mfma_f32_16x16x32_bf16 v[104:107], v[172:175], a[168:171], v[104:107]
    ds_read_b128 v[192:195], v237 offset:48128
    v_mfma_f32_16x16x32_bf16 v[104:107], v[176:179], a[172:175], v[104:107]
    v_exp_f32 v218, v22
    v_mfma_f32_16x16x32_bf16 v[108:111], v[164:167], a[176:179], 0
    v_exp_f32 v219, v23
    v_mfma_f32_16x16x32_bf16 v[108:111], v[168:171], a[180:183], v[108:111]
    buffer_load_dwordx4 v239, s[20:23], s79 offen offset:2048 lds
    v_cvt_pk_bf16_f32 v135, v218, v219
    v_mfma_f32_16x16x32_bf16 v[108:111], v[172:175], a[184:187], v[108:111]
    v_exp_f32 v220, v24
    v_mfma_f32_16x16x32_bf16 v[108:111], v[176:179], a[188:191], v[108:111]
    v_exp_f32 v221, v25
    v_mfma_f32_16x16x32_bf16 v[112:115], v[164:167], a[192:195], 0
    v_exp_f32 v222, v26
    v_mfma_f32_16x16x32_bf16 v[112:115], v[168:171], a[196:199], v[112:115]
    buffer_load_dwordx4 v239, s[20:23], s79 offen offset:3072 lds
    v_or3_b32 v244, v244, v134, v135
    v_mfma_f32_16x16x32_bf16 v[112:115], v[172:175], a[200:203], v[112:115]
    s_add_u32 m0, s58, 102400
    v_exp_f32 v223, v27
    v_mfma_f32_16x16x32_bf16 v[112:115], v[176:179], a[204:207], v[112:115]
    s_waitcnt lgkmcnt(0)
    v_cvt_pk_bf16_f32 v138, v220, v221
    v_cvt_pk_bf16_f32 v139, v222, v223
    v_mfma_f32_16x16x32_bf16 v[116:119], v[180:183], a[144:147], 0
    ds_read_b128 a[212:215], v238 offset:0
    v_or3_b32 v244, v244, v138, v139
    v_mfma_f32_16x16x32_bf16 v[116:119], v[184:187], a[148:151], v[116:119]
    buffer_load_dwordx4 v250, s[20:23], s79 offen offset:0 lds
    v_and_b32 v244, 0x40004000, v244
    v_mfma_f32_16x16x32_bf16 v[116:119], v[188:191], a[152:155], v[116:119]
    ds_read_b128 a[216:219], v238 offset:1024
    v_cmp_ne_u32 vcc, 0, v244
    v_mfma_f32_16x16x32_bf16 v[116:119], v[192:195], a[156:159], v[116:119]
    v_mfma_f32_16x16x32_bf16 v[120:123], v[180:183], a[160:163], 0
    ds_read_b128 a[220:223], v238 offset:2048
    v_mfma_f32_16x16x32_bf16 v[120:123], v[184:187], a[164:167], v[120:123]
    buffer_load_dwordx4 v250, s[20:23], s79 offen offset:1024 lds
    v_mfma_f32_16x16x32_bf16 v[120:123], v[188:191], a[168:171], v[120:123]
    ds_read_b128 a[224:227], v238 offset:3072
    v_mfma_f32_16x16x32_bf16 v[120:123], v[192:195], a[172:175], v[120:123]
    v_mfma_f32_16x16x32_bf16 v[124:127], v[180:183], a[176:179], 0
    v_mfma_f32_16x16x32_bf16 v[124:127], v[184:187], a[180:183], v[124:127]
    buffer_load_dwordx4 v250, s[20:23], s79 offen offset:2048 lds
    v_mfma_f32_16x16x32_bf16 v[124:127], v[188:191], a[184:187], v[124:127]
    v_mfma_f32_16x16x32_bf16 v[124:127], v[192:195], a[188:191], v[124:127]
    v_mfma_f32_16x16x32_bf16 v[128:131], v[180:183], a[192:195], 0
    v_mfma_f32_16x16x32_bf16 v[128:131], v[184:187], a[196:199], v[128:131]
    buffer_load_dwordx4 v250, s[20:23], s79 offen offset:3072 lds
    v_mfma_f32_16x16x32_bf16 v[128:131], v[188:191], a[200:203], v[128:131]
    v_mfma_f32_16x16x32_bf16 v[128:131], v[192:195], a[204:207], v[128:131]
    s_cbranch_vccnz a2_rb0a
a2_rb0a_ret:
    v_mfma_f32_16x16x32_bf16 a[128:131], a[208:211], v[132:135], a[128:131]
    s_mov_b32 s79, s77
    v_exp_f32 v212, v36
    v_mfma_f32_16x16x32_bf16 a[132:135], a[208:211], v[136:139], a[132:135]
    s_mov_b32 s22, s18
    v_exp_f32 v213, v37
    v_mfma_f32_16x16x32_bf16 a[136:139], a[208:211], v[140:143], a[136:139]
    v_exp_f32 v214, v38
    v_mfma_f32_16x16x32_bf16 a[140:143], a[208:211], v[144:147], a[140:143]
    s_waitcnt lgkmcnt(2)
    v_exp_f32 v215, v39
    v_mfma_f32_16x16x32_bf16 a[0:3], a[212:215], v[132:135], a[0:3]
    ds_read_b128 a[228:231], v238 offset:4096
    v_cvt_pk_bf16_f32 v148, v212, v213
    v_mfma_f32_16x16x32_bf16 a[4:7], a[212:215], v[136:139], a[4:7]
    s_add_u32 s77, s77, 32768
    v_exp_f32 v216, v40
    v_mfma_f32_16x16x32_bf16 a[8:11], a[212:215], v[140:143], a[8:11]
    v_exp_f32 v217, v41
    v_mfma_f32_16x16x32_bf16 a[12:15], a[212:215], v[144:147], a[12:15]
    v_exp_f32 v218, v42
    v_mfma_f32_16x16x32_bf16 a[16:19], a[216:219], v[132:135], a[16:19]
    s_lshr_b32 s67, s76, 7
    ds_read_b128 a[232:235], v238 offset:5120
    v_cvt_pk_bf16_f32 v149, v214, v215
    v_mfma_f32_16x16x32_bf16 a[20:23], a[216:219], v[136:139], a[20:23]
    v_exp_f32 v219, v43
    v_mfma_f32_16x16x32_bf16 a[24:27], a[216:219], v[140:143], a[24:27]
    v_exp_f32 v220, v44
    v_mfma_f32_16x16x32_bf16 a[28:31], a[216:219], v[144:147], a[28:31]
    s_waitcnt lgkmcnt(2)
    v_exp_f32 v221, v45
    v_mfma_f32_16x16x32_bf16 a[32:35], a[220:223], v[132:135], a[32:35]
    s_and_b32 s68, s67, 0x30
    ds_read_b128 a[236:239], v238 offset:6144
    v_or_b32 v244, v148, v149
    v_mfma_f32_16x16x32_bf16 a[36:39], a[220:223], v[136:139], a[36:39]
    v_exp_f32 v222, v46
    v_mfma_f32_16x16x32_bf16 a[40:43], a[220:223], v[140:143], a[40:43]
    v_exp_f32 v223, v47
    v_mfma_f32_16x16x32_bf16 a[44:47], a[220:223], v[144:147], a[44:47]
    s_lshl_b32 s68, s68, 15
    v_exp_f32 v224, v48
    v_mfma_f32_16x16x32_bf16 a[48:51], a[224:227], v[132:135], a[48:51]
    ds_read_b128 a[240:243], v238 offset:7168
    v_cvt_pk_bf16_f32 v152, v216, v217
    v_mfma_f32_16x16x32_bf16 a[52:55], a[224:227], v[136:139], a[52:55]
    v_exp_f32 v225, v49
    v_mfma_f32_16x16x32_bf16 a[56:59], a[224:227], v[140:143], a[56:59]
    v_exp_f32 v226, v50
    v_mfma_f32_16x16x32_bf16 a[60:63], a[224:227], v[144:147], a[60:63]
    s_waitcnt lgkmcnt(2)
    v_exp_f32 v227, v51
    v_mfma_f32_16x16x32_bf16 a[64:67], a[228:231], v[132:135], a[64:67]
    ds_read_b128 a[212:215], v238 offset:8192
    v_cvt_pk_bf16_f32 v153, v218, v219
    v_mfma_f32_16x16x32_bf16 a[68:71], a[228:231], v[136:139], a[68:71]
    s_cmp_gt_u32 s77, s78
    s_cselect_b32 s76, s67, s76
    s_cselect_b32 s77, s68, s77
    v_mfma_f32_16x16x32_bf16 a[72:75], a[228:231], v[140:143], a[72:75]
    v_exp_f32 v212, v52
    v_mfma_f32_16x16x32_bf16 a[76:79], a[228:231], v[144:147], a[76:79]
    s_and_b32 s67, s76, 63
    v_exp_f32 v213, v53
    v_mfma_f32_16x16x32_bf16 a[80:83], a[232:235], v[132:135], a[80:83]
    ds_read_b128 a[216:219], v238 offset:9216
    v_or3_b32 v244, v244, v152, v153
    v_mfma_f32_16x16x32_bf16 a[84:87], a[232:235], v[136:139], a[84:87]
    v_exp_f32 v214, v54
    v_mfma_f32_16x16x32_bf16 a[88:91], a[232:235], v[140:143], a[88:91]
    s_lshl_b32 s78, s67, 15
    v_exp_f32 v215, v55
    v_mfma_f32_16x16x32_bf16 a[92:95], a[232:235], v[144:147], a[92:95]
    s_waitcnt lgkmcnt(2)
    v_exp_f32 v216, v56
    v_mfma_f32_16x16x32_bf16 a[96:99], a[236:239], v[132:135], a[96:99]
    ds_read_b128 a[220:223], v238 offset:10240
    v_cvt_pk_bf16_f32 v156, v220, v221
    v_mfma_f32_16x16x32_bf16 a[100:103], a[236:239], v[136:139], a[100:103]
    v_exp_f32 v217, v57
    v_mfma_f32_16x16x32_bf16 a[104:107], a[236:239], v[140:143], a[104:107]
    s_cmp_eq_u32 s76, 0
    s_cselect_b32 s18, 0, s18
    v_mfma_f32_16x16x32_bf16 a[108:111], a[236:239], v[144:147], a[108:111]
    v_exp_f32 v218, v58
    v_mfma_f32_16x16x32_bf16 a[112:115], a[240:243], v[132:135], a[112:115]
    ds_read_b128 a[224:227], v238 offset:11264
    v_cvt_pk_bf16_f32 v157, v222, v223
    v_mfma_f32_16x16x32_bf16 a[116:119], a[240:243], v[136:139], a[116:119]
    v_exp_f32 v219, v59
    v_mfma_f32_16x16x32_bf16 a[120:123], a[240:243], v[140:143], a[120:123]
    v_exp_f32 v220, v60
    v_mfma_f32_16x16x32_bf16 a[124:127], a[240:243], v[144:147], a[124:127]
    v_exp_f32 v221, v61
    v_exp_f32 v222, v62
    v_exp_f32 v223, v63
    v_or3_b32 v244, v244, v156, v157
    v_cvt_pk_bf16_f32 v160, v224, v225
    s_nop 0
    v_exp_f32 v224, v64
    s_nop 0
    v_exp_f32 v225, v65
    v_cvt_pk_bf16_f32 v161, v226, v227
    s_nop 0
    v_exp_f32 v226, v66
    s_nop 0
    v_exp_f32 v227, v67
    v_or3_b32 v244, v244, v160, v161
    v_cvt_pk_bf16_f32 v150, v212, v213
    v_cvt_pk_bf16_f32 v151, v214, v215
    v_or3_b32 v244, v244, v150, v151
    v_cvt_pk_bf16_f32 v154, v216, v217
    v_cvt_pk_bf16_f32 v155, v218, v219
    v_or3_b32 v244, v244, v154, v155
    s_nop 0
    v_cvt_pk_bf16_f32 v158, v220, v221
    s_nop 0
    v_cvt_pk_bf16_f32 v159, v222, v223
    v_or3_b32 v244, v244, v158, v159
    s_nop 0
    v_cvt_pk_bf16_f32 v162, v224, v225
    s_nop 0
    v_cvt_pk_bf16_f32 v163, v226, v227
    v_or3_b32 v244, v244, v162, v163
    v_and_b32 v244, 0x40004000, v244
    v_cmp_ne_u32 vcc, 0, v244
    s_cbranch_vccnz a2_rb0b
a2_rb0b_ret:
    v_mfma_f32_16x16x32_bf16 a[128:131], a[208:211], v[148:151], a[128:131]
    v_mfma_f32_16x16x32_bf16 a[132:135], a[208:211], v[152:155], a[132:135]
    v_mfma_f32_16x16x32_bf16 a[136:139], a[208:211], v[156:159], a[136:139]
    v_mfma_f32_16x16x32_bf16 a[140:143], a[208:211], v[160:163], a[140:143]
    s_waitcnt lgkmcnt(2)
    v_mfma_f32_16x16x32_bf16 a[0:3], a[212:215], v[148:151], a[0:3]
    ds_read_b128 a[228:231], v238 offset:12288
    v_mfma_f32_16x16x32_bf16 a[4:7], a[212:215], v[152:155], a[4:7]
    v_mfma_f32_16x16x32_bf16 a[8:11], a[212:215], v[156:159], a[8:11]
    v_mfma_f32_16x16x32_bf16 a[12:15], a[212:215], v[160:163], a[12:15]
    v_mfma_f32_16x16x32_bf16 a[16:19], a[216:219], v[148:151], a[16:19]
    ds_read_b128 a[232:235], v238 offset:13312
    v_mfma_f32_16x16x32_bf16 a[20:23], a[216:219], v[152:155], a[20:23]
    v_mfma_f32_16x16x32_bf16 a[24:27], a[216:219], v[156:159], a[24:27]
    v_mfma_f32_16x16x32_bf16 a[28:31], a[216:219], v[160:163], a[28:31]
    s_waitcnt lgkmcnt(2)
    v_mfma_f32_16x16x32_bf16 a[32:35], a[220:223], v[148:151], a[32:35]
    ds_read_b128 a[236:239], v238 offset:14336
    v_mfma_f32_16x16x32_bf16 a[36:39], a[220:223], v[152:155], a[36:39]
    v_mfma_f32_16x16x32_bf16 a[40:43], a[220:223], v[156:159], a[40:43]
    v_mfma_f32_16x16x32_bf16 a[44:47], a[220:223], v[160:163], a[44:47]
    v_mfma_f32_16x16x32_bf16 a[48:51], a[224:227], v[148:151], a[48:51]
    ds_read_b128 a[240:243], v238 offset:15360
    v_mfma_f32_16x16x32_bf16 a[52:55], a[224:227], v[152:155], a[52:55]
    v_mfma_f32_16x16x32_bf16 a[56:59], a[224:227], v[156:159], a[56:59]
    v_mfma_f32_16x16x32_bf16 a[60:63], a[224:227], v[160:163], a[60:63]
    s_waitcnt lgkmcnt(2)
    v_mfma_f32_16x16x32_bf16 a[64:67], a[228:231], v[148:151], a[64:67]
    v_mfma_f32_16x16x32_bf16 a[68:71], a[228:231], v[152:155], a[68:71]
    v_mfma_f32_16x16x32_bf16 a[72:75], a[228:231], v[156:159], a[72:75]
    v_mfma_f32_16x16x32_bf16 a[76:79], a[228:231], v[160:163], a[76:79]
    v_mfma_f32_16x16x32_bf16 a[80:83], a[232:235], v[148:151], a[80:83]
    v_mfma_f32_16x16x32_bf16 a[84:87], a[232:235], v[152:155], a[84:87]
    v_mfma_f32_16x16x32_bf16 a[88:91], a[232:235], v[156:159], a[88:91]
    v_mfma_f32_16x16x32_bf16 a[92:95], a[232:235], v[160:163], a[92:95]
    s_waitcnt vmcnt(0) lgkmcnt(0)
    s_barrier
    v_mfma_f32_16x16x32_bf16 a[96:99], a[236:239], v[148:151], a[96:99]
    ds_read_b128 v[164:167], v237 offset:0
    v_mfma_f32_16x16x32_bf16 a[100:103], a[236:239], v[152:155], a[100:103]
    ds_read_b128 v[168:171], v237 offset:1024
    v_mfma_f32_16x16x32_bf16 a[104:107], a[236:239], v[156:159], a[104:107]
    ds_read_b128 v[172:175], v237 offset:2048
    v_mfma_f32_16x16x32_bf16 a[108:111], a[236:239], v[160:163], a[108:111]
    ds_read_b128 v[176:179], v237 offset:3072
    v_mfma_f32_16x16x32_bf16 a[112:115], a[240:243], v[148:151], a[112:115]
    ds_read_b128 v[180:183], v237 offset:4096
    v_mfma_f32_16x16x32_bf16 a[116:119], a[240:243], v[152:155], a[116:119]
    ds_read_b128 v[184:187], v237 offset:5120
    v_mfma_f32_16x16x32_bf16 a[120:123], a[240:243], v[156:159], a[120:123]
    ds_read_b128 v[188:191], v237 offset:6144
    v_mfma_f32_16x16x32_bf16 a[124:127], a[240:243], v[160:163], a[124:127]
    ds_read_b128 v[192:195], v237 offset:7168
    s_branch a2_merge0
a2_rb0_w2:
    s_waitcnt lgkmcnt(4)
    v_mfma_f32_16x16x32_bf16 v[68:71], v[164:167], a[144:147], 0
    s_add_u32 m0, s58, 0
    v_mfma_f32_16x16x32_bf16 v[68:71], v[168:171], a[148:151], v[68:71]
    buffer_load_dwordx4 v239, s[16:19], s77 offen offset:0 lds
    v_mfma_f32_16x16x32_bf16 v[68:71], v[172:175], a[152:155], v[68:71]
    v_mfma_f32_16x16x32_bf16 v[68:71], v[176:179], a[156:159], v[68:71]
    v_mfma_f32_16x16x32_bf16 v[72:75], v[164:167], a[160:163], 0
    v_mfma_f32_16x16x32_bf16 v[72:75], v[168:171], a[164:167], v[72:75]
    buffer_load_dwordx4 v239, s[16:19], s77 offen offset:1024 lds
    v_mfma_f32_16x16x32_bf16 v[72:75], v[172:175], a[168:171], v[72:75]
    v_mfma_f32_16x16x32_bf16 v[72:75], v[176:179], a[172:175], v[72:75]
    v_mfma_f32_16x16x32_bf16 v[76:79], v[164:167], a[176:179], 0
    v_mfma_f32_16x16x32_bf16 v[76:79], v[168:171], a[180:183], v[76:79]
    buffer_load_dwordx4 v239, s[16:19], s77 offen offset:2048 lds
    v_mfma_f32_16x16x32_bf16 v[76:79], v[172:175], a[184:187], v[76:79]
    v_mfma_f32_16x16x32_bf16 v[76:79], v[176:179], a[188:191], v[76:79]
    v_mfma_f32_16x16x32_bf16 v[80:83], v[164:167], a[192:195], 0
    v_mfma_f32_16x16x32_bf16 v[80:83], v[168:171], a[196:199], v[80:83]
    buffer_load_dwordx4 v239, s[16:19], s77 offen offset:3072 lds
    v_mfma_f32_16x16x32_bf16 v[80:83], v[172:175], a[200:203], v[80:83]
    s_add_u32 m0, s58, 4096
    v_mfma_f32_16x16x32_bf16 v[80:83], v[176:179], a[204:207], v[80:83]
    s_waitcnt lgkmcnt(0)
    v_mfma_f32_16x16x32_bf16 v[84:87], v[180:183], a[144:147], 0
    ds_read_b128 v[164:167], v237 offset:40960
    v_mfma_f32_16x16x32_bf16 v[84:87], v[184:187], a[148:151], v[84:87]
    buffer_load_dwordx4 v250, s[16:19], s77 offen offset:0 lds
    v_mfma_f32_16x16x32_bf16 v[84:87], v[188:191], a[152:155], v[84:87]
    ds_read_b128 v[168:171], v237 offset:41984
    v_mfma_f32_16x16x32_bf16 v[84:87], v[192:195], a[156:159], v[84:87]
    v_mfma_f32_16x16x32_bf16 v[88:91], v[180:183], a[160:163], 0
    ds_read_b128 v[172:175], v237 offset:43008
    v_mfma_f32_16x16x32_bf16 v[88:91], v[184:187], a[164:167], v[88:91]
    buffer_load_dwordx4 v250, s[16:19], s77 offen offset:1024 lds
    v_mfma_f32_16x16x32_bf16 v[88:91], v[188:191], a[168:171], v[88:91]
    ds_read_b128 v[176:179], v237 offset:44032
    v_mfma_f32_16x16x32_bf16 v[88:91], v[192:195], a[172:175], v[88:91]
    v_mfma_f32_16x16x32_bf16 v[92:95], v[180:183], a[176:179], 0
    v_mfma_f32_16x16x32_bf16 v[92:95], v[184:187], a[180:183], v[92:95]
    buffer_load_dwordx4 v250, s[16:19], s77 offen offset:2048 lds
    v_mfma_f32_16x16x32_bf16 v[92:95], v[188:191], a[184:187], v[92:95]
    v_mfma_f32_16x16x32_bf16 v[92:95], v[192:195], a[188:191], v[92:95]
    v_mfma_f32_16x16x32_bf16 v[96:99], v[180:183], a[192:195], 0
    v_mfma_f32_16x16x32_bf16 v[96:99], v[184:187], a[196:199], v[96:99]
    buffer_load_dwordx4 v250, s[16:19], s77 offen offset:3072 lds
    v_mfma_f32_16x16x32_bf16 v[96:99], v[188:191], a[200:203], v[96:99]
    s_add_u32 m0, s58, 98304
    v_mfma_f32_16x16x32_bf16 v[96:99], v[192:195], a[204:207], v[96:99]
    s_waitcnt lgkmcnt(0)
    v_mfma_f32_16x16x32_bf16 v[100:103], v[164:167], a[144:147], 0
    ds_read_b128 v[180:183], v237 offset:45056
    v_mfma_f32_16x16x32_bf16 v[100:103], v[168:171], a[148:151], v[100:103]
    buffer_load_dwordx4 v239, s[20:23], s79 offen offset:0 lds
    v_mfma_f32_16x16x32_bf16 v[100:103], v[172:175], a[152:155], v[100:103]
    ds_read_b128 v[184:187], v237 offset:46080
    v_mfma_f32_16x16x32_bf16 v[100:103], v[176:179], a[156:159], v[100:103]
    v_mfma_f32_16x16x32_bf16 v[104:107], v[164:167], a[160:163], 0
    ds_read_b128 v[188:191], v237 offset:47104
    v_mfma_f32_16x16x32_bf16 v[104:107], v[168:171], a[164:167], v[104:107]
    buffer_load_dwordx4 v239, s[20:23], s79 offen offset:1024 lds
    v_mfma_f32_16x16x32_bf16 v[104:107], v[172:175], a[168:171], v[104:107]
    ds_read_b128 v[192:195], v237 offset:48128
    v_mfma_f32_16x16x32_bf16 v[104:107], v[176:179], a[172:175], v[104:107]
    v_mfma_f32_16x16x32_bf16 v[108:111], v[164:167], a[176:179], 0
    v_mfma_f32_16x16x32_bf16 v[108:111], v[168:171], a[180:183], v[108:111]
    buffer_load_dwordx4 v239, s[20:23], s79 offen offset:2048 lds
    v_mfma_f32_16x16x32_bf16 v[108:111], v[172:175], a[184:187], v[108:111]
    v_mfma_f32_16x16x32_bf16 v[108:111], v[176:179], a[188:191], v[108:111]
    v_mfma_f32_16x16x32_bf16 v[112:115], v[164:167], a[192:195], 0
    v_mfma_f32_16x16x32_bf16 v[112:115], v[168:171], a[196:199], v[112:115]
    buffer_load_dwordx4 v239, s[20:23], s79 offen offset:3072 lds
    v_mfma_f32_16x16x32_bf16 v[112:115], v[172:175], a[200:203], v[112:115]
    s_add_u32 m0, s58, 102400
    v_mfma_f32_16x16x32_bf16 v[112:115], v[176:179], a[204:207], v[112:115]
    s_waitcnt lgkmcnt(0)
    v_mfma_f32_16x16x32_bf16 v[116:119], v[180:183], a[144:147], 0
    v_mfma_f32_16x16x32_bf16 v[116:119], v[184:187], a[148:151], v[116:119]
    buffer_load_dwordx4 v250, s[20:23], s79 offen offset:0 lds
    v_mfma_f32_16x16x32_bf16 v[116:119], v[188:191], a[152:155], v[116:119]
    v_mfma_f32_16x16x32_bf16 v[116:119], v[192:195], a[156:159], v[116:119]
    v_mfma_f32_16x16x32_bf16 v[120:123], v[180:183], a[160:163], 0
    v_mfma_f32_16x16x32_bf16 v[120:123], v[184:187], a[164:167], v[120:123]
    buffer_load_dwordx4 v250, s[20:23], s79 offen offset:1024 lds
    v_mfma_f32_16x16x32_bf16 v[120:123], v[188:191], a[168:171], v[120:123]
    v_mfma_f32_16x16x32_bf16 v[120:123], v[192:195], a[172:175], v[120:123]
    v_mfma_f32_16x16x32_bf16 v[124:127], v[180:183], a[176:179], 0
    v_mfma_f32_16x16x32_bf16 v[124:127], v[184:187], a[180:183], v[124:127]
    buffer_load_dwordx4 v250, s[20:23], s79 offen offset:2048 lds
    v_mfma_f32_16x16x32_bf16 v[124:127], v[188:191], a[184:187], v[124:127]
    v_mfma_f32_16x16x32_bf16 v[124:127], v[192:195], a[188:191], v[124:127]
    v_mfma_f32_16x16x32_bf16 v[128:131], v[180:183], a[192:195], 0
    v_mfma_f32_16x16x32_bf16 v[128:131], v[184:187], a[196:199], v[128:131]
    buffer_load_dwordx4 v250, s[20:23], s79 offen offset:3072 lds
    v_mfma_f32_16x16x32_bf16 v[128:131], v[188:191], a[200:203], v[128:131]
    v_mfma_f32_16x16x32_bf16 v[128:131], v[192:195], a[204:207], v[128:131]
    s_mov_b32 s79, s77
    s_mov_b32 s22, s18
    s_add_u32 s77, s77, 32768
    s_lshr_b32 s67, s76, 7
    s_and_b32 s68, s67, 0x30
    s_lshl_b32 s68, s68, 15
    s_cmp_gt_u32 s77, s78
    s_cselect_b32 s76, s67, s76
    s_cselect_b32 s77, s68, s77
    s_and_b32 s67, s76, 63
    s_lshl_b32 s78, s67, 15
    s_cmp_eq_u32 s76, 0
    s_cselect_b32 s18, 0, s18
    s_waitcnt vmcnt(0) lgkmcnt(0)
    s_barrier
    ds_read_b128 v[164:167], v237 offset:0
    ds_read_b128 v[168:171], v237 offset:1024
    ds_read_b128 v[172:175], v237 offset:2048
    ds_read_b128 v[176:179], v237 offset:3072
    ds_read_b128 v[180:183], v237 offset:4096
    ds_read_b128 v[184:187], v237 offset:5120
    ds_read_b128 v[188:191], v237 offset:6144
    ds_read_b128 v[192:195], v237 offset:7168
    s_branch a2_merge0
a2_lf0:
    s_cmp_eq_u32 s101, 2
    s_cbranch_scc1 a2_rf0_w2
    ds_read_b128 a[212:215], v238 offset:0
    ds_read_b128 a[216:219], v238 offset:1024
    ds_read_b128 a[220:223], v238 offset:2048
    ds_read_b128 a[224:227], v238 offset:3072
    v_cndmask_b32 v4, v4, v243, s[40:41]
    v_cndmask_b32 v5, v5, v243, s[42:43]
    v_cndmask_b32 v6, v6, v243, s[44:45]
    v_cndmask_b32 v7, v7, v243, s[46:47]
    v_cndmask_b32 v20, v20, v243, s[48:49]
    v_cndmask_b32 v21, v21, v243, s[48:49]
    v_cndmask_b32 v22, v22, v243, s[48:49]
    v_cndmask_b32 v23, v23, v243, s[48:49]
    v_cndmask_b32 v24, v24, v243, s[40:41]
    v_cndmask_b32 v25, v25, v243, s[42:43]
    v_cndmask_b32 v26, v26, v243, s[44:45]
    v_cndmask_b32 v27, v27, v243, s[46:47]
    v_cndmask_b32 v36, v36, v243, s[48:49]
    v_cndmask_b32 v37, v37, v243, s[48:49]
    v_cndmask_b32 v38, v38, v243, s[48:49]
    v_cndmask_b32 v39, v39, v243, s[48:49]
    v_cndmask_b32 v40, v40, v243, s[48:49]
    v_cndmask_b32 v41, v41, v243, s[48:49]
    v_cndmask_b32 v42, v42, v243, s[48:49]
    v_cndmask_b32 v43, v43, v243, s[48:49]
    v_cndmask_b32 v44, v44, v243, s[40:41]
    v_cndmask_b32 v45, v45, v243, s[42:43]
    v_cndmask_b32 v46, v46, v243, s[44:45]
    v_cndmask_b32 v47, v47, v243, s[46:47]
    v_cndmask_b32 v52, v52, v243, s[48:49]
    v_cndmask_b32 v53, v53, v243, s[48:49]
    v_cndmask_b32 v54, v54, v243, s[48:49]
    v_cndmask_b32 v55, v55, v243, s[48:49]
    v_cndmask_b32 v56, v56, v243, s[48:49]
    v_cndmask_b32 v57, v57, v243, s[48:49]
    v_cndmask_b32 v58, v58, v243, s[48:49]
    v_cndmask_b32 v59, v59, v243, s[48:49]
    v_cndmask_b32 v60, v60, v243, s[48:49]
    v_cndmask_b32 v61, v61, v243, s[48:49]
    v_cndmask_b32 v62, v62, v243, s[48:49]
    v_cndmask_b32 v63, v63, v243, s[48:49]
    v_cndmask_b32 v64, v64, v243, s[40:41]
    v_cndmask_b32 v65, v65, v243, s[42:43]
    v_cndmask_b32 v66, v66, v243, s[44:45]
    v_cndmask_b32 v67, v67, v243, s[46:47]
    s_cmp_lg_u32 s54, 0
    s_cbranch_scc1 a2_rf0_nf
    s_nop 7
    s_waitcnt lgkmcnt(0)
    v_max3_f32 v232, v4, v5, v6
    v_max3_f32 v232, v232, v7, v20
    v_max3_f32 v232, v232, v21, v22
    v_max3_f32 v232, v232, v23, v36
    v_max3_f32 v232, v232, v37, v38
    v_max3_f32 v232, v232, v39, v52
    v_max3_f32 v232, v232, v53, v54
    v_max_f32 v232, v232, v55
    v_max3_f32 v233, v8, v9, v10
    v_max3_f32 v233, v233, v11, v24
    v_max3_f32 v233, v233, v25, v26
    v_max3_f32 v233, v233, v27, v40
    v_max3_f32 v233, v233, v41, v42
    v_max3_f32 v233, v233, v43, v56
    v_max3_f32 v233, v233, v57, v58
    v_max_f32 v233, v233, v59
    v_max3_f32 v234, v12, v13, v14
    v_max3_f32 v234, v234, v15, v28
    v_max3_f32 v234, v234, v29, v30
    v_max3_f32 v234, v234, v31, v44
    v_max3_f32 v234, v234, v45, v46
    v_max3_f32 v234, v234, v47, v60
    v_max3_f32 v234, v234, v61, v62
    v_max_f32 v234, v234, v63
    v_max3_f32 v235, v16, v17, v18
    v_max3_f32 v235, v235, v19, v32
    v_max3_f32 v235, v235, v33, v34
    v_max3_f32 v235, v235, v35, v48
    v_max3_f32 v235, v235, v49, v50
    v_max3_f32 v235, v235, v51, v64
    v_max3_f32 v235, v235, v65, v66
    v_max_f32 v235, v235, v67
    ds_bpermute_b32 v212, v241, v232
    ds_bpermute_b32 v213, v241, v233
    ds_bpermute_b32 v214, v241, v234
    ds_bpermute_b32 v215, v241, v235
    s_waitcnt lgkmcnt(0)
    v_max_f32 v232, v232, v212
    v_max_f32 v233, v233, v213
    v_max_f32 v234, v234, v214
    v_max_f32 v235, v235, v215
    ds_bpermute_b32 v212, v242, v232
    ds_bpermute_b32 v213, v242, v233
    ds_bpermute_b32 v214, v242, v234
    ds_bpermute_b32 v215, v242, v235
    s_waitcnt lgkmcnt(0)
    v_max_f32 v232, v232, v212
    v_max_f32 v233, v233, v213
    v_max_f32 v234, v234, v214
    v_max_f32 v235, v235, v215
    v_add_f32 v232, 0x40e00000, v232
    v_mov_b32 v228, v232
    v_sub_f32 v196, 0, v228
    v_sub_f32 v197, 0, v228
    v_sub_f32 v198, 0, v228
    v_sub_f32 v199, 0, v228
    v_add_f32 v233, 0x40e00000, v233
    v_mov_b32 v229, v233
    v_sub_f32 v200, 0, v229
    v_sub_f32 v201, 0, v229
    v_sub_f32 v202, 0, v229
    v_sub_f32 v203, 0, v229
    v_add_f32 v234, 0x40e00000, v234
    v_mov_b32 v230, v234
    v_sub_f32 v204, 0, v230
    v_sub_f32 v205, 0, v230
    v_sub_f32 v206, 0, v230
    v_sub_f32 v207, 0, v230
    v_add_f32 v235, 0x40e00000, v235
    v_mov_b32 v231, v235
    v_sub_f32 v208, 0, v231
    v_sub_f32 v209, 0, v231
    v_sub_f32 v210, 0, v231
    v_sub_f32 v211, 0, v231
    v_pk_add_f32 v[4:5], v[4:5], v[232:233] op_sel:[0,0] op_sel_hi:[1,0] neg_lo:[0,1] neg_hi:[0,1]
    v_pk_add_f32 v[6:7], v[6:7], v[232:233] op_sel:[0,0] op_sel_hi:[1,0] neg_lo:[0,1] neg_hi:[0,1]
    v_pk_add_f32 v[8:9], v[8:9], v[232:233] op_sel:[0,1] op_sel_hi:[1,1] neg_lo:[0,1] neg_hi:[0,1]
    v_pk_add_f32 v[10:11], v[10:11], v[232:233] op_sel:[0,1] op_sel_hi:[1,1] neg_lo:[0,1] neg_hi:[0,1]
    v_pk_add_f32 v[12:13], v[12:13], v[234:235] op_sel:[0,0] op_sel_hi:[1,0] neg_lo:[0,1] neg_hi:[0,1]
    v_pk_add_f32 v[14:15], v[14:15], v[234:235] op_sel:[0,0] op_sel_hi:[1,0] neg_lo:[0,1] neg_hi:[0,1]
    v_pk_add_f32 v[16:17], v[16:17], v[234:235] op_sel:[0,1] op_sel_hi:[1,1] neg_lo:[0,1] neg_hi:[0,1]
    v_pk_add_f32 v[18:19], v[18:19], v[234:235] op_sel:[0,1] op_sel_hi:[1,1] neg_lo:[0,1] neg_hi:[0,1]
    v_pk_add_f32 v[20:21], v[20:21], v[232:233] op_sel:[0,0] op_sel_hi:[1,0] neg_lo:[0,1] neg_hi:[0,1]
    v_pk_add_f32 v[22:23], v[22:23], v[232:233] op_sel:[0,0] op_sel_hi:[1,0] neg_lo:[0,1] neg_hi:[0,1]
    v_pk_add_f32 v[24:25], v[24:25], v[232:233] op_sel:[0,1] op_sel_hi:[1,1] neg_lo:[0,1] neg_hi:[0,1]
    v_pk_add_f32 v[26:27], v[26:27], v[232:233] op_sel:[0,1] op_sel_hi:[1,1] neg_lo:[0,1] neg_hi:[0,1]
    v_pk_add_f32 v[28:29], v[28:29], v[234:235] op_sel:[0,0] op_sel_hi:[1,0] neg_lo:[0,1] neg_hi:[0,1]
    v_pk_add_f32 v[30:31], v[30:31], v[234:235] op_sel:[0,0] op_sel_hi:[1,0] neg_lo:[0,1] neg_hi:[0,1]
    v_pk_add_f32 v[32:33], v[32:33], v[234:235] op_sel:[0,1] op_sel_hi:[1,1] neg_lo:[0,1] neg_hi:[0,1]
    v_pk_add_f32 v[34:35], v[34:35], v[234:235] op_sel:[0,1] op_sel_hi:[1,1] neg_lo:[0,1] neg_hi:[0,1]
    v_pk_add_f32 v[36:37], v[36:37], v[232:233] op_sel:[0,0] op_sel_hi:[1,0] neg_lo:[0,1] neg_hi:[0,1]
    v_pk_add_f32 v[38:39], v[38:39], v[232:233] op_sel:[0,0] op_sel_hi:[1,0] neg_lo:[0,1] neg_hi:[0,1]
    v_pk_add_f32 v[40:41], v[40:41], v[232:233] op_sel:[0,1] op_sel_hi:[1,1] neg_lo:[0,1] neg_hi:[0,1]
    v_pk_add_f32 v[42:43], v[42:43], v[232:233] op_sel:[0,1] op_sel_hi:[1,1] neg_lo:[0,1] neg_hi:[0,1]
    v_pk_add_f32 v[44:45], v[44:45], v[234:235] op_sel:[0,0] op_sel_hi:[1,0] neg_lo:[0,1] neg_hi:[0,1]
    v_pk_add_f32 v[46:47], v[46:47], v[234:235] op_sel:[0,0] op_sel_hi:[1,0] neg_lo:[0,1] neg_hi:[0,1]
    v_pk_add_f32 v[48:49], v[48:49], v[234:235] op_sel:[0,1] op_sel_hi:[1,1] neg_lo:[0,1] neg_hi:[0,1]
    v_pk_add_f32 v[50:51], v[50:51], v[234:235] op_sel:[0,1] op_sel_hi:[1,1] neg_lo:[0,1] neg_hi:[0,1]
    v_pk_add_f32 v[52:53], v[52:53], v[232:233] op_sel:[0,0] op_sel_hi:[1,0] neg_lo:[0,1] neg_hi:[0,1]
    v_pk_add_f32 v[54:55], v[54:55], v[232:233] op_sel:[0,0] op_sel_hi:[1,0] neg_lo:[0,1] neg_hi:[0,1]
    v_pk_add_f32 v[56:57], v[56:57], v[232:233] op_sel:[0,1] op_sel_hi:[1,1] neg_lo:[0,1] neg_hi:[0,1]
    v_pk_add_f32 v[58:59], v[58:59], v[232:233] op_sel:[0,1] op_sel_hi:[1,1] neg_lo:[0,1] neg_hi:[0,1]
    v_pk_add_f32 v[60:61], v[60:61], v[234:235] op_sel:[0,0] op_sel_hi:[1,0] neg_lo:[0,1] neg_hi:[0,1]
    v_pk_add_f32 v[62:63], v[62:63], v[234:235] op_sel:[0,0] op_sel_hi:[1,0] neg_lo:[0,1] neg_hi:[0,1]
    v_pk_add_f32 v[64:65], v[64:65], v[234:235] op_sel:[0,1] op_sel_hi:[1,1] neg_lo:[0,1] neg_hi:[0,1]
    v_pk_add_f32 v[66:67], v[66:67], v[234:235] op_sel:[0,1] op_sel_hi:[1,1] neg_lo:[0,1] neg_hi:[0,1]
    s_nop 1
    v_exp_f32 v212, v8
    v_exp_f32 v213, v9
    v_exp_f32 v214, v10
    v_exp_f32 v215, v11
    v_exp_f32 v216, v12
    v_exp_f32 v217, v13
    v_cvt_pk_bf16_f32 v136, v212, v213
    v_exp_f32 v218, v14
    v_cvt_pk_bf16_f32 v137, v214, v215
    v_exp_f32 v219, v15
    v_exp_f32 v212, v16
    v_exp_f32 v213, v17
    v_cvt_pk_bf16_f32 v140, v216, v217
    v_exp_f32 v214, v18
    v_cvt_pk_bf16_f32 v141, v218, v219
    v_exp_f32 v215, v19
    v_or_b32 v244, v136, v137
    v_exp_f32 v216, v28
    v_exp_f32 v217, v29
    v_cvt_pk_bf16_f32 v144, v212, v213
    v_exp_f32 v218, v30
    v_cvt_pk_bf16_f32 v145, v214, v215
    v_exp_f32 v219, v31
    v_or3_b32 v244, v244, v140, v141
    v_exp_f32 v212, v32
    v_exp_f32 v213, v33
    v_cvt_pk_bf16_f32 v142, v216, v217
    v_exp_f32 v214, v34
    v_cvt_pk_bf16_f32 v143, v218, v219
    v_exp_f32 v215, v35
    v_or3_b32 v244, v244, v144, v145
    v_cvt_pk_bf16_f32 v146, v212, v213
    v_cvt_pk_bf16_f32 v147, v214, v215
    v_or3_b32 v244, v244, v142, v143
    v_or3_b32 v244, v244, v146, v147
a2_rf0_nf:
    v_exp_f32 v212, v4
    v_exp_f32 v213, v5
    v_exp_f32 v214, v6
    v_exp_f32 v215, v7
    v_exp_f32 v216, v20
    v_exp_f32 v217, v21
    v_cvt_pk_bf16_f32 v132, v212, v213
    v_exp_f32 v218, v22
    v_cvt_pk_bf16_f32 v133, v214, v215
    v_exp_f32 v219, v23
    v_exp_f32 v212, v24
    v_exp_f32 v213, v25
    v_cvt_pk_bf16_f32 v134, v216, v217
    v_exp_f32 v214, v26
    v_cvt_pk_bf16_f32 v135, v218, v219
    v_exp_f32 v215, v27
    v_or3_b32 v244, v244, v132, v133
    v_cvt_pk_bf16_f32 v138, v212, v213
    v_cvt_pk_bf16_f32 v139, v214, v215
    v_or3_b32 v244, v244, v134, v135
    v_or3_b32 v244, v244, v138, v139
    v_and_b32 v244, 0x40004000, v244
    v_cmp_ne_u32 vcc, 0, v244
    s_cbranch_vccnz a2_rf0a
a2_rf0a_ret:
    v_mfma_f32_16x16x32_bf16 a[128:131], a[208:211], v[132:135], a[128:131]
    v_exp_f32 v212, v36
    v_mfma_f32_16x16x32_bf16 a[132:135], a[208:211], v[136:139], a[132:135]
    v_exp_f32 v213, v37
    v_mfma_f32_16x16x32_bf16 a[136:139], a[208:211], v[140:143], a[136:139]
    v_exp_f32 v214, v38
    v_mfma_f32_16x16x32_bf16 a[140:143], a[208:211], v[144:147], a[140:143]
    s_waitcnt lgkmcnt(2)
    v_exp_f32 v215, v39
    v_mfma_f32_16x16x32_bf16 a[0:3], a[212:215], v[132:135], a[0:3]
    ds_read_b128 a[228:231], v238 offset:4096
    v_cvt_pk_bf16_f32 v148, v212, v213
    v_mfma_f32_16x16x32_bf16 a[4:7], a[212:215], v[136:139], a[4:7]
    v_exp_f32 v216, v40
    v_mfma_f32_16x16x32_bf16 a[8:11], a[212:215], v[140:143], a[8:11]
    v_exp_f32 v217, v41
    v_mfma_f32_16x16x32_bf16 a[12:15], a[212:215], v[144:147], a[12:15]
    v_exp_f32 v218, v42
    v_mfma_f32_16x16x32_bf16 a[16:19], a[216:219], v[132:135], a[16:19]
    ds_read_b128 a[232:235], v238 offset:5120
    v_cvt_pk_bf16_f32 v149, v214, v215
    v_mfma_f32_16x16x32_bf16 a[20:23], a[216:219], v[136:139], a[20:23]
    v_exp_f32 v219, v43
    v_mfma_f32_16x16x32_bf16 a[24:27], a[216:219], v[140:143], a[24:27]
    v_exp_f32 v220, v44
    v_mfma_f32_16x16x32_bf16 a[28:31], a[216:219], v[144:147], a[28:31]
    s_waitcnt lgkmcnt(2)
    v_exp_f32 v221, v45
    v_mfma_f32_16x16x32_bf16 a[32:35], a[220:223], v[132:135], a[32:35]
    ds_read_b128 a[236:239], v238 offset:6144
    v_or_b32 v244, v148, v149
    v_mfma_f32_16x16x32_bf16 a[36:39], a[220:223], v[136:139], a[36:39]
    v_exp_f32 v222, v46
    v_mfma_f32_16x16x32_bf16 a[40:43], a[220:223], v[140:143], a[40:43]
    v_exp_f32 v223, v47
    v_mfma_f32_16x16x32_bf16 a[44:47], a[220:223], v[144:147], a[44:47]
    v_exp_f32 v224, v48
    v_mfma_f32_16x16x32_bf16 a[48:51], a[224:227], v[132:135], a[48:51]
    ds_read_b128 a[240:243], v238 offset:7168
    v_cvt_pk_bf16_f32 v152, v216, v217
    v_mfma_f32_16x16x32_bf16 a[52:55], a[224:227], v[136:139], a[52:55]
    v_exp_f32 v225, v49
    v_mfma_f32_16x16x32_bf16 a[56:59], a[224:227], v[140:143], a[56:59]
    v_exp_f32 v226, v50
    v_mfma_f32_16x16x32_bf16 a[60:63], a[224:227], v[144:147], a[60:63]
    s_waitcnt lgkmcnt(2)
    v_exp_f32 v227, v51
    v_mfma_f32_16x16x32_bf16 a[64:67], a[228:231], v[132:135], a[64:67]
    ds_read_b128 a[212:215], v238 offset:8192
    v_cvt_pk_bf16_f32 v153, v218, v219
    v_mfma_f32_16x16x32_bf16 a[68:71], a[228:231], v[136:139], a[68:71]
    v_exp_f32 v212, v52
    v_mfma_f32_16x16x32_bf16 a[72:75], a[228:231], v[140:143], a[72:75]
    v_exp_f32 v213, v53
    v_mfma_f32_16x16x32_bf16 a[76:79], a[228:231], v[144:147], a[76:79]
    v_exp_f32 v214, v54
    v_mfma_f32_16x16x32_bf16 a[80:83], a[232:235], v[132:135], a[80:83]
    ds_read_b128 a[216:219], v238 offset:9216
    v_or3_b32 v244, v244, v152, v153
    v_mfma_f32_16x16x32_bf16 a[84:87], a[232:235], v[136:139], a[84:87]
    v_exp_f32 v215, v55
    v_mfma_f32_16x16x32_bf16 a[88:91], a[232:235], v[140:143], a[88:91]
    v_exp_f32 v216, v56
    v_mfma_f32_16x16x32_bf16 a[92:95], a[232:235], v[144:147], a[92:95]
    s_waitcnt lgkmcnt(2)
    v_exp_f32 v217, v57
    v_mfma_f32_16x16x32_bf16 a[96:99], a[236:239], v[132:135], a[96:99]
    ds_read_b128 a[220:223], v238 offset:10240
    v_cvt_pk_bf16_f32 v156, v220, v221
    v_mfma_f32_16x16x32_bf16 a[100:103], a[236:239], v[136:139], a[100:103]
    v_exp_f32 v218, v58
    v_mfma_f32_16x16x32_bf16 a[104:107], a[236:239], v[140:143], a[104:107]
    v_exp_f32 v219, v59
    v_mfma_f32_16x16x32_bf16 a[108:111], a[236:239], v[144:147], a[108:111]
    v_exp_f32 v220, v60
    v_mfma_f32_16x16x32_bf16 a[112:115], a[240:243], v[132:135], a[112:115]
    ds_read_b128 a[224:227], v238 offset:11264
    v_cvt_pk_bf16_f32 v157, v222, v223
    v_mfma_f32_16x16x32_bf16 a[116:119], a[240:243], v[136:139], a[116:119]
    v_exp_f32 v221, v61
    v_mfma_f32_16x16x32_bf16 a[120:123], a[240:243], v[140:143], a[120:123]
    v_exp_f32 v222, v62
    v_mfma_f32_16x16x32_bf16 a[124:127], a[240:243], v[144:147], a[124:127]
    v_exp_f32 v223, v63
    v_or3_b32 v244, v244, v156, v157
    v_cvt_pk_bf16_f32 v160, v224, v225
    s_nop 0
    v_exp_f32 v224, v64
    s_nop 0
    v_exp_f32 v225, v65
    v_cvt_pk_bf16_f32 v161, v226, v227
    s_nop 0
    v_exp_f32 v226, v66
    s_nop 0
    v_exp_f32 v227, v67
    v_or3_b32 v244, v244, v160, v161
    v_cvt_pk_bf16_f32 v150, v212, v213
    v_cvt_pk_bf16_f32 v151, v214, v215
    v_or3_b32 v244, v244, v150, v151
    v_cvt_pk_bf16_f32 v154, v216, v217
    v_cvt_pk_bf16_f32 v155, v218, v219
    v_or3_b32 v244, v244, v154, v155
    v_cvt_pk_bf16_f32 v158, v220, v221
    s_nop 0
    v_cvt_pk_bf16_f32 v159, v222, v223
    v_or3_b32 v244, v244, v158, v159
    s_nop 0
    v_cvt_pk_bf16_f32 v162, v224, v225
    s_nop 0
    v_cvt_pk_bf16_f32 v163, v226, v227
    v_or3_b32 v244, v244, v162, v163
    v_and_b32 v244, 0x40004000, v244
    v_cmp_ne_u32 vcc, 0, v244
    s_cbranch_vccnz a2_rf0b
a2_rf0b_ret:
    v_mfma_f32_16x16x32_bf16 a[128:131], a[208:211], v[148:151], a[128:131]
    v_mfma_f32_16x16x32_bf16 a[132:135], a[208:211], v[152:155], a[132:135]
    v_mfma_f32_16x16x32_bf16 a[136:139], a[208:211], v[156:159], a[136:139]
    v_mfma_f32_16x16x32_bf16 a[140:143], a[208:211], v[160:163], a[140:143]
    s_waitcnt lgkmcnt(2)
    v_mfma_f32_16x16x32_bf16 a[0:3], a[212:215], v[148:151], a[0:3]
    ds_read_b128 a[228:231], v238 offset:12288
    v_mfma_f32_16x16x32_bf16 a[4:7], a[212:215], v[152:155], a[4:7]
    v_mfma_f32_16x16x32_bf16 a[8:11], a[212:215], v[156:159], a[8:11]
    v_mfma_f32_16x16x32_bf16 a[12:15], a[212:215], v[160:163], a[12:15]
    v_mfma_f32_16x16x32_bf16 a[16:19], a[216:219], v[148:151], a[16:19]
    ds_read_b128 a[232:235], v238 offset:13312
    v_mfma_f32_16x16x32_bf16 a[20:23], a[216:219], v[152:155], a[20:23]
    v_mfma_f32_16x16x32_bf16 a[24:27], a[216:219], v[156:159], a[24:27]
    v_mfma_f32_16x16x32_bf16 a[28:31], a[216:219], v[160:163], a[28:31]
    s_waitcnt lgkmcnt(2)
    v_mfma_f32_16x16x32_bf16 a[32:35], a[220:223], v[148:151], a[32:35]
    ds_read_b128 a[236:239], v238 offset:14336
    v_mfma_f32_16x16x32_bf16 a[36:39], a[220:223], v[152:155], a[36:39]
    v_mfma_f32_16x16x32_bf16 a[40:43], a[220:223], v[156:159], a[40:43]
    v_mfma_f32_16x16x32_bf16 a[44:47], a[220:223], v[160:163], a[44:47]
    v_mfma_f32_16x16x32_bf16 a[48:51], a[224:227], v[148:151], a[48:51]
    ds_read_b128 a[240:243], v238 offset:15360
    v_mfma_f32_16x16x32_bf16 a[52:55], a[224:227], v[152:155], a[52:55]
    v_mfma_f32_16x16x32_bf16 a[56:59], a[224:227], v[156:159], a[56:59]
    v_mfma_f32_16x16x32_bf16 a[60:63], a[224:227], v[160:163], a[60:63]
    s_waitcnt lgkmcnt(2)
    v_mfma_f32_16x16x32_bf16 a[64:67], a[228:231], v[148:151], a[64:67]
    v_mfma_f32_16x16x32_bf16 a[68:71], a[228:231], v[152:155], a[68:71]
    v_mfma_f32_16x16x32_bf16 a[72:75], a[228:231], v[156:159], a[72:75]
    v_mfma_f32_16x16x32_bf16 a[76:79], a[228:231], v[160:163], a[76:79]
    v_mfma_f32_16x16x32_bf16 a[80:83], a[232:235], v[148:151], a[80:83]
    v_mfma_f32_16x16x32_bf16 a[84:87], a[232:235], v[152:155], a[84:87]
    v_mfma_f32_16x16x32_bf16 a[88:91], a[232:235], v[156:159], a[88:91]
    v_mfma_f32_16x16x32_bf16 a[92:95], a[232:235], v[160:163], a[92:95]
    s_waitcnt vmcnt(0) lgkmcnt(0)
    s_barrier
    v_mfma_f32_16x16x32_bf16 a[96:99], a[236:239], v[148:151], a[96:99]
    ds_read_b128 v[164:167], v237 offset:0
    v_mfma_f32_16x16x32_bf16 a[100:103], a[236:239], v[152:155], a[100:103]
    ds_read_b128 v[168:171], v237 offset:1024
    v_mfma_f32_16x16x32_bf16 a[104:107], a[236:239], v[156:159], a[104:107]
    ds_read_b128 v[172:175], v237 offset:2048
    v_mfma_f32_16x16x32_bf16 a[108:111], a[236:239], v[160:163], a[108:111]
    ds_read_b128 v[176:179], v237 offset:3072
    v_mfma_f32_16x16x32_bf16 a[112:115], a[240:243], v[148:151], a[112:115]
    ds_read_b128 v[180:183], v237 offset:4096
    v_mfma_f32_16x16x32_bf16 a[116:119], a[240:243], v[152:155], a[116:119]
    ds_read_b128 v[184:187], v237 offset:5120
    v_mfma_f32_16x16x32_bf16 a[120:123], a[240:243], v[156:159], a[120:123]
    ds_read_b128 v[188:191], v237 offset:6144
    v_mfma_f32_16x16x32_bf16 a[124:127], a[240:243], v[160:163], a[124:127]
    ds_read_b128 v[192:195], v237 offset:7168
    s_branch a2_merge0
a2_rf0_w2:
    s_waitcnt vmcnt(0) lgkmcnt(0)
    s_barrier
    ds_read_b128 v[164:167], v237 offset:0
    ds_read_b128 v[168:171], v237 offset:1024
    ds_read_b128 v[172:175], v237 offset:2048
    ds_read_b128 v[176:179], v237 offset:3072
    ds_read_b128 v[180:183], v237 offset:4096
    ds_read_b128 v[184:187], v237 offset:5120
    ds_read_b128 v[188:191], v237 offset:6144
    ds_read_b128 v[192:195], v237 offset:7168
    s_branch a2_merge0
a2_l1:
    s_cmp_eq_u32 s71, 0
    s_cbranch_scc1 a2_lf1
    s_cmp_eq_u32 s101, 2
    s_cbranch_scc1 a2_rb1_w2
    s_waitcnt lgkmcnt(4)
    v_mfma_f32_16x16x32_bf16 v[4:7], v[164:167], a[144:147], 0
    s_add_u32 m0, s58, 32768
    v_cndmask_b32 v68, v68, v243, s[40:41]
    v_cndmask_b32 v69, v69, v243, s[42:43]
    v_mfma_f32_16x16x32_bf16 v[4:7], v[168:171], a[148:151], v[4:7]
    buffer_load_dwordx4 v239, s[16:19], s77 offen offset:0 lds
    v_cndmask_b32 v70, v70, v243, s[44:45]
    v_mfma_f32_16x16x32_bf16 v[4:7], v[172:175], a[152:155], v[4:7]
    v_cndmask_b32 v71, v71, v243, s[46:47]
    v_cndmask_b32 v84, v84, v243, s[48:49]
    v_mfma_f32_16x16x32_bf16 v[4:7], v[176:179], a[156:159], v[4:7]
    v_cndmask_b32 v85, v85, v243, s[48:49]
    v_cndmask_b32 v86, v86, v243, s[48:49]
    v_mfma_f32_16x16x32_bf16 v[8:11], v[164:167], a[160:163], 0
    v_cndmask_b32 v87, v87, v243, s[48:49]
    v_cndmask_b32 v88, v88, v243, s[40:41]
    v_mfma_f32_16x16x32_bf16 v[8:11], v[168:171], a[164:167], v[8:11]
    buffer_load_dwordx4 v239, s[16:19], s77 offen offset:1024 lds
    v_cndmask_b32 v89, v89, v243, s[42:43]
    v_mfma_f32_16x16x32_bf16 v[8:11], v[172:175], a[168:171], v[8:11]
    v_cndmask_b32 v90, v90, v243, s[44:45]
    v_cndmask_b32 v91, v91, v243, s[46:47]
    v_mfma_f32_16x16x32_bf16 v[8:11], v[176:179], a[172:175], v[8:11]
    v_cndmask_b32 v100, v100, v243, s[48:49]
    v_cndmask_b32 v101, v101, v243, s[48:49]
    v_mfma_f32_16x16x32_bf16 v[12:15], v[164:167], a[176:179], 0
    v_cndmask_b32 v102, v102, v243, s[48:49]
    v_cndmask_b32 v103, v103, v243, s[48:49]
    v_mfma_f32_16x16x32_bf16 v[12:15], v[168:171], a[180:183], v[12:15]
    buffer_load_dwordx4 v239, s[16:19], s77 offen offset:2048 lds
    v_cndmask_b32 v104, v104, v243, s[48:49]
    v_mfma_f32_16x16x32_bf16 v[12:15], v[172:175], a[184:187], v[12:15]
    v_cndmask_b32 v105, v105, v243, s[48:49]
    v_cndmask_b32 v106, v106, v243, s[48:49]
    v_mfma_f32_16x16x32_bf16 v[12:15], v[176:179], a[188:191], v[12:15]
    v_cndmask_b32 v107, v107, v243, s[48:49]
    v_cndmask_b32 v108, v108, v243, s[40:41]
    v_mfma_f32_16x16x32_bf16 v[16:19], v[164:167], a[192:195], 0
    v_cndmask_b32 v109, v109, v243, s[42:43]
    v_cndmask_b32 v110, v110, v243, s[44:45]
    v_mfma_f32_16x16x32_bf16 v[16:19], v[168:171], a[196:199], v[16:19]
    buffer_load_dwordx4 v239, s[16:19], s77 offen offset:3072 lds
    v_cndmask_b32 v111, v111, v243, s[46:47]
    v_mfma_f32_16x16x32_bf16 v[16:19], v[172:175], a[200:203], v[16:19]
    s_add_u32 m0, s58, 36864
    v_cndmask_b32 v116, v116, v243, s[48:49]
    v_cndmask_b32 v117, v117, v243, s[48:49]
    v_mfma_f32_16x16x32_bf16 v[16:19], v[176:179], a[204:207], v[16:19]
    s_waitcnt lgkmcnt(0)
    v_cndmask_b32 v118, v118, v243, s[48:49]
    v_cndmask_b32 v119, v119, v243, s[48:49]
    v_mfma_f32_16x16x32_bf16 v[20:23], v[180:183], a[144:147], 0
    ds_read_b128 v[164:167], v237 offset:8192
    v_cndmask_b32 v120, v120, v243, s[48:49]
    v_mfma_f32_16x16x32_bf16 v[20:23], v[184:187], a[148:151], v[20:23]
    buffer_load_dwordx4 v250, s[16:19], s77 offen offset:0 lds
    v_cndmask_b32 v121, v121, v243, s[48:49]
    v_mfma_f32_16x16x32_bf16 v[20:23], v[188:191], a[152:155], v[20:23]
    ds_read_b128 v[168:171], v237 offset:9216
    v_cndmask_b32 v122, v122, v243, s[48:49]
    v_mfma_f32_16x16x32_bf16 v[20:23], v[192:195], a[156:159], v[20:23]
    v_cndmask_b32 v123, v123, v243, s[48:49]
    v_cndmask_b32 v124, v124, v243, s[48:49]
    v_mfma_f32_16x16x32_bf16 v[24:27], v[180:183], a[160:163], 0
    ds_read_b128 v[172:175], v237 offset:10240
    v_cndmask_b32 v125, v125, v243, s[48:49]
    v_mfma_f32_16x16x32_bf16 v[24:27], v[184:187], a[164:167], v[24:27]
    buffer_load_dwordx4 v250, s[16:19], s77 offen offset:1024 lds
    v_cndmask_b32 v126, v126, v243, s[48:49]
    v_mfma_f32_16x16x32_bf16 v[24:27], v[188:191], a[168:171], v[24:27]
    ds_read_b128 v[176:179], v237 offset:11264
    v_cndmask_b32 v127, v127, v243, s[48:49]
    v_mfma_f32_16x16x32_bf16 v[24:27], v[192:195], a[172:175], v[24:27]
    v_cndmask_b32 v128, v128, v243, s[40:41]
    v_cndmask_b32 v129, v129, v243, s[42:43]
    v_mfma_f32_16x16x32_bf16 v[28:31], v[180:183], a[176:179], 0
    v_cndmask_b32 v130, v130, v243, s[44:45]
    v_cndmask_b32 v131, v131, v243, s[46:47]
    v_mfma_f32_16x16x32_bf16 v[28:31], v[184:187], a[180:183], v[28:31]
    buffer_load_dwordx4 v250, s[16:19], s77 offen offset:2048 lds
    v_mfma_f32_16x16x32_bf16 v[28:31], v[188:191], a[184:187], v[28:31]
    v_exp_f32 v212, v68
    v_mfma_f32_16x16x32_bf16 v[28:31], v[192:195], a[188:191], v[28:31]
    v_exp_f32 v213, v69
    v_mfma_f32_16x16x32_bf16 v[32:35], v[180:183], a[192:195], 0
    v_exp_f32 v214, v70
    v_mfma_f32_16x16x32_bf16 v[32:35], v[184:187], a[196:199], v[32:35]
    buffer_load_dwordx4 v250, s[16:19], s77 offen offset:3072 lds
    v_cvt_pk_bf16_f32 v132, v212, v213
    v_mfma_f32_16x16x32_bf16 v[32:35], v[188:191], a[200:203], v[32:35]
    s_add_u32 m0, s58, 65536
    v_exp_f32 v215, v71
    v_mfma_f32_16x16x32_bf16 v[32:35], v[192:195], a[204:207], v[32:35]
    s_waitcnt lgkmcnt(0)
    v_exp_f32 v216, v84
    v_mfma_f32_16x16x32_bf16 v[36:39], v[164:167], a[144:147], 0
    ds_read_b128 v[180:183], v237 offset:12288
    v_cvt_pk_bf16_f32 v133, v214, v215
    v_mfma_f32_16x16x32_bf16 v[36:39], v[168:171], a[148:151], v[36:39]
    buffer_load_dwordx4 v239, s[20:23], s79 offen offset:0 lds
    v_or3_b32 v244, v244, v132, v133
    v_mfma_f32_16x16x32_bf16 v[36:39], v[172:175], a[152:155], v[36:39]
    ds_read_b128 v[184:187], v237 offset:13312
    v_mfma_f32_16x16x32_bf16 v[36:39], v[176:179], a[156:159], v[36:39]
    v_exp_f32 v217, v85
    v_mfma_f32_16x16x32_bf16 v[40:43], v[164:167], a[160:163], 0
    ds_read_b128 v[188:191], v237 offset:14336
    v_cvt_pk_bf16_f32 v134, v216, v217
    v_mfma_f32_16x16x32_bf16 v[40:43], v[168:171], a[164:167], v[40:43]
    buffer_load_dwordx4 v239, s[20:23], s79 offen offset:1024 lds
    v_mfma_f32_16x16x32_bf16 v[40:43], v[172:175], a[168:171], v[40:43]
    ds_read_b128 v[192:195], v237 offset:15360
    v_mfma_f32_16x16x32_bf16 v[40:43], v[176:179], a[172:175], v[40:43]
    v_exp_f32 v218, v86
    v_mfma_f32_16x16x32_bf16 v[44:47], v[164:167], a[176:179], 0
    v_exp_f32 v219, v87
    v_mfma_f32_16x16x32_bf16 v[44:47], v[168:171], a[180:183], v[44:47]
    buffer_load_dwordx4 v239, s[20:23], s79 offen offset:2048 lds
    v_cvt_pk_bf16_f32 v135, v218, v219
    v_mfma_f32_16x16x32_bf16 v[44:47], v[172:175], a[184:187], v[44:47]
    v_exp_f32 v220, v88
    v_mfma_f32_16x16x32_bf16 v[44:47], v[176:179], a[188:191], v[44:47]
    v_exp_f32 v221, v89
    v_mfma_f32_16x16x32_bf16 v[48:51], v[164:167], a[192:195], 0
    v_exp_f32 v222, v90
    v_mfma_f32_16x16x32_bf16 v[48:51], v[168:171], a[196:199], v[48:51]
    buffer_load_dwordx4 v239, s[20:23], s79 offen offset:3072 lds
    v_or3_b32 v244, v244, v134, v135
    v_mfma_f32_16x16x32_bf16 v[48:51], v[172:175], a[200:203], v[48:51]
    s_add_u32 m0, s58, 69632
    v_exp_f32 v223, v91
    v_mfma_f32_16x16x32_bf16 v[48:51], v[176:179], a[204:207], v[48:51]
    s_waitcnt lgkmcnt(0)
    v_cvt_pk_bf16_f32 v138, v220, v221
    v_cvt_pk_bf16_f32 v139, v222, v223
    v_mfma_f32_16x16x32_bf16 v[52:55], v[180:183], a[144:147], 0
    ds_read_b128 a[212:215], v238 offset:32768
    v_or3_b32 v244, v244, v138, v139
    v_mfma_f32_16x16x32_bf16 v[52:55], v[184:187], a[148:151], v[52:55]
    buffer_load_dwordx4 v250, s[20:23], s79 offen offset:0 lds
    v_and_b32 v244, 0x40004000, v244
    v_mfma_f32_16x16x32_bf16 v[52:55], v[188:191], a[152:155], v[52:55]
    ds_read_b128 a[216:219], v238 offset:33792
    v_cmp_ne_u32 vcc, 0, v244
    v_mfma_f32_16x16x32_bf16 v[52:55], v[192:195], a[156:159], v[52:55]
    v_mfma_f32_16x16x32_bf16 v[56:59], v[180:183], a[160:163], 0
    ds_read_b128 a[220:223], v238 offset:34816
    v_mfma_f32_16x16x32_bf16 v[56:59], v[184:187], a[164:167], v[56:59]
    buffer_load_dwordx4 v250, s[20:23], s79 offen offset:1024 lds
    v_mfma_f32_16x16x32_bf16 v[56:59], v[188:191], a[168:171], v[56:59]
    ds_read_b128 a[224:227], v238 offset:35840
    v_mfma_f32_16x16x32_bf16 v[56:59], v[192:195], a[172:175], v[56:59]
    v_mfma_f32_16x16x32_bf16 v[60:63], v[180:183], a[176:179], 0
    v_mfma_f32_16x16x32_bf16 v[60:63], v[184:187], a[180:183], v[60:63]
    buffer_load_dwordx4 v250, s[20:23], s79 offen offset:2048 lds
    v_mfma_f32_16x16x32_bf16 v[60:63], v[188:191], a[184:187], v[60:63]
    v_mfma_f32_16x16x32_bf16 v[60:63], v[192:195], a[188:191], v[60:63]
    v_mfma_f32_16x16x32_bf16 v[64:67], v[180:183], a[192:195], 0
    v_mfma_f32_16x16x32_bf16 v[64:67], v[184:187], a[196:199], v[64:67]
    buffer_load_dwordx4 v250, s[20:23], s79 offen offset:3072 lds
    v_mfma_f32_16x16x32_bf16 v[64:67], v[188:191], a[200:203], v[64:67]
    v_mfma_f32_16x16x32_bf16 v[64:67], v[192:195], a[204:207], v[64:67]
    s_cbranch_vccnz a2_rb1a
a2_rb1a_ret:
    v_mfma_f32_16x16x32_bf16 a[128:131], a[208:211], v[132:135], a[128:131]
    s_mov_b32 s79, s77
    v_exp_f32 v212, v100
    v_mfma_f32_16x16x32_bf16 a[132:135], a[208:211], v[136:139], a[132:135]
    s_mov_b32 s22, s18
    v_exp_f32 v213, v101
    v_mfma_f32_16x16x32_bf16 a[136:139], a[208:211], v[140:143], a[136:139]
    v_exp_f32 v214, v102
    v_mfma_f32_16x16x32_bf16 a[140:143], a[208:211], v[144:147], a[140:143]
    s_waitcnt lgkmcnt(2)
    v_exp_f32 v215, v103
    v_mfma_f32_16x16x32_bf16 a[0:3], a[212:215], v[132:135], a[0:3]
    ds_read_b128 a[228:231], v238 offset:36864
    v_cvt_pk_bf16_f32 v148, v212, v213
    v_mfma_f32_16x16x32_bf16 a[4:7], a[212:215], v[136:139], a[4:7]
    s_add_u32 s77, s77, 32768
    v_exp_f32 v216, v104
    v_mfma_f32_16x16x32_bf16 a[8:11], a[212:215], v[140:143], a[8:11]
    v_exp_f32 v217, v105
    v_mfma_f32_16x16x32_bf16 a[12:15], a[212:215], v[144:147], a[12:15]
    v_exp_f32 v218, v106
    v_mfma_f32_16x16x32_bf16 a[16:19], a[216:219], v[132:135], a[16:19]
    s_lshr_b32 s67, s76, 7
    ds_read_b128 a[232:235], v238 offset:37888
    v_cvt_pk_bf16_f32 v149, v214, v215
    v_mfma_f32_16x16x32_bf16 a[20:23], a[216:219], v[136:139], a[20:23]
    v_exp_f32 v219, v107
    v_mfma_f32_16x16x32_bf16 a[24:27], a[216:219], v[140:143], a[24:27]
    v_exp_f32 v220, v108
    v_mfma_f32_16x16x32_bf16 a[28:31], a[216:219], v[144:147], a[28:31]
    s_waitcnt lgkmcnt(2)
    v_exp_f32 v221, v109
    v_mfma_f32_16x16x32_bf16 a[32:35], a[220:223], v[132:135], a[32:35]
    s_and_b32 s68, s67, 0x30
    ds_read_b128 a[236:239], v238 offset:38912
    v_or_b32 v244, v148, v149
    v_mfma_f32_16x16x32_bf16 a[36:39], a[220:223], v[136:139], a[36:39]
    v_exp_f32 v222, v110
    v_mfma_f32_16x16x32_bf16 a[40:43], a[220:223], v[140:143], a[40:43]
    v_exp_f32 v223, v111
    v_mfma_f32_16x16x32_bf16 a[44:47], a[220:223], v[144:147], a[44:47]
    s_lshl_b32 s68, s68, 15
    v_exp_f32 v224, v112
    v_mfma_f32_16x16x32_bf16 a[48:51], a[224:227], v[132:135], a[48:51]
    ds_read_b128 a[240:243], v238 offset:39936
    v_cvt_pk_bf16_f32 v152, v216, v217
    v_mfma_f32_16x16x32_bf16 a[52:55], a[224:227], v[136:139], a[52:55]
    v_exp_f32 v225, v113
    v_mfma_f32_16x16x32_bf16 a[56:59], a[224:227], v[140:143], a[56:59]
    v_exp_f32 v226, v114
    v_mfma_f32_16x16x32_bf16 a[60:63], a[224:227], v[144:147], a[60:63]
    s_waitcnt lgkmcnt(2)
    v_exp_f32 v227, v115
    v_mfma_f32_16x16x32_bf16 a[64:67], a[228:231], v[132:135], a[64:67]
    ds_read_b128 a[212:215], v238 offset:40960
    v_cvt_pk_bf16_f32 v153, v218, v219
    v_mfma_f32_16x16x32_bf16 a[68:71], a[228:231], v[136:139], a[68:71]
    s_cmp_gt_u32 s77, s78
    s_cselect_b32 s76, s67, s76
    s_cselect_b32 s77, s68, s77
    v_mfma_f32_16x16x32_bf16 a[72:75], a[228:231], v[140:143], a[72:75]
    v_exp_f32 v212, v116
    v_mfma_f32_16x16x32_bf16 a[76:79], a[228:231], v[144:147], a[76:79]
    s_and_b32 s67, s76, 63
    v_exp_f32 v213, v117
    v_mfma_f32_16x16x32_bf16 a[80:83], a[232:235], v[132:135], a[80:83]
    ds_read_b128 a[216:219], v238 offset:41984
    v_or3_b32 v244, v244, v152, v153
    v_mfma_f32_16x16x32_bf16 a[84:87], a[232:235], v[136:139], a[84:87]
    v_exp_f32 v214, v118
    v_mfma_f32_16x16x32_bf16 a[88:91], a[232:235], v[140:143], a[88:91]
    s_lshl_b32 s78, s67, 15
    v_exp_f32 v215, v119
    v_mfma_f32_16x16x32_bf16 a[92:95], a[232:235], v[144:147], a[92:95]
    s_waitcnt lgkmcnt(2)
    v_exp_f32 v216, v120
    v_mfma_f32_16x16x32_bf16 a[96:99], a[236:239], v[132:135], a[96:99]
    ds_read_b128 a[220:223], v238 offset:43008
    v_cvt_pk_bf16_f32 v156, v220, v221
    v_mfma_f32_16x16x32_bf16 a[100:103], a[236:239], v[136:139], a[100:103]
    v_exp_f32 v217, v121
    v_mfma_f32_16x16x32_bf16 a[104:107], a[236:239], v[140:143], a[104:107]
    s_cmp_eq_u32 s76, 0
    s_cselect_b32 s18, 0, s18
    v_mfma_f32_16x16x32_bf16 a[108:111], a[236:239], v[144:147], a[108:111]
    v_exp_f32 v218, v122
    v_mfma_f32_16x16x32_bf16 a[112:115], a[240:243], v[132:135], a[112:115]
    ds_read_b128 a[224:227], v238 offset:44032
    v_cvt_pk_bf16_f32 v157, v222, v223
    v_mfma_f32_16x16x32_bf16 a[116:119], a[240:243], v[136:139], a[116:119]
    v_exp_f32 v219, v123
    v_mfma_f32_16x16x32_bf16 a[120:123], a[240:243], v[140:143], a[120:123]
    v_exp_f32 v220, v124
    v_mfma_f32_16x16x32_bf16 a[124:127], a[240:243], v[144:147], a[124:127]
    v_exp_f32 v221, v125
    v_exp_f32 v222, v126
    v_exp_f32 v223, v127
    v_or3_b32 v244, v244, v156, v157
    v_cvt_pk_bf16_f32 v160, v224, v225
    s_nop 0
    v_exp_f32 v224, v128
    s_nop 0
    v_exp_f32 v225, v129
    v_cvt_pk_bf16_f32 v161, v226, v227
    s_nop 0
    v_exp_f32 v226, v130
    s_nop 0
    v_exp_f32 v227, v131
    v_or3_b32 v244, v244, v160, v161
    v_cvt_pk_bf16_f32 v150, v212, v213
    v_cvt_pk_bf16_f32 v151, v214, v215
    v_or3_b32 v244, v244, v150, v151
    v_cvt_pk_bf16_f32 v154, v216, v217
    v_cvt_pk_bf16_f32 v155, v218, v219
    v_or3_b32 v244, v244, v154, v155
    s_nop 0
    v_cvt_pk_bf16_f32 v158, v220, v221
    s_nop 0
    v_cvt_pk_bf16_f32 v159, v222, v223
    v_or3_b32 v244, v244, v158, v159
    s_nop 0
    v_cvt_pk_bf16_f32 v162, v224, v225
    s_nop 0
    v_cvt_pk_bf16_f32 v163, v226, v227
    v_or3_b32 v244, v244, v162, v163
    v_and_b32 v244, 0x40004000, v244
    v_cmp_ne_u32 vcc, 0, v244
    s_cbranch_vccnz a2_rb1b
a2_rb1b_ret:
    v_mfma_f32_16x16x32_bf16 a[128:131], a[208:211], v[148:151], a[128:131]
    v_mfma_f32_16x16x32_bf16 a[132:135], a[208:211], v[152:155], a[132:135]
    v_mfma_f32_16x16x32_bf16 a[136:139], a[208:211], v[156:159], a[136:139]
    v_mfma_f32_16x16x32_bf16 a[140:143], a[208:211], v[160:163], a[140:143]
    s_waitcnt lgkmcnt(2)
    v_mfma_f32_16x16x32_bf16 a[0:3], a[212:215], v[148:151], a[0:3]
    ds_read_b128 a[228:231], v238 offset:45056
    v_mfma_f32_16x16x32_bf16 a[4:7], a[212:215], v[152:155], a[4:7]
    v_mfma_f32_16x16x32_bf16 a[8:11], a[212:215], v[156:159], a[8:11]
    v_mfma_f32_16x16x32_bf16 a[12:15], a[212:215], v[160:163], a[12:15]
    v_mfma_f32_16x16x32_bf16 a[16:19], a[216:219], v[148:151], a[16:19]
    ds_read_b128 a[232:235], v238 offset:46080
    v_mfma_f32_16x16x32_bf16 a[20:23], a[216:219], v[152:155], a[20:23]
    v_mfma_f32_16x16x32_bf16 a[24:27], a[216:219], v[156:159], a[24:27]
    v_mfma_f32_16x16x32_bf16 a[28:31], a[216:219], v[160:163], a[28:31]
    s_waitcnt lgkmcnt(2)
    v_mfma_f32_16x16x32_bf16 a[32:35], a[220:223], v[148:151], a[32:35]
    ds_read_b128 a[236:239], v238 offset:47104
    v_mfma_f32_16x16x32_bf16 a[36:39], a[220:223], v[152:155], a[36:39]
    v_mfma_f32_16x16x32_bf16 a[40:43], a[220:223], v[156:159], a[40:43]
    v_mfma_f32_16x16x32_bf16 a[44:47], a[220:223], v[160:163], a[44:47]
    v_mfma_f32_16x16x32_bf16 a[48:51], a[224:227], v[148:151], a[48:51]
    ds_read_b128 a[240:243], v238 offset:48128
    v_mfma_f32_16x16x32_bf16 a[52:55], a[224:227], v[152:155], a[52:55]
    v_mfma_f32_16x16x32_bf16 a[56:59], a[224:227], v[156:159], a[56:59]
    v_mfma_f32_16x16x32_bf16 a[60:63], a[224:227], v[160:163], a[60:63]
    s_waitcnt lgkmcnt(2)
    v_mfma_f32_16x16x32_bf16 a[64:67], a[228:231], v[148:151], a[64:67]
    v_mfma_f32_16x16x32_bf16 a[68:71], a[228:231], v[152:155], a[68:71]
    v_mfma_f32_16x16x32_bf16 a[72:75], a[228:231], v[156:159], a[72:75]
    v_mfma_f32_16x16x32_bf16 a[76:79], a[228:231], v[160:163], a[76:79]
    v_mfma_f32_16x16x32_bf16 a[80:83], a[232:235], v[148:151], a[80:83]
    v_mfma_f32_16x16x32_bf16 a[84:87], a[232:235], v[152:155], a[84:87]
    v_mfma_f32_16x16x32_bf16 a[88:91], a[232:235], v[156:159], a[88:91]
    v_mfma_f32_16x16x32_bf16 a[92:95], a[232:235], v[160:163], a[92:95]
    s_waitcnt vmcnt(0) lgkmcnt(0)
    s_barrier
    v_mfma_f32_16x16x32_bf16 a[96:99], a[236:239], v[148:151], a[96:99]
    ds_read_b128 v[164:167], v237 offset:32768
    v_mfma_f32_16x16x32_bf16 a[100:103], a[236:239], v[152:155], a[100:103]
    ds_read_b128 v[168:171], v237 offset:33792
    v_mfma_f32_16x16x32_bf16 a[104:107], a[236:239], v[156:159], a[104:107]
    ds_read_b128 v[172:175], v237 offset:34816
    v_mfma_f32_16x16x32_bf16 a[108:111], a[236:239], v[160:163], a[108:111]
    ds_read_b128 v[176:179], v237 offset:35840
    v_mfma_f32_16x16x32_bf16 a[112:115], a[240:243], v[148:151], a[112:115]
    ds_read_b128 v[180:183], v237 offset:36864
    v_mfma_f32_16x16x32_bf16 a[116:119], a[240:243], v[152:155], a[116:119]
    ds_read_b128 v[184:187], v237 offset:37888
    v_mfma_f32_16x16x32_bf16 a[120:123], a[240:243], v[156:159], a[120:123]
    ds_read_b128 v[188:191], v237 offset:38912
    v_mfma_f32_16x16x32_bf16 a[124:127], a[240:243], v[160:163], a[124:127]
    ds_read_b128 v[192:195], v237 offset:39936
    s_branch a2_merge1
a2_rb1_w2:
    s_waitcnt lgkmcnt(4)
    v_mfma_f32_16x16x32_bf16 v[4:7], v[164:167], a[144:147], 0
    s_add_u32 m0, s58, 32768
    v_mfma_f32_16x16x32_bf16 v[4:7], v[168:171], a[148:151], v[4:7]
    buffer_load_dwordx4 v239, s[16:19], s77 offen offset:0 lds
    v_mfma_f32_16x16x32_bf16 v[4:7], v[172:175], a[152:155], v[4:7]
    v_mfma_f32_16x16x32_bf16 v[4:7], v[176:179], a[156:159], v[4:7]
    v_mfma_f32_16x16x32_bf16 v[8:11], v[164:167], a[160:163], 0
    v_mfma_f32_16x16x32_bf16 v[8:11], v[168:171], a[164:167], v[8:11]
    buffer_load_dwordx4 v239, s[16:19], s77 offen offset:1024 lds
    v_mfma_f32_16x16x32_bf16 v[8:11], v[172:175], a[168:171], v[8:11]
    v_mfma_f32_16x16x32_bf16 v[8:11], v[176:179], a[172:175], v[8:11]
    v_mfma_f32_16x16x32_bf16 v[12:15], v[164:167], a[176:179], 0
    v_mfma_f32_16x16x32_bf16 v[12:15], v[168:171], a[180:183], v[12:15]
    buffer_load_dwordx4 v239, s[16:19], s77 offen offset:2048 lds
    v_mfma_f32_16x16x32_bf16 v[12:15], v[172:175], a[184:187], v[12:15]
    v_mfma_f32_16x16x32_bf16 v[12:15], v[176:179], a[188:191], v[12:15]
    v_mfma_f32_16x16x32_bf16 v[16:19], v[164:167], a[192:195], 0
    v_mfma_f32_16x16x32_bf16 v[16:19], v[168:171], a[196:199], v[16:19]
    buffer_load_dwordx4 v239, s[16:19], s77 offen offset:3072 lds
    v_mfma_f32_16x16x32_bf16 v[16:19], v[172:175], a[200:203], v[16:19]
    s_add_u32 m0, s58, 36864
    v_mfma_f32_16x16x32_bf16 v[16:19], v[176:179], a[204:207], v[16:19]
    s_waitcnt lgkmcnt(0)
    v_mfma_f32_16x16x32_bf16 v[20:23], v[180:183], a[144:147], 0
    ds_read_b128 v[164:167], v237 offset:8192
    v_mfma_f32_16x16x32_bf16 v[20:23], v[184:187], a[148:151], v[20:23]
    buffer_load_dwordx4 v250, s[16:19], s77 offen offset:0 lds
    v_mfma_f32_16x16x32_bf16 v[20:23], v[188:191], a[152:155], v[20:23]
    ds_read_b128 v[168:171], v237 offset:9216
    v_mfma_f32_16x16x32_bf16 v[20:23], v[192:195], a[156:159], v[20:23]
    v_mfma_f32_16x16x32_bf16 v[24:27], v[180:183], a[160:163], 0
    ds_read_b128 v[172:175], v237 offset:10240
    v_mfma_f32_16x16x32_bf16 v[24:27], v[184:187], a[164:167], v[24:27]
    buffer_load_dwordx4 v250, s[16:19], s77 offen offset:1024 lds
    v_mfma_f32_16x16x32_bf16 v[24:27], v[188:191], a[168:171], v[24:27]
    ds_read_b128 v[176:179], v237 offset:11264
    v_mfma_f32_16x16x32_bf16 v[24:27], v[192:195], a[172:175], v[24:27]
    v_mfma_f32_16x16x32_bf16 v[28:31], v[180:183], a[176:179], 0
    v_mfma_f32_16x16x32_bf16 v[28:31], v[184:187], a[180:183], v[28:31]
    buffer_load_dwordx4 v250, s[16:19], s77 offen offset:2048 lds
    v_mfma_f32_16x16x32_bf16 v[28:31], v[188:191], a[184:187], v[28:31]
    v_mfma_f32_16x16x32_bf16 v[28:31], v[192:195], a[188:191], v[28:31]
    v_mfma_f32_16x16x32_bf16 v[32:35], v[180:183], a[192:195], 0
    v_mfma_f32_16x16x32_bf16 v[32:35], v[184:187], a[196:199], v[32:35]
    buffer_load_dwordx4 v250, s[16:19], s77 offen offset:3072 lds
    v_mfma_f32_16x16x32_bf16 v[32:35], v[188:191], a[200:203], v[32:35]
    s_add_u32 m0, s58, 65536
    v_mfma_f32_16x16x32_bf16 v[32:35], v[192:195], a[204:207], v[32:35]
    s_waitcnt lgkmcnt(0)
    v_mfma_f32_16x16x32_bf16 v[36:39], v[164:167], a[144:147], 0
    ds_read_b128 v[180:183], v237 offset:12288
    v_mfma_f32_16x16x32_bf16 v[36:39], v[168:171], a[148:151], v[36:39]
    buffer_load_dwordx4 v239, s[20:23], s79 offen offset:0 lds
    v_mfma_f32_16x16x32_bf16 v[36:39], v[172:175], a[152:155], v[36:39]
    ds_read_b128 v[184:187], v237 offset:13312
    v_mfma_f32_16x16x32_bf16 v[36:39], v[176:179], a[156:159], v[36:39]
    v_mfma_f32_16x16x32_bf16 v[40:43], v[164:167], a[160:163], 0
    ds_read_b128 v[188:191], v237 offset:14336
    v_mfma_f32_16x16x32_bf16 v[40:43], v[168:171], a[164:167], v[40:43]
    buffer_load_dwordx4 v239, s[20:23], s79 offen offset:1024 lds
    v_mfma_f32_16x16x32_bf16 v[40:43], v[172:175], a[168:171], v[40:43]
    ds_read_b128 v[192:195], v237 offset:15360
    v_mfma_f32_16x16x32_bf16 v[40:43], v[176:179], a[172:175], v[40:43]
    v_mfma_f32_16x16x32_bf16 v[44:47], v[164:167], a[176:179], 0
    v_mfma_f32_16x16x32_bf16 v[44:47], v[168:171], a[180:183], v[44:47]
    buffer_load_dwordx4 v239, s[20:23], s79 offen offset:2048 lds
    v_mfma_f32_16x16x32_bf16 v[44:47], v[172:175], a[184:187], v[44:47]
    v_mfma_f32_16x16x32_bf16 v[44:47], v[176:179], a[188:191], v[44:47]
    v_mfma_f32_16x16x32_bf16 v[48:51], v[164:167], a[192:195], 0
    v_mfma_f32_16x16x32_bf16 v[48:51], v[168:171], a[196:199], v[48:51]
    buffer_load_dwordx4 v239, s[20:23], s79 offen offset:3072 lds
    v_mfma_f32_16x16x32_bf16 v[48:51], v[172:175], a[200:203], v[48:51]
    s_add_u32 m0, s58, 69632
    v_mfma_f32_16x16x32_bf16 v[48:51], v[176:179], a[204:207], v[48:51]
    s_waitcnt lgkmcnt(0)
    v_mfma_f32_16x16x32_bf16 v[52:55], v[180:183], a[144:147], 0
    v_mfma_f32_16x16x32_bf16 v[52:55], v[184:187], a[148:151], v[52:55]
    buffer_load_dwordx4 v250, s[20:23], s79 offen offset:0 lds
    v_mfma_f32_16x16x32_bf16 v[52:55], v[188:191], a[152:155], v[52:55]
    v_mfma_f32_16x16x32_bf16 v[52:55], v[192:195], a[156:159], v[52:55]
    v_mfma_f32_16x16x32_bf16 v[56:59], v[180:183], a[160:163], 0
    v_mfma_f32_16x16x32_bf16 v[56:59], v[184:187], a[164:167], v[56:59]
    buffer_load_dwordx4 v250, s[20:23], s79 offen offset:1024 lds
    v_mfma_f32_16x16x32_bf16 v[56:59], v[188:191], a[168:171], v[56:59]
    v_mfma_f32_16x16x32_bf16 v[56:59], v[192:195], a[172:175], v[56:59]
    v_mfma_f32_16x16x32_bf16 v[60:63], v[180:183], a[176:179], 0
    v_mfma_f32_16x16x32_bf16 v[60:63], v[184:187], a[180:183], v[60:63]
    buffer_load_dwordx4 v250, s[20:23], s79 offen offset:2048 lds
    v_mfma_f32_16x16x32_bf16 v[60:63], v[188:191], a[184:187], v[60:63]
    v_mfma_f32_16x16x32_bf16 v[60:63], v[192:195], a[188:191], v[60:63]
    v_mfma_f32_16x16x32_bf16 v[64:67], v[180:183], a[192:195], 0
    v_mfma_f32_16x16x32_bf16 v[64:67], v[184:187], a[196:199], v[64:67]
    buffer_load_dwordx4 v250, s[20:23], s79 offen offset:3072 lds
    v_mfma_f32_16x16x32_bf16 v[64:67], v[188:191], a[200:203], v[64:67]
    v_mfma_f32_16x16x32_bf16 v[64:67], v[192:195], a[204:207], v[64:67]
    s_mov_b32 s79, s77
    s_mov_b32 s22, s18
    s_add_u32 s77, s77, 32768
    s_lshr_b32 s67, s76, 7
    s_and_b32 s68, s67, 0x30
    s_lshl_b32 s68, s68, 15
    s_cmp_gt_u32 s77, s78
    s_cselect_b32 s76, s67, s76
    s_cselect_b32 s77, s68, s77
    s_and_b32 s67, s76, 63
    s_lshl_b32 s78, s67, 15
    s_cmp_eq_u32 s76, 0
    s_cselect_b32 s18, 0, s18
    s_waitcnt vmcnt(0) lgkmcnt(0)
    s_barrier
    ds_read_b128 v[164:167], v237 offset:32768
    ds_read_b128 v[168:171], v237 offset:33792
    ds_read_b128 v[172:175], v237 offset:34816
    ds_read_b128 v[176:179], v237 offset:35840
    ds_read_b128 v[180:183], v237 offset:36864
    ds_read_b128 v[184:187], v237 offset:37888
    ds_read_b128 v[188:191], v237 offset:38912
    ds_read_b128 v[192:195], v237 offset:39936
    s_branch a2_merge1
a2_lf1:
    s_cmp_eq_u32 s101, 2
    s_cbranch_scc1 a2_rf1_w2
    ds_read_b128 a[212:215], v238 offset:32768
    ds_read_b128 a[216:219], v238 offset:33792
    ds_read_b128 a[220:223], v238 offset:34816
    ds_read_b128 a[224:227], v238 offset:35840
    v_cndmask_b32 v68, v68, v243, s[40:41]
    v_cndmask_b32 v69, v69, v243, s[42:43]
    v_cndmask_b32 v70, v70, v243, s[44:45]
    v_cndmask_b32 v71, v71, v243, s[46:47]
    v_cndmask_b32 v84, v84, v243, s[48:49]
    v_cndmask_b32 v85, v85, v243, s[48:49]
    v_cndmask_b32 v86, v86, v243, s[48:49]
    v_cndmask_b32 v87, v87, v243, s[48:49]
    v_cndmask_b32 v88, v88, v243, s[40:41]
    v_cndmask_b32 v89, v89, v243, s[42:43]
    v_cndmask_b32 v90, v90, v243, s[44:45]
    v_cndmask_b32 v91, v91, v243, s[46:47]
    v_cndmask_b32 v100, v100, v243, s[48:49]
    v_cndmask_b32 v101, v101, v243, s[48:49]
    v_cndmask_b32 v102, v102, v243, s[48:49]
    v_cndmask_b32 v103, v103, v243, s[48:49]
    v_cndmask_b32 v104, v104, v243, s[48:49]
    v_cndmask_b32 v105, v105, v243, s[48:49]
    v_cndmask_b32 v106, v106, v243, s[48:49]
    v_cndmask_b32 v107, v107, v243, s[48:49]
    v_cndmask_b32 v108, v108, v243, s[40:41]
    v_cndmask_b32 v109, v109, v243, s[42:43]
    v_cndmask_b32 v110, v110, v243, s[44:45]
    v_cndmask_b32 v111, v111, v243, s[46:47]
    v_cndmask_b32 v116, v116, v243, s[48:49]
    v_cndmask_b32 v117, v117, v243, s[48:49]
    v_cndmask_b32 v118, v118, v243, s[48:49]
    v_cndmask_b32 v119, v119, v243, s[48:49]
    v_cndmask_b32 v120, v120, v243, s[48:49]
    v_cndmask_b32 v121, v121, v243, s[48:49]
    v_cndmask_b32 v122, v122, v243, s[48:49]
    v_cndmask_b32 v123, v123, v243, s[48:49]
    v_cndmask_b32 v124, v124, v243, s[48:49]
    v_cndmask_b32 v125, v125, v243, s[48:49]
    v_cndmask_b32 v126, v126, v243, s[48:49]
    v_cndmask_b32 v127, v127, v243, s[48:49]
    v_cndmask_b32 v128, v128, v243, s[40:41]
    v_cndmask_b32 v129, v129, v243, s[42:43]
    v_cndmask_b32 v130, v130, v243, s[44:45]
    v_cndmask_b32 v131, v131, v243, s[46:47]
    s_cmp_lg_u32 s54, 0
    s_cbranch_scc1 a2_rf1_nf
    s_nop 7
    s_waitcnt lgkmcnt(0)
    v_max3_f32 v232, v68, v69, v70
    v_max3_f32 v232, v232, v71, v84
    v_max3_f32 v232, v232, v85, v86
    v_max3_f32 v232, v232, v87, v100
    v_max3_f32 v232, v232, v101, v102
    v_max3_f32 v232, v232, v103, v116
    v_max3_f32 v232, v232, v117, v118
    v_max_f32 v232, v232, v119
    v_max3_f32 v233, v72, v73, v74
    v_max3_f32 v233, v233, v75, v88
    v_max3_f32 v233, v233, v89, v90
    v_max3_f32 v233, v233, v91, v104
    v_max3_f32 v233, v233, v105, v106
    v_max3_f32 v233, v233, v107, v120
    v_max3_f32 v233, v233, v121, v122
    v_max_f32 v233, v233, v123
    v_max3_f32 v234, v76, v77, v78
    v_max3_f32 v234, v234, v79, v92
    v_max3_f32 v234, v234, v93, v94
    v_max3_f32 v234, v234, v95, v108
    v_max3_f32 v234, v234, v109, v110
    v_max3_f32 v234, v234, v111, v124
    v_max3_f32 v234, v234, v125, v126
    v_max_f32 v234, v234, v127
    v_max3_f32 v235, v80, v81, v82
    v_max3_f32 v235, v235, v83, v96
    v_max3_f32 v235, v235, v97, v98
    v_max3_f32 v235, v235, v99, v112
    v_max3_f32 v235, v235, v113, v114
    v_max3_f32 v235, v235, v115, v128
    v_max3_f32 v235, v235, v129, v130
    v_max_f32 v235, v235, v131
    ds_bpermute_b32 v212, v241, v232
    ds_bpermute_b32 v213, v241, v233
    ds_bpermute_b32 v214, v241, v234
    ds_bpermute_b32 v215, v241, v235
    s_waitcnt lgkmcnt(0)
    v_max_f32 v232, v232, v212
    v_max_f32 v233, v233, v213
    v_max_f32 v234, v234, v214
    v_max_f32 v235, v235, v215
    ds_bpermute_b32 v212, v242, v232
    ds_bpermute_b32 v213, v242, v233
    ds_bpermute_b32 v214, v242, v234
    ds_bpermute_b32 v215, v242, v235
    s_waitcnt lgkmcnt(0)
    v_max_f32 v232, v232, v212
    v_max_f32 v233, v233, v213
    v_max_f32 v234, v234, v214
    v_max_f32 v235, v235, v215
    v_add_f32 v232, 0x40e00000, v232
    v_mov_b32 v228, v232
    v_sub_f32 v196, 0, v228
    v_sub_f32 v197, 0, v228
    v_sub_f32 v198, 0, v228
    v_sub_f32 v199, 0, v228
    v_add_f32 v233, 0x40e00000, v233
    v_mov_b32 v229, v233
    v_sub_f32 v200, 0, v229
    v_sub_f32 v201, 0, v229
    v_sub_f32 v202, 0, v229
    v_sub_f32 v203, 0, v229
    v_add_f32 v234, 0x40e00000, v234
    v_mov_b32 v230, v234
    v_sub_f32 v204, 0, v230
    v_sub_f32 v205, 0, v230
    v_sub_f32 v206, 0, v230
    v_sub_f32 v207, 0, v230
    v_add_f32 v235, 0x40e00000, v235
    v_mov_b32 v231, v235
    v_sub_f32 v208, 0, v231
    v_sub_f32 v209, 0, v231
    v_sub_f32 v210, 0, v231
    v_sub_f32 v211, 0, v231
    v_pk_add_f32 v[68:69], v[68:69], v[232:233] op_sel:[0,0] op_sel_hi:[1,0] neg_lo:[0,1] neg_hi:[0,1]
    v_pk_add_f32 v[70:71], v[70:71], v[232:233] op_sel:[0,0] op_sel_hi:[1,0] neg_lo:[0,1] neg_hi:[0,1]
    v_pk_add_f32 v[72:73], v[72:73], v[232:233] op_sel:[0,1] op_sel_hi:[1,1] neg_lo:[0,1] neg_hi:[0,1]
    v_pk_add_f32 v[74:75], v[74:75], v[232:233] op_sel:[0,1] op_sel_hi:[1,1] neg_lo:[0,1] neg_hi:[0,1]
    v_pk_add_f32 v[76:77], v[76:77], v[234:235] op_sel:[0,0] op_sel_hi:[1,0] neg_lo:[0,1] neg_hi:[0,1]
    v_pk_add_f32 v[78:79], v[78:79], v[234:235] op_sel:[0,0] op_sel_hi:[1,0] neg_lo:[0,1] neg_hi:[0,1]
    v_pk_add_f32 v[80:81], v[80:81], v[234:235] op_sel:[0,1] op_sel_hi:[1,1] neg_lo:[0,1] neg_hi:[0,1]
    v_pk_add_f32 v[82:83], v[82:83], v[234:235] op_sel:[0,1] op_sel_hi:[1,1] neg_lo:[0,1] neg_hi:[0,1]
    v_pk_add_f32 v[84:85], v[84:85], v[232:233] op_sel:[0,0] op_sel_hi:[1,0] neg_lo:[0,1] neg_hi:[0,1]
    v_pk_add_f32 v[86:87], v[86:87], v[232:233] op_sel:[0,0] op_sel_hi:[1,0] neg_lo:[0,1] neg_hi:[0,1]
    v_pk_add_f32 v[88:89], v[88:89], v[232:233] op_sel:[0,1] op_sel_hi:[1,1] neg_lo:[0,1] neg_hi:[0,1]
    v_pk_add_f32 v[90:91], v[90:91], v[232:233] op_sel:[0,1] op_sel_hi:[1,1] neg_lo:[0,1] neg_hi:[0,1]
    v_pk_add_f32 v[92:93], v[92:93], v[234:235] op_sel:[0,0] op_sel_hi:[1,0] neg_lo:[0,1] neg_hi:[0,1]
    v_pk_add_f32 v[94:95], v[94:95], v[234:235] op_sel:[0,0] op_sel_hi:[1,0] neg_lo:[0,1] neg_hi:[0,1]
    v_pk_add_f32 v[96:97], v[96:97], v[234:235] op_sel:[0,1] op_sel_hi:[1,1] neg_lo:[0,1] neg_hi:[0,1]
    v_pk_add_f32 v[98:99], v[98:99], v[234:235] op_sel:[0,1] op_sel_hi:[1,1] neg_lo:[0,1] neg_hi:[0,1]
    v_pk_add_f32 v[100:101], v[100:101], v[232:233] op_sel:[0,0] op_sel_hi:[1,0] neg_lo:[0,1] neg_hi:[0,1]
    v_pk_add_f32 v[102:103], v[102:103], v[232:233] op_sel:[0,0] op_sel_hi:[1,0] neg_lo:[0,1] neg_hi:[0,1]
    v_pk_add_f32 v[104:105], v[104:105], v[232:233] op_sel:[0,1] op_sel_hi:[1,1] neg_lo:[0,1] neg_hi:[0,1]
    v_pk_add_f32 v[106:107], v[106:107], v[232:233] op_sel:[0,1] op_sel_hi:[1,1] neg_lo:[0,1] neg_hi:[0,1]
    v_pk_add_f32 v[108:109], v[108:109], v[234:235] op_sel:[0,0] op_sel_hi:[1,0] neg_lo:[0,1] neg_hi:[0,1]
    v_pk_add_f32 v[110:111], v[110:111], v[234:235] op_sel:[0,0] op_sel_hi:[1,0] neg_lo:[0,1] neg_hi:[0,1]
    v_pk_add_f32 v[112:113], v[112:113], v[234:235] op_sel:[0,1] op_sel_hi:[1,1] neg_lo:[0,1] neg_hi:[0,1]
    v_pk_add_f32 v[114:115], v[114:115], v[234:235] op_sel:[0,1] op_sel_hi:[1,1] neg_lo:[0,1] neg_hi:[0,1]
    v_pk_add_f32 v[116:117], v[116:117], v[232:233] op_sel:[0,0] op_sel_hi:[1,0] neg_lo:[0,1] neg_hi:[0,1]
    v_pk_add_f32 v[118:119], v[118:119], v[232:233] op_sel:[0,0] op_sel_hi:[1,0] neg_lo:[0,1] neg_hi:[0,1]
    v_pk_add_f32 v[120:121], v[120:121], v[232:233] op_sel:[0,1] op_sel_hi:[1,1] neg_lo:[0,1] neg_hi:[0,1]
    v_pk_add_f32 v[122:123], v[122:123], v[232:233] op_sel:[0,1] op_sel_hi:[1,1] neg_lo:[0,1] neg_hi:[0,1]
    v_pk_add_f32 v[124:125], v[124:125], v[234:235] op_sel:[0,0] op_sel_hi:[1,0] neg_lo:[0,1] neg_hi:[0,1]
    v_pk_add_f32 v[126:127], v[126:127], v[234:235] op_sel:[0,0] op_sel_hi:[1,0] neg_lo:[0,1] neg_hi:[0,1]
    v_pk_add_f32 v[128:129], v[128:129], v[234:235] op_sel:[0,1] op_sel_hi:[1,1] neg_lo:[0,1] neg_hi:[0,1]
    v_pk_add_f32 v[130:131], v[130:131], v[234:235] op_sel:[0,1] op_sel_hi:[1,1] neg_lo:[0,1] neg_hi:[0,1]
    s_nop 1
    v_exp_f32 v212, v72
    v_exp_f32 v213, v73
    v_exp_f32 v214, v74
    v_exp_f32 v215, v75
    v_exp_f32 v216, v76
    v_exp_f32 v217, v77
    v_cvt_pk_bf16_f32 v136, v212, v213
    v_exp_f32 v218, v78
    v_cvt_pk_bf16_f32 v137, v214, v215
    v_exp_f32 v219, v79
    v_exp_f32 v212, v80
    v_exp_f32 v213, v81
    v_cvt_pk_bf16_f32 v140, v216, v217
    v_exp_f32 v214, v82
    v_cvt_pk_bf16_f32 v141, v218, v219
    v_exp_f32 v215, v83
    v_or_b32 v244, v136, v137
    v_exp_f32 v216, v92
    v_exp_f32 v217, v93
    v_cvt_pk_bf16_f32 v144, v212, v213
    v_exp_f32 v218, v94
    v_cvt_pk_bf16_f32 v145, v214, v215
    v_exp_f32 v219, v95
    v_or3_b32 v244, v244, v140, v141
    v_exp_f32 v212, v96
    v_exp_f32 v213, v97
    v_cvt_pk_bf16_f32 v142, v216, v217
    v_exp_f32 v214, v98
    v_cvt_pk_bf16_f32 v143, v218, v219
    v_exp_f32 v215, v99
    v_or3_b32 v244, v244, v144, v145
    v_cvt_pk_bf16_f32 v146, v212, v213
    v_cvt_pk_bf16_f32 v147, v214, v215
    v_or3_b32 v244, v244, v142, v143
    v_or3_b32 v244, v244, v146, v147
a2_rf1_nf:
    v_exp_f32 v212, v68
    v_exp_f32 v213, v69
    v_exp_f32 v214, v70
    v_exp_f32 v215, v71
    v_exp_f32 v216, v84
    v_exp_f32 v217, v85
    v_cvt_pk_bf16_f32 v132, v212, v213
    v_exp_f32 v218, v86
    v_cvt_pk_bf16_f32 v133, v214, v215
    v_exp_f32 v219, v87
    v_exp_f32 v212, v88
    v_exp_f32 v213, v89
    v_cvt_pk_bf16_f32 v134, v216, v217
    v_exp_f32 v214, v90
    v_cvt_pk_bf16_f32 v135, v218, v219
    v_exp_f32 v215, v91
    v_or3_b32 v244, v244, v132, v133
    v_cvt_pk_bf16_f32 v138, v212, v213
    v_cvt_pk_bf16_f32 v139, v214, v215
    v_or3_b32 v244, v244, v134, v135
    v_or3_b32 v244, v244, v138, v139
    v_and_b32 v244, 0x40004000, v244
    v_cmp_ne_u32 vcc, 0, v244
    s_cbranch_vccnz a2_rf1a
a2_rf1a_ret:
    v_mfma_f32_16x16x32_bf16 a[128:131], a[208:211], v[132:135], a[128:131]
    v_exp_f32 v212, v100
    v_mfma_f32_16x16x32_bf16 a[132:135], a[208:211], v[136:139], a[132:135]
    v_exp_f32 v213, v101
    v_mfma_f32_16x16x32_bf16 a[136:139], a[208:211], v[140:143], a[136:139]
    v_exp_f32 v214, v102
    v_mfma_f32_16x16x32_bf16 a[140:143], a[208:211], v[144:147], a[140:143]
    s_waitcnt lgkmcnt(2)
    v_exp_f32 v215, v103
    v_mfma_f32_16x16x32_bf16 a[0:3], a[212:215], v[132:135], a[0:3]
    ds_read_b128 a[228:231], v238 offset:36864
    v_cvt_pk_bf16_f32 v148, v212, v213
    v_mfma_f32_16x16x32_bf16 a[4:7], a[212:215], v[136:139], a[4:7]
    v_exp_f32 v216, v104
    v_mfma_f32_16x16x32_bf16 a[8:11], a[212:215], v[140:143], a[8:11]
    v_exp_f32 v217, v105
    v_mfma_f32_16x16x32_bf16 a[12:15], a[212:215], v[144:147], a[12:15]
    v_exp_f32 v218, v106
    v_mfma_f32_16x16x32_bf16 a[16:19], a[216:219], v[132:135], a[16:19]
    ds_read_b128 a[232:235], v238 offset:37888
    v_cvt_pk_bf16_f32 v149, v214, v215
    v_mfma_f32_16x16x32_bf16 a[20:23], a[216:219], v[136:139], a[20:23]
    v_exp_f32 v219, v107
    v_mfma_f32_16x16x32_bf16 a[24:27], a[216:219], v[140:143], a[24:27]
    v_exp_f32 v220, v108
    v_mfma_f32_16x16x32_bf16 a[28:31], a[216:219], v[144:147], a[28:31]
    s_waitcnt lgkmcnt(2)
    v_exp_f32 v221, v109
    v_mfma_f32_16x16x32_bf16 a[32:35], a[220:223], v[132:135], a[32:35]
    ds_read_b128 a[236:239], v238 offset:38912
    v_or_b32 v244, v148, v149
    v_mfma_f32_16x16x32_bf16 a[36:39], a[220:223], v[136:139], a[36:39]
    v_exp_f32 v222, v110
    v_mfma_f32_16x16x32_bf16 a[40:43], a[220:223], v[140:143], a[40:43]
    v_exp_f32 v223, v111
    v_mfma_f32_16x16x32_bf16 a[44:47], a[220:223], v[144:147], a[44:47]
    v_exp_f32 v224, v112
    v_mfma_f32_16x16x32_bf16 a[48:51], a[224:227], v[132:135], a[48:51]
    ds_read_b128 a[240:243], v238 offset:39936
    v_cvt_pk_bf16_f32 v152, v216, v217
    v_mfma_f32_16x16x32_bf16 a[52:55], a[224:227], v[136:139], a[52:55]
    v_exp_f32 v225, v113
    v_mfma_f32_16x16x32_bf16 a[56:59], a[224:227], v[140:143], a[56:59]
    v_exp_f32 v226, v114
    v_mfma_f32_16x16x32_bf16 a[60:63], a[224:227], v[144:147], a[60:63]
    s_waitcnt lgkmcnt(2)
    v_exp_f32 v227, v115
    v_mfma_f32_16x16x32_bf16 a[64:67], a[228:231], v[132:135], a[64:67]
    ds_read_b128 a[212:215], v238 offset:40960
    v_cvt_pk_bf16_f32 v153, v218, v219
    v_mfma_f32_16x16x32_bf16 a[68:71], a[228:231], v[136:139], a[68:71]
    v_exp_f32 v212, v116
    v_mfma_f32_16x16x32_bf16 a[72:75], a[228:231], v[140:143], a[72:75]
    v_exp_f32 v213, v117
    v_mfma_f32_16x16x32_bf16 a[76:79], a[228:231], v[144:147], a[76:79]
    v_exp_f32 v214, v118
    v_mfma_f32_16x16x32_bf16 a[80:83], a[232:235], v[132:135], a[80:83]
    ds_read_b128 a[216:219], v238 offset:41984
    v_or3_b32 v244, v244, v152, v153
    v_mfma_f32_16x16x32_bf16 a[84:87], a[232:235], v[136:139], a[84:87]
    v_exp_f32 v215, v119
    v_mfma_f32_16x16x32_bf16 a[88:91], a[232:235], v[140:143], a[88:91]
    v_exp_f32 v216, v120
    v_mfma_f32_16x16x32_bf16 a[92:95], a[232:235], v[144:147], a[92:95]
    s_waitcnt lgkmcnt(2)
    v_exp_f32 v217, v121
    v_mfma_f32_16x16x32_bf16 a[96:99], a[236:239], v[132:135], a[96:99]
    ds_read_b128 a[220:223], v238 offset:43008
    v_cvt_pk_bf16_f32 v156, v220, v221
    v_mfma_f32_16x16x32_bf16 a[100:103], a[236:239], v[136:139], a[100:103]
    v_exp_f32 v218, v122
    v_mfma_f32_16x16x32_bf16 a[104:107], a[236:239], v[140:143], a[104:107]
    v_exp_f32 v219, v123
    v_mfma_f32_16x16x32_bf16 a[108:111], a[236:239], v[144:147], a[108:111]
    v_exp_f32 v220, v124
    v_mfma_f32_16x16x32_bf16 a[112:115], a[240:243], v[132:135], a[112:115]
    ds_read_b128 a[224:227], v238 offset:44032
    v_cvt_pk_bf16_f32 v157, v222, v223
    v_mfma_f32_16x16x32_bf16 a[116:119], a[240:243], v[136:139], a[116:119]
    v_exp_f32 v221, v125
    v_mfma_f32_16x16x32_bf16 a[120:123], a[240:243], v[140:143], a[120:123]
    v_exp_f32 v222, v126
    v_mfma_f32_16x16x32_bf16 a[124:127], a[240:243], v[144:147], a[124:127]
    v_exp_f32 v223, v127
    v_or3_b32 v244, v244, v156, v157
    v_cvt_pk_bf16_f32 v160, v224, v225
    s_nop 0
    v_exp_f32 v224, v128
    s_nop 0
    v_exp_f32 v225, v129
    v_cvt_pk_bf16_f32 v161, v226, v227
    s_nop 0
    v_exp_f32 v226, v130
    s_nop 0
    v_exp_f32 v227, v131
    v_or3_b32 v244, v244, v160, v161
    v_cvt_pk_bf16_f32 v150, v212, v213
    v_cvt_pk_bf16_f32 v151, v214, v215
    v_or3_b32 v244, v244, v150, v151
    v_cvt_pk_bf16_f32 v154, v216, v217
    v_cvt_pk_bf16_f32 v155, v218, v219
    v_or3_b32 v244, v244, v154, v155
    v_cvt_pk_bf16_f32 v158, v220, v221
    s_nop 0
    v_cvt_pk_bf16_f32 v159, v222, v223
    v_or3_b32 v244, v244, v158, v159
    s_nop 0
    v_cvt_pk_bf16_f32 v162, v224, v225
    s_nop 0
    v_cvt_pk_bf16_f32 v163, v226, v227
    v_or3_b32 v244, v244, v162, v163
    v_and_b32 v244, 0x40004000, v244
    v_cmp_ne_u32 vcc, 0, v244
    s_cbranch_vccnz a2_rf1b
a2_rf1b_ret:
    v_mfma_f32_16x16x32_bf16 a[128:131], a[208:211], v[148:151], a[128:131]
    v_mfma_f32_16x16x32_bf16 a[132:135], a[208:211], v[152:155], a[132:135]
    v_mfma_f32_16x16x32_bf16 a[136:139], a[208:211], v[156:159], a[136:139]
    v_mfma_f32_16x16x32_bf16 a[140:143], a[208:211], v[160:163], a[140:143]
    s_waitcnt lgkmcnt(2)
    v_mfma_f32_16x16x32_bf16 a[0:3], a[212:215], v[148:151], a[0:3]
    ds_read_b128 a[228:231], v238 offset:45056
    v_mfma_f32_16x16x32_bf16 a[4:7], a[212:215], v[152:155], a[4:7]
    v_mfma_f32_16x16x32_bf16 a[8:11], a[212:215], v[156:159], a[8:11]
    v_mfma_f32_16x16x32_bf16 a[12:15], a[212:215], v[160:163], a[12:15]
    v_mfma_f32_16x16x32_bf16 a[16:19], a[216:219], v[148:151], a[16:19]
    ds_read_b128 a[232:235], v238 offset:46080
    v_mfma_f32_16x16x32_bf16 a[20:23], a[216:219], v[152:155], a[20:23]
    v_mfma_f32_16x16x32_bf16 a[24:27], a[216:219], v[156:159], a[24:27]
    v_mfma_f32_16x16x32_bf16 a[28:31], a[216:219], v[160:163], a[28:31]
    s_waitcnt lgkmcnt(2)
    v_mfma_f32_16x16x32_bf16 a[32:35], a[220:223], v[148:151], a[32:35]
    ds_read_b128 a[236:239], v238 offset:47104
    v_mfma_f32_16x16x32_bf16 a[36:39], a[220:223], v[152:155], a[36:39]
    v_mfma_f32_16x16x32_bf16 a[40:43], a[220:223], v[156:159], a[40:43]
    v_mfma_f32_16x16x32_bf16 a[44:47], a[220:223], v[160:163], a[44:47]
    v_mfma_f32_16x16x32_bf16 a[48:51], a[224:227], v[148:151], a[48:51]
    ds_read_b128 a[240:243], v238 offset:48128
    v_mfma_f32_16x16x32_bf16 a[52:55], a[224:227], v[152:155], a[52:55]
    v_mfma_f32_16x16x32_bf16 a[56:59], a[224:227], v[156:159], a[56:59]
    v_mfma_f32_16x16x32_bf16 a[60:63], a[224:227], v[160:163], a[60:63]
    s_waitcnt lgkmcnt(2)
    v_mfma_f32_16x16x32_bf16 a[64:67], a[228:231], v[148:151], a[64:67]
    v_mfma_f32_16x16x32_bf16 a[68:71], a[228:231], v[152:155], a[68:71]
    v_mfma_f32_16x16x32_bf16 a[72:75], a[228:231], v[156:159], a[72:75]
    v_mfma_f32_16x16x32_bf16 a[76:79], a[228:231], v[160:163], a[76:79]
    v_mfma_f32_16x16x32_bf16 a[80:83], a[232:235], v[148:151], a[80:83]
    v_mfma_f32_16x16x32_bf16 a[84:87], a[232:235], v[152:155], a[84:87]
    v_mfma_f32_16x16x32_bf16 a[88:91], a[232:235], v[156:159], a[88:91]
    v_mfma_f32_16x16x32_bf16 a[92:95], a[232:235], v[160:163], a[92:95]
    s_waitcnt vmcnt(0) lgkmcnt(0)
    s_barrier
    v_mfma_f32_16x16x32_bf16 a[96:99], a[236:239], v[148:151], a[96:99]
    ds_read_b128 v[164:167], v237 offset:32768
    v_mfma_f32_16x16x32_bf16 a[100:103], a[236:239], v[152:155], a[100:103]
    ds_read_b128 v[168:171], v237 offset:33792
    v_mfma_f32_16x16x32_bf16 a[104:107], a[236:239], v[156:159], a[104:107]
    ds_read_b128 v[172:175], v237 offset:34816
    v_mfma_f32_16x16x32_bf16 a[108:111], a[236:239], v[160:163], a[108:111]
    ds_read_b128 v[176:179], v237 offset:35840
    v_mfma_f32_16x16x32_bf16 a[112:115], a[240:243], v[148:151], a[112:115]
    ds_read_b128 v[180:183], v237 offset:36864
    v_mfma_f32_16x16x32_bf16 a[116:119], a[240:243], v[152:155], a[116:119]
    ds_read_b128 v[184:187], v237 offset:37888
    v_mfma_f32_16x16x32_bf16 a[120:123], a[240:243], v[156:159], a[120:123]
    ds_read_b128 v[188:191], v237 offset:38912
    v_mfma_f32_16x16x32_bf16 a[124:127], a[240:243], v[160:163], a[124:127]
    ds_read_b128 v[192:195], v237 offset:39936
    s_branch a2_merge1
a2_rf1_w2:
    s_waitcnt vmcnt(0) lgkmcnt(0)
    s_barrier
    ds_read_b128 v[164:167], v237 offset:32768
    ds_read_b128 v[168:171], v237 offset:33792
    ds_read_b128 v[172:175], v237 offset:34816
    ds_read_b128 v[176:179], v237 offset:35840
    ds_read_b128 v[180:183], v237 offset:36864
    ds_read_b128 v[184:187], v237 offset:37888
    ds_read_b128 v[188:191], v237 offset:38912
    ds_read_b128 v[192:195], v237 offset:39936
    s_branch a2_merge1
a2_merge0:
    s_mov_b64 exec, 1
    buffer_store_dword v243, v236, s[36:39], s72 offen sc1
    s_mov_b64 exec, -1
    s_brev_b32 s72, 1
    s_mov_b32 s28, s60
    s_mov_b32 s29, s61
    s_mov_b32 s30, s62
    buffer_load_dword v249, v248, s[28:31], 0 offen
    s_mov_b32 s60, s63
    s_mov_b32 s61, s64
    s_mov_b32 s62, s65
    s_mov_b32 s65, 0
    v_lshlrev_b32 v244, 2, v236
    s_bfe_u32 s3, s2, 0x10002
    s_lshl_b32 s3, s3, 2
    s_bfe_u32 s6, s2, 0x20004
    s_add_u32 s3, s3, s6
    s_lshl_b32 s3, s3, 7
    s_add_u32 s3, s3, 2048
    buffer_load_dword v249, v244, s[36:39], s3 offen sc1
    s_lshl_b32 s3, s50, 14
    s_add_u32 s6, s3, 65536
    s_add_u32 s7, s3, 32768
    s_cmp_eq_u32 s51, 0
    s_cselect_b32 s3, s6, s7
    s_cselect_b32 s6, s7, s6
    v_add_u32 v246, s3, v240
    v_add_u32 v247, s6, v240
    s_cbranch_scc0 a2_send1_0
    ds_write_b128 v246, a[64:67] offset:0
    ds_write_b128 v246, a[68:71] offset:1024
    ds_write_b128 v246, a[72:75] offset:2048
    ds_write_b128 v246, a[76:79] offset:3072
    ds_write_b128 v246, a[80:83] offset:4096
    ds_write_b128 v246, a[84:87] offset:5120
    ds_write_b128 v246, a[88:91] offset:6144
    ds_write_b128 v246, a[92:95] offset:7168
    ds_write_b128 v246, a[96:99] offset:8192
    ds_write_b128 v246, a[100:103] offset:9216
    ds_write_b128 v246, a[104:107] offset:10240
    ds_write_b128 v246, a[108:111] offset:11264
    ds_write_b128 v246, a[112:115] offset:12288
    ds_write_b128 v246, a[116:119] offset:13312
    ds_write_b128 v246, a[120:123] offset:14336
    ds_write_b128 v246, a[124:127] offset:15360
    s_branch a2_sent_0
a2_send1_0:
    ds_write_b128 v246, a[0:3] offset:0
    ds_write_b128 v246, a[4:7] offset:1024
    ds_write_b128 v246, a[8:11] offset:2048
    ds_write_b128 v246, a[12:15] offset:3072
    ds_write_b128 v246, a[16:19] offset:4096
    ds_write_b128 v246, a[20:23] offset:5120
    ds_write_b128 v246, a[24:27] offset:6144
    ds_write_b128 v246, a[28:31] offset:7168
    ds_write_b128 v246, a[32:35] offset:8192
    ds_write_b128 v246, a[36:39] offset:9216
    ds_write_b128 v246, a[40:43] offset:10240
    ds_write_b128 v246, a[44:47] offset:11264
    ds_write_b128 v246, a[48:51] offset:12288
    ds_write_b128 v246, a[52:55] offset:13312
    ds_write_b128 v246, a[56:59] offset:14336
    ds_write_b128 v246, a[60:63] offset:15360
a2_sent_0:
    v_accvgpr_read_b32 v232, a128
    v_accvgpr_read_b32 v233, a132
    v_accvgpr_read_b32 v234, a136
    v_accvgpr_read_b32 v235, a140
    s_lshl_b32 s3, s101, 11
    s_add_u32 s3, s3, 131072
    v_add_u32 v246, s3, v240
    ds_write_b128 v246, v[228:231]
    ds_write_b128 v246, v[232:235] offset:1024
    v_xor_b32 v246, 0x1000, v246
    s_waitcnt lgkmcnt(0)
    s_barrier
    ds_read_b128 v[212:215], v246
    ds_read_b128 v[216:219], v246 offset:1024
    ds_read_b128 v[4:7], v247 offset:0
    ds_read_b128 v[8:11], v247 offset:1024
    ds_read_b128 v[12:15], v247 offset:2048
    ds_read_b128 v[16:19], v247 offset:3072
    ds_read_b128 v[20:23], v247 offset:4096
    ds_read_b128 v[24:27], v247 offset:5120
    ds_read_b128 v[28:31], v247 offset:6144
    ds_read_b128 v[32:35], v247 offset:7168
    ds_read_b128 v[36:39], v247 offset:8192
    ds_read_b128 v[40:43], v247 offset:9216
    ds_read_b128 v[44:47], v247 offset:10240
    ds_read_b128 v[48:51], v247 offset:11264
    ds_read_b128 v[52:55], v247 offset:12288
    ds_read_b128 v[56:59], v247 offset:13312
    ds_read_b128 v[60:63], v247 offset:14336
    ds_read_b128 v[64:67], v247 offset:15360
    s_lshl_b32 s3, s54, 3
    s_lshl_b32 s6, s50, 2
    s_add_u32 s3, s3, s6
    s_mul_i32 s3, s3, 245760
    s_lshl_b32 s6, s52, 12
    s_add_u32 s3, s3, s6
    s_lshl_b32 s6, s51, 11
    s_add_u32 s3, s3, s6
    s_add_u32 s3, s3, 114688
    v_add_u32 v245, s3, v240
    s_waitcnt lgkmcnt(15)
    s_waitcnt lgkmcnt(0)
    s_barrier
    s_cmp_lg_u32 s71, 0
    s_cbranch_scc1 a2_ng0
    s_waitcnt vmcnt(0)
    v_cmp_eq_u32 vcc, 0, v249
    s_cmp_eq_u32 vcc_lo, 0
    s_cselect_b32 s100, 1, 0
    s_cbranch_scc0 a2_ng0
    s_bfe_u32 s3, s2, 0x10002
    s_lshl_b32 s3, s3, 3
    s_bfe_u32 s4, s2, 0x30003
    s_add_u32 s3, s3, s4
    s_bfe_u32 s5, s2, 0x10001
    s_lshl_b32 s5, s5, 2
    s_lshr_b32 s6, s2, 6
    s_add_u32 s5, s5, s6
    s_lshl_b32 s3, s3, 3
    s_lshl_b32 s6, s6, 1
    s_add_u32 s3, s3, s6
    s_lshr_b32 s6, s101, 1
    s_add_u32 s3, s3, s6
    s_mul_i32 s3, s3, 245760
    s_and_b32 s7, s2, 1
    s_mul_i32 s6, s7, 65536
    s_add_u32 s3, s3, s6
    s_and_b32 s6, s101, 1
    s_lshl_b32 s6, s6, 12
    s_add_u32 s3, s3, s6
    v_lshlrev_b32 v244, 7, v236
    s_mov_b32 exec_hi, 0
    buffer_load_dword v249, v244, s[24:27], s3 offen
    s_mov_b32 s28, s10
    s_mov_b32 s29, s11
    s_mov_b32 s30, 7340032
    s_mov_b32 s31, 0x20000
    s_mul_i32 s3, s7, 2048
    s_lshl_b32 s6, s101, 6
    s_add_u32 s3, s3, s6
    s_lshl_b32 s4, s4, 3
    s_add_u32 s3, s3, s4
    s_lshl_b32 s3, s3, 11
    s_lshl_b32 s5, s5, 8
    s_add_u32 s3, s3, s5
    v_lshrrev_b32 v244, 1, v236
    v_lshlrev_b32 v244, 11, v244
    s_mov_b32 exec_lo, 0x5555
    buffer_load_dword v249, v244, s[28:31], s3 offen
    buffer_load_dword v249, v244, s[28:31], s3 offen offset:128
    s_mov_b64 exec, -1
a2_ng0:
    v_max_f32 v220, v228, v212
    v_max_f32 v221, v229, v213
    v_max_f32 v222, v230, v214
    v_max_f32 v223, v231, v215
    v_sub_f32 v196, v228, v220
    v_sub_f32 v197, v229, v221
    v_sub_f32 v198, v230, v222
    v_sub_f32 v199, v231, v223
    v_sub_f32 v200, v212, v220
    v_sub_f32 v201, v213, v221
    v_sub_f32 v202, v214, v222
    v_sub_f32 v203, v215, v223
    v_exp_f32 v196, v196
    v_exp_f32 v197, v197
    v_exp_f32 v198, v198
    v_exp_f32 v199, v199
    v_exp_f32 v200, v200
    v_exp_f32 v201, v201
    v_exp_f32 v202, v202
    v_exp_f32 v203, v203
    v_mul_f32 v220, v232, v196
    v_mul_f32 v221, v233, v197
    v_mul_f32 v222, v234, v198
    v_mul_f32 v223, v235, v199
    v_fmac_f32 v220, v216, v200
    v_fmac_f32 v221, v217, v201
    v_fmac_f32 v222, v218, v202
    v_fmac_f32 v223, v219, v203
    v_rcp_f32 v220, v220
    v_rcp_f32 v221, v221
    v_rcp_f32 v222, v222
    v_rcp_f32 v223, v223
    s_nop 0
    v_mul_f32 v196, v196, v220
    v_mul_f32 v197, v197, v221
    v_mul_f32 v198, v198, v222
    v_mul_f32 v199, v199, v223
    v_mul_f32 v200, v200, v220
    v_mul_f32 v201, v201, v221
    v_mul_f32 v202, v202, v222
    v_mul_f32 v203, v203, v223
    s_cmp_eq_u32 s51, 0
    s_cbranch_scc0 a2_fin1_0
    s_mov_b32 s3, 0
    v_accvgpr_read_b32 v136, a0
    v_accvgpr_read_b32 v137, a1
    v_accvgpr_read_b32 v138, a2
    v_accvgpr_read_b32 v139, a3
    v_accvgpr_read_b32 v140, a16
    v_accvgpr_read_b32 v141, a17
    v_accvgpr_read_b32 v142, a18
    v_accvgpr_read_b32 v143, a19
    v_pk_mul_f32 v[136:137], v[136:137], v[196:197] op_sel:[0,0] op_sel_hi:[1,0]
    v_pk_mul_f32 v[138:139], v[138:139], v[196:197] op_sel:[0,0] op_sel_hi:[1,0]
    v_pk_mul_f32 v[140:141], v[140:141], v[196:197] op_sel:[0,0] op_sel_hi:[1,0]
    v_pk_mul_f32 v[142:143], v[142:143], v[196:197] op_sel:[0,0] op_sel_hi:[1,0]
    v_pk_fma_f32 v[136:137], v[4:5], v[200:201], v[136:137] op_sel:[0,0,0] op_sel_hi:[1,0,1]
    v_pk_fma_f32 v[138:139], v[6:7], v[200:201], v[138:139] op_sel:[0,0,0] op_sel_hi:[1,0,1]
    v_pk_fma_f32 v[140:141], v[20:21], v[200:201], v[140:141] op_sel:[0,0,0] op_sel_hi:[1,0,1]
    v_pk_fma_f32 v[142:143], v[22:23], v[200:201], v[142:143] op_sel:[0,0,0] op_sel_hi:[1,0,1]
    v_cvt_pk_bf16_f32 v132, v136, v137
    v_cvt_pk_bf16_f32 v133, v138, v139
    v_cvt_pk_bf16_f32 v134, v140, v141
    v_cvt_pk_bf16_f32 v135, v142, v143
    buffer_store_dwordx4 v[132:135], v245, s[24:27], s3 offen offset:0 sc1
    v_accvgpr_read_b32 v148, a32
    v_accvgpr_read_b32 v149, a33
    v_accvgpr_read_b32 v150, a34
    v_accvgpr_read_b32 v151, a35
    v_accvgpr_read_b32 v152, a48
    v_accvgpr_read_b32 v153, a49
    v_accvgpr_read_b32 v154, a50
    v_accvgpr_read_b32 v155, a51
    v_pk_mul_f32 v[148:149], v[148:149], v[196:197] op_sel:[0,0] op_sel_hi:[1,0]
    v_pk_mul_f32 v[150:151], v[150:151], v[196:197] op_sel:[0,0] op_sel_hi:[1,0]
    v_pk_mul_f32 v[152:153], v[152:153], v[196:197] op_sel:[0,0] op_sel_hi:[1,0]
    v_pk_mul_f32 v[154:155], v[154:155], v[196:197] op_sel:[0,0] op_sel_hi:[1,0]
    v_pk_fma_f32 v[148:149], v[36:37], v[200:201], v[148:149] op_sel:[0,0,0] op_sel_hi:[1,0,1]
    v_pk_fma_f32 v[150:151], v[38:39], v[200:201], v[150:151] op_sel:[0,0,0] op_sel_hi:[1,0,1]
    v_pk_fma_f32 v[152:153], v[52:53], v[200:201], v[152:153] op_sel:[0,0,0] op_sel_hi:[1,0,1]
    v_pk_fma_f32 v[154:155], v[54:55], v[200:201], v[154:155] op_sel:[0,0,0] op_sel_hi:[1,0,1]
    v_cvt_pk_bf16_f32 v144, v148, v149
    v_cvt_pk_bf16_f32 v145, v150, v151
    v_cvt_pk_bf16_f32 v146, v152, v153
    v_cvt_pk_bf16_f32 v147, v154, v155
    buffer_store_dwordx4 v[144:147], v245, s[24:27], s3 offen offset:1024 sc1
    s_mov_b32 s3, 245760
    v_accvgpr_read_b32 v136, a4
    v_accvgpr_read_b32 v137, a5
    v_accvgpr_read_b32 v138, a6
    v_accvgpr_read_b32 v139, a7
    v_accvgpr_read_b32 v140, a20
    v_accvgpr_read_b32 v141, a21
    v_accvgpr_read_b32 v142, a22
    v_accvgpr_read_b32 v143, a23
    v_pk_mul_f32 v[136:137], v[136:137], v[196:197] op_sel:[0,1] op_sel_hi:[1,1]
    v_pk_mul_f32 v[138:139], v[138:139], v[196:197] op_sel:[0,1] op_sel_hi:[1,1]
    v_pk_mul_f32 v[140:141], v[140:141], v[196:197] op_sel:[0,1] op_sel_hi:[1,1]
    v_pk_mul_f32 v[142:143], v[142:143], v[196:197] op_sel:[0,1] op_sel_hi:[1,1]
    v_pk_fma_f32 v[136:137], v[8:9], v[200:201], v[136:137] op_sel:[0,1,0] op_sel_hi:[1,1,1]
    v_pk_fma_f32 v[138:139], v[10:11], v[200:201], v[138:139] op_sel:[0,1,0] op_sel_hi:[1,1,1]
    v_pk_fma_f32 v[140:141], v[24:25], v[200:201], v[140:141] op_sel:[0,1,0] op_sel_hi:[1,1,1]
    v_pk_fma_f32 v[142:143], v[26:27], v[200:201], v[142:143] op_sel:[0,1,0] op_sel_hi:[1,1,1]
    v_cvt_pk_bf16_f32 v132, v136, v137
    v_cvt_pk_bf16_f32 v133, v138, v139
    v_cvt_pk_bf16_f32 v134, v140, v141
    v_cvt_pk_bf16_f32 v135, v142, v143
    buffer_store_dwordx4 v[132:135], v245, s[24:27], s3 offen offset:0 sc1
    v_accvgpr_read_b32 v148, a36
    v_accvgpr_read_b32 v149, a37
    v_accvgpr_read_b32 v150, a38
    v_accvgpr_read_b32 v151, a39
    v_accvgpr_read_b32 v152, a52
    v_accvgpr_read_b32 v153, a53
    v_accvgpr_read_b32 v154, a54
    v_accvgpr_read_b32 v155, a55
    v_pk_mul_f32 v[148:149], v[148:149], v[196:197] op_sel:[0,1] op_sel_hi:[1,1]
    v_pk_mul_f32 v[150:151], v[150:151], v[196:197] op_sel:[0,1] op_sel_hi:[1,1]
    v_pk_mul_f32 v[152:153], v[152:153], v[196:197] op_sel:[0,1] op_sel_hi:[1,1]
    v_pk_mul_f32 v[154:155], v[154:155], v[196:197] op_sel:[0,1] op_sel_hi:[1,1]
    v_pk_fma_f32 v[148:149], v[40:41], v[200:201], v[148:149] op_sel:[0,1,0] op_sel_hi:[1,1,1]
    v_pk_fma_f32 v[150:151], v[42:43], v[200:201], v[150:151] op_sel:[0,1,0] op_sel_hi:[1,1,1]
    v_pk_fma_f32 v[152:153], v[56:57], v[200:201], v[152:153] op_sel:[0,1,0] op_sel_hi:[1,1,1]
    v_pk_fma_f32 v[154:155], v[58:59], v[200:201], v[154:155] op_sel:[0,1,0] op_sel_hi:[1,1,1]
    v_cvt_pk_bf16_f32 v144, v148, v149
    v_cvt_pk_bf16_f32 v145, v150, v151
    v_cvt_pk_bf16_f32 v146, v152, v153
    v_cvt_pk_bf16_f32 v147, v154, v155
    buffer_store_dwordx4 v[144:147], v245, s[24:27], s3 offen offset:1024 sc1
    s_mov_b32 s3, 491520
    v_accvgpr_read_b32 v136, a8
    v_accvgpr_read_b32 v137, a9
    v_accvgpr_read_b32 v138, a10
    v_accvgpr_read_b32 v139, a11
    v_accvgpr_read_b32 v140, a24
    v_accvgpr_read_b32 v141, a25
    v_accvgpr_read_b32 v142, a26
    v_accvgpr_read_b32 v143, a27
    v_pk_mul_f32 v[136:137], v[136:137], v[198:199] op_sel:[0,0] op_sel_hi:[1,0]
    v_pk_mul_f32 v[138:139], v[138:139], v[198:199] op_sel:[0,0] op_sel_hi:[1,0]
    v_pk_mul_f32 v[140:141], v[140:141], v[198:199] op_sel:[0,0] op_sel_hi:[1,0]
    v_pk_mul_f32 v[142:143], v[142:143], v[198:199] op_sel:[0,0] op_sel_hi:[1,0]
    v_pk_fma_f32 v[136:137], v[12:13], v[202:203], v[136:137] op_sel:[0,0,0] op_sel_hi:[1,0,1]
    v_pk_fma_f32 v[138:139], v[14:15], v[202:203], v[138:139] op_sel:[0,0,0] op_sel_hi:[1,0,1]
    v_pk_fma_f32 v[140:141], v[28:29], v[202:203], v[140:141] op_sel:[0,0,0] op_sel_hi:[1,0,1]
    v_pk_fma_f32 v[142:143], v[30:31], v[202:203], v[142:143] op_sel:[0,0,0] op_sel_hi:[1,0,1]
    v_cvt_pk_bf16_f32 v132, v136, v137
    v_cvt_pk_bf16_f32 v133, v138, v139
    v_cvt_pk_bf16_f32 v134, v140, v141
    v_cvt_pk_bf16_f32 v135, v142, v143
    buffer_store_dwordx4 v[132:135], v245, s[24:27], s3 offen offset:0 sc1
    v_accvgpr_read_b32 v148, a40
    v_accvgpr_read_b32 v149, a41
    v_accvgpr_read_b32 v150, a42
    v_accvgpr_read_b32 v151, a43
    v_accvgpr_read_b32 v152, a56
    v_accvgpr_read_b32 v153, a57
    v_accvgpr_read_b32 v154, a58
    v_accvgpr_read_b32 v155, a59
    v_pk_mul_f32 v[148:149], v[148:149], v[198:199] op_sel:[0,0] op_sel_hi:[1,0]
    v_pk_mul_f32 v[150:151], v[150:151], v[198:199] op_sel:[0,0] op_sel_hi:[1,0]
    v_pk_mul_f32 v[152:153], v[152:153], v[198:199] op_sel:[0,0] op_sel_hi:[1,0]
    v_pk_mul_f32 v[154:155], v[154:155], v[198:199] op_sel:[0,0] op_sel_hi:[1,0]
    v_pk_fma_f32 v[148:149], v[44:45], v[202:203], v[148:149] op_sel:[0,0,0] op_sel_hi:[1,0,1]
    v_pk_fma_f32 v[150:151], v[46:47], v[202:203], v[150:151] op_sel:[0,0,0] op_sel_hi:[1,0,1]
    v_pk_fma_f32 v[152:153], v[60:61], v[202:203], v[152:153] op_sel:[0,0,0] op_sel_hi:[1,0,1]
    v_pk_fma_f32 v[154:155], v[62:63], v[202:203], v[154:155] op_sel:[0,0,0] op_sel_hi:[1,0,1]
    v_cvt_pk_bf16_f32 v144, v148, v149
    v_cvt_pk_bf16_f32 v145, v150, v151
    v_cvt_pk_bf16_f32 v146, v152, v153
    v_cvt_pk_bf16_f32 v147, v154, v155
    buffer_store_dwordx4 v[144:147], v245, s[24:27], s3 offen offset:1024 sc1
    s_mov_b32 s3, 737280
    v_accvgpr_read_b32 v136, a12
    v_accvgpr_read_b32 v137, a13
    v_accvgpr_read_b32 v138, a14
    v_accvgpr_read_b32 v139, a15
    v_accvgpr_read_b32 v140, a28
    v_accvgpr_read_b32 v141, a29
    v_accvgpr_read_b32 v142, a30
    v_accvgpr_read_b32 v143, a31
    v_pk_mul_f32 v[136:137], v[136:137], v[198:199] op_sel:[0,1] op_sel_hi:[1,1]
    v_pk_mul_f32 v[138:139], v[138:139], v[198:199] op_sel:[0,1] op_sel_hi:[1,1]
    v_pk_mul_f32 v[140:141], v[140:141], v[198:199] op_sel:[0,1] op_sel_hi:[1,1]
    v_pk_mul_f32 v[142:143], v[142:143], v[198:199] op_sel:[0,1] op_sel_hi:[1,1]
    v_pk_fma_f32 v[136:137], v[16:17], v[202:203], v[136:137] op_sel:[0,1,0] op_sel_hi:[1,1,1]
    v_pk_fma_f32 v[138:139], v[18:19], v[202:203], v[138:139] op_sel:[0,1,0] op_sel_hi:[1,1,1]
    v_pk_fma_f32 v[140:141], v[32:33], v[202:203], v[140:141] op_sel:[0,1,0] op_sel_hi:[1,1,1]
    v_pk_fma_f32 v[142:143], v[34:35], v[202:203], v[142:143] op_sel:[0,1,0] op_sel_hi:[1,1,1]
    v_cvt_pk_bf16_f32 v132, v136, v137
    v_cvt_pk_bf16_f32 v133, v138, v139
    v_cvt_pk_bf16_f32 v134, v140, v141
    v_cvt_pk_bf16_f32 v135, v142, v143
    buffer_store_dwordx4 v[132:135], v245, s[24:27], s3 offen offset:0 sc1
    v_accvgpr_read_b32 v148, a44
    v_accvgpr_read_b32 v149, a45
    v_accvgpr_read_b32 v150, a46
    v_accvgpr_read_b32 v151, a47
    v_accvgpr_read_b32 v152, a60
    v_accvgpr_read_b32 v153, a61
    v_accvgpr_read_b32 v154, a62
    v_accvgpr_read_b32 v155, a63
    v_pk_mul_f32 v[148:149], v[148:149], v[198:199] op_sel:[0,1] op_sel_hi:[1,1]
    v_pk_mul_f32 v[150:151], v[150:151], v[198:199] op_sel:[0,1] op_sel_hi:[1,1]
    v_pk_mul_f32 v[152:153], v[152:153], v[198:199] op_sel:[0,1] op_sel_hi:[1,1]
    v_pk_mul_f32 v[154:155], v[154:155], v[198:199] op_sel:[0,1] op_sel_hi:[1,1]
    v_pk_fma_f32 v[148:149], v[48:49], v[202:203], v[148:149] op_sel:[0,1,0] op_sel_hi:[1,1,1]
    v_pk_fma_f32 v[150:151], v[50:51], v[202:203], v[150:151] op_sel:[0,1,0] op_sel_hi:[1,1,1]
    v_pk_fma_f32 v[152:153], v[64:65], v[202:203], v[152:153] op_sel:[0,1,0] op_sel_hi:[1,1,1]
    v_pk_fma_f32 v[154:155], v[66:67], v[202:203], v[154:155] op_sel:[0,1,0] op_sel_hi:[1,1,1]
    v_cvt_pk_bf16_f32 v144, v148, v149
    v_cvt_pk_bf16_f32 v145, v150, v151
    v_cvt_pk_bf16_f32 v146, v152, v153
    v_cvt_pk_bf16_f32 v147, v154, v155
    buffer_store_dwordx4 v[144:147], v245, s[24:27], s3 offen offset:1024 sc1
    s_branch a2_fin_0
a2_fin1_0:
    s_mov_b32 s3, 0
    v_accvgpr_read_b32 v136, a64
    v_accvgpr_read_b32 v137, a65
    v_accvgpr_read_b32 v138, a66
    v_accvgpr_read_b32 v139, a67
    v_accvgpr_read_b32 v140, a80
    v_accvgpr_read_b32 v141, a81
    v_accvgpr_read_b32 v142, a82
    v_accvgpr_read_b32 v143, a83
    v_pk_mul_f32 v[136:137], v[136:137], v[196:197] op_sel:[0,0] op_sel_hi:[1,0]
    v_pk_mul_f32 v[138:139], v[138:139], v[196:197] op_sel:[0,0] op_sel_hi:[1,0]
    v_pk_mul_f32 v[140:141], v[140:141], v[196:197] op_sel:[0,0] op_sel_hi:[1,0]
    v_pk_mul_f32 v[142:143], v[142:143], v[196:197] op_sel:[0,0] op_sel_hi:[1,0]
    v_pk_fma_f32 v[136:137], v[4:5], v[200:201], v[136:137] op_sel:[0,0,0] op_sel_hi:[1,0,1]
    v_pk_fma_f32 v[138:139], v[6:7], v[200:201], v[138:139] op_sel:[0,0,0] op_sel_hi:[1,0,1]
    v_pk_fma_f32 v[140:141], v[20:21], v[200:201], v[140:141] op_sel:[0,0,0] op_sel_hi:[1,0,1]
    v_pk_fma_f32 v[142:143], v[22:23], v[200:201], v[142:143] op_sel:[0,0,0] op_sel_hi:[1,0,1]
    v_cvt_pk_bf16_f32 v132, v136, v137
    v_cvt_pk_bf16_f32 v133, v138, v139
    v_cvt_pk_bf16_f32 v134, v140, v141
    v_cvt_pk_bf16_f32 v135, v142, v143
    buffer_store_dwordx4 v[132:135], v245, s[24:27], s3 offen offset:0 sc1
    v_accvgpr_read_b32 v148, a96
    v_accvgpr_read_b32 v149, a97
    v_accvgpr_read_b32 v150, a98
    v_accvgpr_read_b32 v151, a99
    v_accvgpr_read_b32 v152, a112
    v_accvgpr_read_b32 v153, a113
    v_accvgpr_read_b32 v154, a114
    v_accvgpr_read_b32 v155, a115
    v_pk_mul_f32 v[148:149], v[148:149], v[196:197] op_sel:[0,0] op_sel_hi:[1,0]
    v_pk_mul_f32 v[150:151], v[150:151], v[196:197] op_sel:[0,0] op_sel_hi:[1,0]
    v_pk_mul_f32 v[152:153], v[152:153], v[196:197] op_sel:[0,0] op_sel_hi:[1,0]
    v_pk_mul_f32 v[154:155], v[154:155], v[196:197] op_sel:[0,0] op_sel_hi:[1,0]
    v_pk_fma_f32 v[148:149], v[36:37], v[200:201], v[148:149] op_sel:[0,0,0] op_sel_hi:[1,0,1]
    v_pk_fma_f32 v[150:151], v[38:39], v[200:201], v[150:151] op_sel:[0,0,0] op_sel_hi:[1,0,1]
    v_pk_fma_f32 v[152:153], v[52:53], v[200:201], v[152:153] op_sel:[0,0,0] op_sel_hi:[1,0,1]
    v_pk_fma_f32 v[154:155], v[54:55], v[200:201], v[154:155] op_sel:[0,0,0] op_sel_hi:[1,0,1]
    v_cvt_pk_bf16_f32 v144, v148, v149
    v_cvt_pk_bf16_f32 v145, v150, v151
    v_cvt_pk_bf16_f32 v146, v152, v153
    v_cvt_pk_bf16_f32 v147, v154, v155
    buffer_store_dwordx4 v[144:147], v245, s[24:27], s3 offen offset:1024 sc1
    s_mov_b32 s3, 245760
    v_accvgpr_read_b32 v136, a68
    v_accvgpr_read_b32 v137, a69
    v_accvgpr_read_b32 v138, a70
    v_accvgpr_read_b32 v139, a71
    v_accvgpr_read_b32 v140, a84
    v_accvgpr_read_b32 v141, a85
    v_accvgpr_read_b32 v142, a86
    v_accvgpr_read_b32 v143, a87
    v_pk_mul_f32 v[136:137], v[136:137], v[196:197] op_sel:[0,1] op_sel_hi:[1,1]
    v_pk_mul_f32 v[138:139], v[138:139], v[196:197] op_sel:[0,1] op_sel_hi:[1,1]
    v_pk_mul_f32 v[140:141], v[140:141], v[196:197] op_sel:[0,1] op_sel_hi:[1,1]
    v_pk_mul_f32 v[142:143], v[142:143], v[196:197] op_sel:[0,1] op_sel_hi:[1,1]
    v_pk_fma_f32 v[136:137], v[8:9], v[200:201], v[136:137] op_sel:[0,1,0] op_sel_hi:[1,1,1]
    v_pk_fma_f32 v[138:139], v[10:11], v[200:201], v[138:139] op_sel:[0,1,0] op_sel_hi:[1,1,1]
    v_pk_fma_f32 v[140:141], v[24:25], v[200:201], v[140:141] op_sel:[0,1,0] op_sel_hi:[1,1,1]
    v_pk_fma_f32 v[142:143], v[26:27], v[200:201], v[142:143] op_sel:[0,1,0] op_sel_hi:[1,1,1]
    v_cvt_pk_bf16_f32 v132, v136, v137
    v_cvt_pk_bf16_f32 v133, v138, v139
    v_cvt_pk_bf16_f32 v134, v140, v141
    v_cvt_pk_bf16_f32 v135, v142, v143
    buffer_store_dwordx4 v[132:135], v245, s[24:27], s3 offen offset:0 sc1
    v_accvgpr_read_b32 v148, a100
    v_accvgpr_read_b32 v149, a101
    v_accvgpr_read_b32 v150, a102
    v_accvgpr_read_b32 v151, a103
    v_accvgpr_read_b32 v152, a116
    v_accvgpr_read_b32 v153, a117
    v_accvgpr_read_b32 v154, a118
    v_accvgpr_read_b32 v155, a119
    v_pk_mul_f32 v[148:149], v[148:149], v[196:197] op_sel:[0,1] op_sel_hi:[1,1]
    v_pk_mul_f32 v[150:151], v[150:151], v[196:197] op_sel:[0,1] op_sel_hi:[1,1]
    v_pk_mul_f32 v[152:153], v[152:153], v[196:197] op_sel:[0,1] op_sel_hi:[1,1]
    v_pk_mul_f32 v[154:155], v[154:155], v[196:197] op_sel:[0,1] op_sel_hi:[1,1]
    v_pk_fma_f32 v[148:149], v[40:41], v[200:201], v[148:149] op_sel:[0,1,0] op_sel_hi:[1,1,1]
    v_pk_fma_f32 v[150:151], v[42:43], v[200:201], v[150:151] op_sel:[0,1,0] op_sel_hi:[1,1,1]
    v_pk_fma_f32 v[152:153], v[56:57], v[200:201], v[152:153] op_sel:[0,1,0] op_sel_hi:[1,1,1]
    v_pk_fma_f32 v[154:155], v[58:59], v[200:201], v[154:155] op_sel:[0,1,0] op_sel_hi:[1,1,1]
    v_cvt_pk_bf16_f32 v144, v148, v149
    v_cvt_pk_bf16_f32 v145, v150, v151
    v_cvt_pk_bf16_f32 v146, v152, v153
    v_cvt_pk_bf16_f32 v147, v154, v155
    buffer_store_dwordx4 v[144:147], v245, s[24:27], s3 offen offset:1024 sc1
    s_mov_b32 s3, 491520
    v_accvgpr_read_b32 v136, a72
    v_accvgpr_read_b32 v137, a73
    v_accvgpr_read_b32 v138, a74
    v_accvgpr_read_b32 v139, a75
    v_accvgpr_read_b32 v140, a88
    v_accvgpr_read_b32 v141, a89
    v_accvgpr_read_b32 v142, a90
    v_accvgpr_read_b32 v143, a91
    v_pk_mul_f32 v[136:137], v[136:137], v[198:199] op_sel:[0,0] op_sel_hi:[1,0]
    v_pk_mul_f32 v[138:139], v[138:139], v[198:199] op_sel:[0,0] op_sel_hi:[1,0]
    v_pk_mul_f32 v[140:141], v[140:141], v[198:199] op_sel:[0,0] op_sel_hi:[1,0]
    v_pk_mul_f32 v[142:143], v[142:143], v[198:199] op_sel:[0,0] op_sel_hi:[1,0]
    v_pk_fma_f32 v[136:137], v[12:13], v[202:203], v[136:137] op_sel:[0,0,0] op_sel_hi:[1,0,1]
    v_pk_fma_f32 v[138:139], v[14:15], v[202:203], v[138:139] op_sel:[0,0,0] op_sel_hi:[1,0,1]
    v_pk_fma_f32 v[140:141], v[28:29], v[202:203], v[140:141] op_sel:[0,0,0] op_sel_hi:[1,0,1]
    v_pk_fma_f32 v[142:143], v[30:31], v[202:203], v[142:143] op_sel:[0,0,0] op_sel_hi:[1,0,1]
    v_cvt_pk_bf16_f32 v132, v136, v137
    v_cvt_pk_bf16_f32 v133, v138, v139
    v_cvt_pk_bf16_f32 v134, v140, v141
    v_cvt_pk_bf16_f32 v135, v142, v143
    buffer_store_dwordx4 v[132:135], v245, s[24:27], s3 offen offset:0 sc1
    v_accvgpr_read_b32 v148, a104
    v_accvgpr_read_b32 v149, a105
    v_accvgpr_read_b32 v150, a106
    v_accvgpr_read_b32 v151, a107
    v_accvgpr_read_b32 v152, a120
    v_accvgpr_read_b32 v153, a121
    v_accvgpr_read_b32 v154, a122
    v_accvgpr_read_b32 v155, a123
    v_pk_mul_f32 v[148:149], v[148:149], v[198:199] op_sel:[0,0] op_sel_hi:[1,0]
    v_pk_mul_f32 v[150:151], v[150:151], v[198:199] op_sel:[0,0] op_sel_hi:[1,0]
    v_pk_mul_f32 v[152:153], v[152:153], v[198:199] op_sel:[0,0] op_sel_hi:[1,0]
    v_pk_mul_f32 v[154:155], v[154:155], v[198:199] op_sel:[0,0] op_sel_hi:[1,0]
    v_pk_fma_f32 v[148:149], v[44:45], v[202:203], v[148:149] op_sel:[0,0,0] op_sel_hi:[1,0,1]
    v_pk_fma_f32 v[150:151], v[46:47], v[202:203], v[150:151] op_sel:[0,0,0] op_sel_hi:[1,0,1]
    v_pk_fma_f32 v[152:153], v[60:61], v[202:203], v[152:153] op_sel:[0,0,0] op_sel_hi:[1,0,1]
    v_pk_fma_f32 v[154:155], v[62:63], v[202:203], v[154:155] op_sel:[0,0,0] op_sel_hi:[1,0,1]
    v_cvt_pk_bf16_f32 v144, v148, v149
    v_cvt_pk_bf16_f32 v145, v150, v151
    v_cvt_pk_bf16_f32 v146, v152, v153
    v_cvt_pk_bf16_f32 v147, v154, v155
    buffer_store_dwordx4 v[144:147], v245, s[24:27], s3 offen offset:1024 sc1
    s_mov_b32 s3, 737280
    v_accvgpr_read_b32 v136, a76
    v_accvgpr_read_b32 v137, a77
    v_accvgpr_read_b32 v138, a78
    v_accvgpr_read_b32 v139, a79
    v_accvgpr_read_b32 v140, a92
    v_accvgpr_read_b32 v141, a93
    v_accvgpr_read_b32 v142, a94
    v_accvgpr_read_b32 v143, a95
    v_pk_mul_f32 v[136:137], v[136:137], v[198:199] op_sel:[0,1] op_sel_hi:[1,1]
    v_pk_mul_f32 v[138:139], v[138:139], v[198:199] op_sel:[0,1] op_sel_hi:[1,1]
    v_pk_mul_f32 v[140:141], v[140:141], v[198:199] op_sel:[0,1] op_sel_hi:[1,1]
    v_pk_mul_f32 v[142:143], v[142:143], v[198:199] op_sel:[0,1] op_sel_hi:[1,1]
    v_pk_fma_f32 v[136:137], v[16:17], v[202:203], v[136:137] op_sel:[0,1,0] op_sel_hi:[1,1,1]
    v_pk_fma_f32 v[138:139], v[18:19], v[202:203], v[138:139] op_sel:[0,1,0] op_sel_hi:[1,1,1]
    v_pk_fma_f32 v[140:141], v[32:33], v[202:203], v[140:141] op_sel:[0,1,0] op_sel_hi:[1,1,1]
    v_pk_fma_f32 v[142:143], v[34:35], v[202:203], v[142:143] op_sel:[0,1,0] op_sel_hi:[1,1,1]
    v_cvt_pk_bf16_f32 v132, v136, v137
    v_cvt_pk_bf16_f32 v133, v138, v139
    v_cvt_pk_bf16_f32 v134, v140, v141
    v_cvt_pk_bf16_f32 v135, v142, v143
    buffer_store_dwordx4 v[132:135], v245, s[24:27], s3 offen offset:0 sc1
    v_accvgpr_read_b32 v148, a108
    v_accvgpr_read_b32 v149, a109
    v_accvgpr_read_b32 v150, a110
    v_accvgpr_read_b32 v151, a111
    v_accvgpr_read_b32 v152, a124
    v_accvgpr_read_b32 v153, a125
    v_accvgpr_read_b32 v154, a126
    v_accvgpr_read_b32 v155, a127
    v_pk_mul_f32 v[148:149], v[148:149], v[198:199] op_sel:[0,1] op_sel_hi:[1,1]
    v_pk_mul_f32 v[150:151], v[150:151], v[198:199] op_sel:[0,1] op_sel_hi:[1,1]
    v_pk_mul_f32 v[152:153], v[152:153], v[198:199] op_sel:[0,1] op_sel_hi:[1,1]
    v_pk_mul_f32 v[154:155], v[154:155], v[198:199] op_sel:[0,1] op_sel_hi:[1,1]
    v_pk_fma_f32 v[148:149], v[48:49], v[202:203], v[148:149] op_sel:[0,1,0] op_sel_hi:[1,1,1]
    v_pk_fma_f32 v[150:151], v[50:51], v[202:203], v[150:151] op_sel:[0,1,0] op_sel_hi:[1,1,1]
    v_pk_fma_f32 v[152:153], v[64:65], v[202:203], v[152:153] op_sel:[0,1,0] op_sel_hi:[1,1,1]
    v_pk_fma_f32 v[154:155], v[66:67], v[202:203], v[154:155] op_sel:[0,1,0] op_sel_hi:[1,1,1]
    v_cvt_pk_bf16_f32 v144, v148, v149
    v_cvt_pk_bf16_f32 v145, v150, v151
    v_cvt_pk_bf16_f32 v146, v152, v153
    v_cvt_pk_bf16_f32 v147, v154, v155
    buffer_store_dwordx4 v[144:147], v245, s[24:27], s3 offen offset:1024 sc1
a2_fin_0:
    s_lshl_b32 s3, s54, 1
    s_lshr_b32 s6, s52, 4
    s_add_u32 s3, s3, s6
    s_lshl_b32 s3, s3, 6
    s_and_b32 s6, s52, 15
    s_lshl_b32 s6, s6, 2
    s_add_u32 s3, s3, s6
    s_add_u32 s3, s3, 4096
    s_cmp_eq_u32 s101, 0
    s_cselect_b32 s72, s3, s72
    s_cmp_eq_u32 s71, 0
    s_cbranch_scc1 a2_done
    s_bfe_u32 s3, s71, 0x20004
    s_add_u32 s52, s53, s3
    s_and_b32 s54, s71, 15
    s_lshr_b32 s71, s71, 7
    s_mov_b32 s56, 0
    s_cmp_eq_u32 s71, 0
    s_cselect_b32 s55, 99, s54
    s_cmp_eq_u32 s54, 0
    s_cbranch_scc1 a2_z0
    s_nop 7
    s_waitcnt lgkmcnt(0)
    v_max3_f32 v232, v68, v69, v70
    v_max3_f32 v232, v232, v71, v84
    v_mfma_f32_16x16x32_bf16 a[0:3], a[244:247], a[244:247], 0
    v_max3_f32 v232, v232, v85, v86
    v_max3_f32 v232, v232, v87, v100
    v_mfma_f32_16x16x32_bf16 a[4:7], a[244:247], a[244:247], 0
    v_max3_f32 v232, v232, v101, v102
    v_max3_f32 v232, v232, v103, v116
    v_mfma_f32_16x16x32_bf16 a[8:11], a[244:247], a[244:247], 0
    v_max3_f32 v232, v232, v117, v118
    v_max_f32 v232, v232, v119
    v_mfma_f32_16x16x32_bf16 a[12:15], a[244:247], a[244:247], 0
    v_max3_f32 v233, v72, v73, v74
    v_max3_f32 v233, v233, v75, v88
    v_mfma_f32_16x16x32_bf16 a[16:19], a[244:247], a[244:247], 0
    v_max3_f32 v233, v233, v89, v90
    v_max3_f32 v233, v233, v91, v104
    v_mfma_f32_16x16x32_bf16 a[20:23], a[244:247], a[244:247], 0
    v_max3_f32 v233, v233, v105, v106
    v_max3_f32 v233, v233, v107, v120
    v_mfma_f32_16x16x32_bf16 a[24:27], a[244:247], a[244:247], 0
    v_max3_f32 v233, v233, v121, v122
    v_max_f32 v233, v233, v123
    v_mfma_f32_16x16x32_bf16 a[28:31], a[244:247], a[244:247], 0
    v_max3_f32 v234, v76, v77, v78
    v_max3_f32 v234, v234, v79, v92
    v_mfma_f32_16x16x32_bf16 a[32:35], a[244:247], a[244:247], 0
    v_max3_f32 v234, v234, v93, v94
    v_max3_f32 v234, v234, v95, v108
    v_mfma_f32_16x16x32_bf16 a[36:39], a[244:247], a[244:247], 0
    v_max3_f32 v234, v234, v109, v110
    v_max3_f32 v234, v234, v111, v124
    v_mfma_f32_16x16x32_bf16 a[40:43], a[244:247], a[244:247], 0
    v_max3_f32 v234, v234, v125, v126
    v_max_f32 v234, v234, v127
    v_mfma_f32_16x16x32_bf16 a[44:47], a[244:247], a[244:247], 0
    v_max3_f32 v235, v80, v81, v82
    v_max3_f32 v235, v235, v83, v96
    v_mfma_f32_16x16x32_bf16 a[48:51], a[244:247], a[244:247], 0
    v_max3_f32 v235, v235, v97, v98
    v_max3_f32 v235, v235, v99, v112
    v_mfma_f32_16x16x32_bf16 a[52:55], a[244:247], a[244:247], 0
    v_max3_f32 v235, v235, v113, v114
    v_max3_f32 v235, v235, v115, v128
    v_mfma_f32_16x16x32_bf16 a[56:59], a[244:247], a[244:247], 0
    v_max3_f32 v235, v235, v129, v130
    v_max_f32 v235, v235, v131
    v_mfma_f32_16x16x32_bf16 a[60:63], a[244:247], a[244:247], 0
    ds_bpermute_b32 v212, v241, v232
    ds_bpermute_b32 v213, v241, v233
    ds_bpermute_b32 v214, v241, v234
    ds_bpermute_b32 v215, v241, v235
    s_waitcnt lgkmcnt(0)
    v_max_f32 v232, v232, v212
    v_max_f32 v233, v233, v213
    v_mfma_f32_16x16x32_bf16 a[64:67], a[244:247], a[244:247], 0
    v_max_f32 v234, v234, v214
    v_max_f32 v235, v235, v215
    v_mfma_f32_16x16x32_bf16 a[68:71], a[244:247], a[244:247], 0
    ds_bpermute_b32 v212, v242, v232
    ds_bpermute_b32 v213, v242, v233
    ds_bpermute_b32 v214, v242, v234
    ds_bpermute_b32 v215, v242, v235
    s_waitcnt lgkmcnt(0)
    v_max_f32 v232, v232, v212
    v_max_f32 v233, v233, v213
    v_mfma_f32_16x16x32_bf16 a[72:75], a[244:247], a[244:247], 0
    v_max_f32 v234, v234, v214
    v_max_f32 v235, v235, v215
    v_mfma_f32_16x16x32_bf16 a[76:79], a[244:247], a[244:247], 0
    v_add_f32 v232, 0x40e00000, v232
    v_mov_b32 v228, v232
    v_mfma_f32_16x16x32_bf16 a[80:83], a[244:247], a[244:247], 0
    v_sub_f32 v196, 0, v228
    v_sub_f32 v197, 0, v228
    v_mfma_f32_16x16x32_bf16 a[84:87], a[244:247], a[244:247], 0
    v_sub_f32 v198, 0, v228
    v_sub_f32 v199, 0, v228
    v_mfma_f32_16x16x32_bf16 a[88:91], a[244:247], a[244:247], 0
    v_add_f32 v233, 0x40e00000, v233
    v_mov_b32 v229, v233
    v_mfma_f32_16x16x32_bf16 a[92:95], a[244:247], a[244:247], 0
    v_sub_f32 v200, 0, v229
    v_sub_f32 v201, 0, v229
    v_mfma_f32_16x16x32_bf16 a[96:99], a[244:247], a[244:247], 0
    v_sub_f32 v202, 0, v229
    v_sub_f32 v203, 0, v229
    v_mfma_f32_16x16x32_bf16 a[100:103], a[244:247], a[244:247], 0
    v_add_f32 v234, 0x40e00000, v234
    v_mov_b32 v230, v234
    v_mfma_f32_16x16x32_bf16 a[104:107], a[244:247], a[244:247], 0
    v_sub_f32 v204, 0, v230
    v_sub_f32 v205, 0, v230
    v_mfma_f32_16x16x32_bf16 a[108:111], a[244:247], a[244:247], 0
    v_sub_f32 v206, 0, v230
    v_sub_f32 v207, 0, v230
    v_mfma_f32_16x16x32_bf16 a[112:115], a[244:247], a[244:247], 0
    v_add_f32 v235, 0x40e00000, v235
    v_mov_b32 v231, v235
    v_mfma_f32_16x16x32_bf16 a[116:119], a[244:247], a[244:247], 0
    v_sub_f32 v208, 0, v231
    v_sub_f32 v209, 0, v231
    v_mfma_f32_16x16x32_bf16 a[120:123], a[244:247], a[244:247], 0
    v_sub_f32 v210, 0, v231
    v_sub_f32 v211, 0, v231
    v_mfma_f32_16x16x32_bf16 a[124:127], a[244:247], a[244:247], 0
    v_sub_f32 v68, v68, v232
    v_sub_f32 v69, v69, v232
    v_mfma_f32_16x16x32_bf16 a[128:131], a[244:247], a[244:247], 0
    v_sub_f32 v70, v70, v232
    v_sub_f32 v71, v71, v232
    v_mfma_f32_16x16x32_bf16 a[132:135], a[244:247], a[244:247], 0
    v_sub_f32 v72, v72, v233
    v_sub_f32 v73, v73, v233
    v_mfma_f32_16x16x32_bf16 a[136:139], a[244:247], a[244:247], 0
    v_sub_f32 v74, v74, v233
    v_sub_f32 v75, v75, v233
    v_mfma_f32_16x16x32_bf16 a[140:143], a[244:247], a[244:247], 0
    v_sub_f32 v76, v76, v234
    v_sub_f32 v77, v77, v234
    v_sub_f32 v78, v78, v234
    v_sub_f32 v79, v79, v234
    v_sub_f32 v80, v80, v235
    v_sub_f32 v81, v81, v235
    v_sub_f32 v82, v82, v235
    v_sub_f32 v83, v83, v235
    v_sub_f32 v84, v84, v232
    v_sub_f32 v85, v85, v232
    v_sub_f32 v86, v86, v232
    v_sub_f32 v87, v87, v232
    v_sub_f32 v88, v88, v233
    v_sub_f32 v89, v89, v233
    v_sub_f32 v90, v90, v233
    v_sub_f32 v91, v91, v233
    v_sub_f32 v92, v92, v234
    v_sub_f32 v93, v93, v234
    v_sub_f32 v94, v94, v234
    v_sub_f32 v95, v95, v234
    v_sub_f32 v96, v96, v235
    v_sub_f32 v97, v97, v235
    v_sub_f32 v98, v98, v235
    v_sub_f32 v99, v99, v235
    v_sub_f32 v100, v100, v232
    v_sub_f32 v101, v101, v232
    v_sub_f32 v102, v102, v232
    v_sub_f32 v103, v103, v232
    v_sub_f32 v104, v104, v233
    v_sub_f32 v105, v105, v233
    v_sub_f32 v106, v106, v233
    v_sub_f32 v107, v107, v233
    v_sub_f32 v108, v108, v234
    v_sub_f32 v109, v109, v234
    v_sub_f32 v110, v110, v234
    v_sub_f32 v111, v111, v234
    v_sub_f32 v112, v112, v235
    v_sub_f32 v113, v113, v235
    v_sub_f32 v114, v114, v235
    v_sub_f32 v115, v115, v235
    v_sub_f32 v116, v116, v232
    v_sub_f32 v117, v117, v232
    v_sub_f32 v118, v118, v232
    v_sub_f32 v119, v119, v232
    v_sub_f32 v120, v120, v233
    v_sub_f32 v121, v121, v233
    v_sub_f32 v122, v122, v233
    v_sub_f32 v123, v123, v233
    v_sub_f32 v124, v124, v234
    v_sub_f32 v125, v125, v234
    v_sub_f32 v126, v126, v234
    v_sub_f32 v127, v127, v234
    v_sub_f32 v128, v128, v235
    v_sub_f32 v129, v129, v235
    v_sub_f32 v130, v130, v235
    v_sub_f32 v131, v131, v235
    s_nop 1
    v_exp_f32 v212, v72
    v_exp_f32 v213, v73
    v_exp_f32 v214, v74
    v_exp_f32 v215, v75
    v_exp_f32 v216, v76
    v_exp_f32 v217, v77
    v_cvt_pk_bf16_f32 v136, v212, v213
    v_exp_f32 v218, v78
    v_cvt_pk_bf16_f32 v137, v214, v215
    v_exp_f32 v219, v79
    v_exp_f32 v212, v80
    v_exp_f32 v213, v81
    v_cvt_pk_bf16_f32 v140, v216, v217
    v_exp_f32 v214, v82
    v_cvt_pk_bf16_f32 v141, v218, v219
    v_exp_f32 v215, v83
    v_or_b32 v244, v136, v137
    v_exp_f32 v216, v92
    v_exp_f32 v217, v93
    v_cvt_pk_bf16_f32 v144, v212, v213
    v_exp_f32 v218, v94
    v_cvt_pk_bf16_f32 v145, v214, v215
    v_exp_f32 v219, v95
    v_or3_b32 v244, v244, v140, v141
    v_exp_f32 v212, v96
    v_exp_f32 v213, v97
    v_cvt_pk_bf16_f32 v142, v216, v217
    v_exp_f32 v214, v98
    v_cvt_pk_bf16_f32 v143, v218, v219
    v_exp_f32 v215, v99
    v_or3_b32 v244, v244, v144, v145
    v_cvt_pk_bf16_f32 v146, v212, v213
    v_cvt_pk_bf16_f32 v147, v214, v215
    v_or3_b32 v244, v244, v142, v143
    v_or3_b32 v244, v244, v146, v147
    s_branch a2_it1
a2_z0:
    v_mfma_f32_16x16x32_bf16 a[0:3], a[244:247], a[244:247], 0
    v_mfma_f32_16x16x32_bf16 a[4:7], a[244:247], a[244:247], 0
    v_mfma_f32_16x16x32_bf16 a[8:11], a[244:247], a[244:247], 0
    v_mfma_f32_16x16x32_bf16 a[12:15], a[244:247], a[244:247], 0
    v_mfma_f32_16x16x32_bf16 a[16:19], a[244:247], a[244:247], 0
    v_mfma_f32_16x16x32_bf16 a[20:23], a[244:247], a[244:247], 0
    v_mfma_f32_16x16x32_bf16 a[24:27], a[244:247], a[244:247], 0
    v_mfma_f32_16x16x32_bf16 a[28:31], a[244:247], a[244:247], 0
    v_mfma_f32_16x16x32_bf16 a[32:35], a[244:247], a[244:247], 0
    v_mfma_f32_16x16x32_bf16 a[36:39], a[244:247], a[244:247], 0
    v_mfma_f32_16x16x32_bf16 a[40:43], a[244:247], a[244:247], 0
    v_mfma_f32_16x16x32_bf16 a[44:47], a[244:247], a[244:247], 0
    v_mfma_f32_16x16x32_bf16 a[48:51], a[244:247], a[244:247], 0
    v_mfma_f32_16x16x32_bf16 a[52:55], a[244:247], a[244:247], 0
    v_mfma_f32_16x16x32_bf16 a[56:59], a[244:247], a[244:247], 0
    v_mfma_f32_16x16x32_bf16 a[60:63], a[244:247], a[244:247], 0
    v_mfma_f32_16x16x32_bf16 a[64:67], a[244:247], a[244:247], 0
    v_mfma_f32_16x16x32_bf16 a[68:71], a[244:247], a[244:247], 0
    v_mfma_f32_16x16x32_bf16 a[72:75], a[244:247], a[244:247], 0
    v_mfma_f32_16x16x32_bf16 a[76:79], a[244:247], a[244:247], 0
    v_mfma_f32_16x16x32_bf16 a[80:83], a[244:247], a[244:247], 0
    v_mfma_f32_16x16x32_bf16 a[84:87], a[244:247], a[244:247], 0
    v_mfma_f32_16x16x32_bf16 a[88:91], a[244:247], a[244:247], 0
    v_mfma_f32_16x16x32_bf16 a[92:95], a[244:247], a[244:247], 0
    v_mfma_f32_16x16x32_bf16 a[96:99], a[244:247], a[244:247], 0
    v_mfma_f32_16x16x32_bf16 a[100:103], a[244:247], a[244:247], 0
    v_mfma_f32_16x16x32_bf16 a[104:107], a[244:247], a[244:247], 0
    v_mfma_f32_16x16x32_bf16 a[108:111], a[244:247], a[244:247], 0
    v_mfma_f32_16x16x32_bf16 a[112:115], a[244:247], a[244:247], 0
    v_mfma_f32_16x16x32_bf16 a[116:119], a[244:247], a[244:247], 0
    v_mfma_f32_16x16x32_bf16 a[120:123], a[244:247], a[244:247], 0
    v_mfma_f32_16x16x32_bf16 a[124:127], a[244:247], a[244:247], 0
    v_mfma_f32_16x16x32_bf16 a[128:131], a[244:247], a[244:247], 0
    v_mfma_f32_16x16x32_bf16 a[132:135], a[244:247], a[244:247], 0
    v_mfma_f32_16x16x32_bf16 a[136:139], a[244:247], a[244:247], 0
    v_mfma_f32_16x16x32_bf16 a[140:143], a[244:247], a[244:247], 0
    v_mov_b32 v228, v243
    v_mov_b32 v229, v243
    v_mov_b32 v230, v243
    v_mov_b32 v231, v243
    s_branch a2_it1
a2_merge1:
    s_mov_b64 exec, 1
    buffer_store_dword v243, v236, s[36:39], s72 offen sc1
    s_mov_b64 exec, -1
    s_brev_b32 s72, 1
    s_mov_b32 s28, s60
    s_mov_b32 s29, s61
    s_mov_b32 s30, s62
    buffer_load_dword v249, v248, s[28:31], 0 offen
    s_mov_b32 s60, s63
    s_mov_b32 s61, s64
    s_mov_b32 s62, s65
    s_mov_b32 s65, 0
    v_lshlrev_b32 v244, 2, v236
    s_bfe_u32 s3, s2, 0x10002
    s_lshl_b32 s3, s3, 2
    s_bfe_u32 s6, s2, 0x20004
    s_add_u32 s3, s3, s6
    s_lshl_b32 s3, s3, 7
    s_add_u32 s3, s3, 2048
    buffer_load_dword v249, v244, s[36:39], s3 offen sc1
    s_lshl_b32 s3, s50, 14
    s_add_u32 s6, s3, 98304
    s_add_u32 s7, s3, 0
    s_cmp_eq_u32 s51, 0
    s_cselect_b32 s3, s6, s7
    s_cselect_b32 s6, s7, s6
    v_add_u32 v246, s3, v240
    v_add_u32 v247, s6, v240
    s_cbranch_scc0 a2_send1_1
    ds_write_b128 v246, a[64:67] offset:0
    ds_write_b128 v246, a[68:71] offset:1024
    ds_write_b128 v246, a[72:75] offset:2048
    ds_write_b128 v246, a[76:79] offset:3072
    ds_write_b128 v246, a[80:83] offset:4096
    ds_write_b128 v246, a[84:87] offset:5120
    ds_write_b128 v246, a[88:91] offset:6144
    ds_write_b128 v246, a[92:95] offset:7168
    ds_write_b128 v246, a[96:99] offset:8192
    ds_write_b128 v246, a[100:103] offset:9216
    ds_write_b128 v246, a[104:107] offset:10240
    ds_write_b128 v246, a[108:111] offset:11264
    ds_write_b128 v246, a[112:115] offset:12288
    ds_write_b128 v246, a[116:119] offset:13312
    ds_write_b128 v246, a[120:123] offset:14336
    ds_write_b128 v246, a[124:127] offset:15360
    s_branch a2_sent_1
a2_send1_1:
    ds_write_b128 v246, a[0:3] offset:0
    ds_write_b128 v246, a[4:7] offset:1024
    ds_write_b128 v246, a[8:11] offset:2048
    ds_write_b128 v246, a[12:15] offset:3072
    ds_write_b128 v246, a[16:19] offset:4096
    ds_write_b128 v246, a[20:23] offset:5120
    ds_write_b128 v246, a[24:27] offset:6144
    ds_write_b128 v246, a[28:31] offset:7168
    ds_write_b128 v246, a[32:35] offset:8192
    ds_write_b128 v246, a[36:39] offset:9216
    ds_write_b128 v246, a[40:43] offset:10240
    ds_write_b128 v246, a[44:47] offset:11264
    ds_write_b128 v246, a[48:51] offset:12288
    ds_write_b128 v246, a[52:55] offset:13312
    ds_write_b128 v246, a[56:59] offset:14336
    ds_write_b128 v246, a[60:63] offset:15360
a2_sent_1:
    v_accvgpr_read_b32 v232, a128
    v_accvgpr_read_b32 v233, a132
    v_accvgpr_read_b32 v234, a136
    v_accvgpr_read_b32 v235, a140
    s_lshl_b32 s3, s101, 11
    s_add_u32 s3, s3, 131072
    v_add_u32 v246, s3, v240
    ds_write_b128 v246, v[228:231]
    ds_write_b128 v246, v[232:235] offset:1024
    v_xor_b32 v246, 0x1000, v246
    s_waitcnt lgkmcnt(0)
    s_barrier
    ds_read_b128 v[212:215], v246
    ds_read_b128 v[216:219], v246 offset:1024
    ds_read_b128 v[68:71], v247 offset:0
    ds_read_b128 v[72:75], v247 offset:1024
    ds_read_b128 v[76:79], v247 offset:2048
    ds_read_b128 v[80:83], v247 offset:3072
    ds_read_b128 v[84:87], v247 offset:4096
    ds_read_b128 v[88:91], v247 offset:5120
    ds_read_b128 v[92:95], v247 offset:6144
    ds_read_b128 v[96:99], v247 offset:7168
    ds_read_b128 v[100:103], v247 offset:8192
    ds_read_b128 v[104:107], v247 offset:9216
    ds_read_b128 v[108:111], v247 offset:10240
    ds_read_b128 v[112:115], v247 offset:11264
    ds_read_b128 v[116:119], v247 offset:12288
    ds_read_b128 v[120:123], v247 offset:13312
    ds_read_b128 v[124:127], v247 offset:14336
    ds_read_b128 v[128:131], v247 offset:15360
    s_lshl_b32 s3, s54, 3
    s_lshl_b32 s6, s50, 2
    s_add_u32 s3, s3, s6
    s_mul_i32 s3, s3, 245760
    s_lshl_b32 s6, s52, 12
    s_add_u32 s3, s3, s6
    s_lshl_b32 s6, s51, 11
    s_add_u32 s3, s3, s6
    s_add_u32 s3, s3, 114688
    v_add_u32 v245, s3, v240
    s_waitcnt lgkmcnt(15)
    s_waitcnt lgkmcnt(0)
    s_barrier
    s_cmp_lg_u32 s71, 0
    s_cbranch_scc1 a2_ng1
    s_waitcnt vmcnt(0)
    v_cmp_eq_u32 vcc, 0, v249
    s_cmp_eq_u32 vcc_lo, 0
    s_cselect_b32 s100, 1, 0
    s_cbranch_scc0 a2_ng1
    s_bfe_u32 s3, s2, 0x10002
    s_lshl_b32 s3, s3, 3
    s_bfe_u32 s4, s2, 0x30003
    s_add_u32 s3, s3, s4
    s_bfe_u32 s5, s2, 0x10001
    s_lshl_b32 s5, s5, 2
    s_lshr_b32 s6, s2, 6
    s_add_u32 s5, s5, s6
    s_lshl_b32 s3, s3, 3
    s_lshl_b32 s6, s6, 1
    s_add_u32 s3, s3, s6
    s_lshr_b32 s6, s101, 1
    s_add_u32 s3, s3, s6
    s_mul_i32 s3, s3, 245760
    s_and_b32 s7, s2, 1
    s_mul_i32 s6, s7, 65536
    s_add_u32 s3, s3, s6
    s_and_b32 s6, s101, 1
    s_lshl_b32 s6, s6, 12
    s_add_u32 s3, s3, s6
    v_lshlrev_b32 v244, 7, v236
    s_mov_b32 exec_hi, 0
    buffer_load_dword v249, v244, s[24:27], s3 offen
    s_mov_b32 s28, s10
    s_mov_b32 s29, s11
    s_mov_b32 s30, 7340032
    s_mov_b32 s31, 0x20000
    s_mul_i32 s3, s7, 2048
    s_lshl_b32 s6, s101, 6
    s_add_u32 s3, s3, s6
    s_lshl_b32 s4, s4, 3
    s_add_u32 s3, s3, s4
    s_lshl_b32 s3, s3, 11
    s_lshl_b32 s5, s5, 8
    s_add_u32 s3, s3, s5
    v_lshrrev_b32 v244, 1, v236
    v_lshlrev_b32 v244, 11, v244
    s_mov_b32 exec_lo, 0x5555
    buffer_load_dword v249, v244, s[28:31], s3 offen
    buffer_load_dword v249, v244, s[28:31], s3 offen offset:128
    s_mov_b64 exec, -1
a2_ng1:
    v_max_f32 v220, v228, v212
    v_max_f32 v221, v229, v213
    v_max_f32 v222, v230, v214
    v_max_f32 v223, v231, v215
    v_sub_f32 v196, v228, v220
    v_sub_f32 v197, v229, v221
    v_sub_f32 v198, v230, v222
    v_sub_f32 v199, v231, v223
    v_sub_f32 v200, v212, v220
    v_sub_f32 v201, v213, v221
    v_sub_f32 v202, v214, v222
    v_sub_f32 v203, v215, v223
    v_exp_f32 v196, v196
    v_exp_f32 v197, v197
    v_exp_f32 v198, v198
    v_exp_f32 v199, v199
    v_exp_f32 v200, v200
    v_exp_f32 v201, v201
    v_exp_f32 v202, v202
    v_exp_f32 v203, v203
    v_mul_f32 v220, v232, v196
    v_mul_f32 v221, v233, v197
    v_mul_f32 v222, v234, v198
    v_mul_f32 v223, v235, v199
    v_fmac_f32 v220, v216, v200
    v_fmac_f32 v221, v217, v201
    v_fmac_f32 v222, v218, v202
    v_fmac_f32 v223, v219, v203
    v_rcp_f32 v220, v220
    v_rcp_f32 v221, v221
    v_rcp_f32 v222, v222
    v_rcp_f32 v223, v223
    s_nop 0
    v_mul_f32 v196, v196, v220
    v_mul_f32 v197, v197, v221
    v_mul_f32 v198, v198, v222
    v_mul_f32 v199, v199, v223
    v_mul_f32 v200, v200, v220
    v_mul_f32 v201, v201, v221
    v_mul_f32 v202, v202, v222
    v_mul_f32 v203, v203, v223
    s_cmp_eq_u32 s51, 0
    s_cbranch_scc0 a2_fin1_1
    s_mov_b32 s3, 0
    v_accvgpr_read_b32 v136, a0
    v_accvgpr_read_b32 v137, a1
    v_accvgpr_read_b32 v138, a2
    v_accvgpr_read_b32 v139, a3
    v_accvgpr_read_b32 v140, a16
    v_accvgpr_read_b32 v141, a17
    v_accvgpr_read_b32 v142, a18
    v_accvgpr_read_b32 v143, a19
    v_pk_mul_f32 v[136:137], v[136:137], v[196:197] op_sel:[0,0] op_sel_hi:[1,0]
    v_pk_mul_f32 v[138:139], v[138:139], v[196:197] op_sel:[0,0] op_sel_hi:[1,0]
    v_pk_mul_f32 v[140:141], v[140:141], v[196:197] op_sel:[0,0] op_sel_hi:[1,0]
    v_pk_mul_f32 v[142:143], v[142:143], v[196:197] op_sel:[0,0] op_sel_hi:[1,0]
    v_pk_fma_f32 v[136:137], v[68:69], v[200:201], v[136:137] op_sel:[0,0,0] op_sel_hi:[1,0,1]
    v_pk_fma_f32 v[138:139], v[70:71], v[200:201], v[138:139] op_sel:[0,0,0] op_sel_hi:[1,0,1]
    v_pk_fma_f32 v[140:141], v[84:85], v[200:201], v[140:141] op_sel:[0,0,0] op_sel_hi:[1,0,1]
    v_pk_fma_f32 v[142:143], v[86:87], v[200:201], v[142:143] op_sel:[0,0,0] op_sel_hi:[1,0,1]
    v_cvt_pk_bf16_f32 v132, v136, v137
    v_cvt_pk_bf16_f32 v133, v138, v139
    v_cvt_pk_bf16_f32 v134, v140, v141
    v_cvt_pk_bf16_f32 v135, v142, v143
    buffer_store_dwordx4 v[132:135], v245, s[24:27], s3 offen offset:0 sc1
    v_accvgpr_read_b32 v148, a32
    v_accvgpr_read_b32 v149, a33
    v_accvgpr_read_b32 v150, a34
    v_accvgpr_read_b32 v151, a35
    v_accvgpr_read_b32 v152, a48
    v_accvgpr_read_b32 v153, a49
    v_accvgpr_read_b32 v154, a50
    v_accvgpr_read_b32 v155, a51
    v_pk_mul_f32 v[148:149], v[148:149], v[196:197] op_sel:[0,0] op_sel_hi:[1,0]
    v_pk_mul_f32 v[150:151], v[150:151], v[196:197] op_sel:[0,0] op_sel_hi:[1,0]
    v_pk_mul_f32 v[152:153], v[152:153], v[196:197] op_sel:[0,0] op_sel_hi:[1,0]
    v_pk_mul_f32 v[154:155], v[154:155], v[196:197] op_sel:[0,0] op_sel_hi:[1,0]
    v_pk_fma_f32 v[148:149], v[100:101], v[200:201], v[148:149] op_sel:[0,0,0] op_sel_hi:[1,0,1]
    v_pk_fma_f32 v[150:151], v[102:103], v[200:201], v[150:151] op_sel:[0,0,0] op_sel_hi:[1,0,1]
    v_pk_fma_f32 v[152:153], v[116:117], v[200:201], v[152:153] op_sel:[0,0,0] op_sel_hi:[1,0,1]
    v_pk_fma_f32 v[154:155], v[118:119], v[200:201], v[154:155] op_sel:[0,0,0] op_sel_hi:[1,0,1]
    v_cvt_pk_bf16_f32 v144, v148, v149
    v_cvt_pk_bf16_f32 v145, v150, v151
    v_cvt_pk_bf16_f32 v146, v152, v153
    v_cvt_pk_bf16_f32 v147, v154, v155
    buffer_store_dwordx4 v[144:147], v245, s[24:27], s3 offen offset:1024 sc1
    s_mov_b32 s3, 245760
    v_accvgpr_read_b32 v136, a4
    v_accvgpr_read_b32 v137, a5
    v_accvgpr_read_b32 v138, a6
    v_accvgpr_read_b32 v139, a7
    v_accvgpr_read_b32 v140, a20
    v_accvgpr_read_b32 v141, a21
    v_accvgpr_read_b32 v142, a22
    v_accvgpr_read_b32 v143, a23
    v_pk_mul_f32 v[136:137], v[136:137], v[196:197] op_sel:[0,1] op_sel_hi:[1,1]
    v_pk_mul_f32 v[138:139], v[138:139], v[196:197] op_sel:[0,1] op_sel_hi:[1,1]
    v_pk_mul_f32 v[140:141], v[140:141], v[196:197] op_sel:[0,1] op_sel_hi:[1,1]
    v_pk_mul_f32 v[142:143], v[142:143], v[196:197] op_sel:[0,1] op_sel_hi:[1,1]
    v_pk_fma_f32 v[136:137], v[72:73], v[200:201], v[136:137] op_sel:[0,1,0] op_sel_hi:[1,1,1]
    v_pk_fma_f32 v[138:139], v[74:75], v[200:201], v[138:139] op_sel:[0,1,0] op_sel_hi:[1,1,1]
    v_pk_fma_f32 v[140:141], v[88:89], v[200:201], v[140:141] op_sel:[0,1,0] op_sel_hi:[1,1,1]
    v_pk_fma_f32 v[142:143], v[90:91], v[200:201], v[142:143] op_sel:[0,1,0] op_sel_hi:[1,1,1]
    v_cvt_pk_bf16_f32 v132, v136, v137
    v_cvt_pk_bf16_f32 v133, v138, v139
    v_cvt_pk_bf16_f32 v134, v140, v141
    v_cvt_pk_bf16_f32 v135, v142, v143
    buffer_store_dwordx4 v[132:135], v245, s[24:27], s3 offen offset:0 sc1
    v_accvgpr_read_b32 v148, a36
    v_accvgpr_read_b32 v149, a37
    v_accvgpr_read_b32 v150, a38
    v_accvgpr_read_b32 v151, a39
    v_accvgpr_read_b32 v152, a52
    v_accvgpr_read_b32 v153, a53
    v_accvgpr_read_b32 v154, a54
    v_accvgpr_read_b32 v155, a55
    v_pk_mul_f32 v[148:149], v[148:149], v[196:197] op_sel:[0,1] op_sel_hi:[1,1]
    v_pk_mul_f32 v[150:151], v[150:151], v[196:197] op_sel:[0,1] op_sel_hi:[1,1]
    v_pk_mul_f32 v[152:153], v[152:153], v[196:197] op_sel:[0,1] op_sel_hi:[1,1]
    v_pk_mul_f32 v[154:155], v[154:155], v[196:197] op_sel:[0,1] op_sel_hi:[1,1]
    v_pk_fma_f32 v[148:149], v[104:105], v[200:201], v[148:149] op_sel:[0,1,0] op_sel_hi:[1,1,1]
    v_pk_fma_f32 v[150:151], v[106:107], v[200:201], v[150:151] op_sel:[0,1,0] op_sel_hi:[1,1,1]
    v_pk_fma_f32 v[152:153], v[120:121], v[200:201], v[152:153] op_sel:[0,1,0] op_sel_hi:[1,1,1]
    v_pk_fma_f32 v[154:155], v[122:123], v[200:201], v[154:155] op_sel:[0,1,0] op_sel_hi:[1,1,1]
    v_cvt_pk_bf16_f32 v144, v148, v149
    v_cvt_pk_bf16_f32 v145, v150, v151
    v_cvt_pk_bf16_f32 v146, v152, v153
    v_cvt_pk_bf16_f32 v147, v154, v155
    buffer_store_dwordx4 v[144:147], v245, s[24:27], s3 offen offset:1024 sc1
    s_mov_b32 s3, 491520
    v_accvgpr_read_b32 v136, a8
    v_accvgpr_read_b32 v137, a9
    v_accvgpr_read_b32 v138, a10
    v_accvgpr_read_b32 v139, a11
    v_accvgpr_read_b32 v140, a24
    v_accvgpr_read_b32 v141, a25
    v_accvgpr_read_b32 v142, a26
    v_accvgpr_read_b32 v143, a27
    v_pk_mul_f32 v[136:137], v[136:137], v[198:199] op_sel:[0,0] op_sel_hi:[1,0]
    v_pk_mul_f32 v[138:139], v[138:139], v[198:199] op_sel:[0,0] op_sel_hi:[1,0]
    v_pk_mul_f32 v[140:141], v[140:141], v[198:199] op_sel:[0,0] op_sel_hi:[1,0]
    v_pk_mul_f32 v[142:143], v[142:143], v[198:199] op_sel:[0,0] op_sel_hi:[1,0]
    v_pk_fma_f32 v[136:137], v[76:77], v[202:203], v[136:137] op_sel:[0,0,0] op_sel_hi:[1,0,1]
    v_pk_fma_f32 v[138:139], v[78:79], v[202:203], v[138:139] op_sel:[0,0,0] op_sel_hi:[1,0,1]
    v_pk_fma_f32 v[140:141], v[92:93], v[202:203], v[140:141] op_sel:[0,0,0] op_sel_hi:[1,0,1]
    v_pk_fma_f32 v[142:143], v[94:95], v[202:203], v[142:143] op_sel:[0,0,0] op_sel_hi:[1,0,1]
    v_cvt_pk_bf16_f32 v132, v136, v137
    v_cvt_pk_bf16_f32 v133, v138, v139
    v_cvt_pk_bf16_f32 v134, v140, v141
    v_cvt_pk_bf16_f32 v135, v142, v143
    buffer_store_dwordx4 v[132:135], v245, s[24:27], s3 offen offset:0 sc1
    v_accvgpr_read_b32 v148, a40
    v_accvgpr_read_b32 v149, a41
    v_accvgpr_read_b32 v150, a42
    v_accvgpr_read_b32 v151, a43
    v_accvgpr_read_b32 v152, a56
    v_accvgpr_read_b32 v153, a57
    v_accvgpr_read_b32 v154, a58
    v_accvgpr_read_b32 v155, a59
    v_pk_mul_f32 v[148:149], v[148:149], v[198:199] op_sel:[0,0] op_sel_hi:[1,0]
    v_pk_mul_f32 v[150:151], v[150:151], v[198:199] op_sel:[0,0] op_sel_hi:[1,0]
    v_pk_mul_f32 v[152:153], v[152:153], v[198:199] op_sel:[0,0] op_sel_hi:[1,0]
    v_pk_mul_f32 v[154:155], v[154:155], v[198:199] op_sel:[0,0] op_sel_hi:[1,0]
    v_pk_fma_f32 v[148:149], v[108:109], v[202:203], v[148:149] op_sel:[0,0,0] op_sel_hi:[1,0,1]
    v_pk_fma_f32 v[150:151], v[110:111], v[202:203], v[150:151] op_sel:[0,0,0] op_sel_hi:[1,0,1]
    v_pk_fma_f32 v[152:153], v[124:125], v[202:203], v[152:153] op_sel:[0,0,0] op_sel_hi:[1,0,1]
    v_pk_fma_f32 v[154:155], v[126:127], v[202:203], v[154:155] op_sel:[0,0,0] op_sel_hi:[1,0,1]
    v_cvt_pk_bf16_f32 v144, v148, v149
    v_cvt_pk_bf16_f32 v145, v150, v151
    v_cvt_pk_bf16_f32 v146, v152, v153
    v_cvt_pk_bf16_f32 v147, v154, v155
    buffer_store_dwordx4 v[144:147], v245, s[24:27], s3 offen offset:1024 sc1
    s_mov_b32 s3, 737280
    v_accvgpr_read_b32 v136, a12
    v_accvgpr_read_b32 v137, a13
    v_accvgpr_read_b32 v138, a14
    v_accvgpr_read_b32 v139, a15
    v_accvgpr_read_b32 v140, a28
    v_accvgpr_read_b32 v141, a29
    v_accvgpr_read_b32 v142, a30
    v_accvgpr_read_b32 v143, a31
    v_pk_mul_f32 v[136:137], v[136:137], v[198:199] op_sel:[0,1] op_sel_hi:[1,1]
    v_pk_mul_f32 v[138:139], v[138:139], v[198:199] op_sel:[0,1] op_sel_hi:[1,1]
    v_pk_mul_f32 v[140:141], v[140:141], v[198:199] op_sel:[0,1] op_sel_hi:[1,1]
    v_pk_mul_f32 v[142:143], v[142:143], v[198:199] op_sel:[0,1] op_sel_hi:[1,1]
    v_pk_fma_f32 v[136:137], v[80:81], v[202:203], v[136:137] op_sel:[0,1,0] op_sel_hi:[1,1,1]
    v_pk_fma_f32 v[138:139], v[82:83], v[202:203], v[138:139] op_sel:[0,1,0] op_sel_hi:[1,1,1]
    v_pk_fma_f32 v[140:141], v[96:97], v[202:203], v[140:141] op_sel:[0,1,0] op_sel_hi:[1,1,1]
    v_pk_fma_f32 v[142:143], v[98:99], v[202:203], v[142:143] op_sel:[0,1,0] op_sel_hi:[1,1,1]
    v_cvt_pk_bf16_f32 v132, v136, v137
    v_cvt_pk_bf16_f32 v133, v138, v139
    v_cvt_pk_bf16_f32 v134, v140, v141
    v_cvt_pk_bf16_f32 v135, v142, v143
    buffer_store_dwordx4 v[132:135], v245, s[24:27], s3 offen offset:0 sc1
    v_accvgpr_read_b32 v148, a44
    v_accvgpr_read_b32 v149, a45
    v_accvgpr_read_b32 v150, a46
    v_accvgpr_read_b32 v151, a47
    v_accvgpr_read_b32 v152, a60
    v_accvgpr_read_b32 v153, a61
    v_accvgpr_read_b32 v154, a62
    v_accvgpr_read_b32 v155, a63
    v_pk_mul_f32 v[148:149], v[148:149], v[198:199] op_sel:[0,1] op_sel_hi:[1,1]
    v_pk_mul_f32 v[150:151], v[150:151], v[198:199] op_sel:[0,1] op_sel_hi:[1,1]
    v_pk_mul_f32 v[152:153], v[152:153], v[198:199] op_sel:[0,1] op_sel_hi:[1,1]
    v_pk_mul_f32 v[154:155], v[154:155], v[198:199] op_sel:[0,1] op_sel_hi:[1,1]
    v_pk_fma_f32 v[148:149], v[112:113], v[202:203], v[148:149] op_sel:[0,1,0] op_sel_hi:[1,1,1]
    v_pk_fma_f32 v[150:151], v[114:115], v[202:203], v[150:151] op_sel:[0,1,0] op_sel_hi:[1,1,1]
    v_pk_fma_f32 v[152:153], v[128:129], v[202:203], v[152:153] op_sel:[0,1,0] op_sel_hi:[1,1,1]
    v_pk_fma_f32 v[154:155], v[130:131], v[202:203], v[154:155] op_sel:[0,1,0] op_sel_hi:[1,1,1]
    v_cvt_pk_bf16_f32 v144, v148, v149
    v_cvt_pk_bf16_f32 v145, v150, v151
    v_cvt_pk_bf16_f32 v146, v152, v153
    v_cvt_pk_bf16_f32 v147, v154, v155
    buffer_store_dwordx4 v[144:147], v245, s[24:27], s3 offen offset:1024 sc1
    s_branch a2_fin_1
a2_fin1_1:
    s_mov_b32 s3, 0
    v_accvgpr_read_b32 v136, a64
    v_accvgpr_read_b32 v137, a65
    v_accvgpr_read_b32 v138, a66
    v_accvgpr_read_b32 v139, a67
    v_accvgpr_read_b32 v140, a80
    v_accvgpr_read_b32 v141, a81
    v_accvgpr_read_b32 v142, a82
    v_accvgpr_read_b32 v143, a83
    v_pk_mul_f32 v[136:137], v[136:137], v[196:197] op_sel:[0,0] op_sel_hi:[1,0]
    v_pk_mul_f32 v[138:139], v[138:139], v[196:197] op_sel:[0,0] op_sel_hi:[1,0]
    v_pk_mul_f32 v[140:141], v[140:141], v[196:197] op_sel:[0,0] op_sel_hi:[1,0]
    v_pk_mul_f32 v[142:143], v[142:143], v[196:197] op_sel:[0,0] op_sel_hi:[1,0]
    v_pk_fma_f32 v[136:137], v[68:69], v[200:201], v[136:137] op_sel:[0,0,0] op_sel_hi:[1,0,1]
    v_pk_fma_f32 v[138:139], v[70:71], v[200:201], v[138:139] op_sel:[0,0,0] op_sel_hi:[1,0,1]
    v_pk_fma_f32 v[140:141], v[84:85], v[200:201], v[140:141] op_sel:[0,0,0] op_sel_hi:[1,0,1]
    v_pk_fma_f32 v[142:143], v[86:87], v[200:201], v[142:143] op_sel:[0,0,0] op_sel_hi:[1,0,1]
    v_cvt_pk_bf16_f32 v132, v136, v137
    v_cvt_pk_bf16_f32 v133, v138, v139
    v_cvt_pk_bf16_f32 v134, v140, v141
    v_cvt_pk_bf16_f32 v135, v142, v143
    buffer_store_dwordx4 v[132:135], v245, s[24:27], s3 offen offset:0 sc1
    v_accvgpr_read_b32 v148, a96
    v_accvgpr_read_b32 v149, a97
    v_accvgpr_read_b32 v150, a98
    v_accvgpr_read_b32 v151, a99
    v_accvgpr_read_b32 v152, a112
    v_accvgpr_read_b32 v153, a113
    v_accvgpr_read_b32 v154, a114
    v_accvgpr_read_b32 v155, a115
    v_pk_mul_f32 v[148:149], v[148:149], v[196:197] op_sel:[0,0] op_sel_hi:[1,0]
    v_pk_mul_f32 v[150:151], v[150:151], v[196:197] op_sel:[0,0] op_sel_hi:[1,0]
    v_pk_mul_f32 v[152:153], v[152:153], v[196:197] op_sel:[0,0] op_sel_hi:[1,0]
    v_pk_mul_f32 v[154:155], v[154:155], v[196:197] op_sel:[0,0] op_sel_hi:[1,0]
    v_pk_fma_f32 v[148:149], v[100:101], v[200:201], v[148:149] op_sel:[0,0,0] op_sel_hi:[1,0,1]
    v_pk_fma_f32 v[150:151], v[102:103], v[200:201], v[150:151] op_sel:[0,0,0] op_sel_hi:[1,0,1]
    v_pk_fma_f32 v[152:153], v[116:117], v[200:201], v[152:153] op_sel:[0,0,0] op_sel_hi:[1,0,1]
    v_pk_fma_f32 v[154:155], v[118:119], v[200:201], v[154:155] op_sel:[0,0,0] op_sel_hi:[1,0,1]
    v_cvt_pk_bf16_f32 v144, v148, v149
    v_cvt_pk_bf16_f32 v145, v150, v151
    v_cvt_pk_bf16_f32 v146, v152, v153
    v_cvt_pk_bf16_f32 v147, v154, v155
    buffer_store_dwordx4 v[144:147], v245, s[24:27], s3 offen offset:1024 sc1
    s_mov_b32 s3, 245760
    v_accvgpr_read_b32 v136, a68
    v_accvgpr_read_b32 v137, a69
    v_accvgpr_read_b32 v138, a70
    v_accvgpr_read_b32 v139, a71
    v_accvgpr_read_b32 v140, a84
    v_accvgpr_read_b32 v141, a85
    v_accvgpr_read_b32 v142, a86
    v_accvgpr_read_b32 v143, a87
    v_pk_mul_f32 v[136:137], v[136:137], v[196:197] op_sel:[0,1] op_sel_hi:[1,1]
    v_pk_mul_f32 v[138:139], v[138:139], v[196:197] op_sel:[0,1] op_sel_hi:[1,1]
    v_pk_mul_f32 v[140:141], v[140:141], v[196:197] op_sel:[0,1] op_sel_hi:[1,1]
    v_pk_mul_f32 v[142:143], v[142:143], v[196:197] op_sel:[0,1] op_sel_hi:[1,1]
    v_pk_fma_f32 v[136:137], v[72:73], v[200:201], v[136:137] op_sel:[0,1,0] op_sel_hi:[1,1,1]
    v_pk_fma_f32 v[138:139], v[74:75], v[200:201], v[138:139] op_sel:[0,1,0] op_sel_hi:[1,1,1]
    v_pk_fma_f32 v[140:141], v[88:89], v[200:201], v[140:141] op_sel:[0,1,0] op_sel_hi:[1,1,1]
    v_pk_fma_f32 v[142:143], v[90:91], v[200:201], v[142:143] op_sel:[0,1,0] op_sel_hi:[1,1,1]
    v_cvt_pk_bf16_f32 v132, v136, v137
    v_cvt_pk_bf16_f32 v133, v138, v139
    v_cvt_pk_bf16_f32 v134, v140, v141
    v_cvt_pk_bf16_f32 v135, v142, v143
    buffer_store_dwordx4 v[132:135], v245, s[24:27], s3 offen offset:0 sc1
    v_accvgpr_read_b32 v148, a100
    v_accvgpr_read_b32 v149, a101
    v_accvgpr_read_b32 v150, a102
    v_accvgpr_read_b32 v151, a103
    v_accvgpr_read_b32 v152, a116
    v_accvgpr_read_b32 v153, a117
    v_accvgpr_read_b32 v154, a118
    v_accvgpr_read_b32 v155, a119
    v_pk_mul_f32 v[148:149], v[148:149], v[196:197] op_sel:[0,1] op_sel_hi:[1,1]
    v_pk_mul_f32 v[150:151], v[150:151], v[196:197] op_sel:[0,1] op_sel_hi:[1,1]
    v_pk_mul_f32 v[152:153], v[152:153], v[196:197] op_sel:[0,1] op_sel_hi:[1,1]
    v_pk_mul_f32 v[154:155], v[154:155], v[196:197] op_sel:[0,1] op_sel_hi:[1,1]
    v_pk_fma_f32 v[148:149], v[104:105], v[200:201], v[148:149] op_sel:[0,1,0] op_sel_hi:[1,1,1]
    v_pk_fma_f32 v[150:151], v[106:107], v[200:201], v[150:151] op_sel:[0,1,0] op_sel_hi:[1,1,1]
    v_pk_fma_f32 v[152:153], v[120:121], v[200:201], v[152:153] op_sel:[0,1,0] op_sel_hi:[1,1,1]
    v_pk_fma_f32 v[154:155], v[122:123], v[200:201], v[154:155] op_sel:[0,1,0] op_sel_hi:[1,1,1]
    v_cvt_pk_bf16_f32 v144, v148, v149
    v_cvt_pk_bf16_f32 v145, v150, v151
    v_cvt_pk_bf16_f32 v146, v152, v153
    v_cvt_pk_bf16_f32 v147, v154, v155
    buffer_store_dwordx4 v[144:147], v245, s[24:27], s3 offen offset:1024 sc1
    s_mov_b32 s3, 491520
    v_accvgpr_read_b32 v136, a72
    v_accvgpr_read_b32 v137, a73
    v_accvgpr_read_b32 v138, a74
    v_accvgpr_read_b32 v139, a75
    v_accvgpr_read_b32 v140, a88
    v_accvgpr_read_b32 v141, a89
    v_accvgpr_read_b32 v142, a90
    v_accvgpr_read_b32 v143, a91
    v_pk_mul_f32 v[136:137], v[136:137], v[198:199] op_sel:[0,0] op_sel_hi:[1,0]
    v_pk_mul_f32 v[138:139], v[138:139], v[198:199] op_sel:[0,0] op_sel_hi:[1,0]
    v_pk_mul_f32 v[140:141], v[140:141], v[198:199] op_sel:[0,0] op_sel_hi:[1,0]
    v_pk_mul_f32 v[142:143], v[142:143], v[198:199] op_sel:[0,0] op_sel_hi:[1,0]
    v_pk_fma_f32 v[136:137], v[76:77], v[202:203], v[136:137] op_sel:[0,0,0] op_sel_hi:[1,0,1]
    v_pk_fma_f32 v[138:139], v[78:79], v[202:203], v[138:139] op_sel:[0,0,0] op_sel_hi:[1,0,1]
    v_pk_fma_f32 v[140:141], v[92:93], v[202:203], v[140:141] op_sel:[0,0,0] op_sel_hi:[1,0,1]
    v_pk_fma_f32 v[142:143], v[94:95], v[202:203], v[142:143] op_sel:[0,0,0] op_sel_hi:[1,0,1]
    v_cvt_pk_bf16_f32 v132, v136, v137
    v_cvt_pk_bf16_f32 v133, v138, v139
    v_cvt_pk_bf16_f32 v134, v140, v141
    v_cvt_pk_bf16_f32 v135, v142, v143
    buffer_store_dwordx4 v[132:135], v245, s[24:27], s3 offen offset:0 sc1
    v_accvgpr_read_b32 v148, a104
    v_accvgpr_read_b32 v149, a105
    v_accvgpr_read_b32 v150, a106
    v_accvgpr_read_b32 v151, a107
    v_accvgpr_read_b32 v152, a120
    v_accvgpr_read_b32 v153, a121
    v_accvgpr_read_b32 v154, a122
    v_accvgpr_read_b32 v155, a123
    v_pk_mul_f32 v[148:149], v[148:149], v[198:199] op_sel:[0,0] op_sel_hi:[1,0]
    v_pk_mul_f32 v[150:151], v[150:151], v[198:199] op_sel:[0,0] op_sel_hi:[1,0]
    v_pk_mul_f32 v[152:153], v[152:153], v[198:199] op_sel:[0,0] op_sel_hi:[1,0]
    v_pk_mul_f32 v[154:155], v[154:155], v[198:199] op_sel:[0,0] op_sel_hi:[1,0]
    v_pk_fma_f32 v[148:149], v[108:109], v[202:203], v[148:149] op_sel:[0,0,0] op_sel_hi:[1,0,1]
    v_pk_fma_f32 v[150:151], v[110:111], v[202:203], v[150:151] op_sel:[0,0,0] op_sel_hi:[1,0,1]
    v_pk_fma_f32 v[152:153], v[124:125], v[202:203], v[152:153] op_sel:[0,0,0] op_sel_hi:[1,0,1]
    v_pk_fma_f32 v[154:155], v[126:127], v[202:203], v[154:155] op_sel:[0,0,0] op_sel_hi:[1,0,1]
    v_cvt_pk_bf16_f32 v144, v148, v149
    v_cvt_pk_bf16_f32 v145, v150, v151
    v_cvt_pk_bf16_f32 v146, v152, v153
    v_cvt_pk_bf16_f32 v147, v154, v155
    buffer_store_dwordx4 v[144:147], v245, s[24:27], s3 offen offset:1024 sc1
    s_mov_b32 s3, 737280
    v_accvgpr_read_b32 v136, a76
    v_accvgpr_read_b32 v137, a77
    v_accvgpr_read_b32 v138, a78
    v_accvgpr_read_b32 v139, a79
    v_accvgpr_read_b32 v140, a92
    v_accvgpr_read_b32 v141, a93
    v_accvgpr_read_b32 v142, a94
    v_accvgpr_read_b32 v143, a95
    v_pk_mul_f32 v[136:137], v[136:137], v[198:199] op_sel:[0,1] op_sel_hi:[1,1]
    v_pk_mul_f32 v[138:139], v[138:139], v[198:199] op_sel:[0,1] op_sel_hi:[1,1]
    v_pk_mul_f32 v[140:141], v[140:141], v[198:199] op_sel:[0,1] op_sel_hi:[1,1]
    v_pk_mul_f32 v[142:143], v[142:143], v[198:199] op_sel:[0,1] op_sel_hi:[1,1]
    v_pk_fma_f32 v[136:137], v[80:81], v[202:203], v[136:137] op_sel:[0,1,0] op_sel_hi:[1,1,1]
    v_pk_fma_f32 v[138:139], v[82:83], v[202:203], v[138:139] op_sel:[0,1,0] op_sel_hi:[1,1,1]
    v_pk_fma_f32 v[140:141], v[96:97], v[202:203], v[140:141] op_sel:[0,1,0] op_sel_hi:[1,1,1]
    v_pk_fma_f32 v[142:143], v[98:99], v[202:203], v[142:143] op_sel:[0,1,0] op_sel_hi:[1,1,1]
    v_cvt_pk_bf16_f32 v132, v136, v137
    v_cvt_pk_bf16_f32 v133, v138, v139
    v_cvt_pk_bf16_f32 v134, v140, v141
    v_cvt_pk_bf16_f32 v135, v142, v143
    buffer_store_dwordx4 v[132:135], v245, s[24:27], s3 offen offset:0 sc1
    v_accvgpr_read_b32 v148, a108
    v_accvgpr_read_b32 v149, a109
    v_accvgpr_read_b32 v150, a110
    v_accvgpr_read_b32 v151, a111
    v_accvgpr_read_b32 v152, a124
    v_accvgpr_read_b32 v153, a125
    v_accvgpr_read_b32 v154, a126
    v_accvgpr_read_b32 v155, a127
    v_pk_mul_f32 v[148:149], v[148:149], v[198:199] op_sel:[0,1] op_sel_hi:[1,1]
    v_pk_mul_f32 v[150:151], v[150:151], v[198:199] op_sel:[0,1] op_sel_hi:[1,1]
    v_pk_mul_f32 v[152:153], v[152:153], v[198:199] op_sel:[0,1] op_sel_hi:[1,1]
    v_pk_mul_f32 v[154:155], v[154:155], v[198:199] op_sel:[0,1] op_sel_hi:[1,1]
    v_pk_fma_f32 v[148:149], v[112:113], v[202:203], v[148:149] op_sel:[0,1,0] op_sel_hi:[1,1,1]
    v_pk_fma_f32 v[150:151], v[114:115], v[202:203], v[150:151] op_sel:[0,1,0] op_sel_hi:[1,1,1]
    v_pk_fma_f32 v[152:153], v[128:129], v[202:203], v[152:153] op_sel:[0,1,0] op_sel_hi:[1,1,1]
    v_pk_fma_f32 v[154:155], v[130:131], v[202:203], v[154:155] op_sel:[0,1,0] op_sel_hi:[1,1,1]
    v_cvt_pk_bf16_f32 v144, v148, v149
    v_cvt_pk_bf16_f32 v145, v150, v151
    v_cvt_pk_bf16_f32 v146, v152, v153
    v_cvt_pk_bf16_f32 v147, v154, v155
    buffer_store_dwordx4 v[144:147], v245, s[24:27], s3 offen offset:1024 sc1
a2_fin_1:
    s_lshl_b32 s3, s54, 1
    s_lshr_b32 s6, s52, 4
    s_add_u32 s3, s3, s6
    s_lshl_b32 s3, s3, 6
    s_and_b32 s6, s52, 15
    s_lshl_b32 s6, s6, 2
    s_add_u32 s3, s3, s6
    s_add_u32 s3, s3, 4096
    s_cmp_eq_u32 s101, 0
    s_cselect_b32 s72, s3, s72
    s_cmp_eq_u32 s71, 0
    s_cbranch_scc1 a2_done
    s_bfe_u32 s3, s71, 0x20004
    s_add_u32 s52, s53, s3
    s_and_b32 s54, s71, 15
    s_lshr_b32 s71, s71, 7
    s_mov_b32 s56, 0
    s_cmp_eq_u32 s71, 0
    s_cselect_b32 s55, 99, s54
    s_cmp_eq_u32 s54, 0
    s_cbranch_scc1 a2_z1
    s_nop 7
    s_waitcnt lgkmcnt(0)
    v_max3_f32 v232, v4, v5, v6
    v_max3_f32 v232, v232, v7, v20
    v_mfma_f32_16x16x32_bf16 a[0:3], a[244:247], a[244:247], 0
    v_max3_f32 v232, v232, v21, v22
    v_max3_f32 v232, v232, v23, v36
    v_mfma_f32_16x16x32_bf16 a[4:7], a[244:247], a[244:247], 0
    v_max3_f32 v232, v232, v37, v38
    v_max3_f32 v232, v232, v39, v52
    v_mfma_f32_16x16x32_bf16 a[8:11], a[244:247], a[244:247], 0
    v_max3_f32 v232, v232, v53, v54
    v_max_f32 v232, v232, v55
    v_mfma_f32_16x16x32_bf16 a[12:15], a[244:247], a[244:247], 0
    v_max3_f32 v233, v8, v9, v10
    v_max3_f32 v233, v233, v11, v24
    v_mfma_f32_16x16x32_bf16 a[16:19], a[244:247], a[244:247], 0
    v_max3_f32 v233, v233, v25, v26
    v_max3_f32 v233, v233, v27, v40
    v_mfma_f32_16x16x32_bf16 a[20:23], a[244:247], a[244:247], 0
    v_max3_f32 v233, v233, v41, v42
    v_max3_f32 v233, v233, v43, v56
    v_mfma_f32_16x16x32_bf16 a[24:27], a[244:247], a[244:247], 0
    v_max3_f32 v233, v233, v57, v58
    v_max_f32 v233, v233, v59
    v_mfma_f32_16x16x32_bf16 a[28:31], a[244:247], a[244:247], 0
    v_max3_f32 v234, v12, v13, v14
    v_max3_f32 v234, v234, v15, v28
    v_mfma_f32_16x16x32_bf16 a[32:35], a[244:247], a[244:247], 0
    v_max3_f32 v234, v234, v29, v30
    v_max3_f32 v234, v234, v31, v44
    v_mfma_f32_16x16x32_bf16 a[36:39], a[244:247], a[244:247], 0
    v_max3_f32 v234, v234, v45, v46
    v_max3_f32 v234, v234, v47, v60
    v_mfma_f32_16x16x32_bf16 a[40:43], a[244:247], a[244:247], 0
    v_max3_f32 v234, v234, v61, v62
    v_max_f32 v234, v234, v63
    v_mfma_f32_16x16x32_bf16 a[44:47], a[244:247], a[244:247], 0
    v_max3_f32 v235, v16, v17, v18
    v_max3_f32 v235, v235, v19, v32
    v_mfma_f32_16x16x32_bf16 a[48:51], a[244:247], a[244:247], 0
    v_max3_f32 v235, v235, v33, v34
    v_max3_f32 v235, v235, v35, v48
    v_mfma_f32_16x16x32_bf16 a[52:55], a[244:247], a[244:247], 0
    v_max3_f32 v235, v235, v49, v50
    v_max3_f32 v235, v235, v51, v64
    v_mfma_f32_16x16x32_bf16 a[56:59], a[244:247], a[244:247], 0
    v_max3_f32 v235, v235, v65, v66
    v_max_f32 v235, v235, v67
    v_mfma_f32_16x16x32_bf16 a[60:63], a[244:247], a[244:247], 0
    ds_bpermute_b32 v212, v241, v232
    ds_bpermute_b32 v213, v241, v233
    ds_bpermute_b32 v214, v241, v234
    ds_bpermute_b32 v215, v241, v235
    s_waitcnt lgkmcnt(0)
    v_max_f32 v232, v232, v212
    v_max_f32 v233, v233, v213
    v_mfma_f32_16x16x32_bf16 a[64:67], a[244:247], a[244:247], 0
    v_max_f32 v234, v234, v214
    v_max_f32 v235, v235, v215
    v_mfma_f32_16x16x32_bf16 a[68:71], a[244:247], a[244:247], 0
    ds_bpermute_b32 v212, v242, v232
    ds_bpermute_b32 v213, v242, v233
    ds_bpermute_b32 v214, v242, v234
    ds_bpermute_b32 v215, v242, v235
    s_waitcnt lgkmcnt(0)
    v_max_f32 v232, v232, v212
    v_max_f32 v233, v233, v213
    v_mfma_f32_16x16x32_bf16 a[72:75], a[244:247], a[244:247], 0
    v_max_f32 v234, v234, v214
    v_max_f32 v235, v235, v215
    v_mfma_f32_16x16x32_bf16 a[76:79], a[244:247], a[244:247], 0
    v_add_f32 v232, 0x40e00000, v232
    v_mov_b32 v228, v232
    v_mfma_f32_16x16x32_bf16 a[80:83], a[244:247], a[244:247], 0
    v_sub_f32 v196, 0, v228
    v_sub_f32 v197, 0, v228
    v_mfma_f32_16x16x32_bf16 a[84:87], a[244:247], a[244:247], 0
    v_sub_f32 v198, 0, v228
    v_sub_f32 v199, 0, v228
    v_mfma_f32_16x16x32_bf16 a[88:91], a[244:247], a[244:247], 0
    v_add_f32 v233, 0x40e00000, v233
    v_mov_b32 v229, v233
    v_mfma_f32_16x16x32_bf16 a[92:95], a[244:247], a[244:247], 0
    v_sub_f32 v200, 0, v229
    v_sub_f32 v201, 0, v229
    v_mfma_f32_16x16x32_bf16 a[96:99], a[244:247], a[244:247], 0
    v_sub_f32 v202, 0, v229
    v_sub_f32 v203, 0, v229
    v_mfma_f32_16x16x32_bf16 a[100:103], a[244:247], a[244:247], 0
    v_add_f32 v234, 0x40e00000, v234
    v_mov_b32 v230, v234
    v_mfma_f32_16x16x32_bf16 a[104:107], a[244:247], a[244:247], 0
    v_sub_f32 v204, 0, v230
    v_sub_f32 v205, 0, v230
    v_mfma_f32_16x16x32_bf16 a[108:111], a[244:247], a[244:247], 0
    v_sub_f32 v206, 0, v230
    v_sub_f32 v207, 0, v230
    v_mfma_f32_16x16x32_bf16 a[112:115], a[244:247], a[244:247], 0
    v_add_f32 v235, 0x40e00000, v235
    v_mov_b32 v231, v235
    v_mfma_f32_16x16x32_bf16 a[116:119], a[244:247], a[244:247], 0
    v_sub_f32 v208, 0, v231
    v_sub_f32 v209, 0, v231
    v_mfma_f32_16x16x32_bf16 a[120:123], a[244:247], a[244:247], 0
    v_sub_f32 v210, 0, v231
    v_sub_f32 v211, 0, v231
    v_mfma_f32_16x16x32_bf16 a[124:127], a[244:247], a[244:247], 0
    v_sub_f32 v4, v4, v232
    v_sub_f32 v5, v5, v232
    v_mfma_f32_16x16x32_bf16 a[128:131], a[244:247], a[244:247], 0
    v_sub_f32 v6, v6, v232
    v_sub_f32 v7, v7, v232
    v_mfma_f32_16x16x32_bf16 a[132:135], a[244:247], a[244:247], 0
    v_sub_f32 v8, v8, v233
    v_sub_f32 v9, v9, v233
    v_mfma_f32_16x16x32_bf16 a[136:139], a[244:247], a[244:247], 0
    v_sub_f32 v10, v10, v233
    v_sub_f32 v11, v11, v233
    v_mfma_f32_16x16x32_bf16 a[140:143], a[244:247], a[244:247], 0
    v_sub_f32 v12, v12, v234
    v_sub_f32 v13, v13, v234
    v_sub_f32 v14, v14, v234
    v_sub_f32 v15, v15, v234
    v_sub_f32 v16, v16, v235
    v_sub_f32 v17, v17, v235
    v_sub_f32 v18, v18, v235
    v_sub_f32 v19, v19, v235
    v_sub_f32 v20, v20, v232
    v_sub_f32 v21, v21, v232
    v_sub_f32 v22, v22, v232
    v_sub_f32 v23, v23, v232
    v_sub_f32 v24, v24, v233
    v_sub_f32 v25, v25, v233
    v_sub_f32 v26, v26, v233
    v_sub_f32 v27, v27, v233
    v_sub_f32 v28, v28, v234
    v_sub_f32 v29, v29, v234
    v_sub_f32 v30, v30, v234
    v_sub_f32 v31, v31, v234
    v_sub_f32 v32, v32, v235
    v_sub_f32 v33, v33, v235
    v_sub_f32 v34, v34, v235
    v_sub_f32 v35, v35, v235
    v_sub_f32 v36, v36, v232
    v_sub_f32 v37, v37, v232
    v_sub_f32 v38, v38, v232
    v_sub_f32 v39, v39, v232
    v_sub_f32 v40, v40, v233
    v_sub_f32 v41, v41, v233
    v_sub_f32 v42, v42, v233
    v_sub_f32 v43, v43, v233
    v_sub_f32 v44, v44, v234
    v_sub_f32 v45, v45, v234
    v_sub_f32 v46, v46, v234
    v_sub_f32 v47, v47, v234
    v_sub_f32 v48, v48, v235
    v_sub_f32 v49, v49, v235
    v_sub_f32 v50, v50, v235
    v_sub_f32 v51, v51, v235
    v_sub_f32 v52, v52, v232
    v_sub_f32 v53, v53, v232
    v_sub_f32 v54, v54, v232
    v_sub_f32 v55, v55, v232
    v_sub_f32 v56, v56, v233
    v_sub_f32 v57, v57, v233
    v_sub_f32 v58, v58, v233
    v_sub_f32 v59, v59, v233
    v_sub_f32 v60, v60, v234
    v_sub_f32 v61, v61, v234
    v_sub_f32 v62, v62, v234
    v_sub_f32 v63, v63, v234
    v_sub_f32 v64, v64, v235
    v_sub_f32 v65, v65, v235
    v_sub_f32 v66, v66, v235
    v_sub_f32 v67, v67, v235
    s_nop 1
    v_exp_f32 v212, v8
    v_exp_f32 v213, v9
    v_exp_f32 v214, v10
    v_exp_f32 v215, v11
    v_exp_f32 v216, v12
    v_exp_f32 v217, v13
    v_cvt_pk_bf16_f32 v136, v212, v213
    v_exp_f32 v218, v14
    v_cvt_pk_bf16_f32 v137, v214, v215
    v_exp_f32 v219, v15
    v_exp_f32 v212, v16
    v_exp_f32 v213, v17
    v_cvt_pk_bf16_f32 v140, v216, v217
    v_exp_f32 v214, v18
    v_cvt_pk_bf16_f32 v141, v218, v219
    v_exp_f32 v215, v19
    v_or_b32 v244, v136, v137
    v_exp_f32 v216, v28
    v_exp_f32 v217, v29
    v_cvt_pk_bf16_f32 v144, v212, v213
    v_exp_f32 v218, v30
    v_cvt_pk_bf16_f32 v145, v214, v215
    v_exp_f32 v219, v31
    v_or3_b32 v244, v244, v140, v141
    v_exp_f32 v212, v32
    v_exp_f32 v213, v33
    v_cvt_pk_bf16_f32 v142, v216, v217
    v_exp_f32 v214, v34
    v_cvt_pk_bf16_f32 v143, v218, v219
    v_exp_f32 v215, v35
    v_or3_b32 v244, v244, v144, v145
    v_cvt_pk_bf16_f32 v146, v212, v213
    v_cvt_pk_bf16_f32 v147, v214, v215
    v_or3_b32 v244, v244, v142, v143
    v_or3_b32 v244, v244, v146, v147
    s_branch a2_it0
a2_z1:
    v_mfma_f32_16x16x32_bf16 a[0:3], a[244:247], a[244:247], 0
    v_mfma_f32_16x16x32_bf16 a[4:7], a[244:247], a[244:247], 0
    v_mfma_f32_16x16x32_bf16 a[8:11], a[244:247], a[244:247], 0
    v_mfma_f32_16x16x32_bf16 a[12:15], a[244:247], a[244:247], 0
    v_mfma_f32_16x16x32_bf16 a[16:19], a[244:247], a[244:247], 0
    v_mfma_f32_16x16x32_bf16 a[20:23], a[244:247], a[244:247], 0
    v_mfma_f32_16x16x32_bf16 a[24:27], a[244:247], a[244:247], 0
    v_mfma_f32_16x16x32_bf16 a[28:31], a[244:247], a[244:247], 0
    v_mfma_f32_16x16x32_bf16 a[32:35], a[244:247], a[244:247], 0
    v_mfma_f32_16x16x32_bf16 a[36:39], a[244:247], a[244:247], 0
    v_mfma_f32_16x16x32_bf16 a[40:43], a[244:247], a[244:247], 0
    v_mfma_f32_16x16x32_bf16 a[44:47], a[244:247], a[244:247], 0
    v_mfma_f32_16x16x32_bf16 a[48:51], a[244:247], a[244:247], 0
    v_mfma_f32_16x16x32_bf16 a[52:55], a[244:247], a[244:247], 0
    v_mfma_f32_16x16x32_bf16 a[56:59], a[244:247], a[244:247], 0
    v_mfma_f32_16x16x32_bf16 a[60:63], a[244:247], a[244:247], 0
    v_mfma_f32_16x16x32_bf16 a[64:67], a[244:247], a[244:247], 0
    v_mfma_f32_16x16x32_bf16 a[68:71], a[244:247], a[244:247], 0
    v_mfma_f32_16x16x32_bf16 a[72:75], a[244:247], a[244:247], 0
    v_mfma_f32_16x16x32_bf16 a[76:79], a[244:247], a[244:247], 0
    v_mfma_f32_16x16x32_bf16 a[80:83], a[244:247], a[244:247], 0
    v_mfma_f32_16x16x32_bf16 a[84:87], a[244:247], a[244:247], 0
    v_mfma_f32_16x16x32_bf16 a[88:91], a[244:247], a[244:247], 0
    v_mfma_f32_16x16x32_bf16 a[92:95], a[244:247], a[244:247], 0
    v_mfma_f32_16x16x32_bf16 a[96:99], a[244:247], a[244:247], 0
    v_mfma_f32_16x16x32_bf16 a[100:103], a[244:247], a[244:247], 0
    v_mfma_f32_16x16x32_bf16 a[104:107], a[244:247], a[244:247], 0
    v_mfma_f32_16x16x32_bf16 a[108:111], a[244:247], a[244:247], 0
    v_mfma_f32_16x16x32_bf16 a[112:115], a[244:247], a[244:247], 0
    v_mfma_f32_16x16x32_bf16 a[116:119], a[244:247], a[244:247], 0
    v_mfma_f32_16x16x32_bf16 a[120:123], a[244:247], a[244:247], 0
    v_mfma_f32_16x16x32_bf16 a[124:127], a[244:247], a[244:247], 0
    v_mfma_f32_16x16x32_bf16 a[128:131], a[244:247], a[244:247], 0
    v_mfma_f32_16x16x32_bf16 a[132:135], a[244:247], a[244:247], 0
    v_mfma_f32_16x16x32_bf16 a[136:139], a[244:247], a[244:247], 0
    v_mfma_f32_16x16x32_bf16 a[140:143], a[244:247], a[244:247], 0
    v_mov_b32 v228, v243
    v_mov_b32 v229, v243
    v_mov_b32 v230, v243
    v_mov_b32 v231, v243
    s_branch a2_it0
a2_done:
    s_waitcnt vmcnt(0)
    s_barrier
    s_mov_b64 exec, 1
    buffer_store_dword v243, v236, s[36:39], s72 offen sc1
    s_mov_b64 exec, -1
    s_brev_b32 s72, 1
    s_load_dwordx16 s[8:23], s[0:1], 0
    s_load_dwordx8 s[24:31], s[0:1], 64
    s_load_dwordx4 s[32:35], s[0:1], 96
    v_mbcnt_lo_u32_b32 v240, -1, 0
    v_mbcnt_hi_u32_b32 v240, -1, v240
    s_lshr_b32 s57, s101, 1
    s_and_b32 s58, s101, 1
    s_and_b32 s61, s2, 1
    s_lshr_b32 s4, s2, 3
    s_bfe_u32 s5, s2, 0x10002
    s_lshl_b32 s5, s5, 3
    s_and_b32 s6, s4, 7
    s_add_u32 s59, s5, s6
    s_bfe_u32 s5, s2, 0x10001
    s_lshl_b32 s5, s5, 2
    s_lshr_b32 s6, s4, 3
    s_add_u32 s60, s5, s6
    s_waitcnt lgkmcnt(0)
    s_add_u32 s88, s34, 84934656
    s_addc_u32 s89, s35, 0
    s_mov_b32 s90, 16384
    s_mov_b32 s91, 0x20000
    s_lshr_b32 s66, s59, 1
    s_lshl_b32 s66, s66, 7
    s_add_u32 s66, s66, 2048
    s_cmp_eq_u32 s100, 1
    s_cbranch_scc1 g3_w0_ok
    v_lshlrev_b32 v238, 2, v240
    s_mov_b32 s3, 0
g3_w0:
    buffer_load_dword v236, v238, s[88:91], s66 offen sc1
    s_waitcnt vmcnt(0)
    v_cmp_eq_u32 vcc, 0, v236
    s_mov_b32 s4, 4294967295
    s_mov_b32 s5, 0
    s_and_b64 vcc, vcc, s[4:5]
    s_cbranch_scc0 g3_w0_ok
    s_sleep 8
    s_add_u32 s3, s3, 1
    s_cmp_lt_u32 s3, 100000
    s_cbranch_scc1 g3_w0
g3_w0_ok:
    s_add_u32 s36, s34, 50331648
    s_addc_u32 s37, s35, 0
    s_mov_b32 s38, 31457280
    s_mov_b32 s39, 0x20000
    s_mov_b32 s40, s26
    s_mov_b32 s41, s27
    s_mov_b32 s42, 7340032
    s_mov_b32 s43, 0x20000
    s_mov_b32 s92, s26
    s_mov_b32 s93, s27
    s_mov_b32 s94, 7340032
    s_mov_b32 s95, 0x20000
    s_mov_b32 s63, 245760
    s_mov_b32 s65, 2048
    s_mul_i32 s62, s59, 1966080
    s_mul_i32 s3, s61, 65536
    s_add_u32 s62, s62, s3
    s_mul_i32 s5, s61, 4194304
    s_lshl_b32 s6, s60, 8
    s_add_u32 s7, s5, s6
    s_lshl_b32 s3, s57, 7
    s_add_u32 s64, s7, s3
    s_mul_i32 s3, s101, 4
    s_lshr_b32 s4, s3, 1
    s_mul_i32 s4, s4, s63
    s_and_b32 s3, s3, 1
    s_lshl_b32 s3, s3, 10
    s_add_u32 s3, s3, s4
    s_add_u32 s3, s3, s62
    v_lshlrev_b32 v241, 4, v240
    v_add_u32 v169, s3, v241
    s_mul_i32 s44, s63, 0
    s_mul_i32 s45, s63, 0
    s_mul_i32 s46, s63, 1
    s_sub_u32 s46, s46, 2048
    s_mul_i32 s47, s63, 1
    s_sub_u32 s47, s47, 2048
    s_mov_b32 s54, 2048
    v_lshrrev_b32 v241, 3, v240
    s_mul_i32 s3, s101, 4
    s_and_b32 s3, s3, 7
    s_lshl_b32 s3, s3, 3
    v_add_u32 v241, s3, v241
    v_mul_lo_u32 v241, v241, s65
    v_add_u32 v241, s64, v241
    v_and_b32 v242, 7, v240
    v_bfe_u32 v243, v240, 4, 2
    v_lshlrev_b32 v243, 1, v243
    v_xor_b32 v242, v242, v243
    v_lshl_add_u32 v170, v242, 4, v241
    s_mul_i32 s48, s65, 0
    s_mul_i32 s49, s65, 8
    s_sub_u32 s49, s49, 1024
    s_mul_i32 s50, s65, 16
    s_sub_u32 s50, s50, 2048
    s_mul_i32 s51, s65, 24
    s_sub_u32 s51, s51, 3072
    s_lshl_b32 s55, s65, 6
    v_lshlrev_b32 v241, 4, v240
    s_mul_i32 s3, s57, 8192
    v_add_u32 v164, s3, v241
    v_lshrrev_b32 v241, 4, v240
    v_lshlrev_b32 v241, 2, v241
    v_bfe_u32 v242, v240, 2, 2
    v_add_u32 v241, v241, v242
    v_bfe_u32 v242, v241, 1, 2
    v_lshlrev_b32 v242, 5, v242
    v_lshlrev_b32 v241, 7, v241
    v_and_b32 v243, 3, v240
    v_lshl_add_u32 v241, v243, 3, v241
    s_mul_i32 s3, s58, 128
    s_lshr_b32 s4, s3, 7
    s_lshl_b32 s4, s4, 13
    s_add_u32 s4, s4, 65536
    s_and_b32 s3, s3, 127
    v_add_u32 v241, s4, v241
    v_xor_b32 v242, s3, v242
    v_xor_b32 v243, 0, v242
    v_add_u32 v165, v241, v243
    v_xor_b32 v243, 32, v242
    v_add_u32 v166, v241, v243
    v_xor_b32 v243, 64, v242
    v_add_u32 v167, v241, v243
    v_xor_b32 v243, 96, v242
    v_add_u32 v168, v241, v243
    s_mul_i32 s52, s101, 4096
    s_add_u32 s52, s52, 0
    s_mul_i32 s53, s101, 4096
    s_add_u32 s53, s53, 65536
    s_add_u32 m0, s53, 0
    s_nop 0
    buffer_load_dwordx4 v170, s[40:43], s48 offen offset:0 lds
    buffer_load_dwordx4 v170, s[40:43], s49 offen offset:1024 lds
    buffer_load_dwordx4 v170, s[40:43], s50 offen offset:2048 lds
    buffer_load_dwordx4 v170, s[40:43], s51 offen offset:3072 lds
    v_add_u32 v170, s55, v170
    s_add_u32 m0, s52, 0
    s_nop 0
    buffer_load_dwordx4 v169, s[36:39], s44 offen offset:0 lds
    buffer_load_dwordx4 v169, s[36:39], s45 offen offset:1024 lds
    buffer_load_dwordx4 v169, s[36:39], s46 offen offset:2048 lds
    buffer_load_dwordx4 v169, s[36:39], s47 offen offset:3072 lds
    v_add_u32 v169, s54, v169
    s_add_u32 m0, s53, 16384
    s_nop 0
    buffer_load_dwordx4 v170, s[40:43], s48 offen offset:0 lds
    buffer_load_dwordx4 v170, s[40:43], s49 offen offset:1024 lds
    buffer_load_dwordx4 v170, s[40:43], s50 offen offset:2048 lds
    buffer_load_dwordx4 v170, s[40:43], s51 offen offset:3072 lds
    v_add_u32 v170, s55, v170
    s_add_u32 m0, s52, 16384
    s_nop 0
    buffer_load_dwordx4 v169, s[36:39], s44 offen offset:0 lds
    buffer_load_dwordx4 v169, s[36:39], s45 offen offset:1024 lds
    buffer_load_dwordx4 v169, s[36:39], s46 offen offset:2048 lds
    buffer_load_dwordx4 v169, s[36:39], s47 offen offset:3072 lds
    v_add_u32 v169, s54, v169
    s_add_u32 m0, s53, 32768
    s_nop 0
    buffer_load_dwordx4 v170, s[40:43], s48 offen offset:0 lds
    buffer_load_dwordx4 v170, s[40:43], s49 offen offset:1024 lds
    buffer_load_dwordx4 v170, s[40:43], s50 offen offset:2048 lds
    buffer_load_dwordx4 v170, s[40:43], s51 offen offset:3072 lds
    v_add_u32 v170, s55, v170
    s_add_u32 m0, s52, 32768
    s_nop 0
    buffer_load_dwordx4 v169, s[36:39], s44 offen offset:0 lds
    buffer_load_dwordx4 v169, s[36:39], s45 offen offset:1024 lds
    buffer_load_dwordx4 v169, s[36:39], s46 offen offset:2048 lds
    buffer_load_dwordx4 v169, s[36:39], s47 offen offset:3072 lds
    v_add_u32 v169, s54, v169
    s_add_u32 m0, s53, 49152
    s_nop 0
    buffer_load_dwordx4 v170, s[40:43], s48 offen offset:0 lds
    buffer_load_dwordx4 v170, s[40:43], s49 offen offset:1024 lds
    buffer_load_dwordx4 v170, s[40:43], s50 offen offset:2048 lds
    buffer_load_dwordx4 v170, s[40:43], s51 offen offset:3072 lds
    v_add_u32 v170, s55, v170
    s_mov_b32 s70, 2048
    s_cmp_eq_u32 s61, 0
    s_mov_b32 s3, 49152
    s_cselect_b32 s68, s3, 65536
    s_mov_b32 s3, 4290772992
    s_cselect_b32 s69, s3, 4291821568
    s_cselect_b32 s56, 8, 6
    s_mov_b32 s76, s30
    s_mov_b32 s77, s31
    s_mov_b32 s78, 4194304
    s_mov_b32 s79, 0x20000
    s_add_u32 s80, s34, 83886080
    s_addc_u32 s81, s35, 0
    s_mov_b32 s82, 8192
    s_mov_b32 s83, 0x20000
    s_add_u32 s84, s34, 85983232
    s_addc_u32 s85, s35, 0
    s_mov_b32 s86, 8388608
    s_mov_b32 s87, 0x20000
    s_and_b32 s3, s60, 3
    s_lshl_b32 s3, s3, 1
    s_add_u32 s3, s3, s57
    s_mul_i32 s3, s3, s63
    s_add_u32 s3, s3, s62
    s_lshl_b32 s4, s58, 12
    s_add_u32 s3, s3, s4
    v_lshlrev_b32 v251, 7, v240
    v_add_u32 v251, s3, v251
    v_bfrev_b32 v244, 1
    v_cmp_gt_u32 vcc, 32, v240
    s_nop 1
    v_cndmask_b32 v251, v244, v251, vcc
    s_and_b32 s3, s59, 7
    s_lshl_b32 s3, s3, 3
    s_lshl_b32 s4, s101, 6
    s_add_u32 s3, s3, s4
    v_lshrrev_b32 v252, 1, v240
    v_add_u32 v252, s3, v252
    v_lshlrev_b32 v252, 11, v252
    v_and_b32 v243, 1, v240
    v_lshl_add_u32 v252, v243, 7, v252
    v_add_u32 v252, s7, v252
    v_cmp_gt_u32 vcc, 16, v240
    s_nop 1
    v_cndmask_b32 v252, v244, v252, vcc
    v_add_u32 v251, 0x2000, v251
    v_add_u32 v252, 524288, v252
    buffer_load_dword v253, v251, s[36:39], 0 offen
    v_add_u32 v251, 0x2000, v251
    buffer_load_dword v253, v252, s[92:95], 0 offen
    v_add_u32 v252, 524288, v252
    s_lshl_b32 s66, s59, 1
    s_add_u32 s66, s66, s61
    s_lshl_b32 s66, s66, 6
    s_add_u32 s66, s66, 4096
    v_and_b32 v255, 15, v240
    v_lshlrev_b32 v255, 2, v255
    s_brev_b32 s73, 1
    s_mov_b32 s72, s73
    s_lshl_b32 s3, s59, 7
    s_lshl_b32 s4, s57, 6
    s_add_u32 s3, s3, s4
    v_and_b32 v241, 15, v240
    v_add_u32 v241, s3, v241
    v_lshlrev_b32 v242, 2, v241
    buffer_load_dword v246, v242, s[80:83], 0 offen offset:0
    buffer_load_dword v247, v242, s[80:83], 0 offen offset:64
    buffer_load_dword v248, v242, s[80:83], 0 offen offset:128
    buffer_load_dword v249, v242, s[80:83], 0 offen offset:192
    v_lshlrev_b32 v245, 11, v241
    v_lshrrev_b32 v243, 4, v240
    v_lshl_add_u32 v245, v243, 3, v245
    s_lshl_b32 s3, s60, 8
    s_lshl_b32 s4, s58, 7
    s_add_u32 s3, s3, s4
    v_add_u32 v245, s3, v245
    s_lshl_b32 s3, s59, 3
    s_add_u32 s3, s3, s60
    s_lshl_b32 s3, s3, 2
    s_add_u32 s67, s3, s101
    s_lshl_b32 s3, s67, 14
    s_lshl_b32 s4, s61, 13
    s_add_u32 s3, s3, s4
    v_lshlrev_b32 v250, 4, v240
    v_add_u32 v250, s3, v250
    s_lshl_b32 s3, s67, 3
    s_lshl_b32 s4, s61, 2
    s_add_u32 s3, s3, s4
    s_add_u32 s71, s3, 8192
    v_mov_b32 v172, 0
    v_mov_b32 v173, 0
    v_mov_b32 v174, 0
    v_mov_b32 v175, 0
    v_mov_b32 v176, 0
    v_mov_b32 v177, 0
    v_mov_b32 v178, 0
    v_mov_b32 v179, 0
    v_mov_b32 v180, 0
    v_mov_b32 v181, 0
    v_mov_b32 v182, 0
    v_mov_b32 v183, 0
    v_mov_b32 v184, 0
    v_mov_b32 v185, 0
    v_mov_b32 v186, 0
    v_mov_b32 v187, 0
    v_mov_b32 v188, 0
    v_mov_b32 v189, 0
    v_mov_b32 v190, 0
    v_mov_b32 v191, 0
    v_mov_b32 v192, 0
    v_mov_b32 v193, 0
    v_mov_b32 v194, 0
    v_mov_b32 v195, 0
    v_mov_b32 v196, 0
    v_mov_b32 v197, 0
    v_mov_b32 v198, 0
    v_mov_b32 v199, 0
    v_mov_b32 v200, 0
    v_mov_b32 v201, 0
    v_mov_b32 v202, 0
    v_mov_b32 v203, 0
    v_mov_b32 v204, 0
    v_mov_b32 v205, 0
    v_mov_b32 v206, 0
    v_mov_b32 v207, 0
    v_mov_b32 v208, 0
    v_mov_b32 v209, 0
    v_mov_b32 v210, 0
    v_mov_b32 v211, 0
    v_mov_b32 v212, 0
    v_mov_b32 v213, 0
    v_mov_b32 v214, 0
    v_mov_b32 v215, 0
    v_mov_b32 v216, 0
    v_mov_b32 v217, 0
    v_mov_b32 v218, 0
    v_mov_b32 v219, 0
    v_mov_b32 v220, 0
    v_mov_b32 v221, 0
    v_mov_b32 v222, 0
    v_mov_b32 v223, 0
    v_mov_b32 v224, 0
    v_mov_b32 v225, 0
    v_mov_b32 v226, 0
    v_mov_b32 v227, 0
    v_mov_b32 v228, 0
    v_mov_b32 v229, 0
    v_mov_b32 v230, 0
    v_mov_b32 v231, 0
    v_mov_b32 v232, 0
    v_mov_b32 v233, 0
    v_mov_b32 v234, 0
    v_mov_b32 v235, 0
    v_mov_b32 v4, 0
    v_mov_b32 v5, 0
    v_mov_b32 v6, 0
    v_mov_b32 v7, 0
    v_mov_b32 v8, 0
    v_mov_b32 v9, 0
    v_mov_b32 v10, 0
    v_mov_b32 v11, 0
    v_mov_b32 v12, 0
    v_mov_b32 v13, 0
    v_mov_b32 v14, 0
    v_mov_b32 v15, 0
    v_mov_b32 v16, 0
    v_mov_b32 v17, 0
    v_mov_b32 v18, 0
    v_mov_b32 v19, 0
    v_mov_b32 v20, 0
    v_mov_b32 v21, 0
    v_mov_b32 v22, 0
    v_mov_b32 v23, 0
    v_mov_b32 v24, 0
    v_mov_b32 v25, 0
    v_mov_b32 v26, 0
    v_mov_b32 v27, 0
    v_mov_b32 v28, 0
    v_mov_b32 v29, 0
    v_mov_b32 v30, 0
    v_mov_b32 v31, 0
    v_mov_b32 v32, 0
    v_mov_b32 v33, 0
    v_mov_b32 v34, 0
    v_mov_b32 v35, 0
    v_mov_b32 v36, 0
    v_mov_b32 v37, 0
    v_mov_b32 v38, 0
    v_mov_b32 v39, 0
    v_mov_b32 v40, 0
    v_mov_b32 v41, 0
    v_mov_b32 v42, 0
    v_mov_b32 v43, 0
    v_mov_b32 v44, 0
    v_mov_b32 v45, 0
    v_mov_b32 v46, 0
    v_mov_b32 v47, 0
    v_mov_b32 v48, 0
    v_mov_b32 v49, 0
    v_mov_b32 v50, 0
    v_mov_b32 v51, 0
    v_mov_b32 v52, 0
    v_mov_b32 v53, 0
    v_mov_b32 v54, 0
    v_mov_b32 v55, 0
    v_mov_b32 v56, 0
    v_mov_b32 v57, 0
    v_mov_b32 v58, 0
    v_mov_b32 v59, 0
    v_mov_b32 v60, 0
    v_mov_b32 v61, 0
    v_mov_b32 v62, 0
    v_mov_b32 v63, 0
    v_mov_b32 v64, 0
    v_mov_b32 v65, 0
    v_mov_b32 v66, 0
    v_mov_b32 v67, 0
    s_waitcnt vmcnt(26)
    s_barrier
    ds_read_b128 v[68:71], v164 offset:0
    ds_read_b128 v[72:75], v164 offset:1024
    ds_read_b64_tr_b16 v[132:133], v165 offset:0
    ds_read_b64_tr_b16 v[134:135], v165 offset:2048
    ds_read_b64_tr_b16 v[136:137], v165 offset:4096
    ds_read_b64_tr_b16 v[138:139], v165 offset:6144
    ds_read_b128 v[76:79], v164 offset:2048
    ds_read_b128 v[80:83], v164 offset:3072
    ds_read_b128 v[84:87], v164 offset:4096
    ds_read_b128 v[88:91], v164 offset:5120
    ds_read_b128 v[92:95], v164 offset:6144
    ds_read_b128 v[96:99], v164 offset:7168
    ds_read_b64_tr_b16 v[140:141], v166 offset:0
    ds_read_b64_tr_b16 v[142:143], v166 offset:2048
    ds_read_b64_tr_b16 v[144:145], v166 offset:4096
    ds_read_b64_tr_b16 v[146:147], v166 offset:6144
g3_l1:
    s_waitcnt lgkmcnt(12)
    v_mfma_f32_16x16x32_bf16 v[4:7], v[132:135], v[68:71], v[4:7]
    s_waitcnt lgkmcnt(10)
    s_add_u32 m0, s52, 49152
    v_mfma_f32_16x16x32_bf16 v[4:7], v[136:139], v[72:75], v[4:7]
    s_waitcnt lgkmcnt(9)
    buffer_load_dwordx4 v169, s[36:39], s44 offen offset:0 lds
    v_mfma_f32_16x16x32_bf16 v[8:11], v[132:135], v[76:79], v[8:11]
    s_waitcnt lgkmcnt(8)
    ds_read_b64_tr_b16 v[148:149], v167 offset:0
    v_mfma_f32_16x16x32_bf16 v[8:11], v[136:139], v[80:83], v[8:11]
    s_waitcnt lgkmcnt(8)
    ds_read_b64_tr_b16 v[150:151], v167 offset:2048
    v_mfma_f32_16x16x32_bf16 v[12:15], v[132:135], v[84:87], v[12:15]
    s_waitcnt lgkmcnt(8)
    ds_read_b64_tr_b16 v[152:153], v167 offset:4096
    buffer_load_dwordx4 v169, s[36:39], s45 offen offset:1024 lds
    v_mfma_f32_16x16x32_bf16 v[12:15], v[136:139], v[88:91], v[12:15]
    s_waitcnt lgkmcnt(8)
    ds_read_b64_tr_b16 v[154:155], v167 offset:6144
    v_mfma_f32_16x16x32_bf16 v[16:19], v[132:135], v[92:95], v[16:19]
    s_waitcnt lgkmcnt(8)
    ds_read_b64_tr_b16 v[156:157], v168 offset:0
    v_mfma_f32_16x16x32_bf16 v[16:19], v[136:139], v[96:99], v[16:19]
    s_waitcnt lgkmcnt(5)
    ds_read_b64_tr_b16 v[158:159], v168 offset:2048
    buffer_load_dwordx4 v169, s[36:39], s46 offen offset:2048 lds
    v_mfma_f32_16x16x32_bf16 v[20:23], v[140:143], v[68:71], v[20:23]
    ds_read_b64_tr_b16 v[160:161], v168 offset:4096
    v_mfma_f32_16x16x32_bf16 v[20:23], v[144:147], v[72:75], v[20:23]
    ds_read_b64_tr_b16 v[162:163], v168 offset:6144
    v_mfma_f32_16x16x32_bf16 v[24:27], v[140:143], v[76:79], v[24:27]
    buffer_load_dwordx4 v169, s[36:39], s47 offen offset:3072 lds
    v_add_u32 v169, s70, v169
    v_mfma_f32_16x16x32_bf16 v[24:27], v[144:147], v[80:83], v[24:27]
    v_mfma_f32_16x16x32_bf16 v[28:31], v[140:143], v[84:87], v[28:31]
    v_mfma_f32_16x16x32_bf16 v[28:31], v[144:147], v[88:91], v[28:31]
    buffer_load_dword v253, v251, s[36:39], 0 offen
    v_add_u32 v251, 0x2000, v251
    v_mfma_f32_16x16x32_bf16 v[32:35], v[140:143], v[92:95], v[32:35]
    v_mfma_f32_16x16x32_bf16 v[32:35], v[144:147], v[96:99], v[32:35]
    buffer_load_dword v254, v255, s[88:91], s72 offen sc1
    s_waitcnt vmcnt(19) lgkmcnt(0)
    s_barrier
    v_mfma_f32_16x16x32_bf16 v[36:39], v[148:151], v[68:71], v[36:39]
    s_add_u32 m0, s53, 0
    ds_read_b128 v[100:103], v164 offset:16384
    v_mfma_f32_16x16x32_bf16 v[36:39], v[152:155], v[72:75], v[36:39]
    ds_read_b128 v[104:107], v164 offset:17408
    buffer_load_dwordx4 v170, s[40:43], s48 offen offset:0 lds
    v_mfma_f32_16x16x32_bf16 v[40:43], v[148:151], v[76:79], v[40:43]
    ds_read_b64_tr_b16 v[132:133], v165 offset:16384
    v_mfma_f32_16x16x32_bf16 v[40:43], v[152:155], v[80:83], v[40:43]
    ds_read_b64_tr_b16 v[134:135], v165 offset:18432
    v_mfma_f32_16x16x32_bf16 v[44:47], v[148:151], v[84:87], v[44:47]
    ds_read_b64_tr_b16 v[136:137], v165 offset:20480
    buffer_load_dwordx4 v170, s[40:43], s49 offen offset:1024 lds
    v_mfma_f32_16x16x32_bf16 v[44:47], v[152:155], v[88:91], v[44:47]
    ds_read_b64_tr_b16 v[138:139], v165 offset:22528
    v_mfma_f32_16x16x32_bf16 v[48:51], v[148:151], v[92:95], v[48:51]
    ds_read_b128 v[108:111], v164 offset:18432
    v_mfma_f32_16x16x32_bf16 v[48:51], v[152:155], v[96:99], v[48:51]
    ds_read_b128 v[112:115], v164 offset:19456
    buffer_load_dwordx4 v170, s[40:43], s50 offen offset:2048 lds
    v_mfma_f32_16x16x32_bf16 v[52:55], v[156:159], v[68:71], v[52:55]
    ds_read_b128 v[116:119], v164 offset:20480
    v_mfma_f32_16x16x32_bf16 v[52:55], v[160:163], v[72:75], v[52:55]
    ds_read_b128 v[120:123], v164 offset:21504
    v_mfma_f32_16x16x32_bf16 v[56:59], v[156:159], v[76:79], v[56:59]
    ds_read_b128 v[124:127], v164 offset:22528
    buffer_load_dwordx4 v170, s[40:43], s51 offen offset:3072 lds
    v_mfma_f32_16x16x32_bf16 v[56:59], v[160:163], v[80:83], v[56:59]
    ds_read_b128 v[128:131], v164 offset:23552
    v_add_u32 v170, s55, v170
    v_mfma_f32_16x16x32_bf16 v[60:63], v[156:159], v[84:87], v[60:63]
    ds_read_b64_tr_b16 v[140:141], v166 offset:16384
    v_mfma_f32_16x16x32_bf16 v[60:63], v[160:163], v[88:91], v[60:63]
    ds_read_b64_tr_b16 v[142:143], v166 offset:18432
    v_mfma_f32_16x16x32_bf16 v[64:67], v[156:159], v[92:95], v[64:67]
    ds_read_b64_tr_b16 v[144:145], v166 offset:20480
    v_mfma_f32_16x16x32_bf16 v[64:67], v[160:163], v[96:99], v[64:67]
    ds_read_b64_tr_b16 v[146:147], v166 offset:22528
    s_waitcnt lgkmcnt(12)
    v_mfma_f32_16x16x32_bf16 v[4:7], v[132:135], v[100:103], v[4:7]
    s_waitcnt lgkmcnt(10)
    s_add_u32 m0, s52, 0
    v_mfma_f32_16x16x32_bf16 v[4:7], v[136:139], v[104:107], v[4:7]
    s_waitcnt lgkmcnt(9)
    buffer_load_dwordx4 v169, s[36:39], s44 offen offset:0 lds
    v_mfma_f32_16x16x32_bf16 v[8:11], v[132:135], v[108:111], v[8:11]
    s_waitcnt lgkmcnt(8)
    ds_read_b64_tr_b16 v[148:149], v167 offset:16384
    v_mfma_f32_16x16x32_bf16 v[8:11], v[136:139], v[112:115], v[8:11]
    s_waitcnt lgkmcnt(8)
    ds_read_b64_tr_b16 v[150:151], v167 offset:18432
    v_mfma_f32_16x16x32_bf16 v[12:15], v[132:135], v[116:119], v[12:15]
    s_waitcnt lgkmcnt(8)
    ds_read_b64_tr_b16 v[152:153], v167 offset:20480
    buffer_load_dwordx4 v169, s[36:39], s45 offen offset:1024 lds
    v_mfma_f32_16x16x32_bf16 v[12:15], v[136:139], v[120:123], v[12:15]
    s_waitcnt lgkmcnt(8)
    ds_read_b64_tr_b16 v[154:155], v167 offset:22528
    v_mfma_f32_16x16x32_bf16 v[16:19], v[132:135], v[124:127], v[16:19]
    s_waitcnt lgkmcnt(8)
    ds_read_b64_tr_b16 v[156:157], v168 offset:16384
    v_mfma_f32_16x16x32_bf16 v[16:19], v[136:139], v[128:131], v[16:19]
    s_waitcnt lgkmcnt(5)
    ds_read_b64_tr_b16 v[158:159], v168 offset:18432
    buffer_load_dwordx4 v169, s[36:39], s46 offen offset:2048 lds
    v_mfma_f32_16x16x32_bf16 v[20:23], v[140:143], v[100:103], v[20:23]
    ds_read_b64_tr_b16 v[160:161], v168 offset:20480
    v_mfma_f32_16x16x32_bf16 v[20:23], v[144:147], v[104:107], v[20:23]
    ds_read_b64_tr_b16 v[162:163], v168 offset:22528
    v_mfma_f32_16x16x32_bf16 v[24:27], v[140:143], v[108:111], v[24:27]
    buffer_load_dwordx4 v169, s[36:39], s47 offen offset:3072 lds
    v_add_u32 v169, s54, v169
    v_mfma_f32_16x16x32_bf16 v[24:27], v[144:147], v[112:115], v[24:27]
    v_mfma_f32_16x16x32_bf16 v[28:31], v[140:143], v[116:119], v[28:31]
    v_mfma_f32_16x16x32_bf16 v[28:31], v[144:147], v[120:123], v[28:31]
    v_mfma_f32_16x16x32_bf16 v[32:35], v[140:143], v[124:127], v[32:35]
    v_mfma_f32_16x16x32_bf16 v[32:35], v[144:147], v[128:131], v[32:35]
    s_waitcnt vmcnt(18) lgkmcnt(0)
    s_barrier
    v_mfma_f32_16x16x32_bf16 v[36:39], v[148:151], v[100:103], v[36:39]
    s_add_u32 m0, s53, 16384
    ds_read_b128 v[68:71], v164 offset:32768
    v_mfma_f32_16x16x32_bf16 v[36:39], v[152:155], v[104:107], v[36:39]
    ds_read_b128 v[72:75], v164 offset:33792
    buffer_load_dwordx4 v170, s[40:43], s48 offen offset:0 lds
    v_mfma_f32_16x16x32_bf16 v[40:43], v[148:151], v[108:111], v[40:43]
    ds_read_b64_tr_b16 v[132:133], v165 offset:32768
    v_mfma_f32_16x16x32_bf16 v[40:43], v[152:155], v[112:115], v[40:43]
    ds_read_b64_tr_b16 v[134:135], v165 offset:34816
    v_mfma_f32_16x16x32_bf16 v[44:47], v[148:151], v[116:119], v[44:47]
    ds_read_b64_tr_b16 v[136:137], v165 offset:36864
    buffer_load_dwordx4 v170, s[40:43], s49 offen offset:1024 lds
    v_mfma_f32_16x16x32_bf16 v[44:47], v[152:155], v[120:123], v[44:47]
    ds_read_b64_tr_b16 v[138:139], v165 offset:38912
    v_mfma_f32_16x16x32_bf16 v[48:51], v[148:151], v[124:127], v[48:51]
    ds_read_b128 v[76:79], v164 offset:34816
    v_mfma_f32_16x16x32_bf16 v[48:51], v[152:155], v[128:131], v[48:51]
    ds_read_b128 v[80:83], v164 offset:35840
    buffer_load_dwordx4 v170, s[40:43], s50 offen offset:2048 lds
    v_mfma_f32_16x16x32_bf16 v[52:55], v[156:159], v[100:103], v[52:55]
    ds_read_b128 v[84:87], v164 offset:36864
    v_mfma_f32_16x16x32_bf16 v[52:55], v[160:163], v[104:107], v[52:55]
    ds_read_b128 v[88:91], v164 offset:37888
    v_mfma_f32_16x16x32_bf16 v[56:59], v[156:159], v[108:111], v[56:59]
    ds_read_b128 v[92:95], v164 offset:38912
    buffer_load_dwordx4 v170, s[40:43], s51 offen offset:3072 lds
    v_mfma_f32_16x16x32_bf16 v[56:59], v[160:163], v[112:115], v[56:59]
    ds_read_b128 v[96:99], v164 offset:39936
    v_add_u32 v170, s55, v170
    v_mfma_f32_16x16x32_bf16 v[60:63], v[156:159], v[116:119], v[60:63]
    ds_read_b64_tr_b16 v[140:141], v166 offset:32768
    v_mfma_f32_16x16x32_bf16 v[60:63], v[160:163], v[120:123], v[60:63]
    ds_read_b64_tr_b16 v[142:143], v166 offset:34816
    v_mfma_f32_16x16x32_bf16 v[64:67], v[156:159], v[124:127], v[64:67]
    ds_read_b64_tr_b16 v[144:145], v166 offset:36864
    v_mfma_f32_16x16x32_bf16 v[64:67], v[160:163], v[128:131], v[64:67]
    ds_read_b64_tr_b16 v[146:147], v166 offset:38912
    s_waitcnt lgkmcnt(12)
    v_mfma_f32_16x16x32_bf16 v[4:7], v[132:135], v[68:71], v[4:7]
    s_waitcnt lgkmcnt(10)
    s_add_u32 m0, s52, 16384
    v_mfma_f32_16x16x32_bf16 v[4:7], v[136:139], v[72:75], v[4:7]
    s_waitcnt lgkmcnt(9)
    buffer_load_dwordx4 v169, s[36:39], s44 offen offset:0 lds
    v_mfma_f32_16x16x32_bf16 v[8:11], v[132:135], v[76:79], v[8:11]
    s_waitcnt lgkmcnt(8)
    ds_read_b64_tr_b16 v[148:149], v167 offset:32768
    v_mfma_f32_16x16x32_bf16 v[8:11], v[136:139], v[80:83], v[8:11]
    s_waitcnt lgkmcnt(8)
    ds_read_b64_tr_b16 v[150:151], v167 offset:34816
    v_mfma_f32_16x16x32_bf16 v[12:15], v[132:135], v[84:87], v[12:15]
    s_waitcnt lgkmcnt(8)
    ds_read_b64_tr_b16 v[152:153], v167 offset:36864
    buffer_load_dwordx4 v169, s[36:39], s45 offen offset:1024 lds
    v_mfma_f32_16x16x32_bf16 v[12:15], v[136:139], v[88:91], v[12:15]
    s_waitcnt lgkmcnt(8)
    ds_read_b64_tr_b16 v[154:155], v167 offset:38912
    v_mfma_f32_16x16x32_bf16 v[16:19], v[132:135], v[92:95], v[16:19]
    s_waitcnt lgkmcnt(8)
    ds_read_b64_tr_b16 v[156:157], v168 offset:32768
    v_mfma_f32_16x16x32_bf16 v[16:19], v[136:139], v[96:99], v[16:19]
    s_waitcnt lgkmcnt(5)
    ds_read_b64_tr_b16 v[158:159], v168 offset:34816
    buffer_load_dwordx4 v169, s[36:39], s46 offen offset:2048 lds
    v_mfma_f32_16x16x32_bf16 v[20:23], v[140:143], v[68:71], v[20:23]
    ds_read_b64_tr_b16 v[160:161], v168 offset:36864
    v_mfma_f32_16x16x32_bf16 v[20:23], v[144:147], v[72:75], v[20:23]
    ds_read_b64_tr_b16 v[162:163], v168 offset:38912
    v_mfma_f32_16x16x32_bf16 v[24:27], v[140:143], v[76:79], v[24:27]
    buffer_load_dwordx4 v169, s[36:39], s47 offen offset:3072 lds
    v_add_u32 v169, s54, v169
    v_mfma_f32_16x16x32_bf16 v[24:27], v[144:147], v[80:83], v[24:27]
    v_mfma_f32_16x16x32_bf16 v[28:31], v[140:143], v[84:87], v[28:31]
    v_mfma_f32_16x16x32_bf16 v[28:31], v[144:147], v[88:91], v[28:31]
    buffer_load_dword v253, v252, s[92:95], 0 offen
    v_add_u32 v252, 524288, v252
    v_mfma_f32_16x16x32_bf16 v[32:35], v[140:143], v[92:95], v[32:35]
    v_mfma_f32_16x16x32_bf16 v[32:35], v[144:147], v[96:99], v[32:35]
    s_waitcnt vmcnt(19) lgkmcnt(0)
    s_barrier
    v_mfma_f32_16x16x32_bf16 v[36:39], v[148:151], v[68:71], v[36:39]
    s_add_u32 m0, s53, 32768
    ds_read_b128 v[100:103], v164 offset:49152
    v_mfma_f32_16x16x32_bf16 v[36:39], v[152:155], v[72:75], v[36:39]
    ds_read_b128 v[104:107], v164 offset:50176
    buffer_load_dwordx4 v170, s[40:43], s48 offen offset:0 lds
    v_mfma_f32_16x16x32_bf16 v[40:43], v[148:151], v[76:79], v[40:43]
    ds_read_b64_tr_b16 v[132:133], v165 offset:49152
    v_mfma_f32_16x16x32_bf16 v[40:43], v[152:155], v[80:83], v[40:43]
    ds_read_b64_tr_b16 v[134:135], v165 offset:51200
    v_mfma_f32_16x16x32_bf16 v[44:47], v[148:151], v[84:87], v[44:47]
    ds_read_b64_tr_b16 v[136:137], v165 offset:53248
    buffer_load_dwordx4 v170, s[40:43], s49 offen offset:1024 lds
    v_mfma_f32_16x16x32_bf16 v[44:47], v[152:155], v[88:91], v[44:47]
    ds_read_b64_tr_b16 v[138:139], v165 offset:55296
    v_mfma_f32_16x16x32_bf16 v[48:51], v[148:151], v[92:95], v[48:51]
    ds_read_b128 v[108:111], v164 offset:51200
    v_mfma_f32_16x16x32_bf16 v[48:51], v[152:155], v[96:99], v[48:51]
    ds_read_b128 v[112:115], v164 offset:52224
    buffer_load_dwordx4 v170, s[40:43], s50 offen offset:2048 lds
    v_mfma_f32_16x16x32_bf16 v[52:55], v[156:159], v[68:71], v[52:55]
    ds_read_b128 v[116:119], v164 offset:53248
    v_mfma_f32_16x16x32_bf16 v[52:55], v[160:163], v[72:75], v[52:55]
    ds_read_b128 v[120:123], v164 offset:54272
    v_mfma_f32_16x16x32_bf16 v[56:59], v[156:159], v[76:79], v[56:59]
    ds_read_b128 v[124:127], v164 offset:55296
    buffer_load_dwordx4 v170, s[40:43], s51 offen offset:3072 lds
    v_mfma_f32_16x16x32_bf16 v[56:59], v[160:163], v[80:83], v[56:59]
    ds_read_b128 v[128:131], v164 offset:56320
    v_add_u32 v170, s55, v170
    v_mfma_f32_16x16x32_bf16 v[60:63], v[156:159], v[84:87], v[60:63]
    ds_read_b64_tr_b16 v[140:141], v166 offset:49152
    v_mfma_f32_16x16x32_bf16 v[60:63], v[160:163], v[88:91], v[60:63]
    ds_read_b64_tr_b16 v[142:143], v166 offset:51200
    v_mfma_f32_16x16x32_bf16 v[64:67], v[156:159], v[92:95], v[64:67]
    ds_read_b64_tr_b16 v[144:145], v166 offset:53248
    v_mfma_f32_16x16x32_bf16 v[64:67], v[160:163], v[96:99], v[64:67]
    ds_read_b64_tr_b16 v[146:147], v166 offset:55296
    s_waitcnt lgkmcnt(12)
    v_mfma_f32_16x16x32_bf16 v[4:7], v[132:135], v[100:103], v[4:7]
    s_waitcnt lgkmcnt(10)
    s_add_u32 m0, s52, 32768
    v_mfma_f32_16x16x32_bf16 v[4:7], v[136:139], v[104:107], v[4:7]
    s_waitcnt lgkmcnt(9)
    buffer_load_dwordx4 v169, s[36:39], s44 offen offset:0 lds
    v_mfma_f32_16x16x32_bf16 v[8:11], v[132:135], v[108:111], v[8:11]
    s_waitcnt lgkmcnt(8)
    ds_read_b64_tr_b16 v[148:149], v167 offset:49152
    v_mfma_f32_16x16x32_bf16 v[8:11], v[136:139], v[112:115], v[8:11]
    s_waitcnt lgkmcnt(8)
    ds_read_b64_tr_b16 v[150:151], v167 offset:51200
    v_mfma_f32_16x16x32_bf16 v[12:15], v[132:135], v[116:119], v[12:15]
    s_waitcnt lgkmcnt(8)
    ds_read_b64_tr_b16 v[152:153], v167 offset:53248
    buffer_load_dwordx4 v169, s[36:39], s45 offen offset:1024 lds
    v_mfma_f32_16x16x32_bf16 v[12:15], v[136:139], v[120:123], v[12:15]
    s_waitcnt lgkmcnt(8)
    ds_read_b64_tr_b16 v[154:155], v167 offset:55296
    v_mfma_f32_16x16x32_bf16 v[16:19], v[132:135], v[124:127], v[16:19]
    s_waitcnt lgkmcnt(8)
    ds_read_b64_tr_b16 v[156:157], v168 offset:49152
    v_mfma_f32_16x16x32_bf16 v[16:19], v[136:139], v[128:131], v[16:19]
    s_waitcnt lgkmcnt(5)
    ds_read_b64_tr_b16 v[158:159], v168 offset:51200
    buffer_load_dwordx4 v169, s[36:39], s46 offen offset:2048 lds
    v_mfma_f32_16x16x32_bf16 v[20:23], v[140:143], v[100:103], v[20:23]
    ds_read_b64_tr_b16 v[160:161], v168 offset:53248
    v_mfma_f32_16x16x32_bf16 v[20:23], v[144:147], v[104:107], v[20:23]
    ds_read_b64_tr_b16 v[162:163], v168 offset:55296
    v_mfma_f32_16x16x32_bf16 v[24:27], v[140:143], v[108:111], v[24:27]
    buffer_load_dwordx4 v169, s[36:39], s47 offen offset:3072 lds
    v_add_u32 v169, s54, v169
    v_mfma_f32_16x16x32_bf16 v[24:27], v[144:147], v[112:115], v[24:27]
    v_mfma_f32_16x16x32_bf16 v[28:31], v[140:143], v[116:119], v[28:31]
    v_mfma_f32_16x16x32_bf16 v[28:31], v[144:147], v[120:123], v[28:31]
    v_mfma_f32_16x16x32_bf16 v[32:35], v[140:143], v[124:127], v[32:35]
    v_mfma_f32_16x16x32_bf16 v[32:35], v[144:147], v[128:131], v[32:35]
    s_waitcnt vmcnt(17) lgkmcnt(0)
    s_barrier
    v_mfma_f32_16x16x32_bf16 v[36:39], v[148:151], v[100:103], v[36:39]
    s_add_u32 m0, s53, 49152
    ds_read_b128 v[68:71], v164 offset:0
    v_mfma_f32_16x16x32_bf16 v[36:39], v[152:155], v[104:107], v[36:39]
    ds_read_b128 v[72:75], v164 offset:1024
    buffer_load_dwordx4 v170, s[40:43], s48 offen offset:0 lds
    v_mfma_f32_16x16x32_bf16 v[40:43], v[148:151], v[108:111], v[40:43]
    ds_read_b64_tr_b16 v[132:133], v165 offset:0
    v_mfma_f32_16x16x32_bf16 v[40:43], v[152:155], v[112:115], v[40:43]
    ds_read_b64_tr_b16 v[134:135], v165 offset:2048
    v_mfma_f32_16x16x32_bf16 v[44:47], v[148:151], v[116:119], v[44:47]
    ds_read_b64_tr_b16 v[136:137], v165 offset:4096
    buffer_load_dwordx4 v170, s[40:43], s49 offen offset:1024 lds
    v_mfma_f32_16x16x32_bf16 v[44:47], v[152:155], v[120:123], v[44:47]
    ds_read_b64_tr_b16 v[138:139], v165 offset:6144
    v_mfma_f32_16x16x32_bf16 v[48:51], v[148:151], v[124:127], v[48:51]
    ds_read_b128 v[76:79], v164 offset:2048
    v_mfma_f32_16x16x32_bf16 v[48:51], v[152:155], v[128:131], v[48:51]
    ds_read_b128 v[80:83], v164 offset:3072
    buffer_load_dwordx4 v170, s[40:43], s50 offen offset:2048 lds
    v_mfma_f32_16x16x32_bf16 v[52:55], v[156:159], v[100:103], v[52:55]
    ds_read_b128 v[84:87], v164 offset:4096
    v_mfma_f32_16x16x32_bf16 v[52:55], v[160:163], v[104:107], v[52:55]
    ds_read_b128 v[88:91], v164 offset:5120
    v_mfma_f32_16x16x32_bf16 v[56:59], v[156:159], v[108:111], v[56:59]
    ds_read_b128 v[92:95], v164 offset:6144
    buffer_load_dwordx4 v170, s[40:43], s51 offen offset:3072 lds
    v_mfma_f32_16x16x32_bf16 v[56:59], v[160:163], v[112:115], v[56:59]
    ds_read_b128 v[96:99], v164 offset:7168
    v_add_u32 v170, s55, v170
    v_mfma_f32_16x16x32_bf16 v[60:63], v[156:159], v[116:119], v[60:63]
    ds_read_b64_tr_b16 v[140:141], v166 offset:0
    v_mfma_f32_16x16x32_bf16 v[60:63], v[160:163], v[120:123], v[60:63]
    ds_read_b64_tr_b16 v[142:143], v166 offset:2048
    v_mfma_f32_16x16x32_bf16 v[64:67], v[156:159], v[124:127], v[64:67]
    ds_read_b64_tr_b16 v[144:145], v166 offset:4096
    v_mfma_f32_16x16x32_bf16 v[64:67], v[160:163], v[128:131], v[64:67]
    ds_read_b64_tr_b16 v[146:147], v166 offset:6144
    s_sub_u32 s56, s56, 1
    s_cmp_eq_u32 s56, 3
    s_cselect_b32 s72, s66, s73
    s_cmp_gt_u32 s56, 2
    s_cbranch_scc1 g3_l1
    s_cmp_eq_u32 s56, 0
    s_cbranch_scc1 g3_l2s
    s_cmp_eq_u32 s56, 1
    s_cbranch_scc1 g3_swd
    v_cmp_eq_u32 vcc, 0, v254
    s_cbranch_vccz g3_w1_ok
    v_lshlrev_b32 v238, 2, v240
    s_mov_b32 s3, 0
g3_w1:
    buffer_load_dword v236, v238, s[88:91], s66 offen sc1
    s_waitcnt vmcnt(0)
    v_cmp_eq_u32 vcc, 0, v236
    s_mov_b32 s4, 65535
    s_mov_b32 s5, 0
    s_and_b64 vcc, vcc, s[4:5]
    s_cbranch_scc0 g3_w1_ok
    s_sleep 8
    s_add_u32 s3, s3, 1
    s_cmp_lt_u32 s3, 100000
    s_cbranch_scc1 g3_w1
g3_w1_ok:
    v_add_u32 v251, s68, v251
    v_add_u32 v252, s69, v252
    s_mov_b32 s92, s18
    s_mov_b32 s93, s19
    s_mov_b32 s94, 8388608
    s_mov_b32 s95, 0x20000
    s_branch g3_l1
g3_swd:
    s_mov_b64 exec, 1
    buffer_store_dword v244, v240, s[88:91], s71 offen sc1
    s_mov_b64 exec, -1
    s_add_u32 s70, s68, 2048
    v_add_u32 v170, s69, v170
    s_mov_b32 s40, s18
    s_mov_b32 s41, s19
    s_mov_b32 s42, 8388608
    s_mov_b32 s43, 0x20000
    s_branch g3_l1
g3_l2s:
    s_mov_b32 s56, 6
    s_mov_b32 s70, 2048
    s_xor_b32 s66, s71, 4
    v_mov_b32 v255, 0
g3_l2:
    s_waitcnt lgkmcnt(12)
    v_mfma_f32_16x16x32_bf16 v[172:175], v[132:135], v[68:71], v[172:175]
    s_waitcnt lgkmcnt(10)
    s_add_u32 m0, s52, 49152
    v_mfma_f32_16x16x32_bf16 v[172:175], v[136:139], v[72:75], v[172:175]
    s_waitcnt lgkmcnt(9)
    buffer_load_dwordx4 v169, s[36:39], s44 offen offset:0 lds
    v_mfma_f32_16x16x32_bf16 v[176:179], v[132:135], v[76:79], v[176:179]
    s_waitcnt lgkmcnt(8)
    ds_read_b64_tr_b16 v[148:149], v167 offset:0
    v_mfma_f32_16x16x32_bf16 v[176:179], v[136:139], v[80:83], v[176:179]
    s_waitcnt lgkmcnt(8)
    ds_read_b64_tr_b16 v[150:151], v167 offset:2048
    v_mfma_f32_16x16x32_bf16 v[180:183], v[132:135], v[84:87], v[180:183]
    s_waitcnt lgkmcnt(8)
    ds_read_b64_tr_b16 v[152:153], v167 offset:4096
    buffer_load_dwordx4 v169, s[36:39], s45 offen offset:1024 lds
    v_mfma_f32_16x16x32_bf16 v[180:183], v[136:139], v[88:91], v[180:183]
    s_waitcnt lgkmcnt(8)
    ds_read_b64_tr_b16 v[154:155], v167 offset:6144
    v_mfma_f32_16x16x32_bf16 v[184:187], v[132:135], v[92:95], v[184:187]
    s_waitcnt lgkmcnt(8)
    ds_read_b64_tr_b16 v[156:157], v168 offset:0
    v_mfma_f32_16x16x32_bf16 v[184:187], v[136:139], v[96:99], v[184:187]
    s_waitcnt lgkmcnt(5)
    ds_read_b64_tr_b16 v[158:159], v168 offset:2048
    buffer_load_dwordx4 v169, s[36:39], s46 offen offset:2048 lds
    v_mfma_f32_16x16x32_bf16 v[188:191], v[140:143], v[68:71], v[188:191]
    ds_read_b64_tr_b16 v[160:161], v168 offset:4096
    v_mfma_f32_16x16x32_bf16 v[188:191], v[144:147], v[72:75], v[188:191]
    ds_read_b64_tr_b16 v[162:163], v168 offset:6144
    v_mfma_f32_16x16x32_bf16 v[192:195], v[140:143], v[76:79], v[192:195]
    buffer_load_dwordx4 v169, s[36:39], s47 offen offset:3072 lds
    v_add_u32 v169, s70, v169
    v_mfma_f32_16x16x32_bf16 v[192:195], v[144:147], v[80:83], v[192:195]
    v_mfma_f32_16x16x32_bf16 v[196:199], v[140:143], v[84:87], v[196:199]
    v_mfma_f32_16x16x32_bf16 v[196:199], v[144:147], v[88:91], v[196:199]
    buffer_load_dword v253, v251, s[36:39], 0 offen
    v_add_u32 v251, 0x2000, v251
    v_mfma_f32_16x16x32_bf16 v[200:203], v[140:143], v[92:95], v[200:203]
    v_mfma_f32_16x16x32_bf16 v[200:203], v[144:147], v[96:99], v[200:203]
    buffer_load_dword v254, v255, s[88:91], s72 offen sc1
    s_waitcnt vmcnt(19) lgkmcnt(0)
    s_barrier
    v_mfma_f32_16x16x32_bf16 v[204:207], v[148:151], v[68:71], v[204:207]
    s_add_u32 m0, s53, 0
    ds_read_b128 v[100:103], v164 offset:16384
    v_mfma_f32_16x16x32_bf16 v[204:207], v[152:155], v[72:75], v[204:207]
    ds_read_b128 v[104:107], v164 offset:17408
    buffer_load_dwordx4 v170, s[40:43], s48 offen offset:0 lds
    v_mfma_f32_16x16x32_bf16 v[208:211], v[148:151], v[76:79], v[208:211]
    ds_read_b64_tr_b16 v[132:133], v165 offset:16384
    v_mfma_f32_16x16x32_bf16 v[208:211], v[152:155], v[80:83], v[208:211]
    ds_read_b64_tr_b16 v[134:135], v165 offset:18432
    v_mfma_f32_16x16x32_bf16 v[212:215], v[148:151], v[84:87], v[212:215]
    ds_read_b64_tr_b16 v[136:137], v165 offset:20480
    buffer_load_dwordx4 v170, s[40:43], s49 offen offset:1024 lds
    v_mfma_f32_16x16x32_bf16 v[212:215], v[152:155], v[88:91], v[212:215]
    ds_read_b64_tr_b16 v[138:139], v165 offset:22528
    v_mfma_f32_16x16x32_bf16 v[216:219], v[148:151], v[92:95], v[216:219]
    ds_read_b128 v[108:111], v164 offset:18432
    v_mfma_f32_16x16x32_bf16 v[216:219], v[152:155], v[96:99], v[216:219]
    ds_read_b128 v[112:115], v164 offset:19456
    buffer_load_dwordx4 v170, s[40:43], s50 offen offset:2048 lds
    v_mfma_f32_16x16x32_bf16 v[220:223], v[156:159], v[68:71], v[220:223]
    ds_read_b128 v[116:119], v164 offset:20480
    v_mfma_f32_16x16x32_bf16 v[220:223], v[160:163], v[72:75], v[220:223]
    ds_read_b128 v[120:123], v164 offset:21504
    v_mfma_f32_16x16x32_bf16 v[224:227], v[156:159], v[76:79], v[224:227]
    ds_read_b128 v[124:127], v164 offset:22528
    buffer_load_dwordx4 v170, s[40:43], s51 offen offset:3072 lds
    v_mfma_f32_16x16x32_bf16 v[224:227], v[160:163], v[80:83], v[224:227]
    ds_read_b128 v[128:131], v164 offset:23552
    v_add_u32 v170, s55, v170
    v_mfma_f32_16x16x32_bf16 v[228:231], v[156:159], v[84:87], v[228:231]
    ds_read_b64_tr_b16 v[140:141], v166 offset:16384
    v_mfma_f32_16x16x32_bf16 v[228:231], v[160:163], v[88:91], v[228:231]
    ds_read_b64_tr_b16 v[142:143], v166 offset:18432
    v_mfma_f32_16x16x32_bf16 v[232:235], v[156:159], v[92:95], v[232:235]
    ds_read_b64_tr_b16 v[144:145], v166 offset:20480
    v_mfma_f32_16x16x32_bf16 v[232:235], v[160:163], v[96:99], v[232:235]
    ds_read_b64_tr_b16 v[146:147], v166 offset:22528
    s_waitcnt lgkmcnt(12)
    v_mfma_f32_16x16x32_bf16 v[172:175], v[132:135], v[100:103], v[172:175]
    s_waitcnt lgkmcnt(10)
    s_add_u32 m0, s52, 0
    v_mfma_f32_16x16x32_bf16 v[172:175], v[136:139], v[104:107], v[172:175]
    s_waitcnt lgkmcnt(9)
    buffer_load_dwordx4 v169, s[36:39], s44 offen offset:0 lds
    v_mfma_f32_16x16x32_bf16 v[176:179], v[132:135], v[108:111], v[176:179]
    s_waitcnt lgkmcnt(8)
    ds_read_b64_tr_b16 v[148:149], v167 offset:16384
    v_mfma_f32_16x16x32_bf16 v[176:179], v[136:139], v[112:115], v[176:179]
    s_waitcnt lgkmcnt(8)
    ds_read_b64_tr_b16 v[150:151], v167 offset:18432
    v_mfma_f32_16x16x32_bf16 v[180:183], v[132:135], v[116:119], v[180:183]
    s_waitcnt lgkmcnt(8)
    ds_read_b64_tr_b16 v[152:153], v167 offset:20480
    buffer_load_dwordx4 v169, s[36:39], s45 offen offset:1024 lds
    v_mfma_f32_16x16x32_bf16 v[180:183], v[136:139], v[120:123], v[180:183]
    s_waitcnt lgkmcnt(8)
    ds_read_b64_tr_b16 v[154:155], v167 offset:22528
    v_mfma_f32_16x16x32_bf16 v[184:187], v[132:135], v[124:127], v[184:187]
    s_waitcnt lgkmcnt(8)
    ds_read_b64_tr_b16 v[156:157], v168 offset:16384
    v_mfma_f32_16x16x32_bf16 v[184:187], v[136:139], v[128:131], v[184:187]
    s_waitcnt lgkmcnt(5)
    ds_read_b64_tr_b16 v[158:159], v168 offset:18432
    buffer_load_dwordx4 v169, s[36:39], s46 offen offset:2048 lds
    v_mfma_f32_16x16x32_bf16 v[188:191], v[140:143], v[100:103], v[188:191]
    ds_read_b64_tr_b16 v[160:161], v168 offset:20480
    v_mfma_f32_16x16x32_bf16 v[188:191], v[144:147], v[104:107], v[188:191]
    ds_read_b64_tr_b16 v[162:163], v168 offset:22528
    v_mfma_f32_16x16x32_bf16 v[192:195], v[140:143], v[108:111], v[192:195]
    buffer_load_dwordx4 v169, s[36:39], s47 offen offset:3072 lds
    v_add_u32 v169, s54, v169
    v_mfma_f32_16x16x32_bf16 v[192:195], v[144:147], v[112:115], v[192:195]
    v_mfma_f32_16x16x32_bf16 v[196:199], v[140:143], v[116:119], v[196:199]
    v_mfma_f32_16x16x32_bf16 v[196:199], v[144:147], v[120:123], v[196:199]
    v_mfma_f32_16x16x32_bf16 v[200:203], v[140:143], v[124:127], v[200:203]
    v_mfma_f32_16x16x32_bf16 v[200:203], v[144:147], v[128:131], v[200:203]
    s_waitcnt vmcnt(18) lgkmcnt(0)
    s_barrier
    v_mfma_f32_16x16x32_bf16 v[204:207], v[148:151], v[100:103], v[204:207]
    s_add_u32 m0, s53, 16384
    ds_read_b128 v[68:71], v164 offset:32768
    v_mfma_f32_16x16x32_bf16 v[204:207], v[152:155], v[104:107], v[204:207]
    ds_read_b128 v[72:75], v164 offset:33792
    buffer_load_dwordx4 v170, s[40:43], s48 offen offset:0 lds
    v_mfma_f32_16x16x32_bf16 v[208:211], v[148:151], v[108:111], v[208:211]
    ds_read_b64_tr_b16 v[132:133], v165 offset:32768
    v_mfma_f32_16x16x32_bf16 v[208:211], v[152:155], v[112:115], v[208:211]
    ds_read_b64_tr_b16 v[134:135], v165 offset:34816
    v_mfma_f32_16x16x32_bf16 v[212:215], v[148:151], v[116:119], v[212:215]
    ds_read_b64_tr_b16 v[136:137], v165 offset:36864
    buffer_load_dwordx4 v170, s[40:43], s49 offen offset:1024 lds
    v_mfma_f32_16x16x32_bf16 v[212:215], v[152:155], v[120:123], v[212:215]
    ds_read_b64_tr_b16 v[138:139], v165 offset:38912
    v_mfma_f32_16x16x32_bf16 v[216:219], v[148:151], v[124:127], v[216:219]
    ds_read_b128 v[76:79], v164 offset:34816
    v_mfma_f32_16x16x32_bf16 v[216:219], v[152:155], v[128:131], v[216:219]
    ds_read_b128 v[80:83], v164 offset:35840
    buffer_load_dwordx4 v170, s[40:43], s50 offen offset:2048 lds
    v_mfma_f32_16x16x32_bf16 v[220:223], v[156:159], v[100:103], v[220:223]
    ds_read_b128 v[84:87], v164 offset:36864
    v_mfma_f32_16x16x32_bf16 v[220:223], v[160:163], v[104:107], v[220:223]
    ds_read_b128 v[88:91], v164 offset:37888
    v_mfma_f32_16x16x32_bf16 v[224:227], v[156:159], v[108:111], v[224:227]
    ds_read_b128 v[92:95], v164 offset:38912
    buffer_load_dwordx4 v170, s[40:43], s51 offen offset:3072 lds
    v_mfma_f32_16x16x32_bf16 v[224:227], v[160:163], v[112:115], v[224:227]
    ds_read_b128 v[96:99], v164 offset:39936
    v_add_u32 v170, s55, v170
    v_mfma_f32_16x16x32_bf16 v[228:231], v[156:159], v[116:119], v[228:231]
    ds_read_b64_tr_b16 v[140:141], v166 offset:32768
    v_mfma_f32_16x16x32_bf16 v[228:231], v[160:163], v[120:123], v[228:231]
    ds_read_b64_tr_b16 v[142:143], v166 offset:34816
    v_mfma_f32_16x16x32_bf16 v[232:235], v[156:159], v[124:127], v[232:235]
    ds_read_b64_tr_b16 v[144:145], v166 offset:36864
    v_mfma_f32_16x16x32_bf16 v[232:235], v[160:163], v[128:131], v[232:235]
    ds_read_b64_tr_b16 v[146:147], v166 offset:38912
    s_waitcnt lgkmcnt(12)
    v_mfma_f32_16x16x32_bf16 v[172:175], v[132:135], v[68:71], v[172:175]
    s_waitcnt lgkmcnt(10)
    s_add_u32 m0, s52, 16384
    v_mfma_f32_16x16x32_bf16 v[172:175], v[136:139], v[72:75], v[172:175]
    s_waitcnt lgkmcnt(9)
    buffer_load_dwordx4 v169, s[36:39], s44 offen offset:0 lds
    v_mfma_f32_16x16x32_bf16 v[176:179], v[132:135], v[76:79], v[176:179]
    s_waitcnt lgkmcnt(8)
    ds_read_b64_tr_b16 v[148:149], v167 offset:32768
    v_mfma_f32_16x16x32_bf16 v[176:179], v[136:139], v[80:83], v[176:179]
    s_waitcnt lgkmcnt(8)
    ds_read_b64_tr_b16 v[150:151], v167 offset:34816
    v_mfma_f32_16x16x32_bf16 v[180:183], v[132:135], v[84:87], v[180:183]
    s_waitcnt lgkmcnt(8)
    ds_read_b64_tr_b16 v[152:153], v167 offset:36864
    buffer_load_dwordx4 v169, s[36:39], s45 offen offset:1024 lds
    v_mfma_f32_16x16x32_bf16 v[180:183], v[136:139], v[88:91], v[180:183]
    s_waitcnt lgkmcnt(8)
    ds_read_b64_tr_b16 v[154:155], v167 offset:38912
    v_mfma_f32_16x16x32_bf16 v[184:187], v[132:135], v[92:95], v[184:187]
    s_waitcnt lgkmcnt(8)
    ds_read_b64_tr_b16 v[156:157], v168 offset:32768
    v_mfma_f32_16x16x32_bf16 v[184:187], v[136:139], v[96:99], v[184:187]
    s_waitcnt lgkmcnt(5)
    ds_read_b64_tr_b16 v[158:159], v168 offset:34816
    buffer_load_dwordx4 v169, s[36:39], s46 offen offset:2048 lds
    v_mfma_f32_16x16x32_bf16 v[188:191], v[140:143], v[68:71], v[188:191]
    ds_read_b64_tr_b16 v[160:161], v168 offset:36864
    v_mfma_f32_16x16x32_bf16 v[188:191], v[144:147], v[72:75], v[188:191]
    ds_read_b64_tr_b16 v[162:163], v168 offset:38912
    v_mfma_f32_16x16x32_bf16 v[192:195], v[140:143], v[76:79], v[192:195]
    buffer_load_dwordx4 v169, s[36:39], s47 offen offset:3072 lds
    v_add_u32 v169, s54, v169
    v_mfma_f32_16x16x32_bf16 v[192:195], v[144:147], v[80:83], v[192:195]
    v_mfma_f32_16x16x32_bf16 v[196:199], v[140:143], v[84:87], v[196:199]
    v_mfma_f32_16x16x32_bf16 v[196:199], v[144:147], v[88:91], v[196:199]
    buffer_load_dword v253, v252, s[92:95], 0 offen
    v_add_u32 v252, 524288, v252
    v_mfma_f32_16x16x32_bf16 v[200:203], v[140:143], v[92:95], v[200:203]
    v_mfma_f32_16x16x32_bf16 v[200:203], v[144:147], v[96:99], v[200:203]
    s_waitcnt vmcnt(19) lgkmcnt(0)
    s_barrier
    v_mfma_f32_16x16x32_bf16 v[204:207], v[148:151], v[68:71], v[204:207]
    s_add_u32 m0, s53, 32768
    ds_read_b128 v[100:103], v164 offset:49152
    v_mfma_f32_16x16x32_bf16 v[204:207], v[152:155], v[72:75], v[204:207]
    ds_read_b128 v[104:107], v164 offset:50176
    buffer_load_dwordx4 v170, s[40:43], s48 offen offset:0 lds
    v_mfma_f32_16x16x32_bf16 v[208:211], v[148:151], v[76:79], v[208:211]
    ds_read_b64_tr_b16 v[132:133], v165 offset:49152
    v_mfma_f32_16x16x32_bf16 v[208:211], v[152:155], v[80:83], v[208:211]
    ds_read_b64_tr_b16 v[134:135], v165 offset:51200
    v_mfma_f32_16x16x32_bf16 v[212:215], v[148:151], v[84:87], v[212:215]
    ds_read_b64_tr_b16 v[136:137], v165 offset:53248
    buffer_load_dwordx4 v170, s[40:43], s49 offen offset:1024 lds
    v_mfma_f32_16x16x32_bf16 v[212:215], v[152:155], v[88:91], v[212:215]
    ds_read_b64_tr_b16 v[138:139], v165 offset:55296
    v_mfma_f32_16x16x32_bf16 v[216:219], v[148:151], v[92:95], v[216:219]
    ds_read_b128 v[108:111], v164 offset:51200
    v_mfma_f32_16x16x32_bf16 v[216:219], v[152:155], v[96:99], v[216:219]
    ds_read_b128 v[112:115], v164 offset:52224
    buffer_load_dwordx4 v170, s[40:43], s50 offen offset:2048 lds
    v_mfma_f32_16x16x32_bf16 v[220:223], v[156:159], v[68:71], v[220:223]
    ds_read_b128 v[116:119], v164 offset:53248
    v_mfma_f32_16x16x32_bf16 v[220:223], v[160:163], v[72:75], v[220:223]
    ds_read_b128 v[120:123], v164 offset:54272
    v_mfma_f32_16x16x32_bf16 v[224:227], v[156:159], v[76:79], v[224:227]
    ds_read_b128 v[124:127], v164 offset:55296
    buffer_load_dwordx4 v170, s[40:43], s51 offen offset:3072 lds
    v_mfma_f32_16x16x32_bf16 v[224:227], v[160:163], v[80:83], v[224:227]
    ds_read_b128 v[128:131], v164 offset:56320
    v_add_u32 v170, s55, v170
    v_mfma_f32_16x16x32_bf16 v[228:231], v[156:159], v[84:87], v[228:231]
    ds_read_b64_tr_b16 v[140:141], v166 offset:49152
    v_mfma_f32_16x16x32_bf16 v[228:231], v[160:163], v[88:91], v[228:231]
    ds_read_b64_tr_b16 v[142:143], v166 offset:51200
    v_mfma_f32_16x16x32_bf16 v[232:235], v[156:159], v[92:95], v[232:235]
    ds_read_b64_tr_b16 v[144:145], v166 offset:53248
    v_mfma_f32_16x16x32_bf16 v[232:235], v[160:163], v[96:99], v[232:235]
    ds_read_b64_tr_b16 v[146:147], v166 offset:55296
    s_waitcnt lgkmcnt(12)
    v_mfma_f32_16x16x32_bf16 v[172:175], v[132:135], v[100:103], v[172:175]
    s_waitcnt lgkmcnt(10)
    s_add_u32 m0, s52, 32768
    v_mfma_f32_16x16x32_bf16 v[172:175], v[136:139], v[104:107], v[172:175]
    s_waitcnt lgkmcnt(9)
    buffer_load_dwordx4 v169, s[36:39], s44 offen offset:0 lds
    v_mfma_f32_16x16x32_bf16 v[176:179], v[132:135], v[108:111], v[176:179]
    s_waitcnt lgkmcnt(8)
    ds_read_b64_tr_b16 v[148:149], v167 offset:49152
    v_mfma_f32_16x16x32_bf16 v[176:179], v[136:139], v[112:115], v[176:179]
    s_waitcnt lgkmcnt(8)
    ds_read_b64_tr_b16 v[150:151], v167 offset:51200
    v_mfma_f32_16x16x32_bf16 v[180:183], v[132:135], v[116:119], v[180:183]
    s_waitcnt lgkmcnt(8)
    ds_read_b64_tr_b16 v[152:153], v167 offset:53248
    buffer_load_dwordx4 v169, s[36:39], s45 offen offset:1024 lds
    v_mfma_f32_16x16x32_bf16 v[180:183], v[136:139], v[120:123], v[180:183]
    s_waitcnt lgkmcnt(8)
    ds_read_b64_tr_b16 v[154:155], v167 offset:55296
    v_mfma_f32_16x16x32_bf16 v[184:187], v[132:135], v[124:127], v[184:187]
    s_waitcnt lgkmcnt(8)
    ds_read_b64_tr_b16 v[156:157], v168 offset:49152
    v_mfma_f32_16x16x32_bf16 v[184:187], v[136:139], v[128:131], v[184:187]
    s_waitcnt lgkmcnt(5)
    ds_read_b64_tr_b16 v[158:159], v168 offset:51200
    buffer_load_dwordx4 v169, s[36:39], s46 offen offset:2048 lds
    v_mfma_f32_16x16x32_bf16 v[188:191], v[140:143], v[100:103], v[188:191]
    ds_read_b64_tr_b16 v[160:161], v168 offset:53248
    v_mfma_f32_16x16x32_bf16 v[188:191], v[144:147], v[104:107], v[188:191]
    ds_read_b64_tr_b16 v[162:163], v168 offset:55296
    v_mfma_f32_16x16x32_bf16 v[192:195], v[140:143], v[108:111], v[192:195]
    buffer_load_dwordx4 v169, s[36:39], s47 offen offset:3072 lds
    v_add_u32 v169, s54, v169
    v_mfma_f32_16x16x32_bf16 v[192:195], v[144:147], v[112:115], v[192:195]
    v_mfma_f32_16x16x32_bf16 v[196:199], v[140:143], v[116:119], v[196:199]
    v_mfma_f32_16x16x32_bf16 v[196:199], v[144:147], v[120:123], v[196:199]
    v_mfma_f32_16x16x32_bf16 v[200:203], v[140:143], v[124:127], v[200:203]
    v_mfma_f32_16x16x32_bf16 v[200:203], v[144:147], v[128:131], v[200:203]
    s_waitcnt vmcnt(17) lgkmcnt(0)
    s_barrier
    v_mfma_f32_16x16x32_bf16 v[204:207], v[148:151], v[100:103], v[204:207]
    s_add_u32 m0, s53, 49152
    ds_read_b128 v[68:71], v164 offset:0
    v_mfma_f32_16x16x32_bf16 v[204:207], v[152:155], v[104:107], v[204:207]
    ds_read_b128 v[72:75], v164 offset:1024
    buffer_load_dwordx4 v170, s[40:43], s48 offen offset:0 lds
    v_mfma_f32_16x16x32_bf16 v[208:211], v[148:151], v[108:111], v[208:211]
    ds_read_b64_tr_b16 v[132:133], v165 offset:0
    v_mfma_f32_16x16x32_bf16 v[208:211], v[152:155], v[112:115], v[208:211]
    ds_read_b64_tr_b16 v[134:135], v165 offset:2048
    v_mfma_f32_16x16x32_bf16 v[212:215], v[148:151], v[116:119], v[212:215]
    ds_read_b64_tr_b16 v[136:137], v165 offset:4096
    buffer_load_dwordx4 v170, s[40:43], s49 offen offset:1024 lds
    v_mfma_f32_16x16x32_bf16 v[212:215], v[152:155], v[120:123], v[212:215]
    ds_read_b64_tr_b16 v[138:139], v165 offset:6144
    v_mfma_f32_16x16x32_bf16 v[216:219], v[148:151], v[124:127], v[216:219]
    ds_read_b128 v[76:79], v164 offset:2048
    v_mfma_f32_16x16x32_bf16 v[216:219], v[152:155], v[128:131], v[216:219]
    ds_read_b128 v[80:83], v164 offset:3072
    buffer_load_dwordx4 v170, s[40:43], s50 offen offset:2048 lds
    v_mfma_f32_16x16x32_bf16 v[220:223], v[156:159], v[100:103], v[220:223]
    ds_read_b128 v[84:87], v164 offset:4096
    v_mfma_f32_16x16x32_bf16 v[220:223], v[160:163], v[104:107], v[220:223]
    ds_read_b128 v[88:91], v164 offset:5120
    v_mfma_f32_16x16x32_bf16 v[224:227], v[156:159], v[108:111], v[224:227]
    ds_read_b128 v[92:95], v164 offset:6144
    buffer_load_dwordx4 v170, s[40:43], s51 offen offset:3072 lds
    v_mfma_f32_16x16x32_bf16 v[224:227], v[160:163], v[112:115], v[224:227]
    ds_read_b128 v[96:99], v164 offset:7168
    v_add_u32 v170, s55, v170
    v_mfma_f32_16x16x32_bf16 v[228:231], v[156:159], v[116:119], v[228:231]
    ds_read_b64_tr_b16 v[140:141], v166 offset:0
    v_mfma_f32_16x16x32_bf16 v[228:231], v[160:163], v[120:123], v[228:231]
    ds_read_b64_tr_b16 v[142:143], v166 offset:2048
    v_mfma_f32_16x16x32_bf16 v[232:235], v[156:159], v[124:127], v[232:235]
    ds_read_b64_tr_b16 v[144:145], v166 offset:4096
    v_mfma_f32_16x16x32_bf16 v[232:235], v[160:163], v[128:131], v[232:235]
    ds_read_b64_tr_b16 v[146:147], v166 offset:6144
    s_sub_u32 s56, s56, 1
    s_cmp_eq_u32 s56, 1
    s_cselect_b32 s72, s66, s73
    s_cmp_lg_u32 s56, 0
    s_cbranch_scc1 g3_l2
    s_waitcnt lgkmcnt(12)
    v_mfma_f32_16x16x32_bf16 v[172:175], v[132:135], v[68:71], v[172:175]
    s_waitcnt lgkmcnt(10)
    s_add_u32 m0, s52, 49152
    v_mfma_f32_16x16x32_bf16 v[172:175], v[136:139], v[72:75], v[172:175]
    s_waitcnt lgkmcnt(9)
    buffer_load_dwordx4 v169, s[36:39], s44 offen offset:0 lds
    v_mfma_f32_16x16x32_bf16 v[176:179], v[132:135], v[76:79], v[176:179]
    s_waitcnt lgkmcnt(8)
    ds_read_b64_tr_b16 v[148:149], v167 offset:0
    v_mfma_f32_16x16x32_bf16 v[176:179], v[136:139], v[80:83], v[176:179]
    s_waitcnt lgkmcnt(8)
    ds_read_b64_tr_b16 v[150:151], v167 offset:2048
    v_mfma_f32_16x16x32_bf16 v[180:183], v[132:135], v[84:87], v[180:183]
    s_waitcnt lgkmcnt(8)
    ds_read_b64_tr_b16 v[152:153], v167 offset:4096
    buffer_load_dwordx4 v169, s[36:39], s45 offen offset:1024 lds
    v_mfma_f32_16x16x32_bf16 v[180:183], v[136:139], v[88:91], v[180:183]
    s_waitcnt lgkmcnt(8)
    ds_read_b64_tr_b16 v[154:155], v167 offset:6144
    v_mfma_f32_16x16x32_bf16 v[184:187], v[132:135], v[92:95], v[184:187]
    s_waitcnt lgkmcnt(8)
    ds_read_b64_tr_b16 v[156:157], v168 offset:0
    v_mfma_f32_16x16x32_bf16 v[184:187], v[136:139], v[96:99], v[184:187]
    s_waitcnt lgkmcnt(5)
    ds_read_b64_tr_b16 v[158:159], v168 offset:2048
    buffer_load_dwordx4 v169, s[36:39], s46 offen offset:2048 lds
    v_mfma_f32_16x16x32_bf16 v[188:191], v[140:143], v[68:71], v[188:191]
    ds_read_b64_tr_b16 v[160:161], v168 offset:4096
    v_mfma_f32_16x16x32_bf16 v[188:191], v[144:147], v[72:75], v[188:191]
    ds_read_b64_tr_b16 v[162:163], v168 offset:6144
    v_mfma_f32_16x16x32_bf16 v[192:195], v[140:143], v[76:79], v[192:195]
    buffer_load_dwordx4 v169, s[36:39], s47 offen offset:3072 lds
    v_add_u32 v169, s54, v169
    v_mfma_f32_16x16x32_bf16 v[192:195], v[144:147], v[80:83], v[192:195]
    v_mfma_f32_16x16x32_bf16 v[196:199], v[140:143], v[84:87], v[196:199]
    v_mfma_f32_16x16x32_bf16 v[196:199], v[144:147], v[88:91], v[196:199]
    v_mfma_f32_16x16x32_bf16 v[200:203], v[140:143], v[92:95], v[200:203]
    v_mfma_f32_16x16x32_bf16 v[200:203], v[144:147], v[96:99], v[200:203]
    s_waitcnt vmcnt(16) lgkmcnt(0)
    s_barrier
    v_mfma_f32_16x16x32_bf16 v[204:207], v[148:151], v[68:71], v[204:207]
    s_add_u32 m0, s53, 0
    ds_read_b128 v[100:103], v164 offset:16384
    v_mfma_f32_16x16x32_bf16 v[204:207], v[152:155], v[72:75], v[204:207]
    ds_read_b128 v[104:107], v164 offset:17408
    buffer_load_dwordx4 v170, s[40:43], s48 offen offset:0 lds
    v_mfma_f32_16x16x32_bf16 v[208:211], v[148:151], v[76:79], v[208:211]
    ds_read_b64_tr_b16 v[132:133], v165 offset:16384
    v_mfma_f32_16x16x32_bf16 v[208:211], v[152:155], v[80:83], v[208:211]
    ds_read_b64_tr_b16 v[134:135], v165 offset:18432
    v_mfma_f32_16x16x32_bf16 v[212:215], v[148:151], v[84:87], v[212:215]
    ds_read_b64_tr_b16 v[136:137], v165 offset:20480
    buffer_load_dwordx4 v170, s[40:43], s49 offen offset:1024 lds
    v_mfma_f32_16x16x32_bf16 v[212:215], v[152:155], v[88:91], v[212:215]
    ds_read_b64_tr_b16 v[138:139], v165 offset:22528
    v_mfma_f32_16x16x32_bf16 v[216:219], v[148:151], v[92:95], v[216:219]
    ds_read_b128 v[108:111], v164 offset:18432
    v_mfma_f32_16x16x32_bf16 v[216:219], v[152:155], v[96:99], v[216:219]
    ds_read_b128 v[112:115], v164 offset:19456
    buffer_load_dwordx4 v170, s[40:43], s50 offen offset:2048 lds
    v_mfma_f32_16x16x32_bf16 v[220:223], v[156:159], v[68:71], v[220:223]
    ds_read_b128 v[116:119], v164 offset:20480
    v_mfma_f32_16x16x32_bf16 v[220:223], v[160:163], v[72:75], v[220:223]
    ds_read_b128 v[120:123], v164 offset:21504
    v_mfma_f32_16x16x32_bf16 v[224:227], v[156:159], v[76:79], v[224:227]
    ds_read_b128 v[124:127], v164 offset:22528
    buffer_load_dwordx4 v170, s[40:43], s51 offen offset:3072 lds
    v_mfma_f32_16x16x32_bf16 v[224:227], v[160:163], v[80:83], v[224:227]
    ds_read_b128 v[128:131], v164 offset:23552
    v_add_u32 v170, s55, v170
    v_mfma_f32_16x16x32_bf16 v[228:231], v[156:159], v[84:87], v[228:231]
    ds_read_b64_tr_b16 v[140:141], v166 offset:16384
    v_mfma_f32_16x16x32_bf16 v[228:231], v[160:163], v[88:91], v[228:231]
    ds_read_b64_tr_b16 v[142:143], v166 offset:18432
    v_mfma_f32_16x16x32_bf16 v[232:235], v[156:159], v[92:95], v[232:235]
    ds_read_b64_tr_b16 v[144:145], v166 offset:20480
    v_mfma_f32_16x16x32_bf16 v[232:235], v[160:163], v[96:99], v[232:235]
    ds_read_b64_tr_b16 v[146:147], v166 offset:22528
    s_waitcnt lgkmcnt(12)
    v_mfma_f32_16x16x32_bf16 v[172:175], v[132:135], v[100:103], v[172:175]
    s_waitcnt lgkmcnt(10)
    s_add_u32 m0, s52, 0
    v_mfma_f32_16x16x32_bf16 v[172:175], v[136:139], v[104:107], v[172:175]
    s_waitcnt lgkmcnt(9)
    buffer_load_dwordx4 v169, s[36:39], s44 offen offset:0 lds
    v_mfma_f32_16x16x32_bf16 v[176:179], v[132:135], v[108:111], v[176:179]
    s_waitcnt lgkmcnt(8)
    ds_read_b64_tr_b16 v[148:149], v167 offset:16384
    v_mfma_f32_16x16x32_bf16 v[176:179], v[136:139], v[112:115], v[176:179]
    s_waitcnt lgkmcnt(8)
    ds_read_b64_tr_b16 v[150:151], v167 offset:18432
    v_mfma_f32_16x16x32_bf16 v[180:183], v[132:135], v[116:119], v[180:183]
    s_waitcnt lgkmcnt(8)
    ds_read_b64_tr_b16 v[152:153], v167 offset:20480
    buffer_load_dwordx4 v169, s[36:39], s45 offen offset:1024 lds
    v_mfma_f32_16x16x32_bf16 v[180:183], v[136:139], v[120:123], v[180:183]
    s_waitcnt lgkmcnt(8)
    ds_read_b64_tr_b16 v[154:155], v167 offset:22528
    v_mfma_f32_16x16x32_bf16 v[184:187], v[132:135], v[124:127], v[184:187]
    s_waitcnt lgkmcnt(8)
    ds_read_b64_tr_b16 v[156:157], v168 offset:16384
    v_mfma_f32_16x16x32_bf16 v[184:187], v[136:139], v[128:131], v[184:187]
    s_waitcnt lgkmcnt(5)
    ds_read_b64_tr_b16 v[158:159], v168 offset:18432
    buffer_load_dwordx4 v169, s[36:39], s46 offen offset:2048 lds
    v_mfma_f32_16x16x32_bf16 v[188:191], v[140:143], v[100:103], v[188:191]
    ds_read_b64_tr_b16 v[160:161], v168 offset:20480
    v_mfma_f32_16x16x32_bf16 v[188:191], v[144:147], v[104:107], v[188:191]
    ds_read_b64_tr_b16 v[162:163], v168 offset:22528
    v_mfma_f32_16x16x32_bf16 v[192:195], v[140:143], v[108:111], v[192:195]
    buffer_load_dwordx4 v169, s[36:39], s47 offen offset:3072 lds
    v_add_u32 v169, s54, v169
    v_mfma_f32_16x16x32_bf16 v[192:195], v[144:147], v[112:115], v[192:195]
    v_mfma_f32_16x16x32_bf16 v[196:199], v[140:143], v[116:119], v[196:199]
    v_mfma_f32_16x16x32_bf16 v[196:199], v[144:147], v[120:123], v[196:199]
    v_mfma_f32_16x16x32_bf16 v[200:203], v[140:143], v[124:127], v[200:203]
    v_mfma_f32_16x16x32_bf16 v[200:203], v[144:147], v[128:131], v[200:203]
    s_waitcnt vmcnt(16) lgkmcnt(0)
    s_barrier
    v_mfma_f32_16x16x32_bf16 v[204:207], v[148:151], v[100:103], v[204:207]
    s_add_u32 m0, s53, 16384
    ds_read_b128 v[68:71], v164 offset:32768
    v_mfma_f32_16x16x32_bf16 v[204:207], v[152:155], v[104:107], v[204:207]
    ds_read_b128 v[72:75], v164 offset:33792
    buffer_load_dwordx4 v170, s[40:43], s48 offen offset:0 lds
    v_mfma_f32_16x16x32_bf16 v[208:211], v[148:151], v[108:111], v[208:211]
    ds_read_b64_tr_b16 v[132:133], v165 offset:32768
    v_mfma_f32_16x16x32_bf16 v[208:211], v[152:155], v[112:115], v[208:211]
    ds_read_b64_tr_b16 v[134:135], v165 offset:34816
    v_mfma_f32_16x16x32_bf16 v[212:215], v[148:151], v[116:119], v[212:215]
    ds_read_b64_tr_b16 v[136:137], v165 offset:36864
    buffer_load_dwordx4 v170, s[40:43], s49 offen offset:1024 lds
    v_mfma_f32_16x16x32_bf16 v[212:215], v[152:155], v[120:123], v[212:215]
    ds_read_b64_tr_b16 v[138:139], v165 offset:38912
    v_mfma_f32_16x16x32_bf16 v[216:219], v[148:151], v[124:127], v[216:219]
    ds_read_b128 v[76:79], v164 offset:34816
    v_mfma_f32_16x16x32_bf16 v[216:219], v[152:155], v[128:131], v[216:219]
    ds_read_b128 v[80:83], v164 offset:35840
    buffer_load_dwordx4 v170, s[40:43], s50 offen offset:2048 lds
    v_mfma_f32_16x16x32_bf16 v[220:223], v[156:159], v[100:103], v[220:223]
    ds_read_b128 v[84:87], v164 offset:36864
    v_mfma_f32_16x16x32_bf16 v[220:223], v[160:163], v[104:107], v[220:223]
    ds_read_b128 v[88:91], v164 offset:37888
    v_mfma_f32_16x16x32_bf16 v[224:227], v[156:159], v[108:111], v[224:227]
    ds_read_b128 v[92:95], v164 offset:38912
    buffer_load_dwordx4 v170, s[40:43], s51 offen offset:3072 lds
    v_mfma_f32_16x16x32_bf16 v[224:227], v[160:163], v[112:115], v[224:227]
    ds_read_b128 v[96:99], v164 offset:39936
    v_add_u32 v170, s55, v170
    v_mfma_f32_16x16x32_bf16 v[228:231], v[156:159], v[116:119], v[228:231]
    ds_read_b64_tr_b16 v[140:141], v166 offset:32768
    v_mfma_f32_16x16x32_bf16 v[228:231], v[160:163], v[120:123], v[228:231]
    ds_read_b64_tr_b16 v[142:143], v166 offset:34816
    v_mfma_f32_16x16x32_bf16 v[232:235], v[156:159], v[124:127], v[232:235]
    ds_read_b64_tr_b16 v[144:145], v166 offset:36864
    v_mfma_f32_16x16x32_bf16 v[232:235], v[160:163], v[128:131], v[232:235]
    ds_read_b64_tr_b16 v[146:147], v166 offset:38912
    s_waitcnt lgkmcnt(12)
    v_mfma_f32_16x16x32_bf16 v[172:175], v[132:135], v[68:71], v[172:175]
    s_waitcnt lgkmcnt(10)
    s_add_u32 m0, s52, 16384
    v_mfma_f32_16x16x32_bf16 v[172:175], v[136:139], v[72:75], v[172:175]
    s_waitcnt lgkmcnt(9)
    buffer_load_dwordx4 v169, s[36:39], s44 offen offset:0 lds
    v_mfma_f32_16x16x32_bf16 v[176:179], v[132:135], v[76:79], v[176:179]
    s_waitcnt lgkmcnt(8)
    ds_read_b64_tr_b16 v[148:149], v167 offset:32768
    v_mfma_f32_16x16x32_bf16 v[176:179], v[136:139], v[80:83], v[176:179]
    s_waitcnt lgkmcnt(8)
    ds_read_b64_tr_b16 v[150:151], v167 offset:34816
    v_mfma_f32_16x16x32_bf16 v[180:183], v[132:135], v[84:87], v[180:183]
    s_waitcnt lgkmcnt(8)
    ds_read_b64_tr_b16 v[152:153], v167 offset:36864
    buffer_load_dwordx4 v169, s[36:39], s45 offen offset:1024 lds
    v_mfma_f32_16x16x32_bf16 v[180:183], v[136:139], v[88:91], v[180:183]
    s_waitcnt lgkmcnt(8)
    ds_read_b64_tr_b16 v[154:155], v167 offset:38912
    v_mfma_f32_16x16x32_bf16 v[184:187], v[132:135], v[92:95], v[184:187]
    s_waitcnt lgkmcnt(8)
    ds_read_b64_tr_b16 v[156:157], v168 offset:32768
    v_mfma_f32_16x16x32_bf16 v[184:187], v[136:139], v[96:99], v[184:187]
    s_waitcnt lgkmcnt(5)
    ds_read_b64_tr_b16 v[158:159], v168 offset:34816
    buffer_load_dwordx4 v169, s[36:39], s46 offen offset:2048 lds
    v_mfma_f32_16x16x32_bf16 v[188:191], v[140:143], v[68:71], v[188:191]
    ds_read_b64_tr_b16 v[160:161], v168 offset:36864
    v_mfma_f32_16x16x32_bf16 v[188:191], v[144:147], v[72:75], v[188:191]
    ds_read_b64_tr_b16 v[162:163], v168 offset:38912
    v_mfma_f32_16x16x32_bf16 v[192:195], v[140:143], v[76:79], v[192:195]
    buffer_load_dwordx4 v169, s[36:39], s47 offen offset:3072 lds
    v_add_u32 v169, s54, v169
    v_mfma_f32_16x16x32_bf16 v[192:195], v[144:147], v[80:83], v[192:195]
    v_mfma_f32_16x16x32_bf16 v[196:199], v[140:143], v[84:87], v[196:199]
    v_mfma_f32_16x16x32_bf16 v[196:199], v[144:147], v[88:91], v[196:199]
    v_mfma_f32_16x16x32_bf16 v[200:203], v[140:143], v[92:95], v[200:203]
    v_mfma_f32_16x16x32_bf16 v[200:203], v[144:147], v[96:99], v[200:203]
    s_waitcnt vmcnt(16) lgkmcnt(0)
    s_barrier
    v_mfma_f32_16x16x32_bf16 v[204:207], v[148:151], v[68:71], v[204:207]
    s_add_u32 m0, s53, 32768
    ds_read_b128 v[100:103], v164 offset:49152
    v_mfma_f32_16x16x32_bf16 v[204:207], v[152:155], v[72:75], v[204:207]
    ds_read_b128 v[104:107], v164 offset:50176
    buffer_load_dwordx4 v170, s[40:43], s48 offen offset:0 lds
    v_mfma_f32_16x16x32_bf16 v[208:211], v[148:151], v[76:79], v[208:211]
    ds_read_b64_tr_b16 v[132:133], v165 offset:49152
    v_mfma_f32_16x16x32_bf16 v[208:211], v[152:155], v[80:83], v[208:211]
    ds_read_b64_tr_b16 v[134:135], v165 offset:51200
    v_mfma_f32_16x16x32_bf16 v[212:215], v[148:151], v[84:87], v[212:215]
    ds_read_b64_tr_b16 v[136:137], v165 offset:53248
    buffer_load_dwordx4 v170, s[40:43], s49 offen offset:1024 lds
    v_mfma_f32_16x16x32_bf16 v[212:215], v[152:155], v[88:91], v[212:215]
    ds_read_b64_tr_b16 v[138:139], v165 offset:55296
    v_mfma_f32_16x16x32_bf16 v[216:219], v[148:151], v[92:95], v[216:219]
    ds_read_b128 v[108:111], v164 offset:51200
    v_mfma_f32_16x16x32_bf16 v[216:219], v[152:155], v[96:99], v[216:219]
    ds_read_b128 v[112:115], v164 offset:52224
    buffer_load_dwordx4 v170, s[40:43], s50 offen offset:2048 lds
    v_mfma_f32_16x16x32_bf16 v[220:223], v[156:159], v[68:71], v[220:223]
    ds_read_b128 v[116:119], v164 offset:53248
    v_mfma_f32_16x16x32_bf16 v[220:223], v[160:163], v[72:75], v[220:223]
    ds_read_b128 v[120:123], v164 offset:54272
    v_mfma_f32_16x16x32_bf16 v[224:227], v[156:159], v[76:79], v[224:227]
    ds_read_b128 v[124:127], v164 offset:55296
    buffer_load_dwordx4 v170, s[40:43], s51 offen offset:3072 lds
    v_mfma_f32_16x16x32_bf16 v[224:227], v[160:163], v[80:83], v[224:227]
    ds_read_b128 v[128:131], v164 offset:56320
    v_add_u32 v170, s55, v170
    v_mfma_f32_16x16x32_bf16 v[228:231], v[156:159], v[84:87], v[228:231]
    ds_read_b64_tr_b16 v[140:141], v166 offset:49152
    v_mfma_f32_16x16x32_bf16 v[228:231], v[160:163], v[88:91], v[228:231]
    ds_read_b64_tr_b16 v[142:143], v166 offset:51200
    v_mfma_f32_16x16x32_bf16 v[232:235], v[156:159], v[92:95], v[232:235]
    ds_read_b64_tr_b16 v[144:145], v166 offset:53248
    v_mfma_f32_16x16x32_bf16 v[232:235], v[160:163], v[96:99], v[232:235]
    ds_read_b64_tr_b16 v[146:147], v166 offset:55296
    s_waitcnt lgkmcnt(12)
    v_mfma_f32_16x16x32_bf16 v[172:175], v[132:135], v[100:103], v[172:175]
    s_waitcnt lgkmcnt(10)
    s_add_u32 m0, s52, 32768
    v_mfma_f32_16x16x32_bf16 v[172:175], v[136:139], v[104:107], v[172:175]
    s_waitcnt lgkmcnt(9)
    buffer_load_dwordx4 v169, s[36:39], s44 offen offset:0 lds
    v_mfma_f32_16x16x32_bf16 v[176:179], v[132:135], v[108:111], v[176:179]
    s_waitcnt lgkmcnt(8)
    ds_read_b64_tr_b16 v[148:149], v167 offset:49152
    v_mfma_f32_16x16x32_bf16 v[176:179], v[136:139], v[112:115], v[176:179]
    s_waitcnt lgkmcnt(8)
    ds_read_b64_tr_b16 v[150:151], v167 offset:51200
    v_mfma_f32_16x16x32_bf16 v[180:183], v[132:135], v[116:119], v[180:183]
    s_waitcnt lgkmcnt(8)
    ds_read_b64_tr_b16 v[152:153], v167 offset:53248
    buffer_load_dwordx4 v169, s[36:39], s45 offen offset:1024 lds
    v_mfma_f32_16x16x32_bf16 v[180:183], v[136:139], v[120:123], v[180:183]
    s_waitcnt lgkmcnt(8)
    ds_read_b64_tr_b16 v[154:155], v167 offset:55296
    v_mfma_f32_16x16x32_bf16 v[184:187], v[132:135], v[124:127], v[184:187]
    s_waitcnt lgkmcnt(8)
    ds_read_b64_tr_b16 v[156:157], v168 offset:49152
    v_mfma_f32_16x16x32_bf16 v[184:187], v[136:139], v[128:131], v[184:187]
    s_waitcnt lgkmcnt(5)
    ds_read_b64_tr_b16 v[158:159], v168 offset:51200
    buffer_load_dwordx4 v169, s[36:39], s46 offen offset:2048 lds
    v_mfma_f32_16x16x32_bf16 v[188:191], v[140:143], v[100:103], v[188:191]
    ds_read_b64_tr_b16 v[160:161], v168 offset:53248
    v_mfma_f32_16x16x32_bf16 v[188:191], v[144:147], v[104:107], v[188:191]
    ds_read_b64_tr_b16 v[162:163], v168 offset:55296
    v_mfma_f32_16x16x32_bf16 v[192:195], v[140:143], v[108:111], v[192:195]
    buffer_load_dwordx4 v169, s[36:39], s47 offen offset:3072 lds
    v_add_u32 v169, s54, v169
    v_mfma_f32_16x16x32_bf16 v[192:195], v[144:147], v[112:115], v[192:195]
    v_mfma_f32_16x16x32_bf16 v[196:199], v[140:143], v[116:119], v[196:199]
    v_mfma_f32_16x16x32_bf16 v[196:199], v[144:147], v[120:123], v[196:199]
    v_mfma_f32_16x16x32_bf16 v[200:203], v[140:143], v[124:127], v[200:203]
    v_mfma_f32_16x16x32_bf16 v[200:203], v[144:147], v[128:131], v[200:203]
    s_waitcnt vmcnt(16) lgkmcnt(0)
    s_barrier
    v_mfma_f32_16x16x32_bf16 v[204:207], v[148:151], v[100:103], v[204:207]
    s_add_u32 m0, s53, 49152
    ds_read_b128 v[68:71], v164 offset:0
    v_mfma_f32_16x16x32_bf16 v[204:207], v[152:155], v[104:107], v[204:207]
    ds_read_b128 v[72:75], v164 offset:1024
    buffer_load_dwordx4 v170, s[40:43], s48 offen offset:0 lds
    v_mfma_f32_16x16x32_bf16 v[208:211], v[148:151], v[108:111], v[208:211]
    ds_read_b64_tr_b16 v[132:133], v165 offset:0
    v_mfma_f32_16x16x32_bf16 v[208:211], v[152:155], v[112:115], v[208:211]
    ds_read_b64_tr_b16 v[134:135], v165 offset:2048
    v_mfma_f32_16x16x32_bf16 v[212:215], v[148:151], v[116:119], v[212:215]
    ds_read_b64_tr_b16 v[136:137], v165 offset:4096
    buffer_load_dwordx4 v170, s[40:43], s49 offen offset:1024 lds
    v_mfma_f32_16x16x32_bf16 v[212:215], v[152:155], v[120:123], v[212:215]
    ds_read_b64_tr_b16 v[138:139], v165 offset:6144
    v_mfma_f32_16x16x32_bf16 v[216:219], v[148:151], v[124:127], v[216:219]
    ds_read_b128 v[76:79], v164 offset:2048
    v_mfma_f32_16x16x32_bf16 v[216:219], v[152:155], v[128:131], v[216:219]
    ds_read_b128 v[80:83], v164 offset:3072
    buffer_load_dwordx4 v170, s[40:43], s50 offen offset:2048 lds
    v_mfma_f32_16x16x32_bf16 v[220:223], v[156:159], v[100:103], v[220:223]
    ds_read_b128 v[84:87], v164 offset:4096
    v_mfma_f32_16x16x32_bf16 v[220:223], v[160:163], v[104:107], v[220:223]
    ds_read_b128 v[88:91], v164 offset:5120
    v_mfma_f32_16x16x32_bf16 v[224:227], v[156:159], v[108:111], v[224:227]
    ds_read_b128 v[92:95], v164 offset:6144
    buffer_load_dwordx4 v170, s[40:43], s51 offen offset:3072 lds
    v_mfma_f32_16x16x32_bf16 v[224:227], v[160:163], v[112:115], v[224:227]
    ds_read_b128 v[96:99], v164 offset:7168
    v_add_u32 v170, s55, v170
    v_mfma_f32_16x16x32_bf16 v[228:231], v[156:159], v[116:119], v[228:231]
    ds_read_b64_tr_b16 v[140:141], v166 offset:0
    v_mfma_f32_16x16x32_bf16 v[228:231], v[160:163], v[120:123], v[228:231]
    ds_read_b64_tr_b16 v[142:143], v166 offset:2048
    v_mfma_f32_16x16x32_bf16 v[232:235], v[156:159], v[124:127], v[232:235]
    ds_read_b64_tr_b16 v[144:145], v166 offset:4096
    v_mfma_f32_16x16x32_bf16 v[232:235], v[160:163], v[128:131], v[232:235]
    ds_read_b64_tr_b16 v[146:147], v166 offset:6144
    s_waitcnt lgkmcnt(12)
    v_mfma_f32_16x16x32_bf16 v[172:175], v[132:135], v[68:71], v[172:175]
    s_waitcnt lgkmcnt(10)
    s_add_u32 m0, s52, 49152
    v_mfma_f32_16x16x32_bf16 v[172:175], v[136:139], v[72:75], v[172:175]
    s_waitcnt lgkmcnt(9)
    buffer_load_dwordx4 v169, s[36:39], s44 offen offset:0 lds
    v_mfma_f32_16x16x32_bf16 v[176:179], v[132:135], v[76:79], v[176:179]
    s_waitcnt lgkmcnt(8)
    ds_read_b64_tr_b16 v[148:149], v167 offset:0
    v_mfma_f32_16x16x32_bf16 v[176:179], v[136:139], v[80:83], v[176:179]
    s_waitcnt lgkmcnt(8)
    ds_read_b64_tr_b16 v[150:151], v167 offset:2048
    v_mfma_f32_16x16x32_bf16 v[180:183], v[132:135], v[84:87], v[180:183]
    s_waitcnt lgkmcnt(8)
    ds_read_b64_tr_b16 v[152:153], v167 offset:4096
    buffer_load_dwordx4 v169, s[36:39], s45 offen offset:1024 lds
    v_mfma_f32_16x16x32_bf16 v[180:183], v[136:139], v[88:91], v[180:183]
    s_waitcnt lgkmcnt(8)
    ds_read_b64_tr_b16 v[154:155], v167 offset:6144
    v_mfma_f32_16x16x32_bf16 v[184:187], v[132:135], v[92:95], v[184:187]
    s_waitcnt lgkmcnt(8)
    ds_read_b64_tr_b16 v[156:157], v168 offset:0
    v_mfma_f32_16x16x32_bf16 v[184:187], v[136:139], v[96:99], v[184:187]
    s_waitcnt lgkmcnt(5)
    ds_read_b64_tr_b16 v[158:159], v168 offset:2048
    buffer_load_dwordx4 v169, s[36:39], s46 offen offset:2048 lds
    v_mfma_f32_16x16x32_bf16 v[188:191], v[140:143], v[68:71], v[188:191]
    ds_read_b64_tr_b16 v[160:161], v168 offset:4096
    v_mfma_f32_16x16x32_bf16 v[188:191], v[144:147], v[72:75], v[188:191]
    ds_read_b64_tr_b16 v[162:163], v168 offset:6144
    v_mfma_f32_16x16x32_bf16 v[192:195], v[140:143], v[76:79], v[192:195]
    buffer_load_dwordx4 v169, s[36:39], s47 offen offset:3072 lds
    v_add_u32 v169, s54, v169
    v_mfma_f32_16x16x32_bf16 v[192:195], v[144:147], v[80:83], v[192:195]
    v_mfma_f32_16x16x32_bf16 v[196:199], v[140:143], v[84:87], v[196:199]
    v_mfma_f32_16x16x32_bf16 v[196:199], v[144:147], v[88:91], v[196:199]
    v_mfma_f32_16x16x32_bf16 v[200:203], v[140:143], v[92:95], v[200:203]
    v_mfma_f32_16x16x32_bf16 v[200:203], v[144:147], v[96:99], v[200:203]
    s_waitcnt vmcnt(16) lgkmcnt(0)
    s_barrier
    v_mfma_f32_16x16x32_bf16 v[204:207], v[148:151], v[68:71], v[204:207]
    ds_read_b128 v[100:103], v164 offset:16384
    v_mfma_f32_16x16x32_bf16 v[204:207], v[152:155], v[72:75], v[204:207]
    ds_read_b128 v[104:107], v164 offset:17408
    v_mfma_f32_16x16x32_bf16 v[208:211], v[148:151], v[76:79], v[208:211]
    ds_read_b64_tr_b16 v[132:133], v165 offset:16384
    v_mfma_f32_16x16x32_bf16 v[208:211], v[152:155], v[80:83], v[208:211]
    ds_read_b64_tr_b16 v[134:135], v165 offset:18432
    v_mfma_f32_16x16x32_bf16 v[212:215], v[148:151], v[84:87], v[212:215]
    ds_read_b64_tr_b16 v[136:137], v165 offset:20480
    v_mfma_f32_16x16x32_bf16 v[212:215], v[152:155], v[88:91], v[212:215]
    ds_read_b64_tr_b16 v[138:139], v165 offset:22528
    v_mfma_f32_16x16x32_bf16 v[216:219], v[148:151], v[92:95], v[216:219]
    ds_read_b128 v[108:111], v164 offset:18432
    v_mfma_f32_16x16x32_bf16 v[216:219], v[152:155], v[96:99], v[216:219]
    ds_read_b128 v[112:115], v164 offset:19456
    v_mfma_f32_16x16x32_bf16 v[220:223], v[156:159], v[68:71], v[220:223]
    ds_read_b128 v[116:119], v164 offset:20480
    v_mfma_f32_16x16x32_bf16 v[220:223], v[160:163], v[72:75], v[220:223]
    ds_read_b128 v[120:123], v164 offset:21504
    v_mfma_f32_16x16x32_bf16 v[224:227], v[156:159], v[76:79], v[224:227]
    ds_read_b128 v[124:127], v164 offset:22528
    v_mfma_f32_16x16x32_bf16 v[224:227], v[160:163], v[80:83], v[224:227]
    ds_read_b128 v[128:131], v164 offset:23552
    v_mfma_f32_16x16x32_bf16 v[228:231], v[156:159], v[84:87], v[228:231]
    ds_read_b64_tr_b16 v[140:141], v166 offset:16384
    v_mfma_f32_16x16x32_bf16 v[228:231], v[160:163], v[88:91], v[228:231]
    ds_read_b64_tr_b16 v[142:143], v166 offset:18432
    v_mfma_f32_16x16x32_bf16 v[232:235], v[156:159], v[92:95], v[232:235]
    ds_read_b64_tr_b16 v[144:145], v166 offset:20480
    v_mfma_f32_16x16x32_bf16 v[232:235], v[160:163], v[96:99], v[232:235]
    ds_read_b64_tr_b16 v[146:147], v166 offset:22528
    s_waitcnt lgkmcnt(12)
    v_mfma_f32_16x16x32_bf16 v[172:175], v[132:135], v[100:103], v[172:175]
    s_waitcnt lgkmcnt(10)
    v_mfma_f32_16x16x32_bf16 v[172:175], v[136:139], v[104:107], v[172:175]
    s_waitcnt lgkmcnt(9)
    v_mfma_f32_16x16x32_bf16 v[176:179], v[132:135], v[108:111], v[176:179]
    s_waitcnt lgkmcnt(8)
    ds_read_b64_tr_b16 v[148:149], v167 offset:16384
    v_mfma_f32_16x16x32_bf16 v[176:179], v[136:139], v[112:115], v[176:179]
    s_waitcnt lgkmcnt(8)
    ds_read_b64_tr_b16 v[150:151], v167 offset:18432
    v_mfma_f32_16x16x32_bf16 v[180:183], v[132:135], v[116:119], v[180:183]
    s_waitcnt lgkmcnt(8)
    ds_read_b64_tr_b16 v[152:153], v167 offset:20480
    v_mfma_f32_16x16x32_bf16 v[180:183], v[136:139], v[120:123], v[180:183]
    s_waitcnt lgkmcnt(8)
    ds_read_b64_tr_b16 v[154:155], v167 offset:22528
    v_mfma_f32_16x16x32_bf16 v[184:187], v[132:135], v[124:127], v[184:187]
    s_waitcnt lgkmcnt(8)
    ds_read_b64_tr_b16 v[156:157], v168 offset:16384
    v_mfma_f32_16x16x32_bf16 v[184:187], v[136:139], v[128:131], v[184:187]
    s_waitcnt lgkmcnt(5)
    ds_read_b64_tr_b16 v[158:159], v168 offset:18432
    v_mfma_f32_16x16x32_bf16 v[188:191], v[140:143], v[100:103], v[188:191]
    ds_read_b64_tr_b16 v[160:161], v168 offset:20480
    v_mfma_f32_16x16x32_bf16 v[188:191], v[144:147], v[104:107], v[188:191]
    ds_read_b64_tr_b16 v[162:163], v168 offset:22528
    v_mfma_f32_16x16x32_bf16 v[192:195], v[140:143], v[108:111], v[192:195]
    v_mfma_f32_16x16x32_bf16 v[192:195], v[144:147], v[112:115], v[192:195]
    v_mfma_f32_16x16x32_bf16 v[196:199], v[140:143], v[116:119], v[196:199]
    v_mfma_f32_16x16x32_bf16 v[196:199], v[144:147], v[120:123], v[196:199]
    v_mfma_f32_16x16x32_bf16 v[200:203], v[140:143], v[124:127], v[200:203]
    v_mfma_f32_16x16x32_bf16 v[200:203], v[144:147], v[128:131], v[200:203]
    s_waitcnt vmcnt(8) lgkmcnt(0)
    s_barrier
    v_mfma_f32_16x16x32_bf16 v[204:207], v[148:151], v[100:103], v[204:207]
    ds_read_b128 v[68:71], v164 offset:32768
    v_mfma_f32_16x16x32_bf16 v[204:207], v[152:155], v[104:107], v[204:207]
    ds_read_b128 v[72:75], v164 offset:33792
    v_mfma_f32_16x16x32_bf16 v[208:211], v[148:151], v[108:111], v[208:211]
    ds_read_b64_tr_b16 v[132:133], v165 offset:32768
    v_mfma_f32_16x16x32_bf16 v[208:211], v[152:155], v[112:115], v[208:211]
    ds_read_b64_tr_b16 v[134:135], v165 offset:34816
    v_mfma_f32_16x16x32_bf16 v[212:215], v[148:151], v[116:119], v[212:215]
    ds_read_b64_tr_b16 v[136:137], v165 offset:36864
    v_mfma_f32_16x16x32_bf16 v[212:215], v[152:155], v[120:123], v[212:215]
    ds_read_b64_tr_b16 v[138:139], v165 offset:38912
    v_mfma_f32_16x16x32_bf16 v[216:219], v[148:151], v[124:127], v[216:219]
    ds_read_b128 v[76:79], v164 offset:34816
    v_mfma_f32_16x16x32_bf16 v[216:219], v[152:155], v[128:131], v[216:219]
    ds_read_b128 v[80:83], v164 offset:35840
    v_mfma_f32_16x16x32_bf16 v[220:223], v[156:159], v[100:103], v[220:223]
    ds_read_b128 v[84:87], v164 offset:36864
    v_mfma_f32_16x16x32_bf16 v[220:223], v[160:163], v[104:107], v[220:223]
    ds_read_b128 v[88:91], v164 offset:37888
    v_mfma_f32_16x16x32_bf16 v[224:227], v[156:159], v[108:111], v[224:227]
    ds_read_b128 v[92:95], v164 offset:38912
    v_mfma_f32_16x16x32_bf16 v[224:227], v[160:163], v[112:115], v[224:227]
    ds_read_b128 v[96:99], v164 offset:39936
    v_mfma_f32_16x16x32_bf16 v[228:231], v[156:159], v[116:119], v[228:231]
    ds_read_b64_tr_b16 v[140:141], v166 offset:32768
    v_mfma_f32_16x16x32_bf16 v[228:231], v[160:163], v[120:123], v[228:231]
    ds_read_b64_tr_b16 v[142:143], v166 offset:34816
    v_mfma_f32_16x16x32_bf16 v[232:235], v[156:159], v[124:127], v[232:235]
    ds_read_b64_tr_b16 v[144:145], v166 offset:36864
    v_mfma_f32_16x16x32_bf16 v[232:235], v[160:163], v[128:131], v[232:235]
    ds_read_b64_tr_b16 v[146:147], v166 offset:38912
    s_waitcnt lgkmcnt(12)
    v_mfma_f32_16x16x32_bf16 v[172:175], v[132:135], v[68:71], v[172:175]
    s_waitcnt lgkmcnt(10)
    v_mfma_f32_16x16x32_bf16 v[172:175], v[136:139], v[72:75], v[172:175]
    s_waitcnt lgkmcnt(9)
    v_mfma_f32_16x16x32_bf16 v[176:179], v[132:135], v[76:79], v[176:179]
    s_waitcnt lgkmcnt(8)
    ds_read_b64_tr_b16 v[148:149], v167 offset:32768
    v_mfma_f32_16x16x32_bf16 v[176:179], v[136:139], v[80:83], v[176:179]
    s_waitcnt lgkmcnt(8)
    ds_read_b64_tr_b16 v[150:151], v167 offset:34816
    v_mfma_f32_16x16x32_bf16 v[180:183], v[132:135], v[84:87], v[180:183]
    s_waitcnt lgkmcnt(8)
    ds_read_b64_tr_b16 v[152:153], v167 offset:36864
    v_mfma_f32_16x16x32_bf16 v[180:183], v[136:139], v[88:91], v[180:183]
    s_waitcnt lgkmcnt(8)
    ds_read_b64_tr_b16 v[154:155], v167 offset:38912
    v_mfma_f32_16x16x32_bf16 v[184:187], v[132:135], v[92:95], v[184:187]
    s_waitcnt lgkmcnt(8)
    ds_read_b64_tr_b16 v[156:157], v168 offset:32768
    v_mfma_f32_16x16x32_bf16 v[184:187], v[136:139], v[96:99], v[184:187]
    s_waitcnt lgkmcnt(5)
    ds_read_b64_tr_b16 v[158:159], v168 offset:34816
    v_mfma_f32_16x16x32_bf16 v[188:191], v[140:143], v[68:71], v[188:191]
    ds_read_b64_tr_b16 v[160:161], v168 offset:36864
    v_mfma_f32_16x16x32_bf16 v[188:191], v[144:147], v[72:75], v[188:191]
    ds_read_b64_tr_b16 v[162:163], v168 offset:38912
    v_mfma_f32_16x16x32_bf16 v[192:195], v[140:143], v[76:79], v[192:195]
    v_mfma_f32_16x16x32_bf16 v[192:195], v[144:147], v[80:83], v[192:195]
    v_mfma_f32_16x16x32_bf16 v[196:199], v[140:143], v[84:87], v[196:199]
    v_mfma_f32_16x16x32_bf16 v[196:199], v[144:147], v[88:91], v[196:199]
    v_mfma_f32_16x16x32_bf16 v[200:203], v[140:143], v[92:95], v[200:203]
    v_mfma_f32_16x16x32_bf16 v[200:203], v[144:147], v[96:99], v[200:203]
    s_waitcnt vmcnt(0) lgkmcnt(0)
    s_barrier
    v_mfma_f32_16x16x32_bf16 v[204:207], v[148:151], v[68:71], v[204:207]
    ds_read_b128 v[100:103], v164 offset:49152
    v_mfma_f32_16x16x32_bf16 v[204:207], v[152:155], v[72:75], v[204:207]
    ds_read_b128 v[104:107], v164 offset:50176
    v_mfma_f32_16x16x32_bf16 v[208:211], v[148:151], v[76:79], v[208:211]
    ds_read_b64_tr_b16 v[132:133], v165 offset:49152
    v_mfma_f32_16x16x32_bf16 v[208:211], v[152:155], v[80:83], v[208:211]
    ds_read_b64_tr_b16 v[134:135], v165 offset:51200
    v_mfma_f32_16x16x32_bf16 v[212:215], v[148:151], v[84:87], v[212:215]
    ds_read_b64_tr_b16 v[136:137], v165 offset:53248
    v_mfma_f32_16x16x32_bf16 v[212:215], v[152:155], v[88:91], v[212:215]
    ds_read_b64_tr_b16 v[138:139], v165 offset:55296
    v_mfma_f32_16x16x32_bf16 v[216:219], v[148:151], v[92:95], v[216:219]
    ds_read_b128 v[108:111], v164 offset:51200
    v_mfma_f32_16x16x32_bf16 v[216:219], v[152:155], v[96:99], v[216:219]
    ds_read_b128 v[112:115], v164 offset:52224
    v_mfma_f32_16x16x32_bf16 v[220:223], v[156:159], v[68:71], v[220:223]
    ds_read_b128 v[116:119], v164 offset:53248
    v_mfma_f32_16x16x32_bf16 v[220:223], v[160:163], v[72:75], v[220:223]
    ds_read_b128 v[120:123], v164 offset:54272
    v_mfma_f32_16x16x32_bf16 v[224:227], v[156:159], v[76:79], v[224:227]
    ds_read_b128 v[124:127], v164 offset:55296
    v_mfma_f32_16x16x32_bf16 v[224:227], v[160:163], v[80:83], v[224:227]
    ds_read_b128 v[128:131], v164 offset:56320
    v_mfma_f32_16x16x32_bf16 v[228:231], v[156:159], v[84:87], v[228:231]
    ds_read_b64_tr_b16 v[140:141], v166 offset:49152
    v_mfma_f32_16x16x32_bf16 v[228:231], v[160:163], v[88:91], v[228:231]
    ds_read_b64_tr_b16 v[142:143], v166 offset:51200
    v_mfma_f32_16x16x32_bf16 v[232:235], v[156:159], v[92:95], v[232:235]
    ds_read_b64_tr_b16 v[144:145], v166 offset:53248
    v_mfma_f32_16x16x32_bf16 v[232:235], v[160:163], v[96:99], v[232:235]
    ds_read_b64_tr_b16 v[146:147], v166 offset:55296
    s_waitcnt lgkmcnt(12)
    v_mfma_f32_16x16x32_bf16 v[172:175], v[132:135], v[100:103], v[172:175]
    s_waitcnt lgkmcnt(10)
    v_mfma_f32_16x16x32_bf16 v[172:175], v[136:139], v[104:107], v[172:175]
    s_waitcnt lgkmcnt(9)
    v_mfma_f32_16x16x32_bf16 v[176:179], v[132:135], v[108:111], v[176:179]
    s_waitcnt lgkmcnt(8)
    ds_read_b64_tr_b16 v[148:149], v167 offset:49152
    v_mfma_f32_16x16x32_bf16 v[176:179], v[136:139], v[112:115], v[176:179]
    s_waitcnt lgkmcnt(8)
    ds_read_b64_tr_b16 v[150:151], v167 offset:51200
    v_mfma_f32_16x16x32_bf16 v[180:183], v[132:135], v[116:119], v[180:183]
    s_waitcnt lgkmcnt(8)
    ds_read_b64_tr_b16 v[152:153], v167 offset:53248
    v_mfma_f32_16x16x32_bf16 v[180:183], v[136:139], v[120:123], v[180:183]
    s_waitcnt lgkmcnt(8)
    ds_read_b64_tr_b16 v[154:155], v167 offset:55296
    v_mfma_f32_16x16x32_bf16 v[184:187], v[132:135], v[124:127], v[184:187]
    s_waitcnt lgkmcnt(8)
    ds_read_b64_tr_b16 v[156:157], v168 offset:49152
    v_mfma_f32_16x16x32_bf16 v[184:187], v[136:139], v[128:131], v[184:187]
    s_waitcnt lgkmcnt(5)
    ds_read_b64_tr_b16 v[158:159], v168 offset:51200
    v_mfma_f32_16x16x32_bf16 v[188:191], v[140:143], v[100:103], v[188:191]
    ds_read_b64_tr_b16 v[160:161], v168 offset:53248
    v_mfma_f32_16x16x32_bf16 v[188:191], v[144:147], v[104:107], v[188:191]
    ds_read_b64_tr_b16 v[162:163], v168 offset:55296
    v_mfma_f32_16x16x32_bf16 v[192:195], v[140:143], v[108:111], v[192:195]
    v_mfma_f32_16x16x32_bf16 v[192:195], v[144:147], v[112:115], v[192:195]
    v_mfma_f32_16x16x32_bf16 v[196:199], v[140:143], v[116:119], v[196:199]
    v_mfma_f32_16x16x32_bf16 v[196:199], v[144:147], v[120:123], v[196:199]
    v_mfma_f32_16x16x32_bf16 v[200:203], v[140:143], v[124:127], v[200:203]
    v_mfma_f32_16x16x32_bf16 v[200:203], v[144:147], v[128:131], v[200:203]
    s_waitcnt lgkmcnt(0)
    v_mfma_f32_16x16x32_bf16 v[204:207], v[148:151], v[100:103], v[204:207]
    v_mfma_f32_16x16x32_bf16 v[204:207], v[152:155], v[104:107], v[204:207]
    v_mfma_f32_16x16x32_bf16 v[208:211], v[148:151], v[108:111], v[208:211]
    v_mfma_f32_16x16x32_bf16 v[208:211], v[152:155], v[112:115], v[208:211]
    v_mfma_f32_16x16x32_bf16 v[212:215], v[148:151], v[116:119], v[212:215]
    v_mfma_f32_16x16x32_bf16 v[212:215], v[152:155], v[120:123], v[212:215]
    v_mfma_f32_16x16x32_bf16 v[216:219], v[148:151], v[124:127], v[216:219]
    v_mfma_f32_16x16x32_bf16 v[216:219], v[152:155], v[128:131], v[216:219]
    v_mfma_f32_16x16x32_bf16 v[220:223], v[156:159], v[100:103], v[220:223]
    v_mfma_f32_16x16x32_bf16 v[220:223], v[160:163], v[104:107], v[220:223]
    v_mfma_f32_16x16x32_bf16 v[224:227], v[156:159], v[108:111], v[224:227]
    v_mfma_f32_16x16x32_bf16 v[224:227], v[160:163], v[112:115], v[224:227]
    v_mfma_f32_16x16x32_bf16 v[228:231], v[156:159], v[116:119], v[228:231]
    v_mfma_f32_16x16x32_bf16 v[228:231], v[160:163], v[120:123], v[228:231]
    v_mfma_f32_16x16x32_bf16 v[232:235], v[156:159], v[124:127], v[232:235]
    v_mfma_f32_16x16x32_bf16 v[232:235], v[160:163], v[128:131], v[232:235]
    s_nop 7
    s_mov_b32 s6, 4096
    s_cmp_lg_u32 s61, 0
    s_cbranch_scc1 g3_fin1
    v_cmp_eq_u32 vcc, 0, v254
    s_cbranch_vccz g3_wx0_ok
    v_lshlrev_b32 v238, 2, v240
    s_mov_b32 s3, 0
g3_wx0:
    buffer_load_dword v236, v238, s[88:91], s66 offen sc1
    s_waitcnt vmcnt(0)
    v_cmp_eq_u32 vcc, 0, v236
    s_mov_b32 s4, 1
    s_mov_b32 s5, 0
    s_and_b64 vcc, vcc, s[4:5]
    s_cbranch_scc0 g3_wx0_ok
    s_sleep 1
    s_add_u32 s3, s3, 1
    s_cmp_lt_u32 s3, 100000
    s_cbranch_scc1 g3_wx0
g3_wx0_ok:
    v_sub_f32 v204, v204, v36
    v_sub_f32 v205, v205, v37
    v_sub_f32 v206, v206, v38
    v_sub_f32 v207, v207, v39
    v_fma_f32 v204, v204, v246, v36
    v_fma_f32 v205, v205, v246, v37
    v_fma_f32 v206, v206, v246, v38
    v_fma_f32 v207, v207, v246, v39
    buffer_store_dwordx4 v[204:207], v250, s[84:87], 0 offen offset:0 sc1
    v_sub_f32 v208, v208, v40
    v_sub_f32 v209, v209, v41
    v_sub_f32 v210, v210, v42
    v_sub_f32 v211, v211, v43
    v_fma_f32 v208, v208, v247, v40
    v_fma_f32 v209, v209, v247, v41
    v_fma_f32 v210, v210, v247, v42
    v_fma_f32 v211, v211, v247, v43
    buffer_store_dwordx4 v[208:211], v250, s[84:87], 0 offen offset:1024 sc1
    v_sub_f32 v212, v212, v44
    v_sub_f32 v213, v213, v45
    v_sub_f32 v214, v214, v46
    v_sub_f32 v215, v215, v47
    v_fma_f32 v212, v212, v248, v44
    v_fma_f32 v213, v213, v248, v45
    v_fma_f32 v214, v214, v248, v46
    v_fma_f32 v215, v215, v248, v47
    buffer_store_dwordx4 v[212:215], v250, s[84:87], 0 offen offset:2048 sc1
    v_sub_f32 v216, v216, v48
    v_sub_f32 v217, v217, v49
    v_sub_f32 v218, v218, v50
    v_sub_f32 v219, v219, v51
    v_fma_f32 v216, v216, v249, v48
    v_fma_f32 v217, v217, v249, v49
    v_fma_f32 v218, v218, v249, v50
    v_fma_f32 v219, v219, v249, v51
    buffer_store_dwordx4 v[216:219], v250, s[84:87], 0 offen offset:3072 sc1
    v_sub_f32 v220, v220, v52
    v_sub_f32 v221, v221, v53
    v_sub_f32 v222, v222, v54
    v_sub_f32 v223, v223, v55
    v_fma_f32 v220, v220, v246, v52
    v_fma_f32 v221, v221, v246, v53
    v_fma_f32 v222, v222, v246, v54
    v_fma_f32 v223, v223, v246, v55
    buffer_store_dwordx4 v[220:223], v250, s[84:87], s6 offen offset:0 sc1
    v_sub_f32 v224, v224, v56
    v_sub_f32 v225, v225, v57
    v_sub_f32 v226, v226, v58
    v_sub_f32 v227, v227, v59
    v_fma_f32 v224, v224, v247, v56
    v_fma_f32 v225, v225, v247, v57
    v_fma_f32 v226, v226, v247, v58
    v_fma_f32 v227, v227, v247, v59
    buffer_store_dwordx4 v[224:227], v250, s[84:87], s6 offen offset:1024 sc1
    v_sub_f32 v228, v228, v60
    v_sub_f32 v229, v229, v61
    v_sub_f32 v230, v230, v62
    v_sub_f32 v231, v231, v63
    v_fma_f32 v228, v228, v248, v60
    v_fma_f32 v229, v229, v248, v61
    v_fma_f32 v230, v230, v248, v62
    v_fma_f32 v231, v231, v248, v63
    buffer_store_dwordx4 v[228:231], v250, s[84:87], s6 offen offset:2048 sc1
    v_sub_f32 v232, v232, v64
    v_sub_f32 v233, v233, v65
    v_sub_f32 v234, v234, v66
    v_sub_f32 v235, v235, v67
    v_fma_f32 v232, v232, v249, v64
    v_fma_f32 v233, v233, v249, v65
    v_fma_f32 v234, v234, v249, v66
    v_fma_f32 v235, v235, v249, v67
    buffer_store_dwordx4 v[232:235], v250, s[84:87], s6 offen offset:3072 sc1
    v_xor_b32 v241, 0x2000, v250
    v_sub_f32 v172, v172, v4
    v_sub_f32 v173, v173, v5
    v_sub_f32 v174, v174, v6
    v_sub_f32 v175, v175, v7
    v_fma_f32 v172, v172, v246, v4
    v_fma_f32 v173, v173, v246, v5
    v_fma_f32 v174, v174, v246, v6
    v_fma_f32 v175, v175, v246, v7
    v_sub_f32 v176, v176, v8
    v_sub_f32 v177, v177, v9
    v_sub_f32 v178, v178, v10
    v_sub_f32 v179, v179, v11
    v_fma_f32 v176, v176, v247, v8
    v_fma_f32 v177, v177, v247, v9
    v_fma_f32 v178, v178, v247, v10
    v_fma_f32 v179, v179, v247, v11
    v_sub_f32 v180, v180, v12
    v_sub_f32 v181, v181, v13
    v_sub_f32 v182, v182, v14
    v_sub_f32 v183, v183, v15
    v_fma_f32 v180, v180, v248, v12
    v_fma_f32 v181, v181, v248, v13
    v_fma_f32 v182, v182, v248, v14
    v_fma_f32 v183, v183, v248, v15
    v_sub_f32 v184, v184, v16
    v_sub_f32 v185, v185, v17
    v_sub_f32 v186, v186, v18
    v_sub_f32 v187, v187, v19
    v_fma_f32 v184, v184, v249, v16
    v_fma_f32 v185, v185, v249, v17
    v_fma_f32 v186, v186, v249, v18
    v_fma_f32 v187, v187, v249, v19
    v_sub_f32 v188, v188, v20
    v_sub_f32 v189, v189, v21
    v_sub_f32 v190, v190, v22
    v_sub_f32 v191, v191, v23
    v_fma_f32 v188, v188, v246, v20
    v_fma_f32 v189, v189, v246, v21
    v_fma_f32 v190, v190, v246, v22
    v_fma_f32 v191, v191, v246, v23
    v_sub_f32 v192, v192, v24
    v_sub_f32 v193, v193, v25
    v_sub_f32 v194, v194, v26
    v_sub_f32 v195, v195, v27
    v_fma_f32 v192, v192, v247, v24
    v_fma_f32 v193, v193, v247, v25
    v_fma_f32 v194, v194, v247, v26
    v_fma_f32 v195, v195, v247, v27
    v_sub_f32 v196, v196, v28
    v_sub_f32 v197, v197, v29
    v_sub_f32 v198, v198, v30
    v_sub_f32 v199, v199, v31
    v_fma_f32 v196, v196, v248, v28
    v_fma_f32 v197, v197, v248, v29
    v_fma_f32 v198, v198, v248, v30
    v_fma_f32 v199, v199, v248, v31
    v_sub_f32 v200, v200, v32
    v_sub_f32 v201, v201, v33
    v_sub_f32 v202, v202, v34
    v_sub_f32 v203, v203, v35
    v_fma_f32 v200, v200, v249, v32
    v_fma_f32 v201, v201, v249, v33
    v_fma_f32 v202, v202, v249, v34
    v_fma_f32 v203, v203, v249, v35
    s_mov_b32 s3, 0
g3_rd0:
    buffer_load_dwordx4 v[68:71], v241, s[84:87], 0 offen offset:0 sc1
    buffer_load_dwordx4 v[72:75], v241, s[84:87], 0 offen offset:1024 sc1
    buffer_load_dwordx4 v[76:79], v241, s[84:87], 0 offen offset:2048 sc1
    buffer_load_dwordx4 v[80:83], v241, s[84:87], 0 offen offset:3072 sc1
    buffer_load_dwordx4 v[84:87], v241, s[84:87], s6 offen offset:0 sc1
    buffer_load_dwordx4 v[88:91], v241, s[84:87], s6 offen offset:1024 sc1
    buffer_load_dwordx4 v[92:95], v241, s[84:87], s6 offen offset:2048 sc1
    buffer_load_dwordx4 v[96:99], v241, s[84:87], s6 offen offset:3072 sc1
    s_waitcnt vmcnt(7)
    v_max_u32 v242, v68, v69
    v_max3_u32 v242, v242, v70, v71
    s_waitcnt vmcnt(6)
    v_max3_u32 v242, v242, v72, v73
    v_max3_u32 v242, v242, v74, v75
    s_waitcnt vmcnt(5)
    v_max3_u32 v242, v242, v76, v77
    v_max3_u32 v242, v242, v78, v79
    s_waitcnt vmcnt(4)
    v_max3_u32 v242, v242, v80, v81
    v_max3_u32 v242, v242, v82, v83
    s_waitcnt vmcnt(3)
    v_max3_u32 v242, v242, v84, v85
    v_max3_u32 v242, v242, v86, v87
    s_waitcnt vmcnt(2)
    v_max3_u32 v242, v242, v88, v89
    v_max3_u32 v242, v242, v90, v91
    s_waitcnt vmcnt(1)
    v_max3_u32 v242, v242, v92, v93
    v_max3_u32 v242, v242, v94, v95
    s_waitcnt vmcnt(0)
    v_max3_u32 v242, v242, v96, v97
    v_max3_u32 v242, v242, v98, v99
    v_cmp_eq_u32 vcc, -1, v242
    s_cbranch_vccz g3_rd0_ok
    s_add_u32 s3, s3, 1
    s_cmp_lt_u32 s3, 100000
    s_cbranch_scc1 g3_rd0
g3_rd0_ok:
    v_add_f32 v134, v172, v68
    v_add_f32 v135, v173, v69
    v_add_f32 v136, v174, v70
    v_add_f32 v137, v175, v71
    v_cvt_pk_bf16_f32 v132, v134, v135
    v_cvt_pk_bf16_f32 v133, v136, v137
    s_mov_b32 s3, 0
    buffer_store_dwordx2 v[132:133], v245, s[76:79], s3 offen offset:0 sc1
    v_add_f32 v142, v176, v72
    v_add_f32 v143, v177, v73
    v_add_f32 v144, v178, v74
    v_add_f32 v145, v179, v75
    v_cvt_pk_bf16_f32 v140, v142, v143
    v_cvt_pk_bf16_f32 v141, v144, v145
    s_mov_b32 s3, 32768
    buffer_store_dwordx2 v[140:141], v245, s[76:79], s3 offen offset:0 sc1
    v_add_f32 v150, v180, v76
    v_add_f32 v151, v181, v77
    v_add_f32 v152, v182, v78
    v_add_f32 v153, v183, v79
    v_cvt_pk_bf16_f32 v148, v150, v151
    v_cvt_pk_bf16_f32 v149, v152, v153
    s_mov_b32 s3, 65536
    buffer_store_dwordx2 v[148:149], v245, s[76:79], s3 offen offset:0 sc1
    v_add_f32 v158, v184, v80
    v_add_f32 v159, v185, v81
    v_add_f32 v160, v186, v82
    v_add_f32 v161, v187, v83
    v_cvt_pk_bf16_f32 v156, v158, v159
    v_cvt_pk_bf16_f32 v157, v160, v161
    s_mov_b32 s3, 98304
    buffer_store_dwordx2 v[156:157], v245, s[76:79], s3 offen offset:0 sc1
    v_add_f32 v134, v188, v84
    v_add_f32 v135, v189, v85
    v_add_f32 v136, v190, v86
    v_add_f32 v137, v191, v87
    v_cvt_pk_bf16_f32 v132, v134, v135
    v_cvt_pk_bf16_f32 v133, v136, v137
    s_mov_b32 s3, 0
    buffer_store_dwordx2 v[132:133], v245, s[76:79], s3 offen offset:32 sc1
    v_add_f32 v142, v192, v88
    v_add_f32 v143, v193, v89
    v_add_f32 v144, v194, v90
    v_add_f32 v145, v195, v91
    v_cvt_pk_bf16_f32 v140, v142, v143
    v_cvt_pk_bf16_f32 v141, v144, v145
    s_mov_b32 s3, 32768
    buffer_store_dwordx2 v[140:141], v245, s[76:79], s3 offen offset:32 sc1
    v_add_f32 v150, v196, v92
    v_add_f32 v151, v197, v93
    v_add_f32 v152, v198, v94
    v_add_f32 v153, v199, v95
    v_cvt_pk_bf16_f32 v148, v150, v151
    v_cvt_pk_bf16_f32 v149, v152, v153
    s_mov_b32 s3, 65536
    buffer_store_dwordx2 v[148:149], v245, s[76:79], s3 offen offset:32 sc1
    v_add_f32 v158, v200, v96
    v_add_f32 v159, v201, v97
    v_add_f32 v160, v202, v98
    v_add_f32 v161, v203, v99
    v_cvt_pk_bf16_f32 v156, v158, v159
    v_cvt_pk_bf16_f32 v157, v160, v161
    s_mov_b32 s3, 98304
    buffer_store_dwordx2 v[156:157], v245, s[76:79], s3 offen offset:32 sc1
    s_branch g3_end
g3_fin1:
    v_cmp_eq_u32 vcc, 0, v254
    s_cbranch_vccz g3_wx1_ok
    v_lshlrev_b32 v238, 2, v240
    s_mov_b32 s3, 0
g3_wx1:
    buffer_load_dword v236, v238, s[88:91], s66 offen sc1
    s_waitcnt vmcnt(0)
    v_cmp_eq_u32 vcc, 0, v236
    s_mov_b32 s4, 1
    s_mov_b32 s5, 0
    s_and_b64 vcc, vcc, s[4:5]
    s_cbranch_scc0 g3_wx1_ok
    s_sleep 1
    s_add_u32 s3, s3, 1
    s_cmp_lt_u32 s3, 100000
    s_cbranch_scc1 g3_wx1
g3_wx1_ok:
    v_sub_f32 v172, v172, v4
    v_sub_f32 v173, v173, v5
    v_sub_f32 v174, v174, v6
    v_sub_f32 v175, v175, v7
    v_fma_f32 v172, v172, v246, v4
    v_fma_f32 v173, v173, v246, v5
    v_fma_f32 v174, v174, v246, v6
    v_fma_f32 v175, v175, v246, v7
    buffer_store_dwordx4 v[172:175], v250, s[84:87], 0 offen offset:0 sc1
    v_sub_f32 v176, v176, v8
    v_sub_f32 v177, v177, v9
    v_sub_f32 v178, v178, v10
    v_sub_f32 v179, v179, v11
    v_fma_f32 v176, v176, v247, v8
    v_fma_f32 v177, v177, v247, v9
    v_fma_f32 v178, v178, v247, v10
    v_fma_f32 v179, v179, v247, v11
    buffer_store_dwordx4 v[176:179], v250, s[84:87], 0 offen offset:1024 sc1
    v_sub_f32 v180, v180, v12
    v_sub_f32 v181, v181, v13
    v_sub_f32 v182, v182, v14
    v_sub_f32 v183, v183, v15
    v_fma_f32 v180, v180, v248, v12
    v_fma_f32 v181, v181, v248, v13
    v_fma_f32 v182, v182, v248, v14
    v_fma_f32 v183, v183, v248, v15
    buffer_store_dwordx4 v[180:183], v250, s[84:87], 0 offen offset:2048 sc1
    v_sub_f32 v184, v184, v16
    v_sub_f32 v185, v185, v17
    v_sub_f32 v186, v186, v18
    v_sub_f32 v187, v187, v19
    v_fma_f32 v184, v184, v249, v16
    v_fma_f32 v185, v185, v249, v17
    v_fma_f32 v186, v186, v249, v18
    v_fma_f32 v187, v187, v249, v19
    buffer_store_dwordx4 v[184:187], v250, s[84:87], 0 offen offset:3072 sc1
    v_sub_f32 v188, v188, v20
    v_sub_f32 v189, v189, v21
    v_sub_f32 v190, v190, v22
    v_sub_f32 v191, v191, v23
    v_fma_f32 v188, v188, v246, v20
    v_fma_f32 v189, v189, v246, v21
    v_fma_f32 v190, v190, v246, v22
    v_fma_f32 v191, v191, v246, v23
    buffer_store_dwordx4 v[188:191], v250, s[84:87], s6 offen offset:0 sc1
    v_sub_f32 v192, v192, v24
    v_sub_f32 v193, v193, v25
    v_sub_f32 v194, v194, v26
    v_sub_f32 v195, v195, v27
    v_fma_f32 v192, v192, v247, v24
    v_fma_f32 v193, v193, v247, v25
    v_fma_f32 v194, v194, v247, v26
    v_fma_f32 v195, v195, v247, v27
    buffer_store_dwordx4 v[192:195], v250, s[84:87], s6 offen offset:1024 sc1
    v_sub_f32 v196, v196, v28
    v_sub_f32 v197, v197, v29
    v_sub_f32 v198, v198, v30
    v_sub_f32 v199, v199, v31
    v_fma_f32 v196, v196, v248, v28
    v_fma_f32 v197, v197, v248, v29
    v_fma_f32 v198, v198, v248, v30
    v_fma_f32 v199, v199, v248, v31
    buffer_store_dwordx4 v[196:199], v250, s[84:87], s6 offen offset:2048 sc1
    v_sub_f32 v200, v200, v32
    v_sub_f32 v201, v201, v33
    v_sub_f32 v202, v202, v34
    v_sub_f32 v203, v203, v35
    v_fma_f32 v200, v200, v249, v32
    v_fma_f32 v201, v201, v249, v33
    v_fma_f32 v202, v202, v249, v34
    v_fma_f32 v203, v203, v249, v35
    buffer_store_dwordx4 v[200:203], v250, s[84:87], s6 offen offset:3072 sc1
    v_xor_b32 v241, 0x2000, v250
    v_sub_f32 v204, v204, v36
    v_sub_f32 v205, v205, v37
    v_sub_f32 v206, v206, v38
    v_sub_f32 v207, v207, v39
    v_fma_f32 v204, v204, v246, v36
    v_fma_f32 v205, v205, v246, v37
    v_fma_f32 v206, v206, v246, v38
    v_fma_f32 v207, v207, v246, v39
    v_sub_f32 v208, v208, v40
    v_sub_f32 v209, v209, v41
    v_sub_f32 v210, v210, v42
    v_sub_f32 v211, v211, v43
    v_fma_f32 v208, v208, v247, v40
    v_fma_f32 v209, v209, v247, v41
    v_fma_f32 v210, v210, v247, v42
    v_fma_f32 v211, v211, v247, v43
    v_sub_f32 v212, v212, v44
    v_sub_f32 v213, v213, v45
    v_sub_f32 v214, v214, v46
    v_sub_f32 v215, v215, v47
    v_fma_f32 v212, v212, v248, v44
    v_fma_f32 v213, v213, v248, v45
    v_fma_f32 v214, v214, v248, v46
    v_fma_f32 v215, v215, v248, v47
    v_sub_f32 v216, v216, v48
    v_sub_f32 v217, v217, v49
    v_sub_f32 v218, v218, v50
    v_sub_f32 v219, v219, v51
    v_fma_f32 v216, v216, v249, v48
    v_fma_f32 v217, v217, v249, v49
    v_fma_f32 v218, v218, v249, v50
    v_fma_f32 v219, v219, v249, v51
    v_sub_f32 v220, v220, v52
    v_sub_f32 v221, v221, v53
    v_sub_f32 v222, v222, v54
    v_sub_f32 v223, v223, v55
    v_fma_f32 v220, v220, v246, v52
    v_fma_f32 v221, v221, v246, v53
    v_fma_f32 v222, v222, v246, v54
    v_fma_f32 v223, v223, v246, v55
    v_sub_f32 v224, v224, v56
    v_sub_f32 v225, v225, v57
    v_sub_f32 v226, v226, v58
    v_sub_f32 v227, v227, v59
    v_fma_f32 v224, v224, v247, v56
    v_fma_f32 v225, v225, v247, v57
    v_fma_f32 v226, v226, v247, v58
    v_fma_f32 v227, v227, v247, v59
    v_sub_f32 v228, v228, v60
    v_sub_f32 v229, v229, v61
    v_sub_f32 v230, v230, v62
    v_sub_f32 v231, v231, v63
    v_fma_f32 v228, v228, v248, v60
    v_fma_f32 v229, v229, v248, v61
    v_fma_f32 v230, v230, v248, v62
    v_fma_f32 v231, v231, v248, v63
    v_sub_f32 v232, v232, v64
    v_sub_f32 v233, v233, v65
    v_sub_f32 v234, v234, v66
    v_sub_f32 v235, v235, v67
    v_fma_f32 v232, v232, v249, v64
    v_fma_f32 v233, v233, v249, v65
    v_fma_f32 v234, v234, v249, v66
    v_fma_f32 v235, v235, v249, v67
    s_mov_b32 s3, 0
g3_rd1:
    buffer_load_dwordx4 v[68:71], v241, s[84:87], 0 offen offset:0 sc1
    buffer_load_dwordx4 v[72:75], v241, s[84:87], 0 offen offset:1024 sc1
    buffer_load_dwordx4 v[76:79], v241, s[84:87], 0 offen offset:2048 sc1
    buffer_load_dwordx4 v[80:83], v241, s[84:87], 0 offen offset:3072 sc1
    buffer_load_dwordx4 v[84:87], v241, s[84:87], s6 offen offset:0 sc1
    buffer_load_dwordx4 v[88:91], v241, s[84:87], s6 offen offset:1024 sc1
    buffer_load_dwordx4 v[92:95], v241, s[84:87], s6 offen offset:2048 sc1
    buffer_load_dwordx4 v[96:99], v241, s[84:87], s6 offen offset:3072 sc1
    s_waitcnt vmcnt(7)
    v_max_u32 v242, v68, v69
    v_max3_u32 v242, v242, v70, v71
    s_waitcnt vmcnt(6)
    v_max3_u32 v242, v242, v72, v73
    v_max3_u32 v242, v242, v74, v75
    s_waitcnt vmcnt(5)
    v_max3_u32 v242, v242, v76, v77
    v_max3_u32 v242, v242, v78, v79
    s_waitcnt vmcnt(4)
    v_max3_u32 v242, v242, v80, v81
    v_max3_u32 v242, v242, v82, v83
    s_waitcnt vmcnt(3)
    v_max3_u32 v242, v242, v84, v85
    v_max3_u32 v242, v242, v86, v87
    s_waitcnt vmcnt(2)
    v_max3_u32 v242, v242, v88, v89
    v_max3_u32 v242, v242, v90, v91
    s_waitcnt vmcnt(1)
    v_max3_u32 v242, v242, v92, v93
    v_max3_u32 v242, v242, v94, v95
    s_waitcnt vmcnt(0)
    v_max3_u32 v242, v242, v96, v97
    v_max3_u32 v242, v242, v98, v99
    v_cmp_eq_u32 vcc, -1, v242
    s_cbranch_vccz g3_rd1_ok
    s_add_u32 s3, s3, 1
    s_cmp_lt_u32 s3, 100000
    s_cbranch_scc1 g3_rd1
g3_rd1_ok:
    v_add_f32 v134, v204, v68
    v_add_f32 v135, v205, v69
    v_add_f32 v136, v206, v70
    v_add_f32 v137, v207, v71
    v_cvt_pk_bf16_f32 v132, v134, v135
    v_cvt_pk_bf16_f32 v133, v136, v137
    s_mov_b32 s3, 0
    buffer_store_dwordx2 v[132:133], v245, s[76:79], s3 offen offset:64 sc1
    v_add_f32 v142, v208, v72
    v_add_f32 v143, v209, v73
    v_add_f32 v144, v210, v74
    v_add_f32 v145, v211, v75
    v_cvt_pk_bf16_f32 v140, v142, v143
    v_cvt_pk_bf16_f32 v141, v144, v145
    s_mov_b32 s3, 32768
    buffer_store_dwordx2 v[140:141], v245, s[76:79], s3 offen offset:64 sc1
    v_add_f32 v150, v212, v76
    v_add_f32 v151, v213, v77
    v_add_f32 v152, v214, v78
    v_add_f32 v153, v215, v79
    v_cvt_pk_bf16_f32 v148, v150, v151
    v_cvt_pk_bf16_f32 v149, v152, v153
    s_mov_b32 s3, 65536
    buffer_store_dwordx2 v[148:149], v245, s[76:79], s3 offen offset:64 sc1
    v_add_f32 v158, v216, v80
    v_add_f32 v159, v217, v81
    v_add_f32 v160, v218, v82
    v_add_f32 v161, v219, v83
    v_cvt_pk_bf16_f32 v156, v158, v159
    v_cvt_pk_bf16_f32 v157, v160, v161
    s_mov_b32 s3, 98304
    buffer_store_dwordx2 v[156:157], v245, s[76:79], s3 offen offset:64 sc1
    v_add_f32 v134, v220, v84
    v_add_f32 v135, v221, v85
    v_add_f32 v136, v222, v86
    v_add_f32 v137, v223, v87
    v_cvt_pk_bf16_f32 v132, v134, v135
    v_cvt_pk_bf16_f32 v133, v136, v137
    s_mov_b32 s3, 0
    buffer_store_dwordx2 v[132:133], v245, s[76:79], s3 offen offset:96 sc1
    v_add_f32 v142, v224, v88
    v_add_f32 v143, v225, v89
    v_add_f32 v144, v226, v90
    v_add_f32 v145, v227, v91
    v_cvt_pk_bf16_f32 v140, v142, v143
    v_cvt_pk_bf16_f32 v141, v144, v145
    s_mov_b32 s3, 32768
    buffer_store_dwordx2 v[140:141], v245, s[76:79], s3 offen offset:96 sc1
    v_add_f32 v150, v228, v92
    v_add_f32 v151, v229, v93
    v_add_f32 v152, v230, v94
    v_add_f32 v153, v231, v95
    v_cvt_pk_bf16_f32 v148, v150, v151
    v_cvt_pk_bf16_f32 v149, v152, v153
    s_mov_b32 s3, 65536
    buffer_store_dwordx2 v[148:149], v245, s[76:79], s3 offen offset:96 sc1
    v_add_f32 v158, v232, v96
    v_add_f32 v159, v233, v97
    v_add_f32 v160, v234, v98
    v_add_f32 v161, v235, v99
    v_cvt_pk_bf16_f32 v156, v158, v159
    v_cvt_pk_bf16_f32 v157, v160, v161
    s_mov_b32 s3, 98304
    buffer_store_dwordx2 v[156:157], v245, s[76:79], s3 offen offset:96 sc1
g3_end:
gated_mix__compressed_kv_cla__geglu_ffn__prompt_kernel_end:
    s_endpgm
mega_code_end:
a2_rn0a:
    s_call_b64 s[74:75], a2_fix01
    v_exp_f32 v212, v8
    v_exp_f32 v213, v9
    v_exp_f32 v214, v10
    v_exp_f32 v215, v11
    v_exp_f32 v216, v12
    v_exp_f32 v217, v13
    v_cvt_pk_bf16_f32 v136, v212, v213
    v_exp_f32 v218, v14
    v_cvt_pk_bf16_f32 v137, v214, v215
    v_exp_f32 v219, v15
    v_exp_f32 v212, v16
    v_exp_f32 v213, v17
    v_cvt_pk_bf16_f32 v140, v216, v217
    v_exp_f32 v214, v18
    v_cvt_pk_bf16_f32 v141, v218, v219
    v_exp_f32 v215, v19
    v_or_b32 v244, v136, v137
    v_exp_f32 v216, v28
    v_exp_f32 v217, v29
    v_cvt_pk_bf16_f32 v144, v212, v213
    v_exp_f32 v218, v30
    v_cvt_pk_bf16_f32 v145, v214, v215
    v_exp_f32 v219, v31
    v_or3_b32 v244, v244, v140, v141
    v_exp_f32 v212, v32
    v_exp_f32 v213, v33
    v_cvt_pk_bf16_f32 v142, v216, v217
    v_exp_f32 v214, v34
    v_cvt_pk_bf16_f32 v143, v218, v219
    v_exp_f32 v215, v35
    v_or3_b32 v244, v244, v144, v145
    v_exp_f32 v216, v4
    v_exp_f32 v217, v5
    v_cvt_pk_bf16_f32 v146, v212, v213
    v_exp_f32 v218, v6
    v_cvt_pk_bf16_f32 v147, v214, v215
    v_exp_f32 v219, v7
    v_or3_b32 v244, v244, v142, v143
    v_exp_f32 v212, v20
    v_exp_f32 v213, v21
    v_cvt_pk_bf16_f32 v132, v216, v217
    v_exp_f32 v214, v22
    v_cvt_pk_bf16_f32 v133, v218, v219
    v_exp_f32 v215, v23
    v_or3_b32 v244, v244, v146, v147
    v_exp_f32 v216, v24
    v_exp_f32 v217, v25
    v_cvt_pk_bf16_f32 v134, v212, v213
    v_exp_f32 v218, v26
    v_cvt_pk_bf16_f32 v135, v214, v215
    v_exp_f32 v219, v27
    v_or3_b32 v244, v244, v132, v133
    v_exp_f32 v212, v36
    v_exp_f32 v213, v37
    v_cvt_pk_bf16_f32 v138, v216, v217
    v_exp_f32 v214, v38
    v_cvt_pk_bf16_f32 v139, v218, v219
    v_exp_f32 v215, v39
    v_or3_b32 v244, v244, v134, v135
    v_exp_f32 v216, v40
    v_exp_f32 v217, v41
    v_cvt_pk_bf16_f32 v148, v212, v213
    v_exp_f32 v218, v42
    v_cvt_pk_bf16_f32 v149, v214, v215
    v_exp_f32 v219, v43
    v_or3_b32 v244, v244, v138, v139
    v_exp_f32 v212, v44
    v_exp_f32 v213, v45
    v_cvt_pk_bf16_f32 v152, v216, v217
    v_exp_f32 v214, v46
    v_cvt_pk_bf16_f32 v153, v218, v219
    v_exp_f32 v215, v47
    v_or3_b32 v244, v244, v148, v149
    v_exp_f32 v216, v48
    v_exp_f32 v217, v49
    v_cvt_pk_bf16_f32 v156, v212, v213
    v_exp_f32 v218, v50
    v_cvt_pk_bf16_f32 v157, v214, v215
    v_exp_f32 v219, v51
    v_or3_b32 v244, v244, v152, v153
    v_cvt_pk_bf16_f32 v160, v216, v217
    v_cvt_pk_bf16_f32 v161, v218, v219
    v_or3_b32 v244, v244, v156, v157
    v_or3_b32 v244, v244, v160, v161
    s_nop 1
    s_branch a2_rn0a_ret
a2_rn0b:
    s_call_b64 s[74:75], a2_fix01
    v_exp_f32 v212, v36
    v_exp_f32 v213, v37
    v_exp_f32 v214, v38
    v_exp_f32 v215, v39
    v_exp_f32 v216, v40
    v_exp_f32 v217, v41
    v_cvt_pk_bf16_f32 v148, v212, v213
    v_exp_f32 v218, v42
    v_cvt_pk_bf16_f32 v149, v214, v215
    v_exp_f32 v219, v43
    v_exp_f32 v212, v44
    v_exp_f32 v213, v45
    v_cvt_pk_bf16_f32 v152, v216, v217
    v_exp_f32 v214, v46
    v_cvt_pk_bf16_f32 v153, v218, v219
    v_exp_f32 v215, v47
    v_or_b32 v244, v148, v149
    v_exp_f32 v216, v48
    v_exp_f32 v217, v49
    v_cvt_pk_bf16_f32 v156, v212, v213
    v_exp_f32 v218, v50
    v_cvt_pk_bf16_f32 v157, v214, v215
    v_exp_f32 v219, v51
    v_or3_b32 v244, v244, v152, v153
    v_exp_f32 v212, v52
    v_exp_f32 v213, v53
    v_cvt_pk_bf16_f32 v160, v216, v217
    v_exp_f32 v214, v54
    v_cvt_pk_bf16_f32 v161, v218, v219
    v_exp_f32 v215, v55
    v_or3_b32 v244, v244, v156, v157
    v_exp_f32 v216, v56
    v_exp_f32 v217, v57
    v_cvt_pk_bf16_f32 v150, v212, v213
    v_exp_f32 v218, v58
    v_cvt_pk_bf16_f32 v151, v214, v215
    v_exp_f32 v219, v59
    v_or3_b32 v244, v244, v160, v161
    v_exp_f32 v212, v60
    v_exp_f32 v213, v61
    v_cvt_pk_bf16_f32 v154, v216, v217
    v_exp_f32 v214, v62
    v_cvt_pk_bf16_f32 v155, v218, v219
    v_exp_f32 v215, v63
    v_or3_b32 v244, v244, v150, v151
    v_exp_f32 v216, v64
    v_exp_f32 v217, v65
    v_cvt_pk_bf16_f32 v158, v212, v213
    v_exp_f32 v218, v66
    v_cvt_pk_bf16_f32 v159, v214, v215
    v_exp_f32 v219, v67
    v_or3_b32 v244, v244, v154, v155
    v_cvt_pk_bf16_f32 v162, v216, v217
    v_cvt_pk_bf16_f32 v163, v218, v219
    v_or3_b32 v244, v244, v158, v159
    v_or3_b32 v244, v244, v162, v163
    s_nop 1
    s_branch a2_rn0b_ret
a2_rn1a:
    s_call_b64 s[74:75], a2_fix11
    v_exp_f32 v212, v72
    v_exp_f32 v213, v73
    v_exp_f32 v214, v74
    v_exp_f32 v215, v75
    v_exp_f32 v216, v76
    v_exp_f32 v217, v77
    v_cvt_pk_bf16_f32 v136, v212, v213
    v_exp_f32 v218, v78
    v_cvt_pk_bf16_f32 v137, v214, v215
    v_exp_f32 v219, v79
    v_exp_f32 v212, v80
    v_exp_f32 v213, v81
    v_cvt_pk_bf16_f32 v140, v216, v217
    v_exp_f32 v214, v82
    v_cvt_pk_bf16_f32 v141, v218, v219
    v_exp_f32 v215, v83
    v_or_b32 v244, v136, v137
    v_exp_f32 v216, v92
    v_exp_f32 v217, v93
    v_cvt_pk_bf16_f32 v144, v212, v213
    v_exp_f32 v218, v94
    v_cvt_pk_bf16_f32 v145, v214, v215
    v_exp_f32 v219, v95
    v_or3_b32 v244, v244, v140, v141
    v_exp_f32 v212, v96
    v_exp_f32 v213, v97
    v_cvt_pk_bf16_f32 v142, v216, v217
    v_exp_f32 v214, v98
    v_cvt_pk_bf16_f32 v143, v218, v219
    v_exp_f32 v215, v99
    v_or3_b32 v244, v244, v144, v145
    v_exp_f32 v216, v68
    v_exp_f32 v217, v69
    v_cvt_pk_bf16_f32 v146, v212, v213
    v_exp_f32 v218, v70
    v_cvt_pk_bf16_f32 v147, v214, v215
    v_exp_f32 v219, v71
    v_or3_b32 v244, v244, v142, v143
    v_exp_f32 v212, v84
    v_exp_f32 v213, v85
    v_cvt_pk_bf16_f32 v132, v216, v217
    v_exp_f32 v214, v86
    v_cvt_pk_bf16_f32 v133, v218, v219
    v_exp_f32 v215, v87
    v_or3_b32 v244, v244, v146, v147
    v_exp_f32 v216, v88
    v_exp_f32 v217, v89
    v_cvt_pk_bf16_f32 v134, v212, v213
    v_exp_f32 v218, v90
    v_cvt_pk_bf16_f32 v135, v214, v215
    v_exp_f32 v219, v91
    v_or3_b32 v244, v244, v132, v133
    v_exp_f32 v212, v100
    v_exp_f32 v213, v101
    v_cvt_pk_bf16_f32 v138, v216, v217
    v_exp_f32 v214, v102
    v_cvt_pk_bf16_f32 v139, v218, v219
    v_exp_f32 v215, v103
    v_or3_b32 v244, v244, v134, v135
    v_exp_f32 v216, v104
    v_exp_f32 v217, v105
    v_cvt_pk_bf16_f32 v148, v212, v213
    v_exp_f32 v218, v106
    v_cvt_pk_bf16_f32 v149, v214, v215
    v_exp_f32 v219, v107
    v_or3_b32 v244, v244, v138, v139
    v_exp_f32 v212, v108
    v_exp_f32 v213, v109
    v_cvt_pk_bf16_f32 v152, v216, v217
    v_exp_f32 v214, v110
    v_cvt_pk_bf16_f32 v153, v218, v219
    v_exp_f32 v215, v111
    v_or3_b32 v244, v244, v148, v149
    v_exp_f32 v216, v112
    v_exp_f32 v217, v113
    v_cvt_pk_bf16_f32 v156, v212, v213
    v_exp_f32 v218, v114
    v_cvt_pk_bf16_f32 v157, v214, v215
    v_exp_f32 v219, v115
    v_or3_b32 v244, v244, v152, v153
    v_cvt_pk_bf16_f32 v160, v216, v217
    v_cvt_pk_bf16_f32 v161, v218, v219
    v_or3_b32 v244, v244, v156, v157
    v_or3_b32 v244, v244, v160, v161
    s_nop 1
    s_branch a2_rn1a_ret
a2_rn1b:
    s_call_b64 s[74:75], a2_fix11
    v_exp_f32 v212, v100
    v_exp_f32 v213, v101
    v_exp_f32 v214, v102
    v_exp_f32 v215, v103
    v_exp_f32 v216, v104
    v_exp_f32 v217, v105
    v_cvt_pk_bf16_f32 v148, v212, v213
    v_exp_f32 v218, v106
    v_cvt_pk_bf16_f32 v149, v214, v215
    v_exp_f32 v219, v107
    v_exp_f32 v212, v108
    v_exp_f32 v213, v109
    v_cvt_pk_bf16_f32 v152, v216, v217
    v_exp_f32 v214, v110
    v_cvt_pk_bf16_f32 v153, v218, v219
    v_exp_f32 v215, v111
    v_or_b32 v244, v148, v149
    v_exp_f32 v216, v112
    v_exp_f32 v217, v113
    v_cvt_pk_bf16_f32 v156, v212, v213
    v_exp_f32 v218, v114
    v_cvt_pk_bf16_f32 v157, v214, v215
    v_exp_f32 v219, v115
    v_or3_b32 v244, v244, v152, v153
    v_exp_f32 v212, v116
    v_exp_f32 v213, v117
    v_cvt_pk_bf16_f32 v160, v216, v217
    v_exp_f32 v214, v118
    v_cvt_pk_bf16_f32 v161, v218, v219
    v_exp_f32 v215, v119
    v_or3_b32 v244, v244, v156, v157
    v_exp_f32 v216, v120
    v_exp_f32 v217, v121
    v_cvt_pk_bf16_f32 v150, v212, v213
    v_exp_f32 v218, v122
    v_cvt_pk_bf16_f32 v151, v214, v215
    v_exp_f32 v219, v123
    v_or3_b32 v244, v244, v160, v161
    v_exp_f32 v212, v124
    v_exp_f32 v213, v125
    v_cvt_pk_bf16_f32 v154, v216, v217
    v_exp_f32 v214, v126
    v_cvt_pk_bf16_f32 v155, v218, v219
    v_exp_f32 v215, v127
    v_or3_b32 v244, v244, v150, v151
    v_exp_f32 v216, v128
    v_exp_f32 v217, v129
    v_cvt_pk_bf16_f32 v158, v212, v213
    v_exp_f32 v218, v130
    v_cvt_pk_bf16_f32 v159, v214, v215
    v_exp_f32 v219, v131
    v_or3_b32 v244, v244, v154, v155
    v_cvt_pk_bf16_f32 v162, v216, v217
    v_cvt_pk_bf16_f32 v163, v218, v219
    v_or3_b32 v244, v244, v158, v159
    v_or3_b32 v244, v244, v162, v163
    s_nop 1
    s_branch a2_rn1b_ret
a2_rb0a:
    s_call_b64 s[74:75], a2_fix00
    v_exp_f32 v212, v8
    v_exp_f32 v213, v9
    v_exp_f32 v214, v10
    v_exp_f32 v215, v11
    v_exp_f32 v216, v12
    v_exp_f32 v217, v13
    v_cvt_pk_bf16_f32 v136, v212, v213
    v_exp_f32 v218, v14
    v_cvt_pk_bf16_f32 v137, v214, v215
    v_exp_f32 v219, v15
    v_exp_f32 v212, v16
    v_exp_f32 v213, v17
    v_cvt_pk_bf16_f32 v140, v216, v217
    v_exp_f32 v214, v18
    v_cvt_pk_bf16_f32 v141, v218, v219
    v_exp_f32 v215, v19
    v_or_b32 v244, v136, v137
    v_exp_f32 v216, v28
    v_exp_f32 v217, v29
    v_cvt_pk_bf16_f32 v144, v212, v213
    v_exp_f32 v218, v30
    v_cvt_pk_bf16_f32 v145, v214, v215
    v_exp_f32 v219, v31
    v_or3_b32 v244, v244, v140, v141
    v_exp_f32 v212, v32
    v_exp_f32 v213, v33
    v_cvt_pk_bf16_f32 v142, v216, v217
    v_exp_f32 v214, v34
    v_cvt_pk_bf16_f32 v143, v218, v219
    v_exp_f32 v215, v35
    v_or3_b32 v244, v244, v144, v145
    v_exp_f32 v216, v4
    v_exp_f32 v217, v5
    v_cvt_pk_bf16_f32 v146, v212, v213
    v_exp_f32 v218, v6
    v_cvt_pk_bf16_f32 v147, v214, v215
    v_exp_f32 v219, v7
    v_or3_b32 v244, v244, v142, v143
    v_exp_f32 v212, v20
    v_exp_f32 v213, v21
    v_cvt_pk_bf16_f32 v132, v216, v217
    v_exp_f32 v214, v22
    v_cvt_pk_bf16_f32 v133, v218, v219
    v_exp_f32 v215, v23
    v_or3_b32 v244, v244, v146, v147
    v_exp_f32 v216, v24
    v_exp_f32 v217, v25
    v_cvt_pk_bf16_f32 v134, v212, v213
    v_exp_f32 v218, v26
    v_cvt_pk_bf16_f32 v135, v214, v215
    v_exp_f32 v219, v27
    v_or3_b32 v244, v244, v132, v133
    v_cvt_pk_bf16_f32 v138, v216, v217
    v_cvt_pk_bf16_f32 v139, v218, v219
    v_or3_b32 v244, v244, v134, v135
    v_or3_b32 v244, v244, v138, v139
    s_nop 1
    s_branch a2_rb0a_ret
a2_rb0b:
    s_call_b64 s[74:75], a2_fix00
    v_exp_f32 v212, v36
    v_exp_f32 v213, v37
    v_exp_f32 v214, v38
    v_exp_f32 v215, v39
    v_exp_f32 v216, v40
    v_exp_f32 v217, v41
    v_cvt_pk_bf16_f32 v148, v212, v213
    v_exp_f32 v218, v42
    v_cvt_pk_bf16_f32 v149, v214, v215
    v_exp_f32 v219, v43
    v_exp_f32 v212, v44
    v_exp_f32 v213, v45
    v_cvt_pk_bf16_f32 v152, v216, v217
    v_exp_f32 v214, v46
    v_cvt_pk_bf16_f32 v153, v218, v219
    v_exp_f32 v215, v47
    v_or_b32 v244, v148, v149
    v_exp_f32 v216, v48
    v_exp_f32 v217, v49
    v_cvt_pk_bf16_f32 v156, v212, v213
    v_exp_f32 v218, v50
    v_cvt_pk_bf16_f32 v157, v214, v215
    v_exp_f32 v219, v51
    v_or3_b32 v244, v244, v152, v153
    v_exp_f32 v212, v52
    v_exp_f32 v213, v53
    v_cvt_pk_bf16_f32 v160, v216, v217
    v_exp_f32 v214, v54
    v_cvt_pk_bf16_f32 v161, v218, v219
    v_exp_f32 v215, v55
    v_or3_b32 v244, v244, v156, v157
    v_exp_f32 v216, v56
    v_exp_f32 v217, v57
    v_cvt_pk_bf16_f32 v150, v212, v213
    v_exp_f32 v218, v58
    v_cvt_pk_bf16_f32 v151, v214, v215
    v_exp_f32 v219, v59
    v_or3_b32 v244, v244, v160, v161
    v_exp_f32 v212, v60
    v_exp_f32 v213, v61
    v_cvt_pk_bf16_f32 v154, v216, v217
    v_exp_f32 v214, v62
    v_cvt_pk_bf16_f32 v155, v218, v219
    v_exp_f32 v215, v63
    v_or3_b32 v244, v244, v150, v151
    v_exp_f32 v216, v64
    v_exp_f32 v217, v65
    v_cvt_pk_bf16_f32 v158, v212, v213
    v_exp_f32 v218, v66
    v_cvt_pk_bf16_f32 v159, v214, v215
    v_exp_f32 v219, v67
    v_or3_b32 v244, v244, v154, v155
    v_cvt_pk_bf16_f32 v162, v216, v217
    v_cvt_pk_bf16_f32 v163, v218, v219
    v_or3_b32 v244, v244, v158, v159
    v_or3_b32 v244, v244, v162, v163
    s_nop 1
    s_branch a2_rb0b_ret
a2_rf0a:
    s_call_b64 s[74:75], a2_fix00
    v_exp_f32 v212, v8
    v_exp_f32 v213, v9
    v_exp_f32 v214, v10
    v_exp_f32 v215, v11
    v_exp_f32 v216, v12
    v_exp_f32 v217, v13
    v_cvt_pk_bf16_f32 v136, v212, v213
    v_exp_f32 v218, v14
    v_cvt_pk_bf16_f32 v137, v214, v215
    v_exp_f32 v219, v15
    v_exp_f32 v212, v16
    v_exp_f32 v213, v17
    v_cvt_pk_bf16_f32 v140, v216, v217
    v_exp_f32 v214, v18
    v_cvt_pk_bf16_f32 v141, v218, v219
    v_exp_f32 v215, v19
    v_or_b32 v244, v136, v137
    v_exp_f32 v216, v28
    v_exp_f32 v217, v29
    v_cvt_pk_bf16_f32 v144, v212, v213
    v_exp_f32 v218, v30
    v_cvt_pk_bf16_f32 v145, v214, v215
    v_exp_f32 v219, v31
    v_or3_b32 v244, v244, v140, v141
    v_exp_f32 v212, v32
    v_exp_f32 v213, v33
    v_cvt_pk_bf16_f32 v142, v216, v217
    v_exp_f32 v214, v34
    v_cvt_pk_bf16_f32 v143, v218, v219
    v_exp_f32 v215, v35
    v_or3_b32 v244, v244, v144, v145
    v_exp_f32 v216, v4
    v_exp_f32 v217, v5
    v_cvt_pk_bf16_f32 v146, v212, v213
    v_exp_f32 v218, v6
    v_cvt_pk_bf16_f32 v147, v214, v215
    v_exp_f32 v219, v7
    v_or3_b32 v244, v244, v142, v143
    v_exp_f32 v212, v20
    v_exp_f32 v213, v21
    v_cvt_pk_bf16_f32 v132, v216, v217
    v_exp_f32 v214, v22
    v_cvt_pk_bf16_f32 v133, v218, v219
    v_exp_f32 v215, v23
    v_or3_b32 v244, v244, v146, v147
    v_exp_f32 v216, v24
    v_exp_f32 v217, v25
    v_cvt_pk_bf16_f32 v134, v212, v213
    v_exp_f32 v218, v26
    v_cvt_pk_bf16_f32 v135, v214, v215
    v_exp_f32 v219, v27
    v_or3_b32 v244, v244, v132, v133
    v_cvt_pk_bf16_f32 v138, v216, v217
    v_cvt_pk_bf16_f32 v139, v218, v219
    v_or3_b32 v244, v244, v134, v135
    v_or3_b32 v244, v244, v138, v139
    s_nop 1
    s_branch a2_rf0a_ret
a2_rf0b:
    s_call_b64 s[74:75], a2_fix00
    v_exp_f32 v212, v36
    v_exp_f32 v213, v37
    v_exp_f32 v214, v38
    v_exp_f32 v215, v39
    v_exp_f32 v216, v40
    v_exp_f32 v217, v41
    v_cvt_pk_bf16_f32 v148, v212, v213
    v_exp_f32 v218, v42
    v_cvt_pk_bf16_f32 v149, v214, v215
    v_exp_f32 v219, v43
    v_exp_f32 v212, v44
    v_exp_f32 v213, v45
    v_cvt_pk_bf16_f32 v152, v216, v217
    v_exp_f32 v214, v46
    v_cvt_pk_bf16_f32 v153, v218, v219
    v_exp_f32 v215, v47
    v_or_b32 v244, v148, v149
    v_exp_f32 v216, v48
    v_exp_f32 v217, v49
    v_cvt_pk_bf16_f32 v156, v212, v213
    v_exp_f32 v218, v50
    v_cvt_pk_bf16_f32 v157, v214, v215
    v_exp_f32 v219, v51
    v_or3_b32 v244, v244, v152, v153
    v_exp_f32 v212, v52
    v_exp_f32 v213, v53
    v_cvt_pk_bf16_f32 v160, v216, v217
    v_exp_f32 v214, v54
    v_cvt_pk_bf16_f32 v161, v218, v219
    v_exp_f32 v215, v55
    v_or3_b32 v244, v244, v156, v157
    v_exp_f32 v216, v56
    v_exp_f32 v217, v57
    v_cvt_pk_bf16_f32 v150, v212, v213
    v_exp_f32 v218, v58
    v_cvt_pk_bf16_f32 v151, v214, v215
    v_exp_f32 v219, v59
    v_or3_b32 v244, v244, v160, v161
    v_exp_f32 v212, v60
    v_exp_f32 v213, v61
    v_cvt_pk_bf16_f32 v154, v216, v217
    v_exp_f32 v214, v62
    v_cvt_pk_bf16_f32 v155, v218, v219
    v_exp_f32 v215, v63
    v_or3_b32 v244, v244, v150, v151
    v_exp_f32 v216, v64
    v_exp_f32 v217, v65
    v_cvt_pk_bf16_f32 v158, v212, v213
    v_exp_f32 v218, v66
    v_cvt_pk_bf16_f32 v159, v214, v215
    v_exp_f32 v219, v67
    v_or3_b32 v244, v244, v154, v155
    v_cvt_pk_bf16_f32 v162, v216, v217
    v_cvt_pk_bf16_f32 v163, v218, v219
    v_or3_b32 v244, v244, v158, v159
    v_or3_b32 v244, v244, v162, v163
    s_nop 1
    s_branch a2_rf0b_ret
a2_rb1a:
    s_call_b64 s[74:75], a2_fix10
    v_exp_f32 v212, v72
    v_exp_f32 v213, v73
    v_exp_f32 v214, v74
    v_exp_f32 v215, v75
    v_exp_f32 v216, v76
    v_exp_f32 v217, v77
    v_cvt_pk_bf16_f32 v136, v212, v213
    v_exp_f32 v218, v78
    v_cvt_pk_bf16_f32 v137, v214, v215
    v_exp_f32 v219, v79
    v_exp_f32 v212, v80
    v_exp_f32 v213, v81
    v_cvt_pk_bf16_f32 v140, v216, v217
    v_exp_f32 v214, v82
    v_cvt_pk_bf16_f32 v141, v218, v219
    v_exp_f32 v215, v83
    v_or_b32 v244, v136, v137
    v_exp_f32 v216, v92
    v_exp_f32 v217, v93
    v_cvt_pk_bf16_f32 v144, v212, v213
    v_exp_f32 v218, v94
    v_cvt_pk_bf16_f32 v145, v214, v215
    v_exp_f32 v219, v95
    v_or3_b32 v244, v244, v140, v141
    v_exp_f32 v212, v96
    v_exp_f32 v213, v97
    v_cvt_pk_bf16_f32 v142, v216, v217
    v_exp_f32 v214, v98
    v_cvt_pk_bf16_f32 v143, v218, v219
    v_exp_f32 v215, v99
    v_or3_b32 v244, v244, v144, v145
    v_exp_f32 v216, v68
    v_exp_f32 v217, v69
    v_cvt_pk_bf16_f32 v146, v212, v213
    v_exp_f32 v218, v70
    v_cvt_pk_bf16_f32 v147, v214, v215
    v_exp_f32 v219, v71
    v_or3_b32 v244, v244, v142, v143
    v_exp_f32 v212, v84
    v_exp_f32 v213, v85
    v_cvt_pk_bf16_f32 v132, v216, v217
    v_exp_f32 v214, v86
    v_cvt_pk_bf16_f32 v133, v218, v219
    v_exp_f32 v215, v87
    v_or3_b32 v244, v244, v146, v147
    v_exp_f32 v216, v88
    v_exp_f32 v217, v89
    v_cvt_pk_bf16_f32 v134, v212, v213
    v_exp_f32 v218, v90
    v_cvt_pk_bf16_f32 v135, v214, v215
    v_exp_f32 v219, v91
    v_or3_b32 v244, v244, v132, v133
    v_cvt_pk_bf16_f32 v138, v216, v217
    v_cvt_pk_bf16_f32 v139, v218, v219
    v_or3_b32 v244, v244, v134, v135
    v_or3_b32 v244, v244, v138, v139
    s_nop 1
    s_branch a2_rb1a_ret
a2_rb1b:
    s_call_b64 s[74:75], a2_fix10
    v_exp_f32 v212, v100
    v_exp_f32 v213, v101
    v_exp_f32 v214, v102
    v_exp_f32 v215, v103
    v_exp_f32 v216, v104
    v_exp_f32 v217, v105
    v_cvt_pk_bf16_f32 v148, v212, v213
    v_exp_f32 v218, v106
    v_cvt_pk_bf16_f32 v149, v214, v215
    v_exp_f32 v219, v107
    v_exp_f32 v212, v108
    v_exp_f32 v213, v109
    v_cvt_pk_bf16_f32 v152, v216, v217
    v_exp_f32 v214, v110
    v_cvt_pk_bf16_f32 v153, v218, v219
    v_exp_f32 v215, v111
    v_or_b32 v244, v148, v149
    v_exp_f32 v216, v112
    v_exp_f32 v217, v113
    v_cvt_pk_bf16_f32 v156, v212, v213
    v_exp_f32 v218, v114
    v_cvt_pk_bf16_f32 v157, v214, v215
    v_exp_f32 v219, v115
    v_or3_b32 v244, v244, v152, v153
    v_exp_f32 v212, v116
    v_exp_f32 v213, v117
    v_cvt_pk_bf16_f32 v160, v216, v217
    v_exp_f32 v214, v118
    v_cvt_pk_bf16_f32 v161, v218, v219
    v_exp_f32 v215, v119
    v_or3_b32 v244, v244, v156, v157
    v_exp_f32 v216, v120
    v_exp_f32 v217, v121
    v_cvt_pk_bf16_f32 v150, v212, v213
    v_exp_f32 v218, v122
    v_cvt_pk_bf16_f32 v151, v214, v215
    v_exp_f32 v219, v123
    v_or3_b32 v244, v244, v160, v161
    v_exp_f32 v212, v124
    v_exp_f32 v213, v125
    v_cvt_pk_bf16_f32 v154, v216, v217
    v_exp_f32 v214, v126
    v_cvt_pk_bf16_f32 v155, v218, v219
    v_exp_f32 v215, v127
    v_or3_b32 v244, v244, v150, v151
    v_exp_f32 v216, v128
    v_exp_f32 v217, v129
    v_cvt_pk_bf16_f32 v158, v212, v213
    v_exp_f32 v218, v130
    v_cvt_pk_bf16_f32 v159, v214, v215
    v_exp_f32 v219, v131
    v_or3_b32 v244, v244, v154, v155
    v_cvt_pk_bf16_f32 v162, v216, v217
    v_cvt_pk_bf16_f32 v163, v218, v219
    v_or3_b32 v244, v244, v158, v159
    v_or3_b32 v244, v244, v162, v163
    s_nop 1
    s_branch a2_rb1b_ret
a2_rf1a:
    s_call_b64 s[74:75], a2_fix10
    v_exp_f32 v212, v72
    v_exp_f32 v213, v73
    v_exp_f32 v214, v74
    v_exp_f32 v215, v75
    v_exp_f32 v216, v76
    v_exp_f32 v217, v77
    v_cvt_pk_bf16_f32 v136, v212, v213
    v_exp_f32 v218, v78
    v_cvt_pk_bf16_f32 v137, v214, v215
    v_exp_f32 v219, v79
    v_exp_f32 v212, v80
    v_exp_f32 v213, v81
    v_cvt_pk_bf16_f32 v140, v216, v217
    v_exp_f32 v214, v82
    v_cvt_pk_bf16_f32 v141, v218, v219
    v_exp_f32 v215, v83
    v_or_b32 v244, v136, v137
    v_exp_f32 v216, v92
    v_exp_f32 v217, v93
    v_cvt_pk_bf16_f32 v144, v212, v213
    v_exp_f32 v218, v94
    v_cvt_pk_bf16_f32 v145, v214, v215
    v_exp_f32 v219, v95
    v_or3_b32 v244, v244, v140, v141
    v_exp_f32 v212, v96
    v_exp_f32 v213, v97
    v_cvt_pk_bf16_f32 v142, v216, v217
    v_exp_f32 v214, v98
    v_cvt_pk_bf16_f32 v143, v218, v219
    v_exp_f32 v215, v99
    v_or3_b32 v244, v244, v144, v145
    v_exp_f32 v216, v68
    v_exp_f32 v217, v69
    v_cvt_pk_bf16_f32 v146, v212, v213
    v_exp_f32 v218, v70
    v_cvt_pk_bf16_f32 v147, v214, v215
    v_exp_f32 v219, v71
    v_or3_b32 v244, v244, v142, v143
    v_exp_f32 v212, v84
    v_exp_f32 v213, v85
    v_cvt_pk_bf16_f32 v132, v216, v217
    v_exp_f32 v214, v86
    v_cvt_pk_bf16_f32 v133, v218, v219
    v_exp_f32 v215, v87
    v_or3_b32 v244, v244, v146, v147
    v_exp_f32 v216, v88
    v_exp_f32 v217, v89
    v_cvt_pk_bf16_f32 v134, v212, v213
    v_exp_f32 v218, v90
    v_cvt_pk_bf16_f32 v135, v214, v215
    v_exp_f32 v219, v91
    v_or3_b32 v244, v244, v132, v133
    v_cvt_pk_bf16_f32 v138, v216, v217
    v_cvt_pk_bf16_f32 v139, v218, v219
    v_or3_b32 v244, v244, v134, v135
    v_or3_b32 v244, v244, v138, v139
    s_nop 1
    s_branch a2_rf1a_ret
a2_rf1b:
    s_call_b64 s[74:75], a2_fix10
    v_exp_f32 v212, v100
    v_exp_f32 v213, v101
    v_exp_f32 v214, v102
    v_exp_f32 v215, v103
    v_exp_f32 v216, v104
    v_exp_f32 v217, v105
    v_cvt_pk_bf16_f32 v148, v212, v213
    v_exp_f32 v218, v106
    v_cvt_pk_bf16_f32 v149, v214, v215
    v_exp_f32 v219, v107
    v_exp_f32 v212, v108
    v_exp_f32 v213, v109
    v_cvt_pk_bf16_f32 v152, v216, v217
    v_exp_f32 v214, v110
    v_cvt_pk_bf16_f32 v153, v218, v219
    v_exp_f32 v215, v111
    v_or_b32 v244, v148, v149
    v_exp_f32 v216, v112
    v_exp_f32 v217, v113
    v_cvt_pk_bf16_f32 v156, v212, v213
    v_exp_f32 v218, v114
    v_cvt_pk_bf16_f32 v157, v214, v215
    v_exp_f32 v219, v115
    v_or3_b32 v244, v244, v152, v153
    v_exp_f32 v212, v116
    v_exp_f32 v213, v117
    v_cvt_pk_bf16_f32 v160, v216, v217
    v_exp_f32 v214, v118
    v_cvt_pk_bf16_f32 v161, v218, v219
    v_exp_f32 v215, v119
    v_or3_b32 v244, v244, v156, v157
    v_exp_f32 v216, v120
    v_exp_f32 v217, v121
    v_cvt_pk_bf16_f32 v150, v212, v213
    v_exp_f32 v218, v122
    v_cvt_pk_bf16_f32 v151, v214, v215
    v_exp_f32 v219, v123
    v_or3_b32 v244, v244, v160, v161
    v_exp_f32 v212, v124
    v_exp_f32 v213, v125
    v_cvt_pk_bf16_f32 v154, v216, v217
    v_exp_f32 v214, v126
    v_cvt_pk_bf16_f32 v155, v218, v219
    v_exp_f32 v215, v127
    v_or3_b32 v244, v244, v150, v151
    v_exp_f32 v216, v128
    v_exp_f32 v217, v129
    v_cvt_pk_bf16_f32 v158, v212, v213
    v_exp_f32 v218, v130
    v_cvt_pk_bf16_f32 v159, v214, v215
    v_exp_f32 v219, v131
    v_or3_b32 v244, v244, v154, v155
    v_cvt_pk_bf16_f32 v162, v216, v217
    v_cvt_pk_bf16_f32 v163, v218, v219
    v_or3_b32 v244, v244, v158, v159
    v_or3_b32 v244, v244, v162, v163
    s_nop 1
    s_branch a2_rf1b_ret
a2_fix00:
    s_nop 7
    s_waitcnt lgkmcnt(0)
    v_max3_f32 v232, v4, v5, v6
    v_max3_f32 v232, v232, v7, v20
    v_max3_f32 v232, v232, v21, v22
    v_max3_f32 v232, v232, v23, v36
    v_max3_f32 v232, v232, v37, v38
    v_max3_f32 v232, v232, v39, v52
    v_max3_f32 v232, v232, v53, v54
    v_max_f32 v232, v232, v55
    v_max3_f32 v233, v8, v9, v10
    v_max3_f32 v233, v233, v11, v24
    v_max3_f32 v233, v233, v25, v26
    v_max3_f32 v233, v233, v27, v40
    v_max3_f32 v233, v233, v41, v42
    v_max3_f32 v233, v233, v43, v56
    v_max3_f32 v233, v233, v57, v58
    v_max_f32 v233, v233, v59
    v_max3_f32 v234, v12, v13, v14
    v_max3_f32 v234, v234, v15, v28
    v_max3_f32 v234, v234, v29, v30
    v_max3_f32 v234, v234, v31, v44
    v_max3_f32 v234, v234, v45, v46
    v_max3_f32 v234, v234, v47, v60
    v_max3_f32 v234, v234, v61, v62
    v_max_f32 v234, v234, v63
    v_max3_f32 v235, v16, v17, v18
    v_max3_f32 v235, v235, v19, v32
    v_max3_f32 v235, v235, v33, v34
    v_max3_f32 v235, v235, v35, v48
    v_max3_f32 v235, v235, v49, v50
    v_max3_f32 v235, v235, v51, v64
    v_max3_f32 v235, v235, v65, v66
    v_max_f32 v235, v235, v67
    ds_bpermute_b32 v212, v241, v232
    ds_bpermute_b32 v213, v241, v233
    ds_bpermute_b32 v214, v241, v234
    ds_bpermute_b32 v215, v241, v235
    s_waitcnt lgkmcnt(0)
    v_max_f32 v232, v232, v212
    v_max_f32 v233, v233, v213
    v_max_f32 v234, v234, v214
    v_max_f32 v235, v235, v215
    ds_bpermute_b32 v212, v242, v232
    ds_bpermute_b32 v213, v242, v233
    ds_bpermute_b32 v214, v242, v234
    ds_bpermute_b32 v215, v242, v235
    s_waitcnt lgkmcnt(0)
    v_max_f32 v232, v232, v212
    v_max_f32 v233, v233, v213
    v_max_f32 v234, v234, v214
    v_max_f32 v235, v235, v215
    v_add_f32 v232, 0x40e00000, v232
    v_max_f32 v232, 0, v232
    v_add_f32 v228, v228, v232
    v_sub_f32 v196, 0, v228
    v_sub_f32 v197, 0, v228
    v_sub_f32 v198, 0, v228
    v_sub_f32 v199, 0, v228
    v_add_f32 v233, 0x40e00000, v233
    v_max_f32 v233, 0, v233
    v_add_f32 v229, v229, v233
    v_sub_f32 v200, 0, v229
    v_sub_f32 v201, 0, v229
    v_sub_f32 v202, 0, v229
    v_sub_f32 v203, 0, v229
    v_add_f32 v234, 0x40e00000, v234
    v_max_f32 v234, 0, v234
    v_add_f32 v230, v230, v234
    v_sub_f32 v204, 0, v230
    v_sub_f32 v205, 0, v230
    v_sub_f32 v206, 0, v230
    v_sub_f32 v207, 0, v230
    v_add_f32 v235, 0x40e00000, v235
    v_max_f32 v235, 0, v235
    v_add_f32 v231, v231, v235
    v_sub_f32 v208, 0, v231
    v_sub_f32 v209, 0, v231
    v_sub_f32 v210, 0, v231
    v_sub_f32 v211, 0, v231
    v_pk_add_f32 v[4:5], v[4:5], v[232:233] op_sel:[0,0] op_sel_hi:[1,0] neg_lo:[0,1] neg_hi:[0,1]
    v_pk_add_f32 v[6:7], v[6:7], v[232:233] op_sel:[0,0] op_sel_hi:[1,0] neg_lo:[0,1] neg_hi:[0,1]
    v_pk_add_f32 v[8:9], v[8:9], v[232:233] op_sel:[0,1] op_sel_hi:[1,1] neg_lo:[0,1] neg_hi:[0,1]
    v_pk_add_f32 v[10:11], v[10:11], v[232:233] op_sel:[0,1] op_sel_hi:[1,1] neg_lo:[0,1] neg_hi:[0,1]
    v_pk_add_f32 v[12:13], v[12:13], v[234:235] op_sel:[0,0] op_sel_hi:[1,0] neg_lo:[0,1] neg_hi:[0,1]
    v_pk_add_f32 v[14:15], v[14:15], v[234:235] op_sel:[0,0] op_sel_hi:[1,0] neg_lo:[0,1] neg_hi:[0,1]
    v_pk_add_f32 v[16:17], v[16:17], v[234:235] op_sel:[0,1] op_sel_hi:[1,1] neg_lo:[0,1] neg_hi:[0,1]
    v_pk_add_f32 v[18:19], v[18:19], v[234:235] op_sel:[0,1] op_sel_hi:[1,1] neg_lo:[0,1] neg_hi:[0,1]
    v_pk_add_f32 v[20:21], v[20:21], v[232:233] op_sel:[0,0] op_sel_hi:[1,0] neg_lo:[0,1] neg_hi:[0,1]
    v_pk_add_f32 v[22:23], v[22:23], v[232:233] op_sel:[0,0] op_sel_hi:[1,0] neg_lo:[0,1] neg_hi:[0,1]
    v_pk_add_f32 v[24:25], v[24:25], v[232:233] op_sel:[0,1] op_sel_hi:[1,1] neg_lo:[0,1] neg_hi:[0,1]
    v_pk_add_f32 v[26:27], v[26:27], v[232:233] op_sel:[0,1] op_sel_hi:[1,1] neg_lo:[0,1] neg_hi:[0,1]
    v_pk_add_f32 v[28:29], v[28:29], v[234:235] op_sel:[0,0] op_sel_hi:[1,0] neg_lo:[0,1] neg_hi:[0,1]
    v_pk_add_f32 v[30:31], v[30:31], v[234:235] op_sel:[0,0] op_sel_hi:[1,0] neg_lo:[0,1] neg_hi:[0,1]
    v_pk_add_f32 v[32:33], v[32:33], v[234:235] op_sel:[0,1] op_sel_hi:[1,1] neg_lo:[0,1] neg_hi:[0,1]
    v_pk_add_f32 v[34:35], v[34:35], v[234:235] op_sel:[0,1] op_sel_hi:[1,1] neg_lo:[0,1] neg_hi:[0,1]
    v_pk_add_f32 v[36:37], v[36:37], v[232:233] op_sel:[0,0] op_sel_hi:[1,0] neg_lo:[0,1] neg_hi:[0,1]
    v_pk_add_f32 v[38:39], v[38:39], v[232:233] op_sel:[0,0] op_sel_hi:[1,0] neg_lo:[0,1] neg_hi:[0,1]
    v_pk_add_f32 v[40:41], v[40:41], v[232:233] op_sel:[0,1] op_sel_hi:[1,1] neg_lo:[0,1] neg_hi:[0,1]
    v_pk_add_f32 v[42:43], v[42:43], v[232:233] op_sel:[0,1] op_sel_hi:[1,1] neg_lo:[0,1] neg_hi:[0,1]
    v_pk_add_f32 v[44:45], v[44:45], v[234:235] op_sel:[0,0] op_sel_hi:[1,0] neg_lo:[0,1] neg_hi:[0,1]
    v_pk_add_f32 v[46:47], v[46:47], v[234:235] op_sel:[0,0] op_sel_hi:[1,0] neg_lo:[0,1] neg_hi:[0,1]
    v_pk_add_f32 v[48:49], v[48:49], v[234:235] op_sel:[0,1] op_sel_hi:[1,1] neg_lo:[0,1] neg_hi:[0,1]
    v_pk_add_f32 v[50:51], v[50:51], v[234:235] op_sel:[0,1] op_sel_hi:[1,1] neg_lo:[0,1] neg_hi:[0,1]
    v_pk_add_f32 v[52:53], v[52:53], v[232:233] op_sel:[0,0] op_sel_hi:[1,0] neg_lo:[0,1] neg_hi:[0,1]
    v_pk_add_f32 v[54:55], v[54:55], v[232:233] op_sel:[0,0] op_sel_hi:[1,0] neg_lo:[0,1] neg_hi:[0,1]
    v_pk_add_f32 v[56:57], v[56:57], v[232:233] op_sel:[0,1] op_sel_hi:[1,1] neg_lo:[0,1] neg_hi:[0,1]
    v_pk_add_f32 v[58:59], v[58:59], v[232:233] op_sel:[0,1] op_sel_hi:[1,1] neg_lo:[0,1] neg_hi:[0,1]
    v_pk_add_f32 v[60:61], v[60:61], v[234:235] op_sel:[0,0] op_sel_hi:[1,0] neg_lo:[0,1] neg_hi:[0,1]
    v_pk_add_f32 v[62:63], v[62:63], v[234:235] op_sel:[0,0] op_sel_hi:[1,0] neg_lo:[0,1] neg_hi:[0,1]
    v_pk_add_f32 v[64:65], v[64:65], v[234:235] op_sel:[0,1] op_sel_hi:[1,1] neg_lo:[0,1] neg_hi:[0,1]
    v_pk_add_f32 v[66:67], v[66:67], v[234:235] op_sel:[0,1] op_sel_hi:[1,1] neg_lo:[0,1] neg_hi:[0,1]
    v_sub_f32 v220, 0, v232
    v_exp_f32 v220, v220
    v_sub_f32 v221, 0, v233
    v_exp_f32 v221, v221
    v_sub_f32 v222, 0, v234
    v_exp_f32 v222, v222
    v_sub_f32 v223, 0, v235
    v_exp_f32 v223, v223
    s_nop 0
    v_accvgpr_read_b32 v212, a0
    v_accvgpr_read_b32 v213, a1
    v_accvgpr_read_b32 v214, a2
    v_accvgpr_read_b32 v215, a3
    v_mul_f32 v212, v212, v220
    v_mul_f32 v213, v213, v220
    v_mul_f32 v214, v214, v220
    v_mul_f32 v215, v215, v220
    v_accvgpr_write_b32 a0, v212
    v_accvgpr_write_b32 a1, v213
    v_accvgpr_write_b32 a2, v214
    v_accvgpr_write_b32 a3, v215
    v_accvgpr_read_b32 v212, a16
    v_accvgpr_read_b32 v213, a17
    v_accvgpr_read_b32 v214, a18
    v_accvgpr_read_b32 v215, a19
    v_mul_f32 v212, v212, v220
    v_mul_f32 v213, v213, v220
    v_mul_f32 v214, v214, v220
    v_mul_f32 v215, v215, v220
    v_accvgpr_write_b32 a16, v212
    v_accvgpr_write_b32 a17, v213
    v_accvgpr_write_b32 a18, v214
    v_accvgpr_write_b32 a19, v215
    v_accvgpr_read_b32 v212, a32
    v_accvgpr_read_b32 v213, a33
    v_accvgpr_read_b32 v214, a34
    v_accvgpr_read_b32 v215, a35
    v_mul_f32 v212, v212, v220
    v_mul_f32 v213, v213, v220
    v_mul_f32 v214, v214, v220
    v_mul_f32 v215, v215, v220
    v_accvgpr_write_b32 a32, v212
    v_accvgpr_write_b32 a33, v213
    v_accvgpr_write_b32 a34, v214
    v_accvgpr_write_b32 a35, v215
    v_accvgpr_read_b32 v212, a48
    v_accvgpr_read_b32 v213, a49
    v_accvgpr_read_b32 v214, a50
    v_accvgpr_read_b32 v215, a51
    v_mul_f32 v212, v212, v220
    v_mul_f32 v213, v213, v220
    v_mul_f32 v214, v214, v220
    v_mul_f32 v215, v215, v220
    v_accvgpr_write_b32 a48, v212
    v_accvgpr_write_b32 a49, v213
    v_accvgpr_write_b32 a50, v214
    v_accvgpr_write_b32 a51, v215
    v_accvgpr_read_b32 v212, a64
    v_accvgpr_read_b32 v213, a65
    v_accvgpr_read_b32 v214, a66
    v_accvgpr_read_b32 v215, a67
    v_mul_f32 v212, v212, v220
    v_mul_f32 v213, v213, v220
    v_mul_f32 v214, v214, v220
    v_mul_f32 v215, v215, v220
    v_accvgpr_write_b32 a64, v212
    v_accvgpr_write_b32 a65, v213
    v_accvgpr_write_b32 a66, v214
    v_accvgpr_write_b32 a67, v215
    v_accvgpr_read_b32 v212, a80
    v_accvgpr_read_b32 v213, a81
    v_accvgpr_read_b32 v214, a82
    v_accvgpr_read_b32 v215, a83
    v_mul_f32 v212, v212, v220
    v_mul_f32 v213, v213, v220
    v_mul_f32 v214, v214, v220
    v_mul_f32 v215, v215, v220
    v_accvgpr_write_b32 a80, v212
    v_accvgpr_write_b32 a81, v213
    v_accvgpr_write_b32 a82, v214
    v_accvgpr_write_b32 a83, v215
    v_accvgpr_read_b32 v212, a96
    v_accvgpr_read_b32 v213, a97
    v_accvgpr_read_b32 v214, a98
    v_accvgpr_read_b32 v215, a99
    v_mul_f32 v212, v212, v220
    v_mul_f32 v213, v213, v220
    v_mul_f32 v214, v214, v220
    v_mul_f32 v215, v215, v220
    v_accvgpr_write_b32 a96, v212
    v_accvgpr_write_b32 a97, v213
    v_accvgpr_write_b32 a98, v214
    v_accvgpr_write_b32 a99, v215
    v_accvgpr_read_b32 v212, a112
    v_accvgpr_read_b32 v213, a113
    v_accvgpr_read_b32 v214, a114
    v_accvgpr_read_b32 v215, a115
    v_mul_f32 v212, v212, v220
    v_mul_f32 v213, v213, v220
    v_mul_f32 v214, v214, v220
    v_mul_f32 v215, v215, v220
    v_accvgpr_write_b32 a112, v212
    v_accvgpr_write_b32 a113, v213
    v_accvgpr_write_b32 a114, v214
    v_accvgpr_write_b32 a115, v215
    v_accvgpr_read_b32 v212, a128
    v_accvgpr_read_b32 v213, a129
    v_accvgpr_read_b32 v214, a130
    v_accvgpr_read_b32 v215, a131
    v_mul_f32 v212, v212, v220
    v_mul_f32 v213, v213, v220
    v_mul_f32 v214, v214, v220
    v_mul_f32 v215, v215, v220
    v_accvgpr_write_b32 a128, v212
    v_accvgpr_write_b32 a129, v213
    v_accvgpr_write_b32 a130, v214
    v_accvgpr_write_b32 a131, v215
    v_accvgpr_read_b32 v212, a4
    v_accvgpr_read_b32 v213, a5
    v_accvgpr_read_b32 v214, a6
    v_accvgpr_read_b32 v215, a7
    v_mul_f32 v212, v212, v221
    v_mul_f32 v213, v213, v221
    v_mul_f32 v214, v214, v221
    v_mul_f32 v215, v215, v221
    v_accvgpr_write_b32 a4, v212
    v_accvgpr_write_b32 a5, v213
    v_accvgpr_write_b32 a6, v214
    v_accvgpr_write_b32 a7, v215
    v_accvgpr_read_b32 v212, a20
    v_accvgpr_read_b32 v213, a21
    v_accvgpr_read_b32 v214, a22
    v_accvgpr_read_b32 v215, a23
    v_mul_f32 v212, v212, v221
    v_mul_f32 v213, v213, v221
    v_mul_f32 v214, v214, v221
    v_mul_f32 v215, v215, v221
    v_accvgpr_write_b32 a20, v212
    v_accvgpr_write_b32 a21, v213
    v_accvgpr_write_b32 a22, v214
    v_accvgpr_write_b32 a23, v215
    v_accvgpr_read_b32 v212, a36
    v_accvgpr_read_b32 v213, a37
    v_accvgpr_read_b32 v214, a38
    v_accvgpr_read_b32 v215, a39
    v_mul_f32 v212, v212, v221
    v_mul_f32 v213, v213, v221
    v_mul_f32 v214, v214, v221
    v_mul_f32 v215, v215, v221
    v_accvgpr_write_b32 a36, v212
    v_accvgpr_write_b32 a37, v213
    v_accvgpr_write_b32 a38, v214
    v_accvgpr_write_b32 a39, v215
    v_accvgpr_read_b32 v212, a52
    v_accvgpr_read_b32 v213, a53
    v_accvgpr_read_b32 v214, a54
    v_accvgpr_read_b32 v215, a55
    v_mul_f32 v212, v212, v221
    v_mul_f32 v213, v213, v221
    v_mul_f32 v214, v214, v221
    v_mul_f32 v215, v215, v221
    v_accvgpr_write_b32 a52, v212
    v_accvgpr_write_b32 a53, v213
    v_accvgpr_write_b32 a54, v214
    v_accvgpr_write_b32 a55, v215
    v_accvgpr_read_b32 v212, a68
    v_accvgpr_read_b32 v213, a69
    v_accvgpr_read_b32 v214, a70
    v_accvgpr_read_b32 v215, a71
    v_mul_f32 v212, v212, v221
    v_mul_f32 v213, v213, v221
    v_mul_f32 v214, v214, v221
    v_mul_f32 v215, v215, v221
    v_accvgpr_write_b32 a68, v212
    v_accvgpr_write_b32 a69, v213
    v_accvgpr_write_b32 a70, v214
    v_accvgpr_write_b32 a71, v215
    v_accvgpr_read_b32 v212, a84
    v_accvgpr_read_b32 v213, a85
    v_accvgpr_read_b32 v214, a86
    v_accvgpr_read_b32 v215, a87
    v_mul_f32 v212, v212, v221
    v_mul_f32 v213, v213, v221
    v_mul_f32 v214, v214, v221
    v_mul_f32 v215, v215, v221
    v_accvgpr_write_b32 a84, v212
    v_accvgpr_write_b32 a85, v213
    v_accvgpr_write_b32 a86, v214
    v_accvgpr_write_b32 a87, v215
    v_accvgpr_read_b32 v212, a100
    v_accvgpr_read_b32 v213, a101
    v_accvgpr_read_b32 v214, a102
    v_accvgpr_read_b32 v215, a103
    v_mul_f32 v212, v212, v221
    v_mul_f32 v213, v213, v221
    v_mul_f32 v214, v214, v221
    v_mul_f32 v215, v215, v221
    v_accvgpr_write_b32 a100, v212
    v_accvgpr_write_b32 a101, v213
    v_accvgpr_write_b32 a102, v214
    v_accvgpr_write_b32 a103, v215
    v_accvgpr_read_b32 v212, a116
    v_accvgpr_read_b32 v213, a117
    v_accvgpr_read_b32 v214, a118
    v_accvgpr_read_b32 v215, a119
    v_mul_f32 v212, v212, v221
    v_mul_f32 v213, v213, v221
    v_mul_f32 v214, v214, v221
    v_mul_f32 v215, v215, v221
    v_accvgpr_write_b32 a116, v212
    v_accvgpr_write_b32 a117, v213
    v_accvgpr_write_b32 a118, v214
    v_accvgpr_write_b32 a119, v215
    v_accvgpr_read_b32 v212, a132
    v_accvgpr_read_b32 v213, a133
    v_accvgpr_read_b32 v214, a134
    v_accvgpr_read_b32 v215, a135
    v_mul_f32 v212, v212, v221
    v_mul_f32 v213, v213, v221
    v_mul_f32 v214, v214, v221
    v_mul_f32 v215, v215, v221
    v_accvgpr_write_b32 a132, v212
    v_accvgpr_write_b32 a133, v213
    v_accvgpr_write_b32 a134, v214
    v_accvgpr_write_b32 a135, v215
    v_accvgpr_read_b32 v212, a8
    v_accvgpr_read_b32 v213, a9
    v_accvgpr_read_b32 v214, a10
    v_accvgpr_read_b32 v215, a11
    v_mul_f32 v212, v212, v222
    v_mul_f32 v213, v213, v222
    v_mul_f32 v214, v214, v222
    v_mul_f32 v215, v215, v222
    v_accvgpr_write_b32 a8, v212
    v_accvgpr_write_b32 a9, v213
    v_accvgpr_write_b32 a10, v214
    v_accvgpr_write_b32 a11, v215
    v_accvgpr_read_b32 v212, a24
    v_accvgpr_read_b32 v213, a25
    v_accvgpr_read_b32 v214, a26
    v_accvgpr_read_b32 v215, a27
    v_mul_f32 v212, v212, v222
    v_mul_f32 v213, v213, v222
    v_mul_f32 v214, v214, v222
    v_mul_f32 v215, v215, v222
    v_accvgpr_write_b32 a24, v212
    v_accvgpr_write_b32 a25, v213
    v_accvgpr_write_b32 a26, v214
    v_accvgpr_write_b32 a27, v215
    v_accvgpr_read_b32 v212, a40
    v_accvgpr_read_b32 v213, a41
    v_accvgpr_read_b32 v214, a42
    v_accvgpr_read_b32 v215, a43
    v_mul_f32 v212, v212, v222
    v_mul_f32 v213, v213, v222
    v_mul_f32 v214, v214, v222
    v_mul_f32 v215, v215, v222
    v_accvgpr_write_b32 a40, v212
    v_accvgpr_write_b32 a41, v213
    v_accvgpr_write_b32 a42, v214
    v_accvgpr_write_b32 a43, v215
    v_accvgpr_read_b32 v212, a56
    v_accvgpr_read_b32 v213, a57
    v_accvgpr_read_b32 v214, a58
    v_accvgpr_read_b32 v215, a59
    v_mul_f32 v212, v212, v222
    v_mul_f32 v213, v213, v222
    v_mul_f32 v214, v214, v222
    v_mul_f32 v215, v215, v222
    v_accvgpr_write_b32 a56, v212
    v_accvgpr_write_b32 a57, v213
    v_accvgpr_write_b32 a58, v214
    v_accvgpr_write_b32 a59, v215
    v_accvgpr_read_b32 v212, a72
    v_accvgpr_read_b32 v213, a73
    v_accvgpr_read_b32 v214, a74
    v_accvgpr_read_b32 v215, a75
    v_mul_f32 v212, v212, v222
    v_mul_f32 v213, v213, v222
    v_mul_f32 v214, v214, v222
    v_mul_f32 v215, v215, v222
    v_accvgpr_write_b32 a72, v212
    v_accvgpr_write_b32 a73, v213
    v_accvgpr_write_b32 a74, v214
    v_accvgpr_write_b32 a75, v215
    v_accvgpr_read_b32 v212, a88
    v_accvgpr_read_b32 v213, a89
    v_accvgpr_read_b32 v214, a90
    v_accvgpr_read_b32 v215, a91
    v_mul_f32 v212, v212, v222
    v_mul_f32 v213, v213, v222
    v_mul_f32 v214, v214, v222
    v_mul_f32 v215, v215, v222
    v_accvgpr_write_b32 a88, v212
    v_accvgpr_write_b32 a89, v213
    v_accvgpr_write_b32 a90, v214
    v_accvgpr_write_b32 a91, v215
    v_accvgpr_read_b32 v212, a104
    v_accvgpr_read_b32 v213, a105
    v_accvgpr_read_b32 v214, a106
    v_accvgpr_read_b32 v215, a107
    v_mul_f32 v212, v212, v222
    v_mul_f32 v213, v213, v222
    v_mul_f32 v214, v214, v222
    v_mul_f32 v215, v215, v222
    v_accvgpr_write_b32 a104, v212
    v_accvgpr_write_b32 a105, v213
    v_accvgpr_write_b32 a106, v214
    v_accvgpr_write_b32 a107, v215
    v_accvgpr_read_b32 v212, a120
    v_accvgpr_read_b32 v213, a121
    v_accvgpr_read_b32 v214, a122
    v_accvgpr_read_b32 v215, a123
    v_mul_f32 v212, v212, v222
    v_mul_f32 v213, v213, v222
    v_mul_f32 v214, v214, v222
    v_mul_f32 v215, v215, v222
    v_accvgpr_write_b32 a120, v212
    v_accvgpr_write_b32 a121, v213
    v_accvgpr_write_b32 a122, v214
    v_accvgpr_write_b32 a123, v215
    v_accvgpr_read_b32 v212, a136
    v_accvgpr_read_b32 v213, a137
    v_accvgpr_read_b32 v214, a138
    v_accvgpr_read_b32 v215, a139
    v_mul_f32 v212, v212, v222
    v_mul_f32 v213, v213, v222
    v_mul_f32 v214, v214, v222
    v_mul_f32 v215, v215, v222
    v_accvgpr_write_b32 a136, v212
    v_accvgpr_write_b32 a137, v213
    v_accvgpr_write_b32 a138, v214
    v_accvgpr_write_b32 a139, v215
    v_accvgpr_read_b32 v212, a12
    v_accvgpr_read_b32 v213, a13
    v_accvgpr_read_b32 v214, a14
    v_accvgpr_read_b32 v215, a15
    v_mul_f32 v212, v212, v223
    v_mul_f32 v213, v213, v223
    v_mul_f32 v214, v214, v223
    v_mul_f32 v215, v215, v223
    v_accvgpr_write_b32 a12, v212
    v_accvgpr_write_b32 a13, v213
    v_accvgpr_write_b32 a14, v214
    v_accvgpr_write_b32 a15, v215
    v_accvgpr_read_b32 v212, a28
    v_accvgpr_read_b32 v213, a29
    v_accvgpr_read_b32 v214, a30
    v_accvgpr_read_b32 v215, a31
    v_mul_f32 v212, v212, v223
    v_mul_f32 v213, v213, v223
    v_mul_f32 v214, v214, v223
    v_mul_f32 v215, v215, v223
    v_accvgpr_write_b32 a28, v212
    v_accvgpr_write_b32 a29, v213
    v_accvgpr_write_b32 a30, v214
    v_accvgpr_write_b32 a31, v215
    v_accvgpr_read_b32 v212, a44
    v_accvgpr_read_b32 v213, a45
    v_accvgpr_read_b32 v214, a46
    v_accvgpr_read_b32 v215, a47
    v_mul_f32 v212, v212, v223
    v_mul_f32 v213, v213, v223
    v_mul_f32 v214, v214, v223
    v_mul_f32 v215, v215, v223
    v_accvgpr_write_b32 a44, v212
    v_accvgpr_write_b32 a45, v213
    v_accvgpr_write_b32 a46, v214
    v_accvgpr_write_b32 a47, v215
    v_accvgpr_read_b32 v212, a60
    v_accvgpr_read_b32 v213, a61
    v_accvgpr_read_b32 v214, a62
    v_accvgpr_read_b32 v215, a63
    v_mul_f32 v212, v212, v223
    v_mul_f32 v213, v213, v223
    v_mul_f32 v214, v214, v223
    v_mul_f32 v215, v215, v223
    v_accvgpr_write_b32 a60, v212
    v_accvgpr_write_b32 a61, v213
    v_accvgpr_write_b32 a62, v214
    v_accvgpr_write_b32 a63, v215
    v_accvgpr_read_b32 v212, a76
    v_accvgpr_read_b32 v213, a77
    v_accvgpr_read_b32 v214, a78
    v_accvgpr_read_b32 v215, a79
    v_mul_f32 v212, v212, v223
    v_mul_f32 v213, v213, v223
    v_mul_f32 v214, v214, v223
    v_mul_f32 v215, v215, v223
    v_accvgpr_write_b32 a76, v212
    v_accvgpr_write_b32 a77, v213
    v_accvgpr_write_b32 a78, v214
    v_accvgpr_write_b32 a79, v215
    v_accvgpr_read_b32 v212, a92
    v_accvgpr_read_b32 v213, a93
    v_accvgpr_read_b32 v214, a94
    v_accvgpr_read_b32 v215, a95
    v_mul_f32 v212, v212, v223
    v_mul_f32 v213, v213, v223
    v_mul_f32 v214, v214, v223
    v_mul_f32 v215, v215, v223
    v_accvgpr_write_b32 a92, v212
    v_accvgpr_write_b32 a93, v213
    v_accvgpr_write_b32 a94, v214
    v_accvgpr_write_b32 a95, v215
    v_accvgpr_read_b32 v212, a108
    v_accvgpr_read_b32 v213, a109
    v_accvgpr_read_b32 v214, a110
    v_accvgpr_read_b32 v215, a111
    v_mul_f32 v212, v212, v223
    v_mul_f32 v213, v213, v223
    v_mul_f32 v214, v214, v223
    v_mul_f32 v215, v215, v223
    v_accvgpr_write_b32 a108, v212
    v_accvgpr_write_b32 a109, v213
    v_accvgpr_write_b32 a110, v214
    v_accvgpr_write_b32 a111, v215
    v_accvgpr_read_b32 v212, a124
    v_accvgpr_read_b32 v213, a125
    v_accvgpr_read_b32 v214, a126
    v_accvgpr_read_b32 v215, a127
    v_mul_f32 v212, v212, v223
    v_mul_f32 v213, v213, v223
    v_mul_f32 v214, v214, v223
    v_mul_f32 v215, v215, v223
    v_accvgpr_write_b32 a124, v212
    v_accvgpr_write_b32 a125, v213
    v_accvgpr_write_b32 a126, v214
    v_accvgpr_write_b32 a127, v215
    v_accvgpr_read_b32 v212, a140
    v_accvgpr_read_b32 v213, a141
    v_accvgpr_read_b32 v214, a142
    v_accvgpr_read_b32 v215, a143
    v_mul_f32 v212, v212, v223
    v_mul_f32 v213, v213, v223
    v_mul_f32 v214, v214, v223
    v_mul_f32 v215, v215, v223
    v_accvgpr_write_b32 a140, v212
    v_accvgpr_write_b32 a141, v213
    v_accvgpr_write_b32 a142, v214
    v_accvgpr_write_b32 a143, v215
    s_nop 1
    s_setpc_b64 s[74:75]
a2_fix01:
    s_nop 7
    s_waitcnt lgkmcnt(0)
    v_max3_f32 v232, v4, v5, v6
    v_max3_f32 v232, v232, v7, v20
    v_max3_f32 v232, v232, v21, v22
    v_max3_f32 v232, v232, v23, v36
    v_max3_f32 v232, v232, v37, v38
    v_max3_f32 v232, v232, v39, v52
    v_max3_f32 v232, v232, v53, v54
    v_max_f32 v232, v232, v55
    v_max3_f32 v233, v8, v9, v10
    v_max3_f32 v233, v233, v11, v24
    v_max3_f32 v233, v233, v25, v26
    v_max3_f32 v233, v233, v27, v40
    v_max3_f32 v233, v233, v41, v42
    v_max3_f32 v233, v233, v43, v56
    v_max3_f32 v233, v233, v57, v58
    v_max_f32 v233, v233, v59
    v_max3_f32 v234, v12, v13, v14
    v_max3_f32 v234, v234, v15, v28
    v_max3_f32 v234, v234, v29, v30
    v_max3_f32 v234, v234, v31, v44
    v_max3_f32 v234, v234, v45, v46
    v_max3_f32 v234, v234, v47, v60
    v_max3_f32 v234, v234, v61, v62
    v_max_f32 v234, v234, v63
    v_max3_f32 v235, v16, v17, v18
    v_max3_f32 v235, v235, v19, v32
    v_max3_f32 v235, v235, v33, v34
    v_max3_f32 v235, v235, v35, v48
    v_max3_f32 v235, v235, v49, v50
    v_max3_f32 v235, v235, v51, v64
    v_max3_f32 v235, v235, v65, v66
    v_max_f32 v235, v235, v67
    ds_bpermute_b32 v212, v241, v232
    ds_bpermute_b32 v213, v241, v233
    ds_bpermute_b32 v214, v241, v234
    ds_bpermute_b32 v215, v241, v235
    s_waitcnt lgkmcnt(0)
    v_max_f32 v232, v232, v212
    v_max_f32 v233, v233, v213
    v_max_f32 v234, v234, v214
    v_max_f32 v235, v235, v215
    ds_bpermute_b32 v212, v242, v232
    ds_bpermute_b32 v213, v242, v233
    ds_bpermute_b32 v214, v242, v234
    ds_bpermute_b32 v215, v242, v235
    s_waitcnt lgkmcnt(0)
    v_max_f32 v232, v232, v212
    v_max_f32 v233, v233, v213
    v_max_f32 v234, v234, v214
    v_max_f32 v235, v235, v215
    v_add_f32 v232, 0x40e00000, v232
    v_max_f32 v232, 0, v232
    v_add_f32 v228, v228, v232
    v_sub_f32 v196, 0, v228
    v_sub_f32 v197, 0, v228
    v_sub_f32 v198, 0, v228
    v_sub_f32 v199, 0, v228
    v_add_f32 v233, 0x40e00000, v233
    v_max_f32 v233, 0, v233
    v_add_f32 v229, v229, v233
    v_sub_f32 v200, 0, v229
    v_sub_f32 v201, 0, v229
    v_sub_f32 v202, 0, v229
    v_sub_f32 v203, 0, v229
    v_add_f32 v234, 0x40e00000, v234
    v_max_f32 v234, 0, v234
    v_add_f32 v230, v230, v234
    v_sub_f32 v204, 0, v230
    v_sub_f32 v205, 0, v230
    v_sub_f32 v206, 0, v230
    v_sub_f32 v207, 0, v230
    v_add_f32 v235, 0x40e00000, v235
    v_max_f32 v235, 0, v235
    v_add_f32 v231, v231, v235
    v_sub_f32 v208, 0, v231
    v_sub_f32 v209, 0, v231
    v_sub_f32 v210, 0, v231
    v_sub_f32 v211, 0, v231
    v_pk_add_f32 v[4:5], v[4:5], v[232:233] op_sel:[0,0] op_sel_hi:[1,0] neg_lo:[0,1] neg_hi:[0,1]
    v_pk_add_f32 v[6:7], v[6:7], v[232:233] op_sel:[0,0] op_sel_hi:[1,0] neg_lo:[0,1] neg_hi:[0,1]
    v_pk_add_f32 v[8:9], v[8:9], v[232:233] op_sel:[0,1] op_sel_hi:[1,1] neg_lo:[0,1] neg_hi:[0,1]
    v_pk_add_f32 v[10:11], v[10:11], v[232:233] op_sel:[0,1] op_sel_hi:[1,1] neg_lo:[0,1] neg_hi:[0,1]
    v_pk_add_f32 v[12:13], v[12:13], v[234:235] op_sel:[0,0] op_sel_hi:[1,0] neg_lo:[0,1] neg_hi:[0,1]
    v_pk_add_f32 v[14:15], v[14:15], v[234:235] op_sel:[0,0] op_sel_hi:[1,0] neg_lo:[0,1] neg_hi:[0,1]
    v_pk_add_f32 v[16:17], v[16:17], v[234:235] op_sel:[0,1] op_sel_hi:[1,1] neg_lo:[0,1] neg_hi:[0,1]
    v_pk_add_f32 v[18:19], v[18:19], v[234:235] op_sel:[0,1] op_sel_hi:[1,1] neg_lo:[0,1] neg_hi:[0,1]
    v_pk_add_f32 v[20:21], v[20:21], v[232:233] op_sel:[0,0] op_sel_hi:[1,0] neg_lo:[0,1] neg_hi:[0,1]
    v_pk_add_f32 v[22:23], v[22:23], v[232:233] op_sel:[0,0] op_sel_hi:[1,0] neg_lo:[0,1] neg_hi:[0,1]
    v_pk_add_f32 v[24:25], v[24:25], v[232:233] op_sel:[0,1] op_sel_hi:[1,1] neg_lo:[0,1] neg_hi:[0,1]
    v_pk_add_f32 v[26:27], v[26:27], v[232:233] op_sel:[0,1] op_sel_hi:[1,1] neg_lo:[0,1] neg_hi:[0,1]
    v_pk_add_f32 v[28:29], v[28:29], v[234:235] op_sel:[0,0] op_sel_hi:[1,0] neg_lo:[0,1] neg_hi:[0,1]
    v_pk_add_f32 v[30:31], v[30:31], v[234:235] op_sel:[0,0] op_sel_hi:[1,0] neg_lo:[0,1] neg_hi:[0,1]
    v_pk_add_f32 v[32:33], v[32:33], v[234:235] op_sel:[0,1] op_sel_hi:[1,1] neg_lo:[0,1] neg_hi:[0,1]
    v_pk_add_f32 v[34:35], v[34:35], v[234:235] op_sel:[0,1] op_sel_hi:[1,1] neg_lo:[0,1] neg_hi:[0,1]
    v_pk_add_f32 v[36:37], v[36:37], v[232:233] op_sel:[0,0] op_sel_hi:[1,0] neg_lo:[0,1] neg_hi:[0,1]
    v_pk_add_f32 v[38:39], v[38:39], v[232:233] op_sel:[0,0] op_sel_hi:[1,0] neg_lo:[0,1] neg_hi:[0,1]
    v_pk_add_f32 v[40:41], v[40:41], v[232:233] op_sel:[0,1] op_sel_hi:[1,1] neg_lo:[0,1] neg_hi:[0,1]
    v_pk_add_f32 v[42:43], v[42:43], v[232:233] op_sel:[0,1] op_sel_hi:[1,1] neg_lo:[0,1] neg_hi:[0,1]
    v_pk_add_f32 v[44:45], v[44:45], v[234:235] op_sel:[0,0] op_sel_hi:[1,0] neg_lo:[0,1] neg_hi:[0,1]
    v_pk_add_f32 v[46:47], v[46:47], v[234:235] op_sel:[0,0] op_sel_hi:[1,0] neg_lo:[0,1] neg_hi:[0,1]
    v_pk_add_f32 v[48:49], v[48:49], v[234:235] op_sel:[0,1] op_sel_hi:[1,1] neg_lo:[0,1] neg_hi:[0,1]
    v_pk_add_f32 v[50:51], v[50:51], v[234:235] op_sel:[0,1] op_sel_hi:[1,1] neg_lo:[0,1] neg_hi:[0,1]
    v_pk_add_f32 v[52:53], v[52:53], v[232:233] op_sel:[0,0] op_sel_hi:[1,0] neg_lo:[0,1] neg_hi:[0,1]
    v_pk_add_f32 v[54:55], v[54:55], v[232:233] op_sel:[0,0] op_sel_hi:[1,0] neg_lo:[0,1] neg_hi:[0,1]
    v_pk_add_f32 v[56:57], v[56:57], v[232:233] op_sel:[0,1] op_sel_hi:[1,1] neg_lo:[0,1] neg_hi:[0,1]
    v_pk_add_f32 v[58:59], v[58:59], v[232:233] op_sel:[0,1] op_sel_hi:[1,1] neg_lo:[0,1] neg_hi:[0,1]
    v_pk_add_f32 v[60:61], v[60:61], v[234:235] op_sel:[0,0] op_sel_hi:[1,0] neg_lo:[0,1] neg_hi:[0,1]
    v_pk_add_f32 v[62:63], v[62:63], v[234:235] op_sel:[0,0] op_sel_hi:[1,0] neg_lo:[0,1] neg_hi:[0,1]
    v_pk_add_f32 v[64:65], v[64:65], v[234:235] op_sel:[0,1] op_sel_hi:[1,1] neg_lo:[0,1] neg_hi:[0,1]
    v_pk_add_f32 v[66:67], v[66:67], v[234:235] op_sel:[0,1] op_sel_hi:[1,1] neg_lo:[0,1] neg_hi:[0,1]
    v_pk_add_f32 v[68:69], v[68:69], v[232:233] op_sel:[0,0] op_sel_hi:[1,0] neg_lo:[0,1] neg_hi:[0,1]
    v_pk_add_f32 v[70:71], v[70:71], v[232:233] op_sel:[0,0] op_sel_hi:[1,0] neg_lo:[0,1] neg_hi:[0,1]
    v_pk_add_f32 v[72:73], v[72:73], v[232:233] op_sel:[0,1] op_sel_hi:[1,1] neg_lo:[0,1] neg_hi:[0,1]
    v_pk_add_f32 v[74:75], v[74:75], v[232:233] op_sel:[0,1] op_sel_hi:[1,1] neg_lo:[0,1] neg_hi:[0,1]
    v_pk_add_f32 v[76:77], v[76:77], v[234:235] op_sel:[0,0] op_sel_hi:[1,0] neg_lo:[0,1] neg_hi:[0,1]
    v_pk_add_f32 v[78:79], v[78:79], v[234:235] op_sel:[0,0] op_sel_hi:[1,0] neg_lo:[0,1] neg_hi:[0,1]
    v_pk_add_f32 v[80:81], v[80:81], v[234:235] op_sel:[0,1] op_sel_hi:[1,1] neg_lo:[0,1] neg_hi:[0,1]
    v_pk_add_f32 v[82:83], v[82:83], v[234:235] op_sel:[0,1] op_sel_hi:[1,1] neg_lo:[0,1] neg_hi:[0,1]
    v_pk_add_f32 v[84:85], v[84:85], v[232:233] op_sel:[0,0] op_sel_hi:[1,0] neg_lo:[0,1] neg_hi:[0,1]
    v_pk_add_f32 v[86:87], v[86:87], v[232:233] op_sel:[0,0] op_sel_hi:[1,0] neg_lo:[0,1] neg_hi:[0,1]
    v_pk_add_f32 v[88:89], v[88:89], v[232:233] op_sel:[0,1] op_sel_hi:[1,1] neg_lo:[0,1] neg_hi:[0,1]
    v_pk_add_f32 v[90:91], v[90:91], v[232:233] op_sel:[0,1] op_sel_hi:[1,1] neg_lo:[0,1] neg_hi:[0,1]
    v_pk_add_f32 v[92:93], v[92:93], v[234:235] op_sel:[0,0] op_sel_hi:[1,0] neg_lo:[0,1] neg_hi:[0,1]
    v_pk_add_f32 v[94:95], v[94:95], v[234:235] op_sel:[0,0] op_sel_hi:[1,0] neg_lo:[0,1] neg_hi:[0,1]
    v_pk_add_f32 v[96:97], v[96:97], v[234:235] op_sel:[0,1] op_sel_hi:[1,1] neg_lo:[0,1] neg_hi:[0,1]
    v_pk_add_f32 v[98:99], v[98:99], v[234:235] op_sel:[0,1] op_sel_hi:[1,1] neg_lo:[0,1] neg_hi:[0,1]
    v_pk_add_f32 v[100:101], v[100:101], v[232:233] op_sel:[0,0] op_sel_hi:[1,0] neg_lo:[0,1] neg_hi:[0,1]
    v_pk_add_f32 v[102:103], v[102:103], v[232:233] op_sel:[0,0] op_sel_hi:[1,0] neg_lo:[0,1] neg_hi:[0,1]
    v_pk_add_f32 v[104:105], v[104:105], v[232:233] op_sel:[0,1] op_sel_hi:[1,1] neg_lo:[0,1] neg_hi:[0,1]
    v_pk_add_f32 v[106:107], v[106:107], v[232:233] op_sel:[0,1] op_sel_hi:[1,1] neg_lo:[0,1] neg_hi:[0,1]
    v_pk_add_f32 v[108:109], v[108:109], v[234:235] op_sel:[0,0] op_sel_hi:[1,0] neg_lo:[0,1] neg_hi:[0,1]
    v_pk_add_f32 v[110:111], v[110:111], v[234:235] op_sel:[0,0] op_sel_hi:[1,0] neg_lo:[0,1] neg_hi:[0,1]
    v_pk_add_f32 v[112:113], v[112:113], v[234:235] op_sel:[0,1] op_sel_hi:[1,1] neg_lo:[0,1] neg_hi:[0,1]
    v_pk_add_f32 v[114:115], v[114:115], v[234:235] op_sel:[0,1] op_sel_hi:[1,1] neg_lo:[0,1] neg_hi:[0,1]
    v_pk_add_f32 v[116:117], v[116:117], v[232:233] op_sel:[0,0] op_sel_hi:[1,0] neg_lo:[0,1] neg_hi:[0,1]
    v_pk_add_f32 v[118:119], v[118:119], v[232:233] op_sel:[0,0] op_sel_hi:[1,0] neg_lo:[0,1] neg_hi:[0,1]
    v_pk_add_f32 v[120:121], v[120:121], v[232:233] op_sel:[0,1] op_sel_hi:[1,1] neg_lo:[0,1] neg_hi:[0,1]
    v_pk_add_f32 v[122:123], v[122:123], v[232:233] op_sel:[0,1] op_sel_hi:[1,1] neg_lo:[0,1] neg_hi:[0,1]
    v_pk_add_f32 v[124:125], v[124:125], v[234:235] op_sel:[0,0] op_sel_hi:[1,0] neg_lo:[0,1] neg_hi:[0,1]
    v_pk_add_f32 v[126:127], v[126:127], v[234:235] op_sel:[0,0] op_sel_hi:[1,0] neg_lo:[0,1] neg_hi:[0,1]
    v_pk_add_f32 v[128:129], v[128:129], v[234:235] op_sel:[0,1] op_sel_hi:[1,1] neg_lo:[0,1] neg_hi:[0,1]
    v_pk_add_f32 v[130:131], v[130:131], v[234:235] op_sel:[0,1] op_sel_hi:[1,1] neg_lo:[0,1] neg_hi:[0,1]
    v_sub_f32 v220, 0, v232
    v_exp_f32 v220, v220
    v_sub_f32 v221, 0, v233
    v_exp_f32 v221, v221
    v_sub_f32 v222, 0, v234
    v_exp_f32 v222, v222
    v_sub_f32 v223, 0, v235
    v_exp_f32 v223, v223
    s_nop 0
    v_accvgpr_read_b32 v212, a0
    v_accvgpr_read_b32 v213, a1
    v_accvgpr_read_b32 v214, a2
    v_accvgpr_read_b32 v215, a3
    v_mul_f32 v212, v212, v220
    v_mul_f32 v213, v213, v220
    v_mul_f32 v214, v214, v220
    v_mul_f32 v215, v215, v220
    v_accvgpr_write_b32 a0, v212
    v_accvgpr_write_b32 a1, v213
    v_accvgpr_write_b32 a2, v214
    v_accvgpr_write_b32 a3, v215
    v_accvgpr_read_b32 v212, a16
    v_accvgpr_read_b32 v213, a17
    v_accvgpr_read_b32 v214, a18
    v_accvgpr_read_b32 v215, a19
    v_mul_f32 v212, v212, v220
    v_mul_f32 v213, v213, v220
    v_mul_f32 v214, v214, v220
    v_mul_f32 v215, v215, v220
    v_accvgpr_write_b32 a16, v212
    v_accvgpr_write_b32 a17, v213
    v_accvgpr_write_b32 a18, v214
    v_accvgpr_write_b32 a19, v215
    v_accvgpr_read_b32 v212, a32
    v_accvgpr_read_b32 v213, a33
    v_accvgpr_read_b32 v214, a34
    v_accvgpr_read_b32 v215, a35
    v_mul_f32 v212, v212, v220
    v_mul_f32 v213, v213, v220
    v_mul_f32 v214, v214, v220
    v_mul_f32 v215, v215, v220
    v_accvgpr_write_b32 a32, v212
    v_accvgpr_write_b32 a33, v213
    v_accvgpr_write_b32 a34, v214
    v_accvgpr_write_b32 a35, v215
    v_accvgpr_read_b32 v212, a48
    v_accvgpr_read_b32 v213, a49
    v_accvgpr_read_b32 v214, a50
    v_accvgpr_read_b32 v215, a51
    v_mul_f32 v212, v212, v220
    v_mul_f32 v213, v213, v220
    v_mul_f32 v214, v214, v220
    v_mul_f32 v215, v215, v220
    v_accvgpr_write_b32 a48, v212
    v_accvgpr_write_b32 a49, v213
    v_accvgpr_write_b32 a50, v214
    v_accvgpr_write_b32 a51, v215
    v_accvgpr_read_b32 v212, a64
    v_accvgpr_read_b32 v213, a65
    v_accvgpr_read_b32 v214, a66
    v_accvgpr_read_b32 v215, a67
    v_mul_f32 v212, v212, v220
    v_mul_f32 v213, v213, v220
    v_mul_f32 v214, v214, v220
    v_mul_f32 v215, v215, v220
    v_accvgpr_write_b32 a64, v212
    v_accvgpr_write_b32 a65, v213
    v_accvgpr_write_b32 a66, v214
    v_accvgpr_write_b32 a67, v215
    v_accvgpr_read_b32 v212, a80
    v_accvgpr_read_b32 v213, a81
    v_accvgpr_read_b32 v214, a82
    v_accvgpr_read_b32 v215, a83
    v_mul_f32 v212, v212, v220
    v_mul_f32 v213, v213, v220
    v_mul_f32 v214, v214, v220
    v_mul_f32 v215, v215, v220
    v_accvgpr_write_b32 a80, v212
    v_accvgpr_write_b32 a81, v213
    v_accvgpr_write_b32 a82, v214
    v_accvgpr_write_b32 a83, v215
    v_accvgpr_read_b32 v212, a96
    v_accvgpr_read_b32 v213, a97
    v_accvgpr_read_b32 v214, a98
    v_accvgpr_read_b32 v215, a99
    v_mul_f32 v212, v212, v220
    v_mul_f32 v213, v213, v220
    v_mul_f32 v214, v214, v220
    v_mul_f32 v215, v215, v220
    v_accvgpr_write_b32 a96, v212
    v_accvgpr_write_b32 a97, v213
    v_accvgpr_write_b32 a98, v214
    v_accvgpr_write_b32 a99, v215
    v_accvgpr_read_b32 v212, a112
    v_accvgpr_read_b32 v213, a113
    v_accvgpr_read_b32 v214, a114
    v_accvgpr_read_b32 v215, a115
    v_mul_f32 v212, v212, v220
    v_mul_f32 v213, v213, v220
    v_mul_f32 v214, v214, v220
    v_mul_f32 v215, v215, v220
    v_accvgpr_write_b32 a112, v212
    v_accvgpr_write_b32 a113, v213
    v_accvgpr_write_b32 a114, v214
    v_accvgpr_write_b32 a115, v215
    v_accvgpr_read_b32 v212, a128
    v_accvgpr_read_b32 v213, a129
    v_accvgpr_read_b32 v214, a130
    v_accvgpr_read_b32 v215, a131
    v_mul_f32 v212, v212, v220
    v_mul_f32 v213, v213, v220
    v_mul_f32 v214, v214, v220
    v_mul_f32 v215, v215, v220
    v_accvgpr_write_b32 a128, v212
    v_accvgpr_write_b32 a129, v213
    v_accvgpr_write_b32 a130, v214
    v_accvgpr_write_b32 a131, v215
    v_accvgpr_read_b32 v212, a4
    v_accvgpr_read_b32 v213, a5
    v_accvgpr_read_b32 v214, a6
    v_accvgpr_read_b32 v215, a7
    v_mul_f32 v212, v212, v221
    v_mul_f32 v213, v213, v221
    v_mul_f32 v214, v214, v221
    v_mul_f32 v215, v215, v221
    v_accvgpr_write_b32 a4, v212
    v_accvgpr_write_b32 a5, v213
    v_accvgpr_write_b32 a6, v214
    v_accvgpr_write_b32 a7, v215
    v_accvgpr_read_b32 v212, a20
    v_accvgpr_read_b32 v213, a21
    v_accvgpr_read_b32 v214, a22
    v_accvgpr_read_b32 v215, a23
    v_mul_f32 v212, v212, v221
    v_mul_f32 v213, v213, v221
    v_mul_f32 v214, v214, v221
    v_mul_f32 v215, v215, v221
    v_accvgpr_write_b32 a20, v212
    v_accvgpr_write_b32 a21, v213
    v_accvgpr_write_b32 a22, v214
    v_accvgpr_write_b32 a23, v215
    v_accvgpr_read_b32 v212, a36
    v_accvgpr_read_b32 v213, a37
    v_accvgpr_read_b32 v214, a38
    v_accvgpr_read_b32 v215, a39
    v_mul_f32 v212, v212, v221
    v_mul_f32 v213, v213, v221
    v_mul_f32 v214, v214, v221
    v_mul_f32 v215, v215, v221
    v_accvgpr_write_b32 a36, v212
    v_accvgpr_write_b32 a37, v213
    v_accvgpr_write_b32 a38, v214
    v_accvgpr_write_b32 a39, v215
    v_accvgpr_read_b32 v212, a52
    v_accvgpr_read_b32 v213, a53
    v_accvgpr_read_b32 v214, a54
    v_accvgpr_read_b32 v215, a55
    v_mul_f32 v212, v212, v221
    v_mul_f32 v213, v213, v221
    v_mul_f32 v214, v214, v221
    v_mul_f32 v215, v215, v221
    v_accvgpr_write_b32 a52, v212
    v_accvgpr_write_b32 a53, v213
    v_accvgpr_write_b32 a54, v214
    v_accvgpr_write_b32 a55, v215
    v_accvgpr_read_b32 v212, a68
    v_accvgpr_read_b32 v213, a69
    v_accvgpr_read_b32 v214, a70
    v_accvgpr_read_b32 v215, a71
    v_mul_f32 v212, v212, v221
    v_mul_f32 v213, v213, v221
    v_mul_f32 v214, v214, v221
    v_mul_f32 v215, v215, v221
    v_accvgpr_write_b32 a68, v212
    v_accvgpr_write_b32 a69, v213
    v_accvgpr_write_b32 a70, v214
    v_accvgpr_write_b32 a71, v215
    v_accvgpr_read_b32 v212, a84
    v_accvgpr_read_b32 v213, a85
    v_accvgpr_read_b32 v214, a86
    v_accvgpr_read_b32 v215, a87
    v_mul_f32 v212, v212, v221
    v_mul_f32 v213, v213, v221
    v_mul_f32 v214, v214, v221
    v_mul_f32 v215, v215, v221
    v_accvgpr_write_b32 a84, v212
    v_accvgpr_write_b32 a85, v213
    v_accvgpr_write_b32 a86, v214
    v_accvgpr_write_b32 a87, v215
    v_accvgpr_read_b32 v212, a100
    v_accvgpr_read_b32 v213, a101
    v_accvgpr_read_b32 v214, a102
    v_accvgpr_read_b32 v215, a103
    v_mul_f32 v212, v212, v221
    v_mul_f32 v213, v213, v221
    v_mul_f32 v214, v214, v221
    v_mul_f32 v215, v215, v221
    v_accvgpr_write_b32 a100, v212
    v_accvgpr_write_b32 a101, v213
    v_accvgpr_write_b32 a102, v214
    v_accvgpr_write_b32 a103, v215
    v_accvgpr_read_b32 v212, a116
    v_accvgpr_read_b32 v213, a117
    v_accvgpr_read_b32 v214, a118
    v_accvgpr_read_b32 v215, a119
    v_mul_f32 v212, v212, v221
    v_mul_f32 v213, v213, v221
    v_mul_f32 v214, v214, v221
    v_mul_f32 v215, v215, v221
    v_accvgpr_write_b32 a116, v212
    v_accvgpr_write_b32 a117, v213
    v_accvgpr_write_b32 a118, v214
    v_accvgpr_write_b32 a119, v215
    v_accvgpr_read_b32 v212, a132
    v_accvgpr_read_b32 v213, a133
    v_accvgpr_read_b32 v214, a134
    v_accvgpr_read_b32 v215, a135
    v_mul_f32 v212, v212, v221
    v_mul_f32 v213, v213, v221
    v_mul_f32 v214, v214, v221
    v_mul_f32 v215, v215, v221
    v_accvgpr_write_b32 a132, v212
    v_accvgpr_write_b32 a133, v213
    v_accvgpr_write_b32 a134, v214
    v_accvgpr_write_b32 a135, v215
    v_accvgpr_read_b32 v212, a8
    v_accvgpr_read_b32 v213, a9
    v_accvgpr_read_b32 v214, a10
    v_accvgpr_read_b32 v215, a11
    v_mul_f32 v212, v212, v222
    v_mul_f32 v213, v213, v222
    v_mul_f32 v214, v214, v222
    v_mul_f32 v215, v215, v222
    v_accvgpr_write_b32 a8, v212
    v_accvgpr_write_b32 a9, v213
    v_accvgpr_write_b32 a10, v214
    v_accvgpr_write_b32 a11, v215
    v_accvgpr_read_b32 v212, a24
    v_accvgpr_read_b32 v213, a25
    v_accvgpr_read_b32 v214, a26
    v_accvgpr_read_b32 v215, a27
    v_mul_f32 v212, v212, v222
    v_mul_f32 v213, v213, v222
    v_mul_f32 v214, v214, v222
    v_mul_f32 v215, v215, v222
    v_accvgpr_write_b32 a24, v212
    v_accvgpr_write_b32 a25, v213
    v_accvgpr_write_b32 a26, v214
    v_accvgpr_write_b32 a27, v215
    v_accvgpr_read_b32 v212, a40
    v_accvgpr_read_b32 v213, a41
    v_accvgpr_read_b32 v214, a42
    v_accvgpr_read_b32 v215, a43
    v_mul_f32 v212, v212, v222
    v_mul_f32 v213, v213, v222
    v_mul_f32 v214, v214, v222
    v_mul_f32 v215, v215, v222
    v_accvgpr_write_b32 a40, v212
    v_accvgpr_write_b32 a41, v213
    v_accvgpr_write_b32 a42, v214
    v_accvgpr_write_b32 a43, v215
    v_accvgpr_read_b32 v212, a56
    v_accvgpr_read_b32 v213, a57
    v_accvgpr_read_b32 v214, a58
    v_accvgpr_read_b32 v215, a59
    v_mul_f32 v212, v212, v222
    v_mul_f32 v213, v213, v222
    v_mul_f32 v214, v214, v222
    v_mul_f32 v215, v215, v222
    v_accvgpr_write_b32 a56, v212
    v_accvgpr_write_b32 a57, v213
    v_accvgpr_write_b32 a58, v214
    v_accvgpr_write_b32 a59, v215
    v_accvgpr_read_b32 v212, a72
    v_accvgpr_read_b32 v213, a73
    v_accvgpr_read_b32 v214, a74
    v_accvgpr_read_b32 v215, a75
    v_mul_f32 v212, v212, v222
    v_mul_f32 v213, v213, v222
    v_mul_f32 v214, v214, v222
    v_mul_f32 v215, v215, v222
    v_accvgpr_write_b32 a72, v212
    v_accvgpr_write_b32 a73, v213
    v_accvgpr_write_b32 a74, v214
    v_accvgpr_write_b32 a75, v215
    v_accvgpr_read_b32 v212, a88
    v_accvgpr_read_b32 v213, a89
    v_accvgpr_read_b32 v214, a90
    v_accvgpr_read_b32 v215, a91
    v_mul_f32 v212, v212, v222
    v_mul_f32 v213, v213, v222
    v_mul_f32 v214, v214, v222
    v_mul_f32 v215, v215, v222
    v_accvgpr_write_b32 a88, v212
    v_accvgpr_write_b32 a89, v213
    v_accvgpr_write_b32 a90, v214
    v_accvgpr_write_b32 a91, v215
    v_accvgpr_read_b32 v212, a104
    v_accvgpr_read_b32 v213, a105
    v_accvgpr_read_b32 v214, a106
    v_accvgpr_read_b32 v215, a107
    v_mul_f32 v212, v212, v222
    v_mul_f32 v213, v213, v222
    v_mul_f32 v214, v214, v222
    v_mul_f32 v215, v215, v222
    v_accvgpr_write_b32 a104, v212
    v_accvgpr_write_b32 a105, v213
    v_accvgpr_write_b32 a106, v214
    v_accvgpr_write_b32 a107, v215
    v_accvgpr_read_b32 v212, a120
    v_accvgpr_read_b32 v213, a121
    v_accvgpr_read_b32 v214, a122
    v_accvgpr_read_b32 v215, a123
    v_mul_f32 v212, v212, v222
    v_mul_f32 v213, v213, v222
    v_mul_f32 v214, v214, v222
    v_mul_f32 v215, v215, v222
    v_accvgpr_write_b32 a120, v212
    v_accvgpr_write_b32 a121, v213
    v_accvgpr_write_b32 a122, v214
    v_accvgpr_write_b32 a123, v215
    v_accvgpr_read_b32 v212, a136
    v_accvgpr_read_b32 v213, a137
    v_accvgpr_read_b32 v214, a138
    v_accvgpr_read_b32 v215, a139
    v_mul_f32 v212, v212, v222
    v_mul_f32 v213, v213, v222
    v_mul_f32 v214, v214, v222
    v_mul_f32 v215, v215, v222
    v_accvgpr_write_b32 a136, v212
    v_accvgpr_write_b32 a137, v213
    v_accvgpr_write_b32 a138, v214
    v_accvgpr_write_b32 a139, v215
    v_accvgpr_read_b32 v212, a12
    v_accvgpr_read_b32 v213, a13
    v_accvgpr_read_b32 v214, a14
    v_accvgpr_read_b32 v215, a15
    v_mul_f32 v212, v212, v223
    v_mul_f32 v213, v213, v223
    v_mul_f32 v214, v214, v223
    v_mul_f32 v215, v215, v223
    v_accvgpr_write_b32 a12, v212
    v_accvgpr_write_b32 a13, v213
    v_accvgpr_write_b32 a14, v214
    v_accvgpr_write_b32 a15, v215
    v_accvgpr_read_b32 v212, a28
    v_accvgpr_read_b32 v213, a29
    v_accvgpr_read_b32 v214, a30
    v_accvgpr_read_b32 v215, a31
    v_mul_f32 v212, v212, v223
    v_mul_f32 v213, v213, v223
    v_mul_f32 v214, v214, v223
    v_mul_f32 v215, v215, v223
    v_accvgpr_write_b32 a28, v212
    v_accvgpr_write_b32 a29, v213
    v_accvgpr_write_b32 a30, v214
    v_accvgpr_write_b32 a31, v215
    v_accvgpr_read_b32 v212, a44
    v_accvgpr_read_b32 v213, a45
    v_accvgpr_read_b32 v214, a46
    v_accvgpr_read_b32 v215, a47
    v_mul_f32 v212, v212, v223
    v_mul_f32 v213, v213, v223
    v_mul_f32 v214, v214, v223
    v_mul_f32 v215, v215, v223
    v_accvgpr_write_b32 a44, v212
    v_accvgpr_write_b32 a45, v213
    v_accvgpr_write_b32 a46, v214
    v_accvgpr_write_b32 a47, v215
    v_accvgpr_read_b32 v212, a60
    v_accvgpr_read_b32 v213, a61
    v_accvgpr_read_b32 v214, a62
    v_accvgpr_read_b32 v215, a63
    v_mul_f32 v212, v212, v223
    v_mul_f32 v213, v213, v223
    v_mul_f32 v214, v214, v223
    v_mul_f32 v215, v215, v223
    v_accvgpr_write_b32 a60, v212
    v_accvgpr_write_b32 a61, v213
    v_accvgpr_write_b32 a62, v214
    v_accvgpr_write_b32 a63, v215
    v_accvgpr_read_b32 v212, a76
    v_accvgpr_read_b32 v213, a77
    v_accvgpr_read_b32 v214, a78
    v_accvgpr_read_b32 v215, a79
    v_mul_f32 v212, v212, v223
    v_mul_f32 v213, v213, v223
    v_mul_f32 v214, v214, v223
    v_mul_f32 v215, v215, v223
    v_accvgpr_write_b32 a76, v212
    v_accvgpr_write_b32 a77, v213
    v_accvgpr_write_b32 a78, v214
    v_accvgpr_write_b32 a79, v215
    v_accvgpr_read_b32 v212, a92
    v_accvgpr_read_b32 v213, a93
    v_accvgpr_read_b32 v214, a94
    v_accvgpr_read_b32 v215, a95
    v_mul_f32 v212, v212, v223
    v_mul_f32 v213, v213, v223
    v_mul_f32 v214, v214, v223
    v_mul_f32 v215, v215, v223
    v_accvgpr_write_b32 a92, v212
    v_accvgpr_write_b32 a93, v213
    v_accvgpr_write_b32 a94, v214
    v_accvgpr_write_b32 a95, v215
    v_accvgpr_read_b32 v212, a108
    v_accvgpr_read_b32 v213, a109
    v_accvgpr_read_b32 v214, a110
    v_accvgpr_read_b32 v215, a111
    v_mul_f32 v212, v212, v223
    v_mul_f32 v213, v213, v223
    v_mul_f32 v214, v214, v223
    v_mul_f32 v215, v215, v223
    v_accvgpr_write_b32 a108, v212
    v_accvgpr_write_b32 a109, v213
    v_accvgpr_write_b32 a110, v214
    v_accvgpr_write_b32 a111, v215
    v_accvgpr_read_b32 v212, a124
    v_accvgpr_read_b32 v213, a125
    v_accvgpr_read_b32 v214, a126
    v_accvgpr_read_b32 v215, a127
    v_mul_f32 v212, v212, v223
    v_mul_f32 v213, v213, v223
    v_mul_f32 v214, v214, v223
    v_mul_f32 v215, v215, v223
    v_accvgpr_write_b32 a124, v212
    v_accvgpr_write_b32 a125, v213
    v_accvgpr_write_b32 a126, v214
    v_accvgpr_write_b32 a127, v215
    v_accvgpr_read_b32 v212, a140
    v_accvgpr_read_b32 v213, a141
    v_accvgpr_read_b32 v214, a142
    v_accvgpr_read_b32 v215, a143
    v_mul_f32 v212, v212, v223
    v_mul_f32 v213, v213, v223
    v_mul_f32 v214, v214, v223
    v_mul_f32 v215, v215, v223
    v_accvgpr_write_b32 a140, v212
    v_accvgpr_write_b32 a141, v213
    v_accvgpr_write_b32 a142, v214
    v_accvgpr_write_b32 a143, v215
    s_nop 1
    s_setpc_b64 s[74:75]
a2_fix10:
    s_nop 7
    s_waitcnt lgkmcnt(0)
    v_max3_f32 v232, v68, v69, v70
    v_max3_f32 v232, v232, v71, v84
    v_max3_f32 v232, v232, v85, v86
    v_max3_f32 v232, v232, v87, v100
    v_max3_f32 v232, v232, v101, v102
    v_max3_f32 v232, v232, v103, v116
    v_max3_f32 v232, v232, v117, v118
    v_max_f32 v232, v232, v119
    v_max3_f32 v233, v72, v73, v74
    v_max3_f32 v233, v233, v75, v88
    v_max3_f32 v233, v233, v89, v90
    v_max3_f32 v233, v233, v91, v104
    v_max3_f32 v233, v233, v105, v106
    v_max3_f32 v233, v233, v107, v120
    v_max3_f32 v233, v233, v121, v122
    v_max_f32 v233, v233, v123
    v_max3_f32 v234, v76, v77, v78
    v_max3_f32 v234, v234, v79, v92
    v_max3_f32 v234, v234, v93, v94
    v_max3_f32 v234, v234, v95, v108
    v_max3_f32 v234, v234, v109, v110
    v_max3_f32 v234, v234, v111, v124
    v_max3_f32 v234, v234, v125, v126
    v_max_f32 v234, v234, v127
    v_max3_f32 v235, v80, v81, v82
    v_max3_f32 v235, v235, v83, v96
    v_max3_f32 v235, v235, v97, v98
    v_max3_f32 v235, v235, v99, v112
    v_max3_f32 v235, v235, v113, v114
    v_max3_f32 v235, v235, v115, v128
    v_max3_f32 v235, v235, v129, v130
    v_max_f32 v235, v235, v131
    ds_bpermute_b32 v212, v241, v232
    ds_bpermute_b32 v213, v241, v233
    ds_bpermute_b32 v214, v241, v234
    ds_bpermute_b32 v215, v241, v235
    s_waitcnt lgkmcnt(0)
    v_max_f32 v232, v232, v212
    v_max_f32 v233, v233, v213
    v_max_f32 v234, v234, v214
    v_max_f32 v235, v235, v215
    ds_bpermute_b32 v212, v242, v232
    ds_bpermute_b32 v213, v242, v233
    ds_bpermute_b32 v214, v242, v234
    ds_bpermute_b32 v215, v242, v235
    s_waitcnt lgkmcnt(0)
    v_max_f32 v232, v232, v212
    v_max_f32 v233, v233, v213
    v_max_f32 v234, v234, v214
    v_max_f32 v235, v235, v215
    v_add_f32 v232, 0x40e00000, v232
    v_max_f32 v232, 0, v232
    v_add_f32 v228, v228, v232
    v_sub_f32 v196, 0, v228
    v_sub_f32 v197, 0, v228
    v_sub_f32 v198, 0, v228
    v_sub_f32 v199, 0, v228
    v_add_f32 v233, 0x40e00000, v233
    v_max_f32 v233, 0, v233
    v_add_f32 v229, v229, v233
    v_sub_f32 v200, 0, v229
    v_sub_f32 v201, 0, v229
    v_sub_f32 v202, 0, v229
    v_sub_f32 v203, 0, v229
    v_add_f32 v234, 0x40e00000, v234
    v_max_f32 v234, 0, v234
    v_add_f32 v230, v230, v234
    v_sub_f32 v204, 0, v230
    v_sub_f32 v205, 0, v230
    v_sub_f32 v206, 0, v230
    v_sub_f32 v207, 0, v230
    v_add_f32 v235, 0x40e00000, v235
    v_max_f32 v235, 0, v235
    v_add_f32 v231, v231, v235
    v_sub_f32 v208, 0, v231
    v_sub_f32 v209, 0, v231
    v_sub_f32 v210, 0, v231
    v_sub_f32 v211, 0, v231
    v_pk_add_f32 v[68:69], v[68:69], v[232:233] op_sel:[0,0] op_sel_hi:[1,0] neg_lo:[0,1] neg_hi:[0,1]
    v_pk_add_f32 v[70:71], v[70:71], v[232:233] op_sel:[0,0] op_sel_hi:[1,0] neg_lo:[0,1] neg_hi:[0,1]
    v_pk_add_f32 v[72:73], v[72:73], v[232:233] op_sel:[0,1] op_sel_hi:[1,1] neg_lo:[0,1] neg_hi:[0,1]
    v_pk_add_f32 v[74:75], v[74:75], v[232:233] op_sel:[0,1] op_sel_hi:[1,1] neg_lo:[0,1] neg_hi:[0,1]
    v_pk_add_f32 v[76:77], v[76:77], v[234:235] op_sel:[0,0] op_sel_hi:[1,0] neg_lo:[0,1] neg_hi:[0,1]
    v_pk_add_f32 v[78:79], v[78:79], v[234:235] op_sel:[0,0] op_sel_hi:[1,0] neg_lo:[0,1] neg_hi:[0,1]
    v_pk_add_f32 v[80:81], v[80:81], v[234:235] op_sel:[0,1] op_sel_hi:[1,1] neg_lo:[0,1] neg_hi:[0,1]
    v_pk_add_f32 v[82:83], v[82:83], v[234:235] op_sel:[0,1] op_sel_hi:[1,1] neg_lo:[0,1] neg_hi:[0,1]
    v_pk_add_f32 v[84:85], v[84:85], v[232:233] op_sel:[0,0] op_sel_hi:[1,0] neg_lo:[0,1] neg_hi:[0,1]
    v_pk_add_f32 v[86:87], v[86:87], v[232:233] op_sel:[0,0] op_sel_hi:[1,0] neg_lo:[0,1] neg_hi:[0,1]
    v_pk_add_f32 v[88:89], v[88:89], v[232:233] op_sel:[0,1] op_sel_hi:[1,1] neg_lo:[0,1] neg_hi:[0,1]
    v_pk_add_f32 v[90:91], v[90:91], v[232:233] op_sel:[0,1] op_sel_hi:[1,1] neg_lo:[0,1] neg_hi:[0,1]
    v_pk_add_f32 v[92:93], v[92:93], v[234:235] op_sel:[0,0] op_sel_hi:[1,0] neg_lo:[0,1] neg_hi:[0,1]
    v_pk_add_f32 v[94:95], v[94:95], v[234:235] op_sel:[0,0] op_sel_hi:[1,0] neg_lo:[0,1] neg_hi:[0,1]
    v_pk_add_f32 v[96:97], v[96:97], v[234:235] op_sel:[0,1] op_sel_hi:[1,1] neg_lo:[0,1] neg_hi:[0,1]
    v_pk_add_f32 v[98:99], v[98:99], v[234:235] op_sel:[0,1] op_sel_hi:[1,1] neg_lo:[0,1] neg_hi:[0,1]
    v_pk_add_f32 v[100:101], v[100:101], v[232:233] op_sel:[0,0] op_sel_hi:[1,0] neg_lo:[0,1] neg_hi:[0,1]
    v_pk_add_f32 v[102:103], v[102:103], v[232:233] op_sel:[0,0] op_sel_hi:[1,0] neg_lo:[0,1] neg_hi:[0,1]
    v_pk_add_f32 v[104:105], v[104:105], v[232:233] op_sel:[0,1] op_sel_hi:[1,1] neg_lo:[0,1] neg_hi:[0,1]
    v_pk_add_f32 v[106:107], v[106:107], v[232:233] op_sel:[0,1] op_sel_hi:[1,1] neg_lo:[0,1] neg_hi:[0,1]
    v_pk_add_f32 v[108:109], v[108:109], v[234:235] op_sel:[0,0] op_sel_hi:[1,0] neg_lo:[0,1] neg_hi:[0,1]
    v_pk_add_f32 v[110:111], v[110:111], v[234:235] op_sel:[0,0] op_sel_hi:[1,0] neg_lo:[0,1] neg_hi:[0,1]
    v_pk_add_f32 v[112:113], v[112:113], v[234:235] op_sel:[0,1] op_sel_hi:[1,1] neg_lo:[0,1] neg_hi:[0,1]
    v_pk_add_f32 v[114:115], v[114:115], v[234:235] op_sel:[0,1] op_sel_hi:[1,1] neg_lo:[0,1] neg_hi:[0,1]
    v_pk_add_f32 v[116:117], v[116:117], v[232:233] op_sel:[0,0] op_sel_hi:[1,0] neg_lo:[0,1] neg_hi:[0,1]
    v_pk_add_f32 v[118:119], v[118:119], v[232:233] op_sel:[0,0] op_sel_hi:[1,0] neg_lo:[0,1] neg_hi:[0,1]
    v_pk_add_f32 v[120:121], v[120:121], v[232:233] op_sel:[0,1] op_sel_hi:[1,1] neg_lo:[0,1] neg_hi:[0,1]
    v_pk_add_f32 v[122:123], v[122:123], v[232:233] op_sel:[0,1] op_sel_hi:[1,1] neg_lo:[0,1] neg_hi:[0,1]
    v_pk_add_f32 v[124:125], v[124:125], v[234:235] op_sel:[0,0] op_sel_hi:[1,0] neg_lo:[0,1] neg_hi:[0,1]
    v_pk_add_f32 v[126:127], v[126:127], v[234:235] op_sel:[0,0] op_sel_hi:[1,0] neg_lo:[0,1] neg_hi:[0,1]
    v_pk_add_f32 v[128:129], v[128:129], v[234:235] op_sel:[0,1] op_sel_hi:[1,1] neg_lo:[0,1] neg_hi:[0,1]
    v_pk_add_f32 v[130:131], v[130:131], v[234:235] op_sel:[0,1] op_sel_hi:[1,1] neg_lo:[0,1] neg_hi:[0,1]
    v_sub_f32 v220, 0, v232
    v_exp_f32 v220, v220
    v_sub_f32 v221, 0, v233
    v_exp_f32 v221, v221
    v_sub_f32 v222, 0, v234
    v_exp_f32 v222, v222
    v_sub_f32 v223, 0, v235
    v_exp_f32 v223, v223
    s_nop 0
    v_accvgpr_read_b32 v212, a0
    v_accvgpr_read_b32 v213, a1
    v_accvgpr_read_b32 v214, a2
    v_accvgpr_read_b32 v215, a3
    v_mul_f32 v212, v212, v220
    v_mul_f32 v213, v213, v220
    v_mul_f32 v214, v214, v220
    v_mul_f32 v215, v215, v220
    v_accvgpr_write_b32 a0, v212
    v_accvgpr_write_b32 a1, v213
    v_accvgpr_write_b32 a2, v214
    v_accvgpr_write_b32 a3, v215
    v_accvgpr_read_b32 v212, a16
    v_accvgpr_read_b32 v213, a17
    v_accvgpr_read_b32 v214, a18
    v_accvgpr_read_b32 v215, a19
    v_mul_f32 v212, v212, v220
    v_mul_f32 v213, v213, v220
    v_mul_f32 v214, v214, v220
    v_mul_f32 v215, v215, v220
    v_accvgpr_write_b32 a16, v212
    v_accvgpr_write_b32 a17, v213
    v_accvgpr_write_b32 a18, v214
    v_accvgpr_write_b32 a19, v215
    v_accvgpr_read_b32 v212, a32
    v_accvgpr_read_b32 v213, a33
    v_accvgpr_read_b32 v214, a34
    v_accvgpr_read_b32 v215, a35
    v_mul_f32 v212, v212, v220
    v_mul_f32 v213, v213, v220
    v_mul_f32 v214, v214, v220
    v_mul_f32 v215, v215, v220
    v_accvgpr_write_b32 a32, v212
    v_accvgpr_write_b32 a33, v213
    v_accvgpr_write_b32 a34, v214
    v_accvgpr_write_b32 a35, v215
    v_accvgpr_read_b32 v212, a48
    v_accvgpr_read_b32 v213, a49
    v_accvgpr_read_b32 v214, a50
    v_accvgpr_read_b32 v215, a51
    v_mul_f32 v212, v212, v220
    v_mul_f32 v213, v213, v220
    v_mul_f32 v214, v214, v220
    v_mul_f32 v215, v215, v220
    v_accvgpr_write_b32 a48, v212
    v_accvgpr_write_b32 a49, v213
    v_accvgpr_write_b32 a50, v214
    v_accvgpr_write_b32 a51, v215
    v_accvgpr_read_b32 v212, a64
    v_accvgpr_read_b32 v213, a65
    v_accvgpr_read_b32 v214, a66
    v_accvgpr_read_b32 v215, a67
    v_mul_f32 v212, v212, v220
    v_mul_f32 v213, v213, v220
    v_mul_f32 v214, v214, v220
    v_mul_f32 v215, v215, v220
    v_accvgpr_write_b32 a64, v212
    v_accvgpr_write_b32 a65, v213
    v_accvgpr_write_b32 a66, v214
    v_accvgpr_write_b32 a67, v215
    v_accvgpr_read_b32 v212, a80
    v_accvgpr_read_b32 v213, a81
    v_accvgpr_read_b32 v214, a82
    v_accvgpr_read_b32 v215, a83
    v_mul_f32 v212, v212, v220
    v_mul_f32 v213, v213, v220
    v_mul_f32 v214, v214, v220
    v_mul_f32 v215, v215, v220
    v_accvgpr_write_b32 a80, v212
    v_accvgpr_write_b32 a81, v213
    v_accvgpr_write_b32 a82, v214
    v_accvgpr_write_b32 a83, v215
    v_accvgpr_read_b32 v212, a96
    v_accvgpr_read_b32 v213, a97
    v_accvgpr_read_b32 v214, a98
    v_accvgpr_read_b32 v215, a99
    v_mul_f32 v212, v212, v220
    v_mul_f32 v213, v213, v220
    v_mul_f32 v214, v214, v220
    v_mul_f32 v215, v215, v220
    v_accvgpr_write_b32 a96, v212
    v_accvgpr_write_b32 a97, v213
    v_accvgpr_write_b32 a98, v214
    v_accvgpr_write_b32 a99, v215
    v_accvgpr_read_b32 v212, a112
    v_accvgpr_read_b32 v213, a113
    v_accvgpr_read_b32 v214, a114
    v_accvgpr_read_b32 v215, a115
    v_mul_f32 v212, v212, v220
    v_mul_f32 v213, v213, v220
    v_mul_f32 v214, v214, v220
    v_mul_f32 v215, v215, v220
    v_accvgpr_write_b32 a112, v212
    v_accvgpr_write_b32 a113, v213
    v_accvgpr_write_b32 a114, v214
    v_accvgpr_write_b32 a115, v215
    v_accvgpr_read_b32 v212, a128
    v_accvgpr_read_b32 v213, a129
    v_accvgpr_read_b32 v214, a130
    v_accvgpr_read_b32 v215, a131
    v_mul_f32 v212, v212, v220
    v_mul_f32 v213, v213, v220
    v_mul_f32 v214, v214, v220
    v_mul_f32 v215, v215, v220
    v_accvgpr_write_b32 a128, v212
    v_accvgpr_write_b32 a129, v213
    v_accvgpr_write_b32 a130, v214
    v_accvgpr_write_b32 a131, v215
    v_accvgpr_read_b32 v212, a4
    v_accvgpr_read_b32 v213, a5
    v_accvgpr_read_b32 v214, a6
    v_accvgpr_read_b32 v215, a7
    v_mul_f32 v212, v212, v221
    v_mul_f32 v213, v213, v221
    v_mul_f32 v214, v214, v221
    v_mul_f32 v215, v215, v221
    v_accvgpr_write_b32 a4, v212
    v_accvgpr_write_b32 a5, v213
    v_accvgpr_write_b32 a6, v214
    v_accvgpr_write_b32 a7, v215
    v_accvgpr_read_b32 v212, a20
    v_accvgpr_read_b32 v213, a21
    v_accvgpr_read_b32 v214, a22
    v_accvgpr_read_b32 v215, a23
    v_mul_f32 v212, v212, v221
    v_mul_f32 v213, v213, v221
    v_mul_f32 v214, v214, v221
    v_mul_f32 v215, v215, v221
    v_accvgpr_write_b32 a20, v212
    v_accvgpr_write_b32 a21, v213
    v_accvgpr_write_b32 a22, v214
    v_accvgpr_write_b32 a23, v215
    v_accvgpr_read_b32 v212, a36
    v_accvgpr_read_b32 v213, a37
    v_accvgpr_read_b32 v214, a38
    v_accvgpr_read_b32 v215, a39
    v_mul_f32 v212, v212, v221
    v_mul_f32 v213, v213, v221
    v_mul_f32 v214, v214, v221
    v_mul_f32 v215, v215, v221
    v_accvgpr_write_b32 a36, v212
    v_accvgpr_write_b32 a37, v213
    v_accvgpr_write_b32 a38, v214
    v_accvgpr_write_b32 a39, v215
    v_accvgpr_read_b32 v212, a52
    v_accvgpr_read_b32 v213, a53
    v_accvgpr_read_b32 v214, a54
    v_accvgpr_read_b32 v215, a55
    v_mul_f32 v212, v212, v221
    v_mul_f32 v213, v213, v221
    v_mul_f32 v214, v214, v221
    v_mul_f32 v215, v215, v221
    v_accvgpr_write_b32 a52, v212
    v_accvgpr_write_b32 a53, v213
    v_accvgpr_write_b32 a54, v214
    v_accvgpr_write_b32 a55, v215
    v_accvgpr_read_b32 v212, a68
    v_accvgpr_read_b32 v213, a69
    v_accvgpr_read_b32 v214, a70
    v_accvgpr_read_b32 v215, a71
    v_mul_f32 v212, v212, v221
    v_mul_f32 v213, v213, v221
    v_mul_f32 v214, v214, v221
    v_mul_f32 v215, v215, v221
    v_accvgpr_write_b32 a68, v212
    v_accvgpr_write_b32 a69, v213
    v_accvgpr_write_b32 a70, v214
    v_accvgpr_write_b32 a71, v215
    v_accvgpr_read_b32 v212, a84
    v_accvgpr_read_b32 v213, a85
    v_accvgpr_read_b32 v214, a86
    v_accvgpr_read_b32 v215, a87
    v_mul_f32 v212, v212, v221
    v_mul_f32 v213, v213, v221
    v_mul_f32 v214, v214, v221
    v_mul_f32 v215, v215, v221
    v_accvgpr_write_b32 a84, v212
    v_accvgpr_write_b32 a85, v213
    v_accvgpr_write_b32 a86, v214
    v_accvgpr_write_b32 a87, v215
    v_accvgpr_read_b32 v212, a100
    v_accvgpr_read_b32 v213, a101
    v_accvgpr_read_b32 v214, a102
    v_accvgpr_read_b32 v215, a103
    v_mul_f32 v212, v212, v221
    v_mul_f32 v213, v213, v221
    v_mul_f32 v214, v214, v221
    v_mul_f32 v215, v215, v221
    v_accvgpr_write_b32 a100, v212
    v_accvgpr_write_b32 a101, v213
    v_accvgpr_write_b32 a102, v214
    v_accvgpr_write_b32 a103, v215
    v_accvgpr_read_b32 v212, a116
    v_accvgpr_read_b32 v213, a117
    v_accvgpr_read_b32 v214, a118
    v_accvgpr_read_b32 v215, a119
    v_mul_f32 v212, v212, v221
    v_mul_f32 v213, v213, v221
    v_mul_f32 v214, v214, v221
    v_mul_f32 v215, v215, v221
    v_accvgpr_write_b32 a116, v212
    v_accvgpr_write_b32 a117, v213
    v_accvgpr_write_b32 a118, v214
    v_accvgpr_write_b32 a119, v215
    v_accvgpr_read_b32 v212, a132
    v_accvgpr_read_b32 v213, a133
    v_accvgpr_read_b32 v214, a134
    v_accvgpr_read_b32 v215, a135
    v_mul_f32 v212, v212, v221
    v_mul_f32 v213, v213, v221
    v_mul_f32 v214, v214, v221
    v_mul_f32 v215, v215, v221
    v_accvgpr_write_b32 a132, v212
    v_accvgpr_write_b32 a133, v213
    v_accvgpr_write_b32 a134, v214
    v_accvgpr_write_b32 a135, v215
    v_accvgpr_read_b32 v212, a8
    v_accvgpr_read_b32 v213, a9
    v_accvgpr_read_b32 v214, a10
    v_accvgpr_read_b32 v215, a11
    v_mul_f32 v212, v212, v222
    v_mul_f32 v213, v213, v222
    v_mul_f32 v214, v214, v222
    v_mul_f32 v215, v215, v222
    v_accvgpr_write_b32 a8, v212
    v_accvgpr_write_b32 a9, v213
    v_accvgpr_write_b32 a10, v214
    v_accvgpr_write_b32 a11, v215
    v_accvgpr_read_b32 v212, a24
    v_accvgpr_read_b32 v213, a25
    v_accvgpr_read_b32 v214, a26
    v_accvgpr_read_b32 v215, a27
    v_mul_f32 v212, v212, v222
    v_mul_f32 v213, v213, v222
    v_mul_f32 v214, v214, v222
    v_mul_f32 v215, v215, v222
    v_accvgpr_write_b32 a24, v212
    v_accvgpr_write_b32 a25, v213
    v_accvgpr_write_b32 a26, v214
    v_accvgpr_write_b32 a27, v215
    v_accvgpr_read_b32 v212, a40
    v_accvgpr_read_b32 v213, a41
    v_accvgpr_read_b32 v214, a42
    v_accvgpr_read_b32 v215, a43
    v_mul_f32 v212, v212, v222
    v_mul_f32 v213, v213, v222
    v_mul_f32 v214, v214, v222
    v_mul_f32 v215, v215, v222
    v_accvgpr_write_b32 a40, v212
    v_accvgpr_write_b32 a41, v213
    v_accvgpr_write_b32 a42, v214
    v_accvgpr_write_b32 a43, v215
    v_accvgpr_read_b32 v212, a56
    v_accvgpr_read_b32 v213, a57
    v_accvgpr_read_b32 v214, a58
    v_accvgpr_read_b32 v215, a59
    v_mul_f32 v212, v212, v222
    v_mul_f32 v213, v213, v222
    v_mul_f32 v214, v214, v222
    v_mul_f32 v215, v215, v222
    v_accvgpr_write_b32 a56, v212
    v_accvgpr_write_b32 a57, v213
    v_accvgpr_write_b32 a58, v214
    v_accvgpr_write_b32 a59, v215
    v_accvgpr_read_b32 v212, a72
    v_accvgpr_read_b32 v213, a73
    v_accvgpr_read_b32 v214, a74
    v_accvgpr_read_b32 v215, a75
    v_mul_f32 v212, v212, v222
    v_mul_f32 v213, v213, v222
    v_mul_f32 v214, v214, v222
    v_mul_f32 v215, v215, v222
    v_accvgpr_write_b32 a72, v212
    v_accvgpr_write_b32 a73, v213
    v_accvgpr_write_b32 a74, v214
    v_accvgpr_write_b32 a75, v215
    v_accvgpr_read_b32 v212, a88
    v_accvgpr_read_b32 v213, a89
    v_accvgpr_read_b32 v214, a90
    v_accvgpr_read_b32 v215, a91
    v_mul_f32 v212, v212, v222
    v_mul_f32 v213, v213, v222
    v_mul_f32 v214, v214, v222
    v_mul_f32 v215, v215, v222
    v_accvgpr_write_b32 a88, v212
    v_accvgpr_write_b32 a89, v213
    v_accvgpr_write_b32 a90, v214
    v_accvgpr_write_b32 a91, v215
    v_accvgpr_read_b32 v212, a104
    v_accvgpr_read_b32 v213, a105
    v_accvgpr_read_b32 v214, a106
    v_accvgpr_read_b32 v215, a107
    v_mul_f32 v212, v212, v222
    v_mul_f32 v213, v213, v222
    v_mul_f32 v214, v214, v222
    v_mul_f32 v215, v215, v222
    v_accvgpr_write_b32 a104, v212
    v_accvgpr_write_b32 a105, v213
    v_accvgpr_write_b32 a106, v214
    v_accvgpr_write_b32 a107, v215
    v_accvgpr_read_b32 v212, a120
    v_accvgpr_read_b32 v213, a121
    v_accvgpr_read_b32 v214, a122
    v_accvgpr_read_b32 v215, a123
    v_mul_f32 v212, v212, v222
    v_mul_f32 v213, v213, v222
    v_mul_f32 v214, v214, v222
    v_mul_f32 v215, v215, v222
    v_accvgpr_write_b32 a120, v212
    v_accvgpr_write_b32 a121, v213
    v_accvgpr_write_b32 a122, v214
    v_accvgpr_write_b32 a123, v215
    v_accvgpr_read_b32 v212, a136
    v_accvgpr_read_b32 v213, a137
    v_accvgpr_read_b32 v214, a138
    v_accvgpr_read_b32 v215, a139
    v_mul_f32 v212, v212, v222
    v_mul_f32 v213, v213, v222
    v_mul_f32 v214, v214, v222
    v_mul_f32 v215, v215, v222
    v_accvgpr_write_b32 a136, v212
    v_accvgpr_write_b32 a137, v213
    v_accvgpr_write_b32 a138, v214
    v_accvgpr_write_b32 a139, v215
    v_accvgpr_read_b32 v212, a12
    v_accvgpr_read_b32 v213, a13
    v_accvgpr_read_b32 v214, a14
    v_accvgpr_read_b32 v215, a15
    v_mul_f32 v212, v212, v223
    v_mul_f32 v213, v213, v223
    v_mul_f32 v214, v214, v223
    v_mul_f32 v215, v215, v223
    v_accvgpr_write_b32 a12, v212
    v_accvgpr_write_b32 a13, v213
    v_accvgpr_write_b32 a14, v214
    v_accvgpr_write_b32 a15, v215
    v_accvgpr_read_b32 v212, a28
    v_accvgpr_read_b32 v213, a29
    v_accvgpr_read_b32 v214, a30
    v_accvgpr_read_b32 v215, a31
    v_mul_f32 v212, v212, v223
    v_mul_f32 v213, v213, v223
    v_mul_f32 v214, v214, v223
    v_mul_f32 v215, v215, v223
    v_accvgpr_write_b32 a28, v212
    v_accvgpr_write_b32 a29, v213
    v_accvgpr_write_b32 a30, v214
    v_accvgpr_write_b32 a31, v215
    v_accvgpr_read_b32 v212, a44
    v_accvgpr_read_b32 v213, a45
    v_accvgpr_read_b32 v214, a46
    v_accvgpr_read_b32 v215, a47
    v_mul_f32 v212, v212, v223
    v_mul_f32 v213, v213, v223
    v_mul_f32 v214, v214, v223
    v_mul_f32 v215, v215, v223
    v_accvgpr_write_b32 a44, v212
    v_accvgpr_write_b32 a45, v213
    v_accvgpr_write_b32 a46, v214
    v_accvgpr_write_b32 a47, v215
    v_accvgpr_read_b32 v212, a60
    v_accvgpr_read_b32 v213, a61
    v_accvgpr_read_b32 v214, a62
    v_accvgpr_read_b32 v215, a63
    v_mul_f32 v212, v212, v223
    v_mul_f32 v213, v213, v223
    v_mul_f32 v214, v214, v223
    v_mul_f32 v215, v215, v223
    v_accvgpr_write_b32 a60, v212
    v_accvgpr_write_b32 a61, v213
    v_accvgpr_write_b32 a62, v214
    v_accvgpr_write_b32 a63, v215
    v_accvgpr_read_b32 v212, a76
    v_accvgpr_read_b32 v213, a77
    v_accvgpr_read_b32 v214, a78
    v_accvgpr_read_b32 v215, a79
    v_mul_f32 v212, v212, v223
    v_mul_f32 v213, v213, v223
    v_mul_f32 v214, v214, v223
    v_mul_f32 v215, v215, v223
    v_accvgpr_write_b32 a76, v212
    v_accvgpr_write_b32 a77, v213
    v_accvgpr_write_b32 a78, v214
    v_accvgpr_write_b32 a79, v215
    v_accvgpr_read_b32 v212, a92
    v_accvgpr_read_b32 v213, a93
    v_accvgpr_read_b32 v214, a94
    v_accvgpr_read_b32 v215, a95
    v_mul_f32 v212, v212, v223
    v_mul_f32 v213, v213, v223
    v_mul_f32 v214, v214, v223
    v_mul_f32 v215, v215, v223
    v_accvgpr_write_b32 a92, v212
    v_accvgpr_write_b32 a93, v213
    v_accvgpr_write_b32 a94, v214
    v_accvgpr_write_b32 a95, v215
    v_accvgpr_read_b32 v212, a108
    v_accvgpr_read_b32 v213, a109
    v_accvgpr_read_b32 v214, a110
    v_accvgpr_read_b32 v215, a111
    v_mul_f32 v212, v212, v223
    v_mul_f32 v213, v213, v223
    v_mul_f32 v214, v214, v223
    v_mul_f32 v215, v215, v223
    v_accvgpr_write_b32 a108, v212
    v_accvgpr_write_b32 a109, v213
    v_accvgpr_write_b32 a110, v214
    v_accvgpr_write_b32 a111, v215
    v_accvgpr_read_b32 v212, a124
    v_accvgpr_read_b32 v213, a125
    v_accvgpr_read_b32 v214, a126
    v_accvgpr_read_b32 v215, a127
    v_mul_f32 v212, v212, v223
    v_mul_f32 v213, v213, v223
    v_mul_f32 v214, v214, v223
    v_mul_f32 v215, v215, v223
    v_accvgpr_write_b32 a124, v212
    v_accvgpr_write_b32 a125, v213
    v_accvgpr_write_b32 a126, v214
    v_accvgpr_write_b32 a127, v215
    v_accvgpr_read_b32 v212, a140
    v_accvgpr_read_b32 v213, a141
    v_accvgpr_read_b32 v214, a142
    v_accvgpr_read_b32 v215, a143
    v_mul_f32 v212, v212, v223
    v_mul_f32 v213, v213, v223
    v_mul_f32 v214, v214, v223
    v_mul_f32 v215, v215, v223
    v_accvgpr_write_b32 a140, v212
    v_accvgpr_write_b32 a141, v213
    v_accvgpr_write_b32 a142, v214
    v_accvgpr_write_b32 a143, v215
    s_nop 1
    s_setpc_b64 s[74:75]
a2_fix11:
    s_nop 7
    s_waitcnt lgkmcnt(0)
    v_max3_f32 v232, v68, v69, v70
    v_max3_f32 v232, v232, v71, v84
    v_max3_f32 v232, v232, v85, v86
    v_max3_f32 v232, v232, v87, v100
    v_max3_f32 v232, v232, v101, v102
    v_max3_f32 v232, v232, v103, v116
    v_max3_f32 v232, v232, v117, v118
    v_max_f32 v232, v232, v119
    v_max3_f32 v233, v72, v73, v74
    v_max3_f32 v233, v233, v75, v88
    v_max3_f32 v233, v233, v89, v90
    v_max3_f32 v233, v233, v91, v104
    v_max3_f32 v233, v233, v105, v106
    v_max3_f32 v233, v233, v107, v120
    v_max3_f32 v233, v233, v121, v122
    v_max_f32 v233, v233, v123
    v_max3_f32 v234, v76, v77, v78
    v_max3_f32 v234, v234, v79, v92
    v_max3_f32 v234, v234, v93, v94
    v_max3_f32 v234, v234, v95, v108
    v_max3_f32 v234, v234, v109, v110
    v_max3_f32 v234, v234, v111, v124
    v_max3_f32 v234, v234, v125, v126
    v_max_f32 v234, v234, v127
    v_max3_f32 v235, v80, v81, v82
    v_max3_f32 v235, v235, v83, v96
    v_max3_f32 v235, v235, v97, v98
    v_max3_f32 v235, v235, v99, v112
    v_max3_f32 v235, v235, v113, v114
    v_max3_f32 v235, v235, v115, v128
    v_max3_f32 v235, v235, v129, v130
    v_max_f32 v235, v235, v131
    ds_bpermute_b32 v212, v241, v232
    ds_bpermute_b32 v213, v241, v233
    ds_bpermute_b32 v214, v241, v234
    ds_bpermute_b32 v215, v241, v235
    s_waitcnt lgkmcnt(0)
    v_max_f32 v232, v232, v212
    v_max_f32 v233, v233, v213
    v_max_f32 v234, v234, v214
    v_max_f32 v235, v235, v215
    ds_bpermute_b32 v212, v242, v232
    ds_bpermute_b32 v213, v242, v233
    ds_bpermute_b32 v214, v242, v234
    ds_bpermute_b32 v215, v242, v235
    s_waitcnt lgkmcnt(0)
    v_max_f32 v232, v232, v212
    v_max_f32 v233, v233, v213
    v_max_f32 v234, v234, v214
    v_max_f32 v235, v235, v215
    v_add_f32 v232, 0x40e00000, v232
    v_max_f32 v232, 0, v232
    v_add_f32 v228, v228, v232
    v_sub_f32 v196, 0, v228
    v_sub_f32 v197, 0, v228
    v_sub_f32 v198, 0, v228
    v_sub_f32 v199, 0, v228
    v_add_f32 v233, 0x40e00000, v233
    v_max_f32 v233, 0, v233
    v_add_f32 v229, v229, v233
    v_sub_f32 v200, 0, v229
    v_sub_f32 v201, 0, v229
    v_sub_f32 v202, 0, v229
    v_sub_f32 v203, 0, v229
    v_add_f32 v234, 0x40e00000, v234
    v_max_f32 v234, 0, v234
    v_add_f32 v230, v230, v234
    v_sub_f32 v204, 0, v230
    v_sub_f32 v205, 0, v230
    v_sub_f32 v206, 0, v230
    v_sub_f32 v207, 0, v230
    v_add_f32 v235, 0x40e00000, v235
    v_max_f32 v235, 0, v235
    v_add_f32 v231, v231, v235
    v_sub_f32 v208, 0, v231
    v_sub_f32 v209, 0, v231
    v_sub_f32 v210, 0, v231
    v_sub_f32 v211, 0, v231
    v_pk_add_f32 v[68:69], v[68:69], v[232:233] op_sel:[0,0] op_sel_hi:[1,0] neg_lo:[0,1] neg_hi:[0,1]
    v_pk_add_f32 v[70:71], v[70:71], v[232:233] op_sel:[0,0] op_sel_hi:[1,0] neg_lo:[0,1] neg_hi:[0,1]
    v_pk_add_f32 v[72:73], v[72:73], v[232:233] op_sel:[0,1] op_sel_hi:[1,1] neg_lo:[0,1] neg_hi:[0,1]
    v_pk_add_f32 v[74:75], v[74:75], v[232:233] op_sel:[0,1] op_sel_hi:[1,1] neg_lo:[0,1] neg_hi:[0,1]
    v_pk_add_f32 v[76:77], v[76:77], v[234:235] op_sel:[0,0] op_sel_hi:[1,0] neg_lo:[0,1] neg_hi:[0,1]
    v_pk_add_f32 v[78:79], v[78:79], v[234:235] op_sel:[0,0] op_sel_hi:[1,0] neg_lo:[0,1] neg_hi:[0,1]
    v_pk_add_f32 v[80:81], v[80:81], v[234:235] op_sel:[0,1] op_sel_hi:[1,1] neg_lo:[0,1] neg_hi:[0,1]
    v_pk_add_f32 v[82:83], v[82:83], v[234:235] op_sel:[0,1] op_sel_hi:[1,1] neg_lo:[0,1] neg_hi:[0,1]
    v_pk_add_f32 v[84:85], v[84:85], v[232:233] op_sel:[0,0] op_sel_hi:[1,0] neg_lo:[0,1] neg_hi:[0,1]
    v_pk_add_f32 v[86:87], v[86:87], v[232:233] op_sel:[0,0] op_sel_hi:[1,0] neg_lo:[0,1] neg_hi:[0,1]
    v_pk_add_f32 v[88:89], v[88:89], v[232:233] op_sel:[0,1] op_sel_hi:[1,1] neg_lo:[0,1] neg_hi:[0,1]
    v_pk_add_f32 v[90:91], v[90:91], v[232:233] op_sel:[0,1] op_sel_hi:[1,1] neg_lo:[0,1] neg_hi:[0,1]
    v_pk_add_f32 v[92:93], v[92:93], v[234:235] op_sel:[0,0] op_sel_hi:[1,0] neg_lo:[0,1] neg_hi:[0,1]
    v_pk_add_f32 v[94:95], v[94:95], v[234:235] op_sel:[0,0] op_sel_hi:[1,0] neg_lo:[0,1] neg_hi:[0,1]
    v_pk_add_f32 v[96:97], v[96:97], v[234:235] op_sel:[0,1] op_sel_hi:[1,1] neg_lo:[0,1] neg_hi:[0,1]
    v_pk_add_f32 v[98:99], v[98:99], v[234:235] op_sel:[0,1] op_sel_hi:[1,1] neg_lo:[0,1] neg_hi:[0,1]
    v_pk_add_f32 v[100:101], v[100:101], v[232:233] op_sel:[0,0] op_sel_hi:[1,0] neg_lo:[0,1] neg_hi:[0,1]
    v_pk_add_f32 v[102:103], v[102:103], v[232:233] op_sel:[0,0] op_sel_hi:[1,0] neg_lo:[0,1] neg_hi:[0,1]
    v_pk_add_f32 v[104:105], v[104:105], v[232:233] op_sel:[0,1] op_sel_hi:[1,1] neg_lo:[0,1] neg_hi:[0,1]
    v_pk_add_f32 v[106:107], v[106:107], v[232:233] op_sel:[0,1] op_sel_hi:[1,1] neg_lo:[0,1] neg_hi:[0,1]
    v_pk_add_f32 v[108:109], v[108:109], v[234:235] op_sel:[0,0] op_sel_hi:[1,0] neg_lo:[0,1] neg_hi:[0,1]
    v_pk_add_f32 v[110:111], v[110:111], v[234:235] op_sel:[0,0] op_sel_hi:[1,0] neg_lo:[0,1] neg_hi:[0,1]
    v_pk_add_f32 v[112:113], v[112:113], v[234:235] op_sel:[0,1] op_sel_hi:[1,1] neg_lo:[0,1] neg_hi:[0,1]
    v_pk_add_f32 v[114:115], v[114:115], v[234:235] op_sel:[0,1] op_sel_hi:[1,1] neg_lo:[0,1] neg_hi:[0,1]
    v_pk_add_f32 v[116:117], v[116:117], v[232:233] op_sel:[0,0] op_sel_hi:[1,0] neg_lo:[0,1] neg_hi:[0,1]
    v_pk_add_f32 v[118:119], v[118:119], v[232:233] op_sel:[0,0] op_sel_hi:[1,0] neg_lo:[0,1] neg_hi:[0,1]
    v_pk_add_f32 v[120:121], v[120:121], v[232:233] op_sel:[0,1] op_sel_hi:[1,1] neg_lo:[0,1] neg_hi:[0,1]
    v_pk_add_f32 v[122:123], v[122:123], v[232:233] op_sel:[0,1] op_sel_hi:[1,1] neg_lo:[0,1] neg_hi:[0,1]
    v_pk_add_f32 v[124:125], v[124:125], v[234:235] op_sel:[0,0] op_sel_hi:[1,0] neg_lo:[0,1] neg_hi:[0,1]
    v_pk_add_f32 v[126:127], v[126:127], v[234:235] op_sel:[0,0] op_sel_hi:[1,0] neg_lo:[0,1] neg_hi:[0,1]
    v_pk_add_f32 v[128:129], v[128:129], v[234:235] op_sel:[0,1] op_sel_hi:[1,1] neg_lo:[0,1] neg_hi:[0,1]
    v_pk_add_f32 v[130:131], v[130:131], v[234:235] op_sel:[0,1] op_sel_hi:[1,1] neg_lo:[0,1] neg_hi:[0,1]
    v_pk_add_f32 v[4:5], v[4:5], v[232:233] op_sel:[0,0] op_sel_hi:[1,0] neg_lo:[0,1] neg_hi:[0,1]
    v_pk_add_f32 v[6:7], v[6:7], v[232:233] op_sel:[0,0] op_sel_hi:[1,0] neg_lo:[0,1] neg_hi:[0,1]
    v_pk_add_f32 v[8:9], v[8:9], v[232:233] op_sel:[0,1] op_sel_hi:[1,1] neg_lo:[0,1] neg_hi:[0,1]
    v_pk_add_f32 v[10:11], v[10:11], v[232:233] op_sel:[0,1] op_sel_hi:[1,1] neg_lo:[0,1] neg_hi:[0,1]
    v_pk_add_f32 v[12:13], v[12:13], v[234:235] op_sel:[0,0] op_sel_hi:[1,0] neg_lo:[0,1] neg_hi:[0,1]
    v_pk_add_f32 v[14:15], v[14:15], v[234:235] op_sel:[0,0] op_sel_hi:[1,0] neg_lo:[0,1] neg_hi:[0,1]
    v_pk_add_f32 v[16:17], v[16:17], v[234:235] op_sel:[0,1] op_sel_hi:[1,1] neg_lo:[0,1] neg_hi:[0,1]
    v_pk_add_f32 v[18:19], v[18:19], v[234:235] op_sel:[0,1] op_sel_hi:[1,1] neg_lo:[0,1] neg_hi:[0,1]
    v_pk_add_f32 v[20:21], v[20:21], v[232:233] op_sel:[0,0] op_sel_hi:[1,0] neg_lo:[0,1] neg_hi:[0,1]
    v_pk_add_f32 v[22:23], v[22:23], v[232:233] op_sel:[0,0] op_sel_hi:[1,0] neg_lo:[0,1] neg_hi:[0,1]
    v_pk_add_f32 v[24:25], v[24:25], v[232:233] op_sel:[0,1] op_sel_hi:[1,1] neg_lo:[0,1] neg_hi:[0,1]
    v_pk_add_f32 v[26:27], v[26:27], v[232:233] op_sel:[0,1] op_sel_hi:[1,1] neg_lo:[0,1] neg_hi:[0,1]
    v_pk_add_f32 v[28:29], v[28:29], v[234:235] op_sel:[0,0] op_sel_hi:[1,0] neg_lo:[0,1] neg_hi:[0,1]
    v_pk_add_f32 v[30:31], v[30:31], v[234:235] op_sel:[0,0] op_sel_hi:[1,0] neg_lo:[0,1] neg_hi:[0,1]
    v_pk_add_f32 v[32:33], v[32:33], v[234:235] op_sel:[0,1] op_sel_hi:[1,1] neg_lo:[0,1] neg_hi:[0,1]
    v_pk_add_f32 v[34:35], v[34:35], v[234:235] op_sel:[0,1] op_sel_hi:[1,1] neg_lo:[0,1] neg_hi:[0,1]
    v_pk_add_f32 v[36:37], v[36:37], v[232:233] op_sel:[0,0] op_sel_hi:[1,0] neg_lo:[0,1] neg_hi:[0,1]
    v_pk_add_f32 v[38:39], v[38:39], v[232:233] op_sel:[0,0] op_sel_hi:[1,0] neg_lo:[0,1] neg_hi:[0,1]
    v_pk_add_f32 v[40:41], v[40:41], v[232:233] op_sel:[0,1] op_sel_hi:[1,1] neg_lo:[0,1] neg_hi:[0,1]
    v_pk_add_f32 v[42:43], v[42:43], v[232:233] op_sel:[0,1] op_sel_hi:[1,1] neg_lo:[0,1] neg_hi:[0,1]
    v_pk_add_f32 v[44:45], v[44:45], v[234:235] op_sel:[0,0] op_sel_hi:[1,0] neg_lo:[0,1] neg_hi:[0,1]
    v_pk_add_f32 v[46:47], v[46:47], v[234:235] op_sel:[0,0] op_sel_hi:[1,0] neg_lo:[0,1] neg_hi:[0,1]
    v_pk_add_f32 v[48:49], v[48:49], v[234:235] op_sel:[0,1] op_sel_hi:[1,1] neg_lo:[0,1] neg_hi:[0,1]
    v_pk_add_f32 v[50:51], v[50:51], v[234:235] op_sel:[0,1] op_sel_hi:[1,1] neg_lo:[0,1] neg_hi:[0,1]
    v_pk_add_f32 v[52:53], v[52:53], v[232:233] op_sel:[0,0] op_sel_hi:[1,0] neg_lo:[0,1] neg_hi:[0,1]
    v_pk_add_f32 v[54:55], v[54:55], v[232:233] op_sel:[0,0] op_sel_hi:[1,0] neg_lo:[0,1] neg_hi:[0,1]
    v_pk_add_f32 v[56:57], v[56:57], v[232:233] op_sel:[0,1] op_sel_hi:[1,1] neg_lo:[0,1] neg_hi:[0,1]
    v_pk_add_f32 v[58:59], v[58:59], v[232:233] op_sel:[0,1] op_sel_hi:[1,1] neg_lo:[0,1] neg_hi:[0,1]
    v_pk_add_f32 v[60:61], v[60:61], v[234:235] op_sel:[0,0] op_sel_hi:[1,0] neg_lo:[0,1] neg_hi:[0,1]
    v_pk_add_f32 v[62:63], v[62:63], v[234:235] op_sel:[0,0] op_sel_hi:[1,0] neg_lo:[0,1] neg_hi:[0,1]
    v_pk_add_f32 v[64:65], v[64:65], v[234:235] op_sel:[0,1] op_sel_hi:[1,1] neg_lo:[0,1] neg_hi:[0,1]
    v_pk_add_f32 v[66:67], v[66:67], v[234:235] op_sel:[0,1] op_sel_hi:[1,1] neg_lo:[0,1] neg_hi:[0,1]
    v_sub_f32 v220, 0, v232
    v_exp_f32 v220, v220
    v_sub_f32 v221, 0, v233
    v_exp_f32 v221, v221
    v_sub_f32 v222, 0, v234
    v_exp_f32 v222, v222
    v_sub_f32 v223, 0, v235
    v_exp_f32 v223, v223
    s_nop 0
    v_accvgpr_read_b32 v212, a0
    v_accvgpr_read_b32 v213, a1
    v_accvgpr_read_b32 v214, a2
    v_accvgpr_read_b32 v215, a3
    v_mul_f32 v212, v212, v220
    v_mul_f32 v213, v213, v220
    v_mul_f32 v214, v214, v220
    v_mul_f32 v215, v215, v220
    v_accvgpr_write_b32 a0, v212
    v_accvgpr_write_b32 a1, v213
    v_accvgpr_write_b32 a2, v214
    v_accvgpr_write_b32 a3, v215
    v_accvgpr_read_b32 v212, a16
    v_accvgpr_read_b32 v213, a17
    v_accvgpr_read_b32 v214, a18
    v_accvgpr_read_b32 v215, a19
    v_mul_f32 v212, v212, v220
    v_mul_f32 v213, v213, v220
    v_mul_f32 v214, v214, v220
    v_mul_f32 v215, v215, v220
    v_accvgpr_write_b32 a16, v212
    v_accvgpr_write_b32 a17, v213
    v_accvgpr_write_b32 a18, v214
    v_accvgpr_write_b32 a19, v215
    v_accvgpr_read_b32 v212, a32
    v_accvgpr_read_b32 v213, a33
    v_accvgpr_read_b32 v214, a34
    v_accvgpr_read_b32 v215, a35
    v_mul_f32 v212, v212, v220
    v_mul_f32 v213, v213, v220
    v_mul_f32 v214, v214, v220
    v_mul_f32 v215, v215, v220
    v_accvgpr_write_b32 a32, v212
    v_accvgpr_write_b32 a33, v213
    v_accvgpr_write_b32 a34, v214
    v_accvgpr_write_b32 a35, v215
    v_accvgpr_read_b32 v212, a48
    v_accvgpr_read_b32 v213, a49
    v_accvgpr_read_b32 v214, a50
    v_accvgpr_read_b32 v215, a51
    v_mul_f32 v212, v212, v220
    v_mul_f32 v213, v213, v220
    v_mul_f32 v214, v214, v220
    v_mul_f32 v215, v215, v220
    v_accvgpr_write_b32 a48, v212
    v_accvgpr_write_b32 a49, v213
    v_accvgpr_write_b32 a50, v214
    v_accvgpr_write_b32 a51, v215
    v_accvgpr_read_b32 v212, a64
    v_accvgpr_read_b32 v213, a65
    v_accvgpr_read_b32 v214, a66
    v_accvgpr_read_b32 v215, a67
    v_mul_f32 v212, v212, v220
    v_mul_f32 v213, v213, v220
    v_mul_f32 v214, v214, v220
    v_mul_f32 v215, v215, v220
    v_accvgpr_write_b32 a64, v212
    v_accvgpr_write_b32 a65, v213
    v_accvgpr_write_b32 a66, v214
    v_accvgpr_write_b32 a67, v215
    v_accvgpr_read_b32 v212, a80
    v_accvgpr_read_b32 v213, a81
    v_accvgpr_read_b32 v214, a82
    v_accvgpr_read_b32 v215, a83
    v_mul_f32 v212, v212, v220
    v_mul_f32 v213, v213, v220
    v_mul_f32 v214, v214, v220
    v_mul_f32 v215, v215, v220
    v_accvgpr_write_b32 a80, v212
    v_accvgpr_write_b32 a81, v213
    v_accvgpr_write_b32 a82, v214
    v_accvgpr_write_b32 a83, v215
    v_accvgpr_read_b32 v212, a96
    v_accvgpr_read_b32 v213, a97
    v_accvgpr_read_b32 v214, a98
    v_accvgpr_read_b32 v215, a99
    v_mul_f32 v212, v212, v220
    v_mul_f32 v213, v213, v220
    v_mul_f32 v214, v214, v220
    v_mul_f32 v215, v215, v220
    v_accvgpr_write_b32 a96, v212
    v_accvgpr_write_b32 a97, v213
    v_accvgpr_write_b32 a98, v214
    v_accvgpr_write_b32 a99, v215
    v_accvgpr_read_b32 v212, a112
    v_accvgpr_read_b32 v213, a113
    v_accvgpr_read_b32 v214, a114
    v_accvgpr_read_b32 v215, a115
    v_mul_f32 v212, v212, v220
    v_mul_f32 v213, v213, v220
    v_mul_f32 v214, v214, v220
    v_mul_f32 v215, v215, v220
    v_accvgpr_write_b32 a112, v212
    v_accvgpr_write_b32 a113, v213
    v_accvgpr_write_b32 a114, v214
    v_accvgpr_write_b32 a115, v215
    v_accvgpr_read_b32 v212, a128
    v_accvgpr_read_b32 v213, a129
    v_accvgpr_read_b32 v214, a130
    v_accvgpr_read_b32 v215, a131
    v_mul_f32 v212, v212, v220
    v_mul_f32 v213, v213, v220
    v_mul_f32 v214, v214, v220
    v_mul_f32 v215, v215, v220
    v_accvgpr_write_b32 a128, v212
    v_accvgpr_write_b32 a129, v213
    v_accvgpr_write_b32 a130, v214
    v_accvgpr_write_b32 a131, v215
    v_accvgpr_read_b32 v212, a4
    v_accvgpr_read_b32 v213, a5
    v_accvgpr_read_b32 v214, a6
    v_accvgpr_read_b32 v215, a7
    v_mul_f32 v212, v212, v221
    v_mul_f32 v213, v213, v221
    v_mul_f32 v214, v214, v221
    v_mul_f32 v215, v215, v221
    v_accvgpr_write_b32 a4, v212
    v_accvgpr_write_b32 a5, v213
    v_accvgpr_write_b32 a6, v214
    v_accvgpr_write_b32 a7, v215
    v_accvgpr_read_b32 v212, a20
    v_accvgpr_read_b32 v213, a21
    v_accvgpr_read_b32 v214, a22
    v_accvgpr_read_b32 v215, a23
    v_mul_f32 v212, v212, v221
    v_mul_f32 v213, v213, v221
    v_mul_f32 v214, v214, v221
    v_mul_f32 v215, v215, v221
    v_accvgpr_write_b32 a20, v212
    v_accvgpr_write_b32 a21, v213
    v_accvgpr_write_b32 a22, v214
    v_accvgpr_write_b32 a23, v215
    v_accvgpr_read_b32 v212, a36
    v_accvgpr_read_b32 v213, a37
    v_accvgpr_read_b32 v214, a38
    v_accvgpr_read_b32 v215, a39
    v_mul_f32 v212, v212, v221
    v_mul_f32 v213, v213, v221
    v_mul_f32 v214, v214, v221
    v_mul_f32 v215, v215, v221
    v_accvgpr_write_b32 a36, v212
    v_accvgpr_write_b32 a37, v213
    v_accvgpr_write_b32 a38, v214
    v_accvgpr_write_b32 a39, v215
    v_accvgpr_read_b32 v212, a52
    v_accvgpr_read_b32 v213, a53
    v_accvgpr_read_b32 v214, a54
    v_accvgpr_read_b32 v215, a55
    v_mul_f32 v212, v212, v221
    v_mul_f32 v213, v213, v221
    v_mul_f32 v214, v214, v221
    v_mul_f32 v215, v215, v221
    v_accvgpr_write_b32 a52, v212
    v_accvgpr_write_b32 a53, v213
    v_accvgpr_write_b32 a54, v214
    v_accvgpr_write_b32 a55, v215
    v_accvgpr_read_b32 v212, a68
    v_accvgpr_read_b32 v213, a69
    v_accvgpr_read_b32 v214, a70
    v_accvgpr_read_b32 v215, a71
    v_mul_f32 v212, v212, v221
    v_mul_f32 v213, v213, v221
    v_mul_f32 v214, v214, v221
    v_mul_f32 v215, v215, v221
    v_accvgpr_write_b32 a68, v212
    v_accvgpr_write_b32 a69, v213
    v_accvgpr_write_b32 a70, v214
    v_accvgpr_write_b32 a71, v215
    v_accvgpr_read_b32 v212, a84
    v_accvgpr_read_b32 v213, a85
    v_accvgpr_read_b32 v214, a86
    v_accvgpr_read_b32 v215, a87
    v_mul_f32 v212, v212, v221
    v_mul_f32 v213, v213, v221
    v_mul_f32 v214, v214, v221
    v_mul_f32 v215, v215, v221
    v_accvgpr_write_b32 a84, v212
    v_accvgpr_write_b32 a85, v213
    v_accvgpr_write_b32 a86, v214
    v_accvgpr_write_b32 a87, v215
    v_accvgpr_read_b32 v212, a100
    v_accvgpr_read_b32 v213, a101
    v_accvgpr_read_b32 v214, a102
    v_accvgpr_read_b32 v215, a103
    v_mul_f32 v212, v212, v221
    v_mul_f32 v213, v213, v221
    v_mul_f32 v214, v214, v221
    v_mul_f32 v215, v215, v221
    v_accvgpr_write_b32 a100, v212
    v_accvgpr_write_b32 a101, v213
    v_accvgpr_write_b32 a102, v214
    v_accvgpr_write_b32 a103, v215
    v_accvgpr_read_b32 v212, a116
    v_accvgpr_read_b32 v213, a117
    v_accvgpr_read_b32 v214, a118
    v_accvgpr_read_b32 v215, a119
    v_mul_f32 v212, v212, v221
    v_mul_f32 v213, v213, v221
    v_mul_f32 v214, v214, v221
    v_mul_f32 v215, v215, v221
    v_accvgpr_write_b32 a116, v212
    v_accvgpr_write_b32 a117, v213
    v_accvgpr_write_b32 a118, v214
    v_accvgpr_write_b32 a119, v215
    v_accvgpr_read_b32 v212, a132
    v_accvgpr_read_b32 v213, a133
    v_accvgpr_read_b32 v214, a134
    v_accvgpr_read_b32 v215, a135
    v_mul_f32 v212, v212, v221
    v_mul_f32 v213, v213, v221
    v_mul_f32 v214, v214, v221
    v_mul_f32 v215, v215, v221
    v_accvgpr_write_b32 a132, v212
    v_accvgpr_write_b32 a133, v213
    v_accvgpr_write_b32 a134, v214
    v_accvgpr_write_b32 a135, v215
    v_accvgpr_read_b32 v212, a8
    v_accvgpr_read_b32 v213, a9
    v_accvgpr_read_b32 v214, a10
    v_accvgpr_read_b32 v215, a11
    v_mul_f32 v212, v212, v222
    v_mul_f32 v213, v213, v222
    v_mul_f32 v214, v214, v222
    v_mul_f32 v215, v215, v222
    v_accvgpr_write_b32 a8, v212
    v_accvgpr_write_b32 a9, v213
    v_accvgpr_write_b32 a10, v214
    v_accvgpr_write_b32 a11, v215
    v_accvgpr_read_b32 v212, a24
    v_accvgpr_read_b32 v213, a25
    v_accvgpr_read_b32 v214, a26
    v_accvgpr_read_b32 v215, a27
    v_mul_f32 v212, v212, v222
    v_mul_f32 v213, v213, v222
    v_mul_f32 v214, v214, v222
    v_mul_f32 v215, v215, v222
    v_accvgpr_write_b32 a24, v212
    v_accvgpr_write_b32 a25, v213
    v_accvgpr_write_b32 a26, v214
    v_accvgpr_write_b32 a27, v215
    v_accvgpr_read_b32 v212, a40
    v_accvgpr_read_b32 v213, a41
    v_accvgpr_read_b32 v214, a42
    v_accvgpr_read_b32 v215, a43
    v_mul_f32 v212, v212, v222
    v_mul_f32 v213, v213, v222
    v_mul_f32 v214, v214, v222
    v_mul_f32 v215, v215, v222
    v_accvgpr_write_b32 a40, v212
    v_accvgpr_write_b32 a41, v213
    v_accvgpr_write_b32 a42, v214
    v_accvgpr_write_b32 a43, v215
    v_accvgpr_read_b32 v212, a56
    v_accvgpr_read_b32 v213, a57
    v_accvgpr_read_b32 v214, a58
    v_accvgpr_read_b32 v215, a59
    v_mul_f32 v212, v212, v222
    v_mul_f32 v213, v213, v222
    v_mul_f32 v214, v214, v222
    v_mul_f32 v215, v215, v222
    v_accvgpr_write_b32 a56, v212
    v_accvgpr_write_b32 a57, v213
    v_accvgpr_write_b32 a58, v214
    v_accvgpr_write_b32 a59, v215
    v_accvgpr_read_b32 v212, a72
    v_accvgpr_read_b32 v213, a73
    v_accvgpr_read_b32 v214, a74
    v_accvgpr_read_b32 v215, a75
    v_mul_f32 v212, v212, v222
    v_mul_f32 v213, v213, v222
    v_mul_f32 v214, v214, v222
    v_mul_f32 v215, v215, v222
    v_accvgpr_write_b32 a72, v212
    v_accvgpr_write_b32 a73, v213
    v_accvgpr_write_b32 a74, v214
    v_accvgpr_write_b32 a75, v215
    v_accvgpr_read_b32 v212, a88
    v_accvgpr_read_b32 v213, a89
    v_accvgpr_read_b32 v214, a90
    v_accvgpr_read_b32 v215, a91
    v_mul_f32 v212, v212, v222
    v_mul_f32 v213, v213, v222
    v_mul_f32 v214, v214, v222
    v_mul_f32 v215, v215, v222
    v_accvgpr_write_b32 a88, v212
    v_accvgpr_write_b32 a89, v213
    v_accvgpr_write_b32 a90, v214
    v_accvgpr_write_b32 a91, v215
    v_accvgpr_read_b32 v212, a104
    v_accvgpr_read_b32 v213, a105
    v_accvgpr_read_b32 v214, a106
    v_accvgpr_read_b32 v215, a107
    v_mul_f32 v212, v212, v222
    v_mul_f32 v213, v213, v222
    v_mul_f32 v214, v214, v222
    v_mul_f32 v215, v215, v222
    v_accvgpr_write_b32 a104, v212
    v_accvgpr_write_b32 a105, v213
    v_accvgpr_write_b32 a106, v214
    v_accvgpr_write_b32 a107, v215
    v_accvgpr_read_b32 v212, a120
    v_accvgpr_read_b32 v213, a121
    v_accvgpr_read_b32 v214, a122
    v_accvgpr_read_b32 v215, a123
    v_mul_f32 v212, v212, v222
    v_mul_f32 v213, v213, v222
    v_mul_f32 v214, v214, v222
    v_mul_f32 v215, v215, v222
    v_accvgpr_write_b32 a120, v212
    v_accvgpr_write_b32 a121, v213
    v_accvgpr_write_b32 a122, v214
    v_accvgpr_write_b32 a123, v215
    v_accvgpr_read_b32 v212, a136
    v_accvgpr_read_b32 v213, a137
    v_accvgpr_read_b32 v214, a138
    v_accvgpr_read_b32 v215, a139
    v_mul_f32 v212, v212, v222
    v_mul_f32 v213, v213, v222
    v_mul_f32 v214, v214, v222
    v_mul_f32 v215, v215, v222
    v_accvgpr_write_b32 a136, v212
    v_accvgpr_write_b32 a137, v213
    v_accvgpr_write_b32 a138, v214
    v_accvgpr_write_b32 a139, v215
    v_accvgpr_read_b32 v212, a12
    v_accvgpr_read_b32 v213, a13
    v_accvgpr_read_b32 v214, a14
    v_accvgpr_read_b32 v215, a15
    v_mul_f32 v212, v212, v223
    v_mul_f32 v213, v213, v223
    v_mul_f32 v214, v214, v223
    v_mul_f32 v215, v215, v223
    v_accvgpr_write_b32 a12, v212
    v_accvgpr_write_b32 a13, v213
    v_accvgpr_write_b32 a14, v214
    v_accvgpr_write_b32 a15, v215
    v_accvgpr_read_b32 v212, a28
    v_accvgpr_read_b32 v213, a29
    v_accvgpr_read_b32 v214, a30
    v_accvgpr_read_b32 v215, a31
    v_mul_f32 v212, v212, v223
    v_mul_f32 v213, v213, v223
    v_mul_f32 v214, v214, v223
    v_mul_f32 v215, v215, v223
    v_accvgpr_write_b32 a28, v212
    v_accvgpr_write_b32 a29, v213
    v_accvgpr_write_b32 a30, v214
    v_accvgpr_write_b32 a31, v215
    v_accvgpr_read_b32 v212, a44
    v_accvgpr_read_b32 v213, a45
    v_accvgpr_read_b32 v214, a46
    v_accvgpr_read_b32 v215, a47
    v_mul_f32 v212, v212, v223
    v_mul_f32 v213, v213, v223
    v_mul_f32 v214, v214, v223
    v_mul_f32 v215, v215, v223
    v_accvgpr_write_b32 a44, v212
    v_accvgpr_write_b32 a45, v213
    v_accvgpr_write_b32 a46, v214
    v_accvgpr_write_b32 a47, v215
    v_accvgpr_read_b32 v212, a60
    v_accvgpr_read_b32 v213, a61
    v_accvgpr_read_b32 v214, a62
    v_accvgpr_read_b32 v215, a63
    v_mul_f32 v212, v212, v223
    v_mul_f32 v213, v213, v223
    v_mul_f32 v214, v214, v223
    v_mul_f32 v215, v215, v223
    v_accvgpr_write_b32 a60, v212
    v_accvgpr_write_b32 a61, v213
    v_accvgpr_write_b32 a62, v214
    v_accvgpr_write_b32 a63, v215
    v_accvgpr_read_b32 v212, a76
    v_accvgpr_read_b32 v213, a77
    v_accvgpr_read_b32 v214, a78
    v_accvgpr_read_b32 v215, a79
    v_mul_f32 v212, v212, v223
    v_mul_f32 v213, v213, v223
    v_mul_f32 v214, v214, v223
    v_mul_f32 v215, v215, v223
    v_accvgpr_write_b32 a76, v212
    v_accvgpr_write_b32 a77, v213
    v_accvgpr_write_b32 a78, v214
    v_accvgpr_write_b32 a79, v215
    v_accvgpr_read_b32 v212, a92
    v_accvgpr_read_b32 v213, a93
    v_accvgpr_read_b32 v214, a94
    v_accvgpr_read_b32 v215, a95
    v_mul_f32 v212, v212, v223
    v_mul_f32 v213, v213, v223
    v_mul_f32 v214, v214, v223
    v_mul_f32 v215, v215, v223
    v_accvgpr_write_b32 a92, v212
    v_accvgpr_write_b32 a93, v213
    v_accvgpr_write_b32 a94, v214
    v_accvgpr_write_b32 a95, v215
    v_accvgpr_read_b32 v212, a108
    v_accvgpr_read_b32 v213, a109
    v_accvgpr_read_b32 v214, a110
    v_accvgpr_read_b32 v215, a111
    v_mul_f32 v212, v212, v223
    v_mul_f32 v213, v213, v223
    v_mul_f32 v214, v214, v223
    v_mul_f32 v215, v215, v223
    v_accvgpr_write_b32 a108, v212
    v_accvgpr_write_b32 a109, v213
    v_accvgpr_write_b32 a110, v214
    v_accvgpr_write_b32 a111, v215
    v_accvgpr_read_b32 v212, a124
    v_accvgpr_read_b32 v213, a125
    v_accvgpr_read_b32 v214, a126
    v_accvgpr_read_b32 v215, a127
    v_mul_f32 v212, v212, v223
    v_mul_f32 v213, v213, v223
    v_mul_f32 v214, v214, v223
    v_mul_f32 v215, v215, v223
    v_accvgpr_write_b32 a124, v212
    v_accvgpr_write_b32 a125, v213
    v_accvgpr_write_b32 a126, v214
    v_accvgpr_write_b32 a127, v215
    v_accvgpr_read_b32 v212, a140
    v_accvgpr_read_b32 v213, a141
    v_accvgpr_read_b32 v214, a142
    v_accvgpr_read_b32 v215, a143
    v_mul_f32 v212, v212, v223
    v_mul_f32 v213, v213, v223
    v_mul_f32 v214, v214, v223
    v_mul_f32 v215, v215, v223
    v_accvgpr_write_b32 a140, v212
    v_accvgpr_write_b32 a141, v213
    v_accvgpr_write_b32 a142, v214
    v_accvgpr_write_b32 a143, v215
    s_nop 1
    s_setpc_b64 s[74:75]
.section .rodata,"a"
.p2align 6
.amdhsa_kernel gated_mix__compressed_kv_cla__geglu_ffn__prompt_kernel
  .amdhsa_next_free_vgpr 512
  .amdhsa_next_free_sgpr 102
  .amdhsa_accum_offset 256
  .amdhsa_group_segment_fixed_size 0
  .amdhsa_kernarg_size 112
  .amdhsa_user_sgpr_count 2
  .amdhsa_user_sgpr_kernarg_segment_ptr 1
  .amdhsa_system_sgpr_workgroup_id_x 1
  .amdhsa_float_denorm_mode_32 3
  .amdhsa_float_denorm_mode_16_64 3
.end_amdhsa_kernel
```
